```python
import torch

def _softmax(x, axis=-1):
    return torch.softmax(x, dim=axis)

def _gelu(x):
    return torch.nn.functional.gelu(x, approximate='tanh')

def _silu(x):
    return torch.nn.functional.silu(x)

def _sigmoid(x):
    return torch.sigmoid(x)

def _layernorm(x, axis=-1, eps=1e-05):
    m = x.mean(dim=axis, keepdim=True)
    v = x.var(dim=axis, keepdim=True, unbiased=False)
    return (x - m) / torch.sqrt(v + eps)

def _scatter_add(tgt, idx, src, axis=0):
    return tgt.clone().index_add_(axis, idx, src)

def _segment_sum(src, seg, n):
    out = torch.zeros((n,) + src.shape[1:], dtype=src.dtype)
    return out.index_add_(0, seg, src)

def _pad(x, pw):
    flat = tuple((v for pair in reversed(pw) for v in pair))
    return torch.nn.functional.pad(x, flat)
kernel_name = 'gated_mix__memory_aug_recurrent_mem_tr__dense_activation_silu__prompt'

def setup_inputs():

    _w = lambda a: (lambda t: t.to(torch.bfloat16) if t.is_floating_point() else t)(torch.as_tensor(a))

    def _A_setup():
        B, S, Dm = (1, 2048, 512)
        H, Dh = (32, 128)
        M, seg = (8, 32)
        seg = min(seg, S)
        S = S // seg * seg
        return {'x': _w((lambda *s: torch.randn(*s, dtype=torch.bfloat16) * 0.05)(B, S, Dm)), 'mem0': _w((lambda *s: torch.randn(*s, dtype=torch.bfloat16) * 0.4)(B, M, Dm)), 'Wq': _w((lambda *s: torch.randn(*s, dtype=torch.bfloat16) * 6.4)(Dm, H, Dh) * Dm ** (-0.5)), 'Wk': _w((lambda *s: torch.randn(*s, dtype=torch.bfloat16) * 6.4)(Dm, H, Dh) * Dm ** (-0.5)), 'Wv': _w((lambda *s: torch.randn(*s, dtype=torch.bfloat16) * 0.4)(Dm, H, Dh) * Dm ** (-0.5)), 'Wo': _w((lambda *s: torch.randn(*s, dtype=torch.bfloat16) * 0.4)(H, Dh, Dm) * (H * Dh) ** (-0.5)), 'seg_len': seg}
    _A_in = _A_setup()

    def _B_setup():
        B, S, D, F = (1, 2048, 512, 1792)
        return {'x': _w((lambda *s: torch.randn(*s, dtype=torch.bfloat16) * 0.05)(B, S, D)), 'w1': _w((lambda *s: torch.randn(*s, dtype=torch.bfloat16) * 3.2)(D, F) * D ** (-0.5)), 'w2': _w((lambda *s: torch.randn(*s, dtype=torch.bfloat16) * 0.2)(F, D) * F ** (-0.5))}
    _B_in = _B_setup()
    return {'A_x': _A_in['x'], 'A_mem0': _A_in['mem0'], 'A_Wq': _A_in['Wq'], 'A_Wk': _A_in['Wk'], 'A_Wv': _A_in['Wv'], 'A_Wo': _A_in['Wo'], 'A_seg_len': _A_in['seg_len'], 'B_x': _B_in['x'], 'B_w1': _B_in['w1'], 'B_w2': _B_in['w2'], 'gate_w': _w((lambda *s: torch.randn(*s, dtype=torch.bfloat16) * 0.05)(512) * 16.0)}

def reference(A_x, A_mem0, A_Wq, A_Wk, A_Wv, A_Wo, A_seg_len, B_x, B_w1, B_w2, gate_w):

    def _A_ref(x, mem0, Wq, Wk, Wv, Wo, seg_len):
        B, S, Dm = x.shape
        H, Dh = (Wq.shape[1], Wq.shape[2])
        M = mem0.shape[1]
        scale = Dh ** (-0.5)
        n_seg = S // seg_len
        L = M + seg_len
        idx = torch.arange(L)
        mask = (idx[:, None] < M) | (idx[:, None] >= idx[None, :])
        mem = mem0
        outs = []
        for s in range(n_seg):
            xs = x[:, s * seg_len:(s + 1) * seg_len, :].clone()
            h = torch.concatenate([mem, xs], axis=1)
            q = torch.einsum('btd,dhe->bhte', h, Wq)
            k = torch.einsum('btd,dhe->bhte', h, Wk)
            v = torch.einsum('btd,dhe->bhte', h, Wv)
            scores = torch.einsum('bhqe,bhke->bhqk', q, k) * scale
            scores = torch.where(mask[None, None], scores, -1000000000.0)
            p = _softmax(scores, axis=-1)
            o = torch.einsum('bhqk,bhke->bhqe', p, v)
            o = torch.einsum('bhte,hed->btd', o, Wo)
            mem = o[:, :M, :].clone()
            outs.append(o[:, M:, :])
        return torch.concatenate(outs, axis=1)

    def _B_ref(x, w1, w2):
        h = torch.einsum('bsd,df->bsf', x, w1)
        h = _silu(h)
        out = torch.einsum('bsf,fd->bsd', h, w2)
        return out
    x = A_x
    g = _sigmoid((x * gate_w).sum(-1, keepdims=True))
    a = _A_ref(x, A_mem0, A_Wq, A_Wk, A_Wv, A_Wo, A_seg_len)
    b = _B_ref(x, B_w1, B_w2)
    return g * a + (1 - g) * b
```

```asm
; @launch grid=(256,1,1) block=(256,1,1) lds=163840
.amdgcn_target "amdgcn-amd-amdhsa--gfx950"
.text
.globl gated_mix__memory_aug_recurrent_mem_tr__dense_activation_silu__prompt_kernel
.p2align 8
.type gated_mix__memory_aug_recurrent_mem_tr__dense_activation_silu__prompt_kernel,@function
gated_mix__memory_aug_recurrent_mem_tr__dense_activation_silu__prompt_kernel:
  s_cmp_ge_u32 s2, 256
  s_cbranch_scc1 K1_END
  s_load_dwordx16 s[64:79], s[0:1], 0
  s_load_dwordx8 s[80:87], s[0:1], 64
  s_load_dwordx4 s[88:91], s[0:1], 96
  v_lshrrev_b32 v1, 6, v0
  v_and_b32 v0, 63, v0
  v_readfirstlane_b32 s32, v1
  s_and_b32 s34, s2, 7
  s_lshr_b32 s35, s2, 3
  s_waitcnt lgkmcnt(0)
  s_mov_b32 s4, s90
  s_and_b32 s5, s91, 0xffff
  s_mov_b32 s6, 0x10000000
  s_mov_b32 s7, 0x20000
  s_cmp_lt_u32 s34, 0
  s_cbranch_scc1 K1_N0
  s_cmp_gt_u32 s34, 0
  s_cbranch_scc1 K1_N0
  s_mov_b32 s33, s35
  s_mov_b32 s8, s68
  s_and_b32 s9, s69, 0xffff
  s_mov_b32 s10, 0x400000
  s_mov_b32 s11, 0x20000
  s_mov_b32 s12, s70
  s_and_b32 s13, s71, 0xffff
  s_mov_b32 s14, 0x400000
  s_mov_b32 s15, 0x20000
  s_mov_b32 s16, s72
  s_and_b32 s17, s73, 0xffff
  s_mov_b32 s18, 0x400000
  s_mov_b32 s19, 0x20000
  s_mov_b32 s20, s74
  s_and_b32 s21, s75, 0xffff
  s_mov_b32 s22, 0x400000
  s_mov_b32 s23, 0x20000
  s_mov_b32 s28, s88
  s_and_b32 s29, s89, 0xffff
  s_mov_b32 s30, 0x100
  s_mov_b32 s31, 0x20000
  s_mov_b32 s24, s66
  s_and_b32 s25, s67, 0xffff
  s_mov_b32 s26, 0x2000
  s_mov_b32 s27, 0x20000
  v_lshlrev_b32 v9, 4, v0
  v_lshlrev_b32 v10, 3, v0
  s_lshl_b32 s36, s33, 2
  s_add_u32 s36, s36, s32
  s_lshl_b32 s36, s36, 12
  s_add_u32 s54, s36, 83886080
  s_add_u32 s37, s36, 84934656
  v_mov_b32 v24, -1
  v_mov_b32 v28, 0
  v_mov_b32 v25, -1
  v_mov_b32 v29, 0
  v_mov_b32 v26, -1
  v_mov_b32 v30, 0
  v_mov_b32 v27, -1
  v_mov_b32 v31, 0
  buffer_store_dwordx4 v[28:31], v9, s[4:7], s54 offen offset:0 sc1
  buffer_store_dwordx4 v[24:27], v9, s[4:7], s37 offen offset:0 sc1
  buffer_store_dwordx4 v[28:31], v9, s[4:7], s54 offen offset:1024 sc1
  buffer_store_dwordx4 v[24:27], v9, s[4:7], s37 offen offset:1024 sc1
  buffer_store_dwordx4 v[28:31], v9, s[4:7], s54 offen offset:2048 sc1
  buffer_store_dwordx4 v[24:27], v9, s[4:7], s37 offen offset:2048 sc1
  buffer_store_dwordx4 v[28:31], v9, s[4:7], s54 offen offset:3072 sc1
  buffer_store_dwordx4 v[24:27], v9, s[4:7], s37 offen offset:3072 sc1
  v_mov_b64 v[20:21], 0
  s_lshr_b32 s36, s36, 3
  s_add_u32 s36, s36, 87031808
  buffer_store_dwordx2 v[20:21], v10, s[4:7], s36 offen sc1
  s_mul_i32 s36, s33, 0x2100
  s_add_u32 s36, s36, 88080640
  v_lshlrev_b32 v22, 7, v0
  buffer_store_dword v20, v22, s[4:7], s36 offen sc1
  s_getreg_b32 s38, hwreg(HW_REG_XCC_ID)
  s_and_b32 s38, s38, 15
  s_add_u32 s38, s38, 1
  v_mov_b32 v84, s38
  s_lshl_b32 s97, s33, 2
  v_mov_b32 v85, 0
  v_and_b32 v86, 7, v0
  v_lshrrev_b32 v87, 3, v0
  v_lshlrev_b32 v86, 10, v86
  v_lshl_add_u32 v86, v87, 4, v86
  v_and_b32 v87, 31, v0
  v_lshlrev_b32 v87, 2, v87
  s_lshl_b32 s48, s33, 14
  s_lshl_b32 s36, s32, 12
  s_add_u32 s48, s48, s36
  s_mov_b32 s57, 0x400000
  s_lshl_b32 s49, s33, 8
  v_lshrrev_b32 v109, 4, v0
  v_bfe_u32 v107, v0, 1, 3
  v_and_b32 v108, 1, v109
  v_lshlrev_b32 v108, 1, v108
  v_xor_b32 v108, v107, v108
  v_lshlrev_b32 v108, 5, v108
  v_and_b32 v100, 1, v0
  v_lshl_add_u32 v108, v100, 4, v108
  s_lshr_b32 s36, s32, 1
  s_lshl_b32 s36, s36, 7
  v_xor_b32 v102, s36, v108
  v_lshl_add_u32 v102, v109, 10, v102
  s_mov_b32 s36, 8192
  v_mad_u32_u24 v100, v109, s36, v108
  v_xor_b32 v101, 0x80, v100
  v_bfe_u32 v110, v0, 2, 2
  v_and_b32 v111, 3, v0
  s_lshl_b32 s36, s32, 1
  v_and_b32 v112, 1, v110
  v_lshlrev_b32 v112, 1, v112
  v_and_b32 v107, 1, v109
  v_lshl_or_b32 v112, v107, 2, v112
  v_lshrrev_b32 v108, 1, v110
  v_xor_b32 v112, v112, v108
  v_xor_b32 v103, s36, v112
  v_lshlrev_b32 v103, 5, v103
  v_lshl_add_u32 v103, v111, 3, v103
  v_lshlrev_b32 v107, 2, v107
  v_lshl_add_u32 v107, v108, 3, v107
  v_lshrrev_b32 v108, 1, v109
  v_lshl_add_u32 v107, v108, 4, v107
  v_and_b32 v108, 1, v110
  v_add_u32 v107, v107, v108
  v_lshl_add_u32 v103, v107, 8, v103
  v_xor_b32 v105, 0x800, v103
  v_add_u32 v104, 0x10000, v103
  v_add_u32 v106, 0x10000, v105
  s_mul_i32 s36, s32, 131072
  s_add_u32 s40, s49, s36
  s_add_u32 s41, s49, s36
  s_add_u32 s42, s49, s36
  s_lshl_b32 s36, s32, 14
  s_lshl_b32 s37, s33, 17
  s_add_u32 s43, s36, s37
  s_lshl_b32 s44, s32, 12
  s_add_u32 s36, s44, 0
  s_mov_b32 m0, s36
  s_add_u32 s37, s40, 0
  buffer_load_dwordx4 v100, s[8:11], s37 offen lds
  s_add_u32 s36, s44, 1024
  s_mov_b32 m0, s36
  s_add_u32 s37, s40, 32768
  buffer_load_dwordx4 v101, s[8:11], s37 offen lds
  s_add_u32 s36, s44, 2048
  s_mov_b32 m0, s36
  s_add_u32 s37, s40, 65536
  buffer_load_dwordx4 v100, s[8:11], s37 offen lds
  s_add_u32 s36, s44, 3072
  s_mov_b32 m0, s36
  s_add_u32 s37, s40, 98304
  buffer_load_dwordx4 v101, s[8:11], s37 offen lds
  s_add_u32 s36, s44, 16384
  s_mov_b32 m0, s36
  s_add_u32 s37, s40, 524288
  buffer_load_dwordx4 v100, s[8:11], s37 offen lds
  s_add_u32 s36, s44, 17408
  s_mov_b32 m0, s36
  s_add_u32 s37, s40, 557056
  buffer_load_dwordx4 v101, s[8:11], s37 offen lds
  s_add_u32 s36, s44, 18432
  s_mov_b32 m0, s36
  s_add_u32 s37, s40, 589824
  buffer_load_dwordx4 v100, s[8:11], s37 offen lds
  s_add_u32 s36, s44, 19456
  s_mov_b32 m0, s36
  s_add_u32 s37, s40, 622592
  buffer_load_dwordx4 v101, s[8:11], s37 offen lds
  s_add_u32 s36, s44, 32768
  s_mov_b32 m0, s36
  s_add_u32 s37, s40, 1048576
  buffer_load_dwordx4 v100, s[8:11], s37 offen lds
  s_add_u32 s36, s44, 33792
  s_mov_b32 m0, s36
  s_add_u32 s37, s40, 1081344
  buffer_load_dwordx4 v101, s[8:11], s37 offen lds
  s_add_u32 s36, s44, 34816
  s_mov_b32 m0, s36
  s_add_u32 s37, s40, 1114112
  buffer_load_dwordx4 v100, s[8:11], s37 offen lds
  s_add_u32 s36, s44, 35840
  s_mov_b32 m0, s36
  s_add_u32 s37, s40, 1146880
  buffer_load_dwordx4 v101, s[8:11], s37 offen lds
  s_add_u32 s36, s44, 49152
  s_mov_b32 m0, s36
  s_add_u32 s37, s40, 1572864
  buffer_load_dwordx4 v100, s[8:11], s37 offen lds
  s_add_u32 s36, s44, 50176
  s_mov_b32 m0, s36
  s_add_u32 s37, s40, 1605632
  buffer_load_dwordx4 v101, s[8:11], s37 offen lds
  s_add_u32 s36, s44, 51200
  s_mov_b32 m0, s36
  s_add_u32 s37, s40, 1638400
  buffer_load_dwordx4 v100, s[8:11], s37 offen lds
  s_add_u32 s36, s44, 52224
  s_mov_b32 m0, s36
  s_add_u32 s37, s40, 1671168
  buffer_load_dwordx4 v101, s[8:11], s37 offen lds
  s_add_u32 s36, s44, 65536
  s_mov_b32 m0, s36
  s_add_u32 s37, s40, 2097152
  buffer_load_dwordx4 v100, s[8:11], s37 offen lds
  s_add_u32 s36, s44, 66560
  s_mov_b32 m0, s36
  s_add_u32 s37, s40, 2129920
  buffer_load_dwordx4 v101, s[8:11], s37 offen lds
  s_add_u32 s36, s44, 67584
  s_mov_b32 m0, s36
  s_add_u32 s37, s40, 2162688
  buffer_load_dwordx4 v100, s[8:11], s37 offen lds
  s_add_u32 s36, s44, 68608
  s_mov_b32 m0, s36
  s_add_u32 s37, s40, 2195456
  buffer_load_dwordx4 v101, s[8:11], s37 offen lds
  s_add_u32 s36, s44, 81920
  s_mov_b32 m0, s36
  s_add_u32 s37, s40, 2621440
  buffer_load_dwordx4 v100, s[8:11], s37 offen lds
  s_add_u32 s36, s44, 82944
  s_mov_b32 m0, s36
  s_add_u32 s37, s40, 2654208
  buffer_load_dwordx4 v101, s[8:11], s37 offen lds
  s_add_u32 s36, s44, 83968
  s_mov_b32 m0, s36
  s_add_u32 s37, s40, 2686976
  buffer_load_dwordx4 v100, s[8:11], s37 offen lds
  s_add_u32 s36, s44, 84992
  s_mov_b32 m0, s36
  s_add_u32 s37, s40, 2719744
  buffer_load_dwordx4 v101, s[8:11], s37 offen lds
  s_add_u32 s36, s44, 98304
  s_mov_b32 m0, s36
  s_add_u32 s37, s40, 3145728
  buffer_load_dwordx4 v100, s[8:11], s37 offen lds
  s_add_u32 s36, s44, 99328
  s_mov_b32 m0, s36
  s_add_u32 s37, s40, 3178496
  buffer_load_dwordx4 v101, s[8:11], s37 offen lds
  s_add_u32 s36, s44, 100352
  s_mov_b32 m0, s36
  s_add_u32 s37, s40, 3211264
  buffer_load_dwordx4 v100, s[8:11], s37 offen lds
  s_add_u32 s36, s44, 101376
  s_mov_b32 m0, s36
  s_add_u32 s37, s40, 3244032
  buffer_load_dwordx4 v101, s[8:11], s37 offen lds
  s_waitcnt vmcnt(24)
  s_barrier
  s_add_u32 s36, s44, 114688
  s_mov_b32 m0, s36
  s_add_u32 s37, s40, 3670016
  buffer_load_dwordx4 v100, s[8:11], s37 offen lds
  s_add_u32 s36, s44, 115712
  s_mov_b32 m0, s36
  s_add_u32 s37, s40, 3702784
  buffer_load_dwordx4 v101, s[8:11], s37 offen lds
  s_add_u32 s36, s44, 116736
  s_mov_b32 m0, s36
  s_add_u32 s37, s40, 3735552
  buffer_load_dwordx4 v100, s[8:11], s37 offen lds
  s_add_u32 s36, s44, 117760
  s_mov_b32 m0, s36
  s_add_u32 s37, s40, 3768320
  buffer_load_dwordx4 v101, s[8:11], s37 offen lds
  s_cmp_lg_u32 s32, 0
  s_cbranch_scc1 K1_R0_NOANN
  s_mov_b64 exec, 1
  buffer_store_dword v84, v85, s[28:31], s97 offen sc1
  s_mov_b64 exec, -1
K1_R0_NOANN:
  s_add_u32 s97, s97, 87032064
  ds_read_b64_tr_b16 v[128:129], v103 offset:0
  ds_read_b64_tr_b16 v[130:131], v103 offset:512
  ds_read_b64_tr_b16 v[132:133], v103 offset:8192
  ds_read_b64_tr_b16 v[134:135], v103 offset:8704
  ds_read_b64_tr_b16 v[192:193], v105 offset:0
  ds_read_b64_tr_b16 v[194:195], v105 offset:512
  ds_read_b64_tr_b16 v[196:197], v105 offset:8192
  ds_read_b64_tr_b16 v[198:199], v105 offset:8704
  s_waitcnt lgkmcnt(0)
  s_waitcnt vmcnt(24)
  s_barrier
  s_add_u32 s36, s44, 0
  s_mov_b32 m0, s36
  s_add_u32 s37, s41, 0
  buffer_load_dwordx4 v100, s[12:15], s37 offen lds
  s_add_u32 s36, s44, 1024
  s_mov_b32 m0, s36
  s_add_u32 s37, s41, 32768
  buffer_load_dwordx4 v101, s[12:15], s37 offen lds
  s_add_u32 s36, s44, 2048
  s_mov_b32 m0, s36
  s_add_u32 s37, s41, 65536
  buffer_load_dwordx4 v100, s[12:15], s37 offen lds
  s_add_u32 s36, s44, 3072
  s_mov_b32 m0, s36
  s_add_u32 s37, s41, 98304
  buffer_load_dwordx4 v101, s[12:15], s37 offen lds
  ds_read_b64_tr_b16 v[136:137], v103 offset:16384
  ds_read_b64_tr_b16 v[138:139], v103 offset:16896
  ds_read_b64_tr_b16 v[140:141], v103 offset:24576
  ds_read_b64_tr_b16 v[142:143], v103 offset:25088
  ds_read_b64_tr_b16 v[200:201], v105 offset:16384
  ds_read_b64_tr_b16 v[202:203], v105 offset:16896
  ds_read_b64_tr_b16 v[204:205], v105 offset:24576
  ds_read_b64_tr_b16 v[206:207], v105 offset:25088
  s_waitcnt lgkmcnt(0)
  s_waitcnt vmcnt(24)
  s_barrier
  s_add_u32 s36, s44, 16384
  s_mov_b32 m0, s36
  s_add_u32 s37, s41, 524288
  buffer_load_dwordx4 v100, s[12:15], s37 offen lds
  s_add_u32 s36, s44, 17408
  s_mov_b32 m0, s36
  s_add_u32 s37, s41, 557056
  buffer_load_dwordx4 v101, s[12:15], s37 offen lds
  s_add_u32 s36, s44, 18432
  s_mov_b32 m0, s36
  s_add_u32 s37, s41, 589824
  buffer_load_dwordx4 v100, s[12:15], s37 offen lds
  s_add_u32 s36, s44, 19456
  s_mov_b32 m0, s36
  s_add_u32 s37, s41, 622592
  buffer_load_dwordx4 v101, s[12:15], s37 offen lds
  ds_read_b64_tr_b16 v[144:145], v103 offset:32768
  ds_read_b64_tr_b16 v[146:147], v103 offset:33280
  ds_read_b64_tr_b16 v[148:149], v103 offset:40960
  ds_read_b64_tr_b16 v[150:151], v103 offset:41472
  ds_read_b64_tr_b16 v[208:209], v105 offset:32768
  ds_read_b64_tr_b16 v[210:211], v105 offset:33280
  ds_read_b64_tr_b16 v[212:213], v105 offset:40960
  ds_read_b64_tr_b16 v[214:215], v105 offset:41472
  s_waitcnt lgkmcnt(0)
  s_waitcnt vmcnt(24)
  s_barrier
  s_add_u32 s36, s44, 32768
  s_mov_b32 m0, s36
  s_add_u32 s37, s41, 1048576
  buffer_load_dwordx4 v100, s[12:15], s37 offen lds
  s_add_u32 s36, s44, 33792
  s_mov_b32 m0, s36
  s_add_u32 s37, s41, 1081344
  buffer_load_dwordx4 v101, s[12:15], s37 offen lds
  s_add_u32 s36, s44, 34816
  s_mov_b32 m0, s36
  s_add_u32 s37, s41, 1114112
  buffer_load_dwordx4 v100, s[12:15], s37 offen lds
  s_add_u32 s36, s44, 35840
  s_mov_b32 m0, s36
  s_add_u32 s37, s41, 1146880
  buffer_load_dwordx4 v101, s[12:15], s37 offen lds
  ds_read_b64_tr_b16 v[152:153], v103 offset:49152
  ds_read_b64_tr_b16 v[154:155], v103 offset:49664
  ds_read_b64_tr_b16 v[156:157], v103 offset:57344
  ds_read_b64_tr_b16 v[158:159], v103 offset:57856
  ds_read_b64_tr_b16 v[216:217], v105 offset:49152
  ds_read_b64_tr_b16 v[218:219], v105 offset:49664
  ds_read_b64_tr_b16 v[220:221], v105 offset:57344
  ds_read_b64_tr_b16 v[222:223], v105 offset:57856
  s_waitcnt lgkmcnt(0)
  s_waitcnt vmcnt(24)
  s_barrier
  s_add_u32 s36, s44, 49152
  s_mov_b32 m0, s36
  s_add_u32 s37, s41, 1572864
  buffer_load_dwordx4 v100, s[12:15], s37 offen lds
  s_add_u32 s36, s44, 50176
  s_mov_b32 m0, s36
  s_add_u32 s37, s41, 1605632
  buffer_load_dwordx4 v101, s[12:15], s37 offen lds
  s_add_u32 s36, s44, 51200
  s_mov_b32 m0, s36
  s_add_u32 s37, s41, 1638400
  buffer_load_dwordx4 v100, s[12:15], s37 offen lds
  s_add_u32 s36, s44, 52224
  s_mov_b32 m0, s36
  s_add_u32 s37, s41, 1671168
  buffer_load_dwordx4 v101, s[12:15], s37 offen lds
  buffer_load_dword v98, v87, s[28:31], 0 offen sc1
  s_lshl_b32 s36, s32, 8
  buffer_load_dwordx4 v[88:91], v86, s[24:27], s36 offen
  buffer_load_dwordx4 v[92:95], v86, s[24:27], s36 offen offset:128
  ds_read_b64_tr_b16 v[160:161], v104 offset:0
  ds_read_b64_tr_b16 v[162:163], v104 offset:512
  ds_read_b64_tr_b16 v[164:165], v104 offset:8192
  ds_read_b64_tr_b16 v[166:167], v104 offset:8704
  ds_read_b64_tr_b16 v[224:225], v106 offset:0
  ds_read_b64_tr_b16 v[226:227], v106 offset:512
  ds_read_b64_tr_b16 v[228:229], v106 offset:8192
  ds_read_b64_tr_b16 v[230:231], v106 offset:8704
  s_waitcnt lgkmcnt(0)
  s_waitcnt vmcnt(24)
  s_barrier
  s_add_u32 s36, s44, 65536
  s_mov_b32 m0, s36
  s_add_u32 s37, s41, 2097152
  buffer_load_dwordx4 v100, s[12:15], s37 offen lds
  s_add_u32 s36, s44, 66560
  s_mov_b32 m0, s36
  s_add_u32 s37, s41, 2129920
  buffer_load_dwordx4 v101, s[12:15], s37 offen lds
  s_add_u32 s36, s44, 67584
  s_mov_b32 m0, s36
  s_add_u32 s37, s41, 2162688
  buffer_load_dwordx4 v100, s[12:15], s37 offen lds
  s_add_u32 s36, s44, 68608
  s_mov_b32 m0, s36
  s_add_u32 s37, s41, 2195456
  buffer_load_dwordx4 v101, s[12:15], s37 offen lds
  ds_read_b64_tr_b16 v[168:169], v104 offset:16384
  ds_read_b64_tr_b16 v[170:171], v104 offset:16896
  ds_read_b64_tr_b16 v[172:173], v104 offset:24576
  ds_read_b64_tr_b16 v[174:175], v104 offset:25088
  ds_read_b64_tr_b16 v[232:233], v106 offset:16384
  ds_read_b64_tr_b16 v[234:235], v106 offset:16896
  ds_read_b64_tr_b16 v[236:237], v106 offset:24576
  ds_read_b64_tr_b16 v[238:239], v106 offset:25088
  s_waitcnt lgkmcnt(0)
  s_waitcnt vmcnt(24)
  s_barrier
  s_add_u32 s36, s44, 81920
  s_mov_b32 m0, s36
  s_add_u32 s37, s41, 2621440
  buffer_load_dwordx4 v100, s[12:15], s37 offen lds
  s_add_u32 s36, s44, 82944
  s_mov_b32 m0, s36
  s_add_u32 s37, s41, 2654208
  buffer_load_dwordx4 v101, s[12:15], s37 offen lds
  s_add_u32 s36, s44, 83968
  s_mov_b32 m0, s36
  s_add_u32 s37, s41, 2686976
  buffer_load_dwordx4 v100, s[12:15], s37 offen lds
  s_add_u32 s36, s44, 84992
  s_mov_b32 m0, s36
  s_add_u32 s37, s41, 2719744
  buffer_load_dwordx4 v101, s[12:15], s37 offen lds
  ds_read_b64_tr_b16 v[176:177], v104 offset:32768
  ds_read_b64_tr_b16 v[178:179], v104 offset:33280
  ds_read_b64_tr_b16 v[180:181], v104 offset:40960
  ds_read_b64_tr_b16 v[182:183], v104 offset:41472
  ds_read_b64_tr_b16 v[240:241], v106 offset:32768
  ds_read_b64_tr_b16 v[242:243], v106 offset:33280
  ds_read_b64_tr_b16 v[244:245], v106 offset:40960
  ds_read_b64_tr_b16 v[246:247], v106 offset:41472
  s_waitcnt lgkmcnt(0)
  s_waitcnt vmcnt(24)
  s_barrier
  s_add_u32 s36, s44, 98304
  s_mov_b32 m0, s36
  s_add_u32 s37, s41, 3145728
  buffer_load_dwordx4 v100, s[12:15], s37 offen lds
  s_add_u32 s36, s44, 99328
  s_mov_b32 m0, s36
  s_add_u32 s37, s41, 3178496
  buffer_load_dwordx4 v101, s[12:15], s37 offen lds
  s_add_u32 s36, s44, 100352
  s_mov_b32 m0, s36
  s_add_u32 s37, s41, 3211264
  buffer_load_dwordx4 v100, s[12:15], s37 offen lds
  s_add_u32 s36, s44, 101376
  s_mov_b32 m0, s36
  s_add_u32 s37, s41, 3244032
  buffer_load_dwordx4 v101, s[12:15], s37 offen lds
  ds_read_b64_tr_b16 v[184:185], v104 offset:49152
  ds_read_b64_tr_b16 v[186:187], v104 offset:49664
  ds_read_b64_tr_b16 v[188:189], v104 offset:57344
  ds_read_b64_tr_b16 v[190:191], v104 offset:57856
  ds_read_b64_tr_b16 v[248:249], v106 offset:49152
  ds_read_b64_tr_b16 v[250:251], v106 offset:49664
  ds_read_b64_tr_b16 v[252:253], v106 offset:57344
  ds_read_b64_tr_b16 v[254:255], v106 offset:57856
  s_waitcnt lgkmcnt(0)
  s_waitcnt vmcnt(24)
  s_barrier
  s_add_u32 s36, s44, 114688
  s_mov_b32 m0, s36
  s_add_u32 s37, s41, 3670016
  buffer_load_dwordx4 v100, s[12:15], s37 offen lds
  s_add_u32 s36, s44, 115712
  s_mov_b32 m0, s36
  s_add_u32 s37, s41, 3702784
  buffer_load_dwordx4 v101, s[12:15], s37 offen lds
  s_add_u32 s36, s44, 116736
  s_mov_b32 m0, s36
  s_add_u32 s37, s41, 3735552
  buffer_load_dwordx4 v100, s[12:15], s37 offen lds
  s_add_u32 s36, s44, 117760
  s_mov_b32 m0, s36
  s_add_u32 s37, s41, 3768320
  buffer_load_dwordx4 v101, s[12:15], s37 offen lds
  ds_read_b64_tr_b16 a[0:1], v103 offset:0
  ds_read_b64_tr_b16 a[2:3], v103 offset:512
  ds_read_b64_tr_b16 a[4:5], v103 offset:8192
  ds_read_b64_tr_b16 a[6:7], v103 offset:8704
  ds_read_b64_tr_b16 a[64:65], v105 offset:0
  ds_read_b64_tr_b16 a[66:67], v105 offset:512
  ds_read_b64_tr_b16 a[68:69], v105 offset:8192
  ds_read_b64_tr_b16 a[70:71], v105 offset:8704
  s_waitcnt lgkmcnt(0)
  s_waitcnt vmcnt(24)
  s_barrier
  s_add_u32 s36, s44, 0
  s_mov_b32 m0, s36
  s_add_u32 s37, s42, 0
  buffer_load_dwordx4 v100, s[16:19], s37 offen lds
  s_add_u32 s36, s44, 1024
  s_mov_b32 m0, s36
  s_add_u32 s37, s42, 32768
  buffer_load_dwordx4 v101, s[16:19], s37 offen lds
  s_add_u32 s36, s44, 2048
  s_mov_b32 m0, s36
  s_add_u32 s37, s42, 65536
  buffer_load_dwordx4 v100, s[16:19], s37 offen lds
  s_add_u32 s36, s44, 3072
  s_mov_b32 m0, s36
  s_add_u32 s37, s42, 98304
  buffer_load_dwordx4 v101, s[16:19], s37 offen lds
  ds_read_b64_tr_b16 a[8:9], v103 offset:16384
  ds_read_b64_tr_b16 a[10:11], v103 offset:16896
  ds_read_b64_tr_b16 a[12:13], v103 offset:24576
  ds_read_b64_tr_b16 a[14:15], v103 offset:25088
  ds_read_b64_tr_b16 a[72:73], v105 offset:16384
  ds_read_b64_tr_b16 a[74:75], v105 offset:16896
  ds_read_b64_tr_b16 a[76:77], v105 offset:24576
  ds_read_b64_tr_b16 a[78:79], v105 offset:25088
  s_waitcnt lgkmcnt(0)
  s_waitcnt vmcnt(24)
  s_barrier
  s_add_u32 s36, s44, 16384
  s_mov_b32 m0, s36
  s_add_u32 s37, s42, 524288
  buffer_load_dwordx4 v100, s[16:19], s37 offen lds
  s_add_u32 s36, s44, 17408
  s_mov_b32 m0, s36
  s_add_u32 s37, s42, 557056
  buffer_load_dwordx4 v101, s[16:19], s37 offen lds
  s_add_u32 s36, s44, 18432
  s_mov_b32 m0, s36
  s_add_u32 s37, s42, 589824
  buffer_load_dwordx4 v100, s[16:19], s37 offen lds
  s_add_u32 s36, s44, 19456
  s_mov_b32 m0, s36
  s_add_u32 s37, s42, 622592
  buffer_load_dwordx4 v101, s[16:19], s37 offen lds
  ds_read_b64_tr_b16 a[16:17], v103 offset:32768
  ds_read_b64_tr_b16 a[18:19], v103 offset:33280
  ds_read_b64_tr_b16 a[20:21], v103 offset:40960
  ds_read_b64_tr_b16 a[22:23], v103 offset:41472
  ds_read_b64_tr_b16 a[80:81], v105 offset:32768
  ds_read_b64_tr_b16 a[82:83], v105 offset:33280
  ds_read_b64_tr_b16 a[84:85], v105 offset:40960
  ds_read_b64_tr_b16 a[86:87], v105 offset:41472
  s_waitcnt lgkmcnt(0)
  s_waitcnt vmcnt(24)
  s_barrier
  s_add_u32 s36, s44, 32768
  s_mov_b32 m0, s36
  s_add_u32 s37, s42, 1048576
  buffer_load_dwordx4 v100, s[16:19], s37 offen lds
  s_add_u32 s36, s44, 33792
  s_mov_b32 m0, s36
  s_add_u32 s37, s42, 1081344
  buffer_load_dwordx4 v101, s[16:19], s37 offen lds
  s_add_u32 s36, s44, 34816
  s_mov_b32 m0, s36
  s_add_u32 s37, s42, 1114112
  buffer_load_dwordx4 v100, s[16:19], s37 offen lds
  s_add_u32 s36, s44, 35840
  s_mov_b32 m0, s36
  s_add_u32 s37, s42, 1146880
  buffer_load_dwordx4 v101, s[16:19], s37 offen lds
  ds_read_b64_tr_b16 a[24:25], v103 offset:49152
  ds_read_b64_tr_b16 a[26:27], v103 offset:49664
  ds_read_b64_tr_b16 a[28:29], v103 offset:57344
  ds_read_b64_tr_b16 a[30:31], v103 offset:57856
  ds_read_b64_tr_b16 a[88:89], v105 offset:49152
  ds_read_b64_tr_b16 a[90:91], v105 offset:49664
  ds_read_b64_tr_b16 a[92:93], v105 offset:57344
  ds_read_b64_tr_b16 a[94:95], v105 offset:57856
  s_waitcnt lgkmcnt(0)
  s_waitcnt vmcnt(24)
  s_barrier
  s_add_u32 s36, s44, 49152
  s_mov_b32 m0, s36
  s_add_u32 s37, s42, 1572864
  buffer_load_dwordx4 v100, s[16:19], s37 offen lds
  s_add_u32 s36, s44, 50176
  s_mov_b32 m0, s36
  s_add_u32 s37, s42, 1605632
  buffer_load_dwordx4 v101, s[16:19], s37 offen lds
  s_add_u32 s36, s44, 51200
  s_mov_b32 m0, s36
  s_add_u32 s37, s42, 1638400
  buffer_load_dwordx4 v100, s[16:19], s37 offen lds
  s_add_u32 s36, s44, 52224
  s_mov_b32 m0, s36
  s_add_u32 s37, s42, 1671168
  buffer_load_dwordx4 v101, s[16:19], s37 offen lds
  v_cmp_eq_u32 vcc, 0, v98
  s_nop 3
  s_cbranch_vccz K1_R0_HSOK
K1_R0_HS:
  buffer_load_dword v98, v87, s[28:31], 0 offen sc1
  s_sub_u32 s57, s57, 1
  s_cbranch_scc1 K1_END
  s_waitcnt vmcnt(0)
  v_cmp_eq_u32 vcc, 0, v98
  s_nop 3
  s_cbranch_vccnz K1_R0_HS
K1_R0_HSOK:
  ds_read_b64_tr_b16 a[32:33], v104 offset:0
  ds_read_b64_tr_b16 a[34:35], v104 offset:512
  ds_read_b64_tr_b16 a[36:37], v104 offset:8192
  ds_read_b64_tr_b16 a[38:39], v104 offset:8704
  ds_read_b64_tr_b16 a[96:97], v106 offset:0
  ds_read_b64_tr_b16 a[98:99], v106 offset:512
  ds_read_b64_tr_b16 a[100:101], v106 offset:8192
  ds_read_b64_tr_b16 a[102:103], v106 offset:8704
  s_waitcnt lgkmcnt(0)
  s_waitcnt vmcnt(24)
  s_barrier
  s_add_u32 s36, s44, 65536
  s_mov_b32 m0, s36
  s_add_u32 s37, s42, 2097152
  buffer_load_dwordx4 v100, s[16:19], s37 offen lds
  s_add_u32 s36, s44, 66560
  s_mov_b32 m0, s36
  s_add_u32 s37, s42, 2129920
  buffer_load_dwordx4 v101, s[16:19], s37 offen lds
  s_add_u32 s36, s44, 67584
  s_mov_b32 m0, s36
  s_add_u32 s37, s42, 2162688
  buffer_load_dwordx4 v100, s[16:19], s37 offen lds
  s_add_u32 s36, s44, 68608
  s_mov_b32 m0, s36
  s_add_u32 s37, s42, 2195456
  buffer_load_dwordx4 v101, s[16:19], s37 offen lds
  ds_read_b64_tr_b16 a[40:41], v104 offset:16384
  ds_read_b64_tr_b16 a[42:43], v104 offset:16896
  ds_read_b64_tr_b16 a[44:45], v104 offset:24576
  ds_read_b64_tr_b16 a[46:47], v104 offset:25088
  ds_read_b64_tr_b16 a[104:105], v106 offset:16384
  ds_read_b64_tr_b16 a[106:107], v106 offset:16896
  ds_read_b64_tr_b16 a[108:109], v106 offset:24576
  ds_read_b64_tr_b16 a[110:111], v106 offset:25088
  s_waitcnt lgkmcnt(0)
  s_waitcnt vmcnt(24)
  s_barrier
  s_add_u32 s36, s44, 81920
  s_mov_b32 m0, s36
  s_add_u32 s37, s42, 2621440
  buffer_load_dwordx4 v100, s[16:19], s37 offen lds
  s_add_u32 s36, s44, 82944
  s_mov_b32 m0, s36
  s_add_u32 s37, s42, 2654208
  buffer_load_dwordx4 v101, s[16:19], s37 offen lds
  s_add_u32 s36, s44, 83968
  s_mov_b32 m0, s36
  s_add_u32 s37, s42, 2686976
  buffer_load_dwordx4 v100, s[16:19], s37 offen lds
  s_add_u32 s36, s44, 84992
  s_mov_b32 m0, s36
  s_add_u32 s37, s42, 2719744
  buffer_load_dwordx4 v101, s[16:19], s37 offen lds
  ds_read_b64_tr_b16 a[48:49], v104 offset:32768
  ds_read_b64_tr_b16 a[50:51], v104 offset:33280
  ds_read_b64_tr_b16 a[52:53], v104 offset:40960
  ds_read_b64_tr_b16 a[54:55], v104 offset:41472
  ds_read_b64_tr_b16 a[112:113], v106 offset:32768
  ds_read_b64_tr_b16 a[114:115], v106 offset:33280
  ds_read_b64_tr_b16 a[116:117], v106 offset:40960
  ds_read_b64_tr_b16 a[118:119], v106 offset:41472
  s_waitcnt lgkmcnt(0)
  s_waitcnt vmcnt(24)
  s_barrier
  s_add_u32 s36, s44, 98304
  s_mov_b32 m0, s36
  s_add_u32 s37, s42, 3145728
  buffer_load_dwordx4 v100, s[16:19], s37 offen lds
  s_add_u32 s36, s44, 99328
  s_mov_b32 m0, s36
  s_add_u32 s37, s42, 3178496
  buffer_load_dwordx4 v101, s[16:19], s37 offen lds
  s_add_u32 s36, s44, 100352
  s_mov_b32 m0, s36
  s_add_u32 s37, s42, 3211264
  buffer_load_dwordx4 v100, s[16:19], s37 offen lds
  s_add_u32 s36, s44, 101376
  s_mov_b32 m0, s36
  s_add_u32 s37, s42, 3244032
  buffer_load_dwordx4 v101, s[16:19], s37 offen lds
  buffer_load_dword v96, v85, s[4:7], s97 offen sc1
  buffer_load_dword v97, v85, s[4:7], s97 offen offset:128 sc1
  ds_read_b64_tr_b16 a[56:57], v104 offset:49152
  ds_read_b64_tr_b16 a[58:59], v104 offset:49664
  ds_read_b64_tr_b16 a[60:61], v104 offset:57344
  ds_read_b64_tr_b16 a[62:63], v104 offset:57856
  ds_read_b64_tr_b16 a[120:121], v106 offset:49152
  ds_read_b64_tr_b16 a[122:123], v106 offset:49664
  ds_read_b64_tr_b16 a[124:125], v106 offset:57344
  ds_read_b64_tr_b16 a[126:127], v106 offset:57856
  s_waitcnt lgkmcnt(0)
  s_waitcnt vmcnt(24)
  s_barrier
  s_add_u32 s36, s44, 114688
  s_mov_b32 m0, s36
  s_add_u32 s37, s42, 3670016
  buffer_load_dwordx4 v100, s[16:19], s37 offen lds
  s_add_u32 s36, s44, 115712
  s_mov_b32 m0, s36
  s_add_u32 s37, s42, 3702784
  buffer_load_dwordx4 v101, s[16:19], s37 offen lds
  s_add_u32 s36, s44, 116736
  s_mov_b32 m0, s36
  s_add_u32 s37, s42, 3735552
  buffer_load_dwordx4 v100, s[16:19], s37 offen lds
  s_add_u32 s36, s44, 117760
  s_mov_b32 m0, s36
  s_add_u32 s37, s42, 3768320
  buffer_load_dwordx4 v101, s[16:19], s37 offen lds
  ds_read_b64_tr_b16 a[128:129], v103 offset:0
  ds_read_b64_tr_b16 a[130:131], v103 offset:512
  ds_read_b64_tr_b16 a[132:133], v103 offset:8192
  ds_read_b64_tr_b16 a[134:135], v103 offset:8704
  ds_read_b64_tr_b16 a[192:193], v105 offset:0
  ds_read_b64_tr_b16 a[194:195], v105 offset:512
  ds_read_b64_tr_b16 a[196:197], v105 offset:8192
  ds_read_b64_tr_b16 a[198:199], v105 offset:8704
  s_waitcnt lgkmcnt(0)
  s_waitcnt vmcnt(24)
  s_barrier
  s_add_u32 s36, s44, 0
  s_mov_b32 m0, s36
  s_add_u32 s37, s43, 0
  buffer_load_dwordx4 v102, s[20:23], s37 offen lds
  s_add_u32 s36, s44, 1024
  s_mov_b32 m0, s36
  s_add_u32 s37, s43, 4096
  buffer_load_dwordx4 v102, s[20:23], s37 offen lds
  s_add_u32 s36, s44, 2048
  s_mov_b32 m0, s36
  s_add_u32 s37, s43, 8192
  buffer_load_dwordx4 v102, s[20:23], s37 offen lds
  s_add_u32 s36, s44, 3072
  s_mov_b32 m0, s36
  s_add_u32 s37, s43, 12288
  buffer_load_dwordx4 v102, s[20:23], s37 offen lds
  ds_read_b64_tr_b16 a[136:137], v103 offset:16384
  ds_read_b64_tr_b16 a[138:139], v103 offset:16896
  ds_read_b64_tr_b16 a[140:141], v103 offset:24576
  ds_read_b64_tr_b16 a[142:143], v103 offset:25088
  ds_read_b64_tr_b16 a[200:201], v105 offset:16384
  ds_read_b64_tr_b16 a[202:203], v105 offset:16896
  ds_read_b64_tr_b16 a[204:205], v105 offset:24576
  ds_read_b64_tr_b16 a[206:207], v105 offset:25088
  s_waitcnt lgkmcnt(0)
  s_waitcnt vmcnt(24)
  s_barrier
  s_add_u32 s36, s44, 16384
  s_mov_b32 m0, s36
  s_add_u32 s37, s43, 65536
  buffer_load_dwordx4 v102, s[20:23], s37 offen lds
  s_add_u32 s36, s44, 17408
  s_mov_b32 m0, s36
  s_add_u32 s37, s43, 69632
  buffer_load_dwordx4 v102, s[20:23], s37 offen lds
  s_add_u32 s36, s44, 18432
  s_mov_b32 m0, s36
  s_add_u32 s37, s43, 73728
  buffer_load_dwordx4 v102, s[20:23], s37 offen lds
  s_add_u32 s36, s44, 19456
  s_mov_b32 m0, s36
  s_add_u32 s37, s43, 77824
  buffer_load_dwordx4 v102, s[20:23], s37 offen lds
  ds_read_b64_tr_b16 a[144:145], v103 offset:32768
  ds_read_b64_tr_b16 a[146:147], v103 offset:33280
  ds_read_b64_tr_b16 a[148:149], v103 offset:40960
  ds_read_b64_tr_b16 a[150:151], v103 offset:41472
  ds_read_b64_tr_b16 a[208:209], v105 offset:32768
  ds_read_b64_tr_b16 a[210:211], v105 offset:33280
  ds_read_b64_tr_b16 a[212:213], v105 offset:40960
  ds_read_b64_tr_b16 a[214:215], v105 offset:41472
  s_waitcnt lgkmcnt(0)
  s_waitcnt vmcnt(24)
  s_barrier
  s_add_u32 s36, s44, 32768
  s_mov_b32 m0, s36
  s_add_u32 s37, s43, 256
  buffer_load_dwordx4 v102, s[20:23], s37 offen lds
  s_add_u32 s36, s44, 33792
  s_mov_b32 m0, s36
  s_add_u32 s37, s43, 4352
  buffer_load_dwordx4 v102, s[20:23], s37 offen lds
  s_add_u32 s36, s44, 34816
  s_mov_b32 m0, s36
  s_add_u32 s37, s43, 8448
  buffer_load_dwordx4 v102, s[20:23], s37 offen lds
  s_add_u32 s36, s44, 35840
  s_mov_b32 m0, s36
  s_add_u32 s37, s43, 12544
  buffer_load_dwordx4 v102, s[20:23], s37 offen lds
  ds_read_b64_tr_b16 a[152:153], v103 offset:49152
  ds_read_b64_tr_b16 a[154:155], v103 offset:49664
  ds_read_b64_tr_b16 a[156:157], v103 offset:57344
  ds_read_b64_tr_b16 a[158:159], v103 offset:57856
  ds_read_b64_tr_b16 a[216:217], v105 offset:49152
  ds_read_b64_tr_b16 a[218:219], v105 offset:49664
  ds_read_b64_tr_b16 a[220:221], v105 offset:57344
  ds_read_b64_tr_b16 a[222:223], v105 offset:57856
  s_waitcnt lgkmcnt(0)
  s_waitcnt vmcnt(24)
  s_barrier
  s_add_u32 s36, s44, 49152
  s_mov_b32 m0, s36
  s_add_u32 s37, s43, 65792
  buffer_load_dwordx4 v102, s[20:23], s37 offen lds
  s_add_u32 s36, s44, 50176
  s_mov_b32 m0, s36
  s_add_u32 s37, s43, 69888
  buffer_load_dwordx4 v102, s[20:23], s37 offen lds
  s_add_u32 s36, s44, 51200
  s_mov_b32 m0, s36
  s_add_u32 s37, s43, 73984
  buffer_load_dwordx4 v102, s[20:23], s37 offen lds
  s_add_u32 s36, s44, 52224
  s_mov_b32 m0, s36
  s_add_u32 s37, s43, 78080
  buffer_load_dwordx4 v102, s[20:23], s37 offen lds
  ds_read_b64_tr_b16 a[160:161], v104 offset:0
  ds_read_b64_tr_b16 a[162:163], v104 offset:512
  ds_read_b64_tr_b16 a[164:165], v104 offset:8192
  ds_read_b64_tr_b16 a[166:167], v104 offset:8704
  ds_read_b64_tr_b16 a[224:225], v106 offset:0
  ds_read_b64_tr_b16 a[226:227], v106 offset:512
  ds_read_b64_tr_b16 a[228:229], v106 offset:8192
  ds_read_b64_tr_b16 a[230:231], v106 offset:8704
  s_waitcnt lgkmcnt(0)
  s_waitcnt vmcnt(24)
  s_barrier
  s_add_u32 s36, s44, 65536
  s_mov_b32 m0, s36
  s_add_u32 s37, s43, 512
  buffer_load_dwordx4 v102, s[20:23], s37 offen lds
  s_add_u32 s36, s44, 66560
  s_mov_b32 m0, s36
  s_add_u32 s37, s43, 4608
  buffer_load_dwordx4 v102, s[20:23], s37 offen lds
  s_add_u32 s36, s44, 67584
  s_mov_b32 m0, s36
  s_add_u32 s37, s43, 8704
  buffer_load_dwordx4 v102, s[20:23], s37 offen lds
  s_add_u32 s36, s44, 68608
  s_mov_b32 m0, s36
  s_add_u32 s37, s43, 12800
  buffer_load_dwordx4 v102, s[20:23], s37 offen lds
  ds_read_b64_tr_b16 a[168:169], v104 offset:16384
  ds_read_b64_tr_b16 a[170:171], v104 offset:16896
  ds_read_b64_tr_b16 a[172:173], v104 offset:24576
  ds_read_b64_tr_b16 a[174:175], v104 offset:25088
  ds_read_b64_tr_b16 a[232:233], v106 offset:16384
  ds_read_b64_tr_b16 a[234:235], v106 offset:16896
  ds_read_b64_tr_b16 a[236:237], v106 offset:24576
  ds_read_b64_tr_b16 a[238:239], v106 offset:25088
  s_waitcnt lgkmcnt(0)
  s_waitcnt vmcnt(24)
  s_barrier
  s_add_u32 s36, s44, 81920
  s_mov_b32 m0, s36
  s_add_u32 s37, s43, 66048
  buffer_load_dwordx4 v102, s[20:23], s37 offen lds
  s_add_u32 s36, s44, 82944
  s_mov_b32 m0, s36
  s_add_u32 s37, s43, 70144
  buffer_load_dwordx4 v102, s[20:23], s37 offen lds
  s_add_u32 s36, s44, 83968
  s_mov_b32 m0, s36
  s_add_u32 s37, s43, 74240
  buffer_load_dwordx4 v102, s[20:23], s37 offen lds
  s_add_u32 s36, s44, 84992
  s_mov_b32 m0, s36
  s_add_u32 s37, s43, 78336
  buffer_load_dwordx4 v102, s[20:23], s37 offen lds
  ds_read_b64_tr_b16 a[176:177], v104 offset:32768
  ds_read_b64_tr_b16 a[178:179], v104 offset:33280
  ds_read_b64_tr_b16 a[180:181], v104 offset:40960
  ds_read_b64_tr_b16 a[182:183], v104 offset:41472
  ds_read_b64_tr_b16 a[240:241], v106 offset:32768
  ds_read_b64_tr_b16 a[242:243], v106 offset:33280
  ds_read_b64_tr_b16 a[244:245], v106 offset:40960
  ds_read_b64_tr_b16 a[246:247], v106 offset:41472
  s_waitcnt lgkmcnt(0)
  s_waitcnt vmcnt(24)
  s_barrier
  s_add_u32 s36, s44, 98304
  s_mov_b32 m0, s36
  s_add_u32 s37, s43, 768
  buffer_load_dwordx4 v102, s[20:23], s37 offen lds
  s_add_u32 s36, s44, 99328
  s_mov_b32 m0, s36
  s_add_u32 s37, s43, 4864
  buffer_load_dwordx4 v102, s[20:23], s37 offen lds
  s_add_u32 s36, s44, 100352
  s_mov_b32 m0, s36
  s_add_u32 s37, s43, 8960
  buffer_load_dwordx4 v102, s[20:23], s37 offen lds
  s_add_u32 s36, s44, 101376
  s_mov_b32 m0, s36
  s_add_u32 s37, s43, 13056
  buffer_load_dwordx4 v102, s[20:23], s37 offen lds
  ds_read_b64_tr_b16 a[184:185], v104 offset:49152
  ds_read_b64_tr_b16 a[186:187], v104 offset:49664
  ds_read_b64_tr_b16 a[188:189], v104 offset:57344
  ds_read_b64_tr_b16 a[190:191], v104 offset:57856
  ds_read_b64_tr_b16 a[248:249], v106 offset:49152
  ds_read_b64_tr_b16 a[250:251], v106 offset:49664
  ds_read_b64_tr_b16 a[252:253], v106 offset:57344
  ds_read_b64_tr_b16 a[254:255], v106 offset:57856
  s_waitcnt lgkmcnt(0)
  s_barrier
  s_add_u32 s36, s44, 114688
  s_mov_b32 m0, s36
  s_add_u32 s37, s43, 66304
  buffer_load_dwordx4 v102, s[20:23], s37 offen lds
  s_add_u32 s36, s44, 115712
  s_mov_b32 m0, s36
  s_add_u32 s37, s43, 70400
  buffer_load_dwordx4 v102, s[20:23], s37 offen lds
  s_add_u32 s36, s44, 116736
  s_mov_b32 m0, s36
  s_add_u32 s37, s43, 74496
  buffer_load_dwordx4 v102, s[20:23], s37 offen lds
  s_add_u32 s36, s44, 117760
  s_mov_b32 m0, s36
  s_add_u32 s37, s43, 78592
  buffer_load_dwordx4 v102, s[20:23], s37 offen lds
  v_min_u32 v96, v96, v97
  v_cmp_ne_u32 vcc, 0, v96
  s_nop 3
  s_cbranch_vccnz K1_R0_FLOK
  v_mov_b32 v96, 0
  s_mov_b32 s3, 0x100000
  s_branch WF2
WS2:
  s_sleep 1
WF2:
  buffer_load_dword v97, v96, s[4:7], s97 offen sc1
  s_sub_u32 s3, s3, 1
  s_cbranch_scc1 K1_END
  s_waitcnt vmcnt(0)
  v_cmp_eq_u32 vcc, 0, v97
  s_nop 3
  s_cbranch_vccnz WS2
  s_add_u32 s97, s97, 128
  v_mov_b32 v96, 0
  s_mov_b32 s3, 0x100000
  s_branch WF3
WS3:
  s_sleep 1
WF3:
  buffer_load_dword v97, v96, s[4:7], s97 offen sc1
  s_sub_u32 s3, s3, 1
  s_cbranch_scc1 K1_END
  s_waitcnt vmcnt(0)
  v_cmp_eq_u32 vcc, 0, v97
  s_nop 3
  s_cbranch_vccnz WS3
  s_sub_u32 s97, s97, 128
K1_R0_FLOK:
  s_add_u32 s97, s97, 256
  s_lshl_b32 s36, s32, 12
  s_add_u32 s36, s36, 0x20000
  s_mov_b32 m0, s36
  s_nop 0
  buffer_load_dwordx4 v9, s[4:7], s48 offen offset:0 lds
  buffer_load_dwordx4 v9, s[4:7], s48 offen offset:1024 lds
  buffer_load_dwordx4 v9, s[4:7], s48 offen offset:2048 lds
  buffer_load_dwordx4 v9, s[4:7], s48 offen offset:3072 lds
  buffer_load_dword v99, v9, s[4:7], s54 offen offset:0
  buffer_load_dword v99, v9, s[4:7], s54 offen offset:1024
  buffer_load_dword v99, v9, s[4:7], s54 offen offset:2048
  buffer_load_dword v99, v9, s[4:7], s54 offen offset:3072
  v_and_b32 v107, 1, v109
  v_lshlrev_b32 v107, 5, v107
  v_lshrrev_b32 v108, 1, v110
  v_lshl_add_u32 v107, v108, 4, v107
  v_lshrrev_b32 v108, 1, v109
  v_lshl_add_u32 v107, v108, 2, v107
  v_and_b32 v108, 1, v110
  v_add_u32 v107, v107, v108
  v_lshlrev_b32 v107, 8, v107
  v_lshl_add_u32 v107, v112, 5, v107
  v_lshl_add_u32 v107, v111, 3, v107
  s_lshl_b32 s36, s32, 15
  v_add_u32 v103, s36, v107
  v_lshlrev_b32 v105, 4, v0
  v_add_u32 v105, s36, v105
  s_waitcnt vmcnt(0)
  s_barrier
  v_xor_b32 v107, 0, v103
  ds_read_b64_tr_b16 v[20:21], v107 offset:0
  ds_read_b64_tr_b16 v[22:23], v107 offset:512
  ds_read_b64_tr_b16 v[24:25], v107 offset:2048
  ds_read_b64_tr_b16 v[26:27], v107 offset:2560
  v_xor_b32 v107, 4096, v103
  ds_read_b64_tr_b16 v[28:29], v107 offset:0
  ds_read_b64_tr_b16 v[30:31], v107 offset:512
  ds_read_b64_tr_b16 v[32:33], v107 offset:2048
  ds_read_b64_tr_b16 v[34:35], v107 offset:2560
  s_waitcnt lgkmcnt(0)
  v_xor_b32 v107, 64, v103
  ds_read_b64_tr_b16 v[36:37], v107 offset:0
  ds_read_b64_tr_b16 v[38:39], v107 offset:512
  ds_read_b64_tr_b16 v[40:41], v107 offset:2048
  ds_read_b64_tr_b16 v[42:43], v107 offset:2560
  v_xor_b32 v107, 4160, v103
  ds_read_b64_tr_b16 v[44:45], v107 offset:0
  ds_read_b64_tr_b16 v[46:47], v107 offset:512
  ds_read_b64_tr_b16 v[48:49], v107 offset:2048
  ds_read_b64_tr_b16 v[50:51], v107 offset:2560
  s_waitcnt lgkmcnt(0)
  v_xor_b32 v107, 128, v103
  ds_read_b64_tr_b16 v[52:53], v107 offset:0
  ds_read_b64_tr_b16 v[54:55], v107 offset:512
  ds_read_b64_tr_b16 v[56:57], v107 offset:2048
  ds_read_b64_tr_b16 v[58:59], v107 offset:2560
  v_xor_b32 v107, 4224, v103
  ds_read_b64_tr_b16 v[60:61], v107 offset:0
  ds_read_b64_tr_b16 v[62:63], v107 offset:512
  ds_read_b64_tr_b16 v[64:65], v107 offset:2048
  ds_read_b64_tr_b16 v[66:67], v107 offset:2560
  s_waitcnt lgkmcnt(0)
  v_xor_b32 v107, 192, v103
  ds_read_b64_tr_b16 v[68:69], v107 offset:0
  ds_read_b64_tr_b16 v[70:71], v107 offset:512
  ds_read_b64_tr_b16 v[72:73], v107 offset:2048
  ds_read_b64_tr_b16 v[74:75], v107 offset:2560
  v_xor_b32 v107, 4288, v103
  ds_read_b64_tr_b16 v[76:77], v107 offset:0
  ds_read_b64_tr_b16 v[78:79], v107 offset:512
  ds_read_b64_tr_b16 v[80:81], v107 offset:2048
  ds_read_b64_tr_b16 v[82:83], v107 offset:2560
  s_waitcnt lgkmcnt(0)
  ds_write_b128 v105, v[20:23] offset:0
  ds_write_b128 v105, v[24:27] offset:1024
  ds_write_b128 v105, v[28:31] offset:2048
  ds_write_b128 v105, v[32:35] offset:3072
  ds_write_b128 v105, v[36:39] offset:4096
  ds_write_b128 v105, v[40:43] offset:5120
  ds_write_b128 v105, v[44:47] offset:6144
  ds_write_b128 v105, v[48:51] offset:7168
  s_waitcnt lgkmcnt(0)
  ds_write_b128 v105, v[52:55] offset:8192
  ds_write_b128 v105, v[56:59] offset:9216
  ds_write_b128 v105, v[60:63] offset:10240
  ds_write_b128 v105, v[64:67] offset:11264
  ds_write_b128 v105, v[68:71] offset:12288
  ds_write_b128 v105, v[72:75] offset:13312
  ds_write_b128 v105, v[76:79] offset:14336
  ds_write_b128 v105, v[80:83] offset:15360
  s_waitcnt lgkmcnt(0)
  v_xor_b32 v107, 0, v103
  ds_read_b64_tr_b16 v[20:21], v107 offset:16384
  ds_read_b64_tr_b16 v[22:23], v107 offset:16896
  ds_read_b64_tr_b16 v[24:25], v107 offset:18432
  ds_read_b64_tr_b16 v[26:27], v107 offset:18944
  v_xor_b32 v107, 4096, v103
  ds_read_b64_tr_b16 v[28:29], v107 offset:16384
  ds_read_b64_tr_b16 v[30:31], v107 offset:16896
  ds_read_b64_tr_b16 v[32:33], v107 offset:18432
  ds_read_b64_tr_b16 v[34:35], v107 offset:18944
  s_waitcnt lgkmcnt(0)
  v_xor_b32 v107, 64, v103
  ds_read_b64_tr_b16 v[36:37], v107 offset:16384
  ds_read_b64_tr_b16 v[38:39], v107 offset:16896
  ds_read_b64_tr_b16 v[40:41], v107 offset:18432
  ds_read_b64_tr_b16 v[42:43], v107 offset:18944
  v_xor_b32 v107, 4160, v103
  ds_read_b64_tr_b16 v[44:45], v107 offset:16384
  ds_read_b64_tr_b16 v[46:47], v107 offset:16896
  ds_read_b64_tr_b16 v[48:49], v107 offset:18432
  ds_read_b64_tr_b16 v[50:51], v107 offset:18944
  s_waitcnt lgkmcnt(0)
  v_xor_b32 v107, 128, v103
  ds_read_b64_tr_b16 v[52:53], v107 offset:16384
  ds_read_b64_tr_b16 v[54:55], v107 offset:16896
  ds_read_b64_tr_b16 v[56:57], v107 offset:18432
  ds_read_b64_tr_b16 v[58:59], v107 offset:18944
  v_xor_b32 v107, 4224, v103
  ds_read_b64_tr_b16 v[60:61], v107 offset:16384
  ds_read_b64_tr_b16 v[62:63], v107 offset:16896
  ds_read_b64_tr_b16 v[64:65], v107 offset:18432
  ds_read_b64_tr_b16 v[66:67], v107 offset:18944
  s_waitcnt lgkmcnt(0)
  v_xor_b32 v107, 192, v103
  ds_read_b64_tr_b16 v[68:69], v107 offset:16384
  ds_read_b64_tr_b16 v[70:71], v107 offset:16896
  ds_read_b64_tr_b16 v[72:73], v107 offset:18432
  ds_read_b64_tr_b16 v[74:75], v107 offset:18944
  v_xor_b32 v107, 4288, v103
  ds_read_b64_tr_b16 v[76:77], v107 offset:16384
  ds_read_b64_tr_b16 v[78:79], v107 offset:16896
  ds_read_b64_tr_b16 v[80:81], v107 offset:18432
  ds_read_b64_tr_b16 v[82:83], v107 offset:18944
  s_waitcnt lgkmcnt(0)
  ds_write_b128 v105, v[20:23] offset:16384
  ds_write_b128 v105, v[24:27] offset:17408
  ds_write_b128 v105, v[28:31] offset:18432
  ds_write_b128 v105, v[32:35] offset:19456
  ds_write_b128 v105, v[36:39] offset:20480
  ds_write_b128 v105, v[40:43] offset:21504
  ds_write_b128 v105, v[44:47] offset:22528
  ds_write_b128 v105, v[48:51] offset:23552
  s_waitcnt lgkmcnt(0)
  ds_write_b128 v105, v[52:55] offset:24576
  ds_write_b128 v105, v[56:59] offset:25600
  ds_write_b128 v105, v[60:63] offset:26624
  ds_write_b128 v105, v[64:67] offset:27648
  ds_write_b128 v105, v[68:71] offset:28672
  ds_write_b128 v105, v[72:75] offset:29696
  ds_write_b128 v105, v[76:79] offset:30720
  ds_write_b128 v105, v[80:83] offset:31744
  s_waitcnt lgkmcnt(0)
  s_lshr_b32 s36, s32, 1
  s_lshl_b32 s36, s36, 16
  v_add_u32 v1, s36, v9
  v_add_u32 v2, 0x20000, v9
  v_add_u32 v7, 0x20000, v10
  v_bfe_u32 v12, v0, 3, 1
  v_mov_b32 v3, 0x4444
  v_mov_b32 v13, 0xeeee
  v_cmp_eq_u32 vcc, 1, v12
  s_nop 1
  v_cndmask_b32 v3, v3, v13, vcc
  v_lshrrev_b32 v13, 4, v0
  v_lshl_add_u32 v14, v13, 1, v12
  v_lshlrev_b32 v14, 4, v14
  v_and_b32 v15, 7, v0
  v_lshl_add_u32 v4, v15, 10, v14
  v_lshrrev_b32 v12, 5, v0
  v_and_b32 v14, 15, v0
  v_lshl_add_u32 v15, v12, 4, v14
  v_and_b32 v13, 1, v13
  v_lshlrev_b32 v5, 4, v15
  v_lshl_add_u32 v5, v13, 3, v5
  v_add_u32 v5, 0x20000, v5
  v_lshrrev_b32 v15, 3, v0
  v_lshlrev_b32 v8, 12, v15
  s_and_b32 s36, s33, 7
  v_xor_b32 v15, s36, v15
  v_lshl_add_u32 v8, v15, 6, v8
  v_and_b32 v15, 7, v0
  v_lshl_add_u32 v8, v15, 3, v8
  v_lshrrev_b32 v13, 4, v0
  v_bfe_u32 v14, v0, 2, 2
  v_lshl_add_u32 v14, v13, 2, v14
  v_and_b32 v15, 1, v0
  v_lshlrev_b32 v6, 4, v14
  v_lshl_add_u32 v6, v15, 3, v6
  v_add_u32 v6, 0x20000, v6
  v_and_b32 v15, 3, v0
  v_lshlrev_b32 v11, 4, v13
  v_lshl_add_u32 v11, v15, 2, v11
  v_and_b32 v12, 1, v0
  v_bfe_u32 v14, v0, 2, 2
  v_lshl_add_u32 v12, v12, 2, v14
  v_bfe_u32 v14, v0, 1, 1
  v_lshl_add_u32 v12, v14, 3, v12
  v_and_b32 v14, 1, v12
  v_lshlrev_b32 v14, 4, v14
  v_mov_b32 v15, 0x3f80
  v_lshlrev_b32 v15, v14, v15
  v_lshrrev_b32 v12, 1, v12
  v_cmp_eq_u32 vcc, 0, v12
  s_nop 1
  v_cndmask_b32 v20, 0, v15, vcc
  v_cmp_eq_u32 vcc, 1, v12
  s_nop 1
  v_cndmask_b32 v21, 0, v15, vcc
  v_cmp_eq_u32 vcc, 2, v12
  s_nop 1
  v_cndmask_b32 v22, 0, v15, vcc
  v_cmp_eq_u32 vcc, 3, v12
  s_nop 1
  v_cndmask_b32 v23, 0, v15, vcc
  ds_write_b128 v2, v[20:23] offset:30720
  v_mov_b32 v16, 0x3f803f80
  v_mov_b32 v17, 0x3f803f80
  v_mov_b32 v18, 0x3f803f80
  v_mov_b32 v19, 0x3f803f80
  s_lshl_b32 s36, s32, 17
  s_lshr_b32 s37, s33, 3
  s_xor_b32 s38, s37, 0
  s_lshl_b32 s38, s38, 9
  s_add_u32 s38, s38, s36
  s_add_u32 s50, s38, 83886080
  s_xor_b32 s38, s37, 1
  s_lshl_b32 s38, s38, 9
  s_add_u32 s38, s38, s36
  s_add_u32 s51, s38, 83918848
  s_xor_b32 s38, s37, 2
  s_lshl_b32 s38, s38, 9
  s_add_u32 s38, s38, s36
  s_add_u32 s52, s38, 83951616
  s_xor_b32 s38, s37, 3
  s_lshl_b32 s38, s38, 9
  s_add_u32 s38, s38, s36
  s_add_u32 s53, s38, 83984384
  s_lshl_b32 s36, s33, 8
  s_lshr_b32 s37, s32, 1
  s_lshl_b32 s37, s37, 6
  s_add_u32 s36, s36, s37
  s_and_b32 s37, s32, 1
  s_lshl_b32 s37, s37, 7
  s_add_u32 s36, s36, s37
  s_lshl_b32 s37, s32, 11
  s_sub_u32 s55, s36, s37
  s_mov_b32 s58, 0x00ff00ff
  s_mov_b32 s59, 0x00ff00ff
  s_mov_b32 s60, 0xff00ff00
  s_mov_b32 s61, 0xff00ff00
  s_mov_b32 s62, 0x00ff00ff
  s_mov_b32 s63, 0xff00ff00
  s_mov_b32 s92, 0x000f000f
  s_mov_b32 s93, 0x000f000f
  s_mov_b32 s94, 0x3e0293ee
  s_mov_b32 s95, 0x3e0293ee
  s_mov_b32 s45, 0
  s_mov_b32 s96, 0
  s_add_u32 s46, s37, 84934656
  s_lshl_b32 s56, s33, 13
  s_add_u32 s56, s56, 66846720
  s_mul_i32 s49, s33, 0x2100
  s_add_u32 s49, s49, 88080384
  s_lshl_b32 s41, s33, 8
  s_lshl_b32 s36, s32, 11
  s_sub_u32 s41, s41, s36
  s_add_u32 s41, s41, 8192
  v_mov_b64 v[48:49], v[88:89]
  v_mov_b64 v[50:51], v[90:91]
  v_mov_b64 v[52:53], v[92:93]
  v_mov_b64 v[54:55], v[94:95]
  v_mov_b32 v13, v98
  v_mov_b32 v15, 1
  s_xor_b32 s47, s54, 2048
  v_xor_b32 v0, 0x80, v2
  v_mov_b32 v4, v2
  v_add_u32 v10, 0x2000, v2
  v_readfirstlane_b32 s36, v13
  s_nop 1
  v_cmp_ne_u32 vcc, s36, v13
  s_nop 3
  s_cbranch_vccnz K1_R0_SLOW
  s_cmp_eq_u32 s32, 1
  s_cbranch_scc1 K1_R0_W1M0
  s_cmp_eq_u32 s32, 2
  s_cbranch_scc1 K1_R0_W2M0
  s_cmp_eq_u32 s32, 3
  s_cbranch_scc1 K1_R0_W3M0
K1_R0_W0M0:
  ds_read_b128 v[72:75], v1 offset:0
  ds_read_b128 v[76:79], v1 offset:1024
  ds_read_b128 v[80:83], v1 offset:16384
  ds_read_b128 v[84:87], v1 offset:17408
  ds_read_b128 v[88:91], v1 offset:2048
  ds_read_b128 v[92:95], v1 offset:3072
  ds_read_b128 v[96:99], v1 offset:18432
  ds_read_b128 v[100:103], v1 offset:19456
  ds_read_b128 v[104:107], v1 offset:4096
  ds_read_b128 v[108:111], v1 offset:5120
  ds_read_b128 v[112:115], v1 offset:20480
  ds_read_b128 v[116:119], v1 offset:21504
  ds_read_b128 v[120:123], v1 offset:6144
  ds_read_b128 v[124:127], v1 offset:7168
  ds_read_b128 v[32:35], v1 offset:28672
  ds_read_b128 v[36:39], v1 offset:29696
  ds_read_b128 v[40:43], v1 offset:30720
  ds_read_b128 v[44:47], v1 offset:31744
  s_waitcnt lgkmcnt(0)
  ds_write_b128 v1, v[192:195] offset:0
  ds_write_b128 v1, v[196:199] offset:1024
  ds_write_b128 v1, v[200:203] offset:16384
  ds_write_b128 v1, v[204:207] offset:17408
  ds_write_b128 v1, v[144:147] offset:2048
  ds_write_b128 v1, v[148:151] offset:3072
  ds_write_b128 v1, v[208:211] offset:18432
  ds_write_b128 v1, v[212:215] offset:19456
  ds_write_b128 v1, v[152:155] offset:4096
  ds_write_b128 v1, v[156:159] offset:5120
  ds_write_b128 v1, v[216:219] offset:20480
  ds_write_b128 v1, v[220:223] offset:21504
  ds_write_b128 v1, v[160:163] offset:6144
  ds_write_b128 v1, v[164:167] offset:7168
  s_waitcnt lgkmcnt(0)
  v_mov_b64 v[192:193], v[72:73]
  v_mov_b64 v[194:195], v[74:75]
  v_mov_b64 v[196:197], v[76:77]
  v_mov_b64 v[198:199], v[78:79]
  v_mov_b64 v[200:201], v[80:81]
  v_mov_b64 v[202:203], v[82:83]
  v_mov_b64 v[204:205], v[84:85]
  v_mov_b64 v[206:207], v[86:87]
  v_mov_b64 v[144:145], v[88:89]
  v_mov_b64 v[146:147], v[90:91]
  v_mov_b64 v[148:149], v[92:93]
  v_mov_b64 v[150:151], v[94:95]
  v_mov_b64 v[208:209], v[96:97]
  v_mov_b64 v[210:211], v[98:99]
  v_mov_b64 v[212:213], v[100:101]
  v_mov_b64 v[214:215], v[102:103]
  v_mov_b64 v[152:153], v[104:105]
  v_mov_b64 v[154:155], v[106:107]
  v_mov_b64 v[156:157], v[108:109]
  v_mov_b64 v[158:159], v[110:111]
  v_mov_b64 v[216:217], v[112:113]
  v_mov_b64 v[218:219], v[114:115]
  v_mov_b64 v[220:221], v[116:117]
  v_mov_b64 v[222:223], v[118:119]
  v_mov_b64 v[160:161], v[120:121]
  v_mov_b64 v[162:163], v[122:123]
  v_mov_b64 v[164:165], v[124:125]
  v_mov_b64 v[166:167], v[126:127]
  v_mov_b64 v[20:21], 0
  v_mov_b64 v[22:23], 0
  v_mov_b64 v[24:25], 0
  v_mov_b64 v[26:27], 0
  v_mov_b64 v[28:29], 0
  v_mov_b64 v[30:31], 0
  s_mov_b32 s42, 28672
  ds_read_b128 v[88:91], v1 offset:0
  ds_read_b128 v[92:95], v1 offset:1024
  ds_read_b128 v[96:99], v1 offset:16384
  ds_read_b128 v[100:103], v1 offset:17408
  ds_read_b128 v[104:107], v1 offset:2048
  ds_read_b128 v[108:111], v1 offset:3072
  ds_read_b128 v[112:115], v1 offset:18432
  ds_read_b128 v[116:119], v1 offset:19456
  ds_read_b128 v[72:75], v1 offset:4096
  ds_read_b128 v[76:79], v1 offset:5120
  ds_read_b128 v[80:83], v1 offset:20480
  ds_read_b128 v[84:87], v1 offset:21504
  ds_read_b128 v[120:123], v1 offset:6144
  ds_read_b128 v[124:127], v1 offset:7168
  s_branch K1_R0_W0M0_P2OK
K1_R0_W0M0_LOOP:
  ds_read_b128 v[88:91], v1 offset:0
  ds_read_b128 v[92:95], v1 offset:1024
  ds_read_b128 v[96:99], v1 offset:16384
  ds_read_b128 v[100:103], v1 offset:17408
  ds_read_b128 v[104:107], v1 offset:2048
  ds_read_b128 v[108:111], v1 offset:3072
  ds_read_b128 v[112:115], v1 offset:18432
  ds_read_b128 v[116:119], v1 offset:19456
  ds_read_b128 v[72:75], v1 offset:4096
  ds_read_b128 v[76:79], v1 offset:5120
  ds_read_b128 v[80:83], v1 offset:20480
  ds_read_b128 v[84:87], v1 offset:21504
  ds_read_b128 v[120:123], v1 offset:6144
  ds_read_b128 v[124:127], v1 offset:7168
  buffer_load_dwordx4 v[48:51], v9, s[4:7], s46 offen offset:0 sc1
  buffer_load_dwordx4 v[52:55], v9, s[4:7], s46 offen offset:1024 sc1
  s_nop 7
  s_nop 7
  s_nop 7
  s_nop 7
K1_R0_W0M0_P2:
  buffer_load_dwordx4 v[64:67], v9, s[4:7], s46 offen offset:0 sc1
  buffer_load_dwordx4 v[68:71], v9, s[4:7], s46 offen offset:1024 sc1
  s_sub_u32 s57, s57, 1
  s_cbranch_scc1 K1_END
  s_waitcnt vmcnt(2)
  v_max3_u32 v12, v48, v49, v50
  v_max3_u32 v13, v51, v52, v53
  v_max3_u32 v12, v12, v54, v55
  v_max_u32 v12, v12, v13
  v_cmp_eq_u32 vcc, -1, v12
  s_nop 3
  s_cbranch_vccz K1_R0_W0M0_P2OK
  buffer_load_dwordx4 v[48:51], v9, s[4:7], s46 offen offset:0 sc1
  buffer_load_dwordx4 v[52:55], v9, s[4:7], s46 offen offset:1024 sc1
  s_waitcnt vmcnt(2)
  v_max3_u32 v12, v64, v65, v66
  v_max3_u32 v13, v67, v68, v69
  v_max3_u32 v12, v12, v70, v71
  v_max_u32 v12, v12, v13
  v_cmp_eq_u32 vcc, -1, v12
  s_nop 3
  s_cbranch_vccnz K1_R0_W0M0_P2
  v_mov_b64 v[48:49], v[64:65]
  v_mov_b64 v[50:51], v[66:67]
  v_mov_b64 v[52:53], v[68:69]
  v_mov_b64 v[54:55], v[70:71]
  s_nop 1
K1_R0_W0M0_P2OK:
  ds_write_b128 v2, v[48:51] offset:16384
  ds_write_b128 v2, v[52:55] offset:17408
  v_smfmac_f32_16x16x64_bf16 v[20:23], v[48:51], v[128:135], v3
  s_add_u32 s38, s56, -126976
  v_mov_b32_dpp v56, v48 row_ror:8 row_mask:0xf bank_mask:0xf
  v_smfmac_f32_16x16x64_bf16 v[24:27], v[48:51], a[0:7], v3
  buffer_store_dwordx4 v[28:31], v9, s[4:7], s47 offen offset:0
  v_mov_b32_dpp v57, v49 row_ror:8 row_mask:0xf bank_mask:0xf
  v_smfmac_f32_16x16x64_bf16 v[20:23], v[52:55], v[136:143], v3
  buffer_store_dwordx4 v[28:31], v9, s[4:7], s47 offen offset:1024
  v_mov_b32_dpp v58, v50 row_ror:8 row_mask:0xf bank_mask:0xf
  v_smfmac_f32_16x16x64_bf16 v[24:27], v[52:55], a[8:15], v3
  v_mov_b32_dpp v59, v51 row_ror:8 row_mask:0xf bank_mask:0xf
  s_waitcnt vmcnt(2)
  v_smfmac_f32_16x16x64_bf16 v[28:31], v[48:51], a[128:135], v3
  ds_read_b64_tr_b16 v[64:65], v6 offset:26624
  ds_read_b64_tr_b16 v[66:67], v6 offset:26880
  v_mov_b32_dpp v60, v52 row_ror:8 row_mask:0xf bank_mask:0xf
  v_mov_b32_dpp v61, v53 row_ror:8 row_mask:0xf bank_mask:0xf
  v_smfmac_f32_16x16x64_bf16 v[28:31], v[52:55], a[136:143], v3
  ds_read_b64 v[68:69], v7 offset:28672
  v_mov_b32_dpp v62, v54 row_ror:8 row_mask:0xf bank_mask:0xf
  v_mov_b32_dpp v63, v55 row_ror:8 row_mask:0xf bank_mask:0xf
  s_waitcnt lgkmcnt(0)
  s_barrier
  buffer_store_dwordx4 v[64:67], v9, s[4:7], s56 offen offset:0 sc1
  buffer_store_dwordx2 v[68:69], v7, s[4:7], s38 offen offset:0 sc1
  ds_read_b128 v[64:67], v2 offset:18432
  ds_read_b128 v[68:71], v0 offset:18432
  ds_read_b128 v[48:51], v2 offset:19456
  ds_read_b128 v[52:55], v0 offset:19456
  v_smfmac_f32_16x16x64_bf16 v[20:23], v[56:59], v[88:95], v3
  s_mov_b64 exec, 1
  buffer_load_dword v15, v9, s[4:7], s97 offen sc1
  buffer_store_dword v3, v9, s[4:7], s49 offen sc1
  s_mov_b64 exec, -1
  v_smfmac_f32_16x16x64_bf16 v[24:27], v[56:59], a[64:71], v3
  s_add_u32 s48, s48, 524288
  s_mov_b32 m0, s42
  s_xor_b32 s42, s42, 159744
  buffer_load_dwordx4 v9, s[4:7], s48 offen offset:0 lds
  buffer_load_dwordx4 v9, s[4:7], s48 offen offset:1024 lds
  buffer_load_dwordx4 v9, s[4:7], s48 offen offset:2048 lds
  buffer_load_dwordx4 v9, s[4:7], s48 offen offset:3072 lds
  v_smfmac_f32_16x16x64_bf16 v[28:31], v[56:59], a[192:199], v3
  v_smfmac_f32_16x16x64_bf16 v[20:23], v[60:63], v[96:103], v3
  v_smfmac_f32_16x16x64_bf16 v[24:27], v[60:63], a[72:79], v3
  v_smfmac_f32_16x16x64_bf16 v[28:31], v[60:63], a[200:207], v3
  s_waitcnt lgkmcnt(3)
  v_smfmac_f32_16x16x64_bf16 v[20:23], v[64:67], v[104:111], v3
  ds_read_b128 v[56:59], v2 offset:20480
  v_smfmac_f32_16x16x64_bf16 v[24:27], v[64:67], a[16:23], v3
  s_waitcnt lgkmcnt(3)
  v_smfmac_f32_16x16x64_bf16 v[20:23], v[68:71], v[112:119], v3
  ds_read_b128 v[60:63], v0 offset:20480
  v_smfmac_f32_16x16x64_bf16 v[24:27], v[68:71], a[80:87], v3
  s_waitcnt lgkmcnt(3)
  v_smfmac_f32_16x16x64_bf16 v[20:23], v[48:51], v[72:79], v3
  ds_read_b128 v[64:67], v2 offset:21504
  v_smfmac_f32_16x16x64_bf16 v[24:27], v[48:51], a[24:31], v3
  s_waitcnt lgkmcnt(3)
  v_smfmac_f32_16x16x64_bf16 v[20:23], v[52:55], v[80:87], v3
  ds_read_b128 v[68:71], v0 offset:21504
  v_smfmac_f32_16x16x64_bf16 v[24:27], v[52:55], a[88:95], v3
  ds_read_b128 v[88:91], v4 offset:0
  s_waitcnt lgkmcnt(4)
  v_smfmac_f32_16x16x64_bf16 v[20:23], v[56:59], v[120:127], v3
  ds_read_b128 v[48:51], v2 offset:22528
  v_smfmac_f32_16x16x64_bf16 v[24:27], v[56:59], a[32:39], v3
  ds_read_b128 v[92:95], v4 offset:1024
  s_waitcnt lgkmcnt(5)
  v_smfmac_f32_16x16x64_bf16 v[20:23], v[60:63], v[224:231], v3
  ds_read_b128 v[52:55], v0 offset:22528
  v_smfmac_f32_16x16x64_bf16 v[24:27], v[60:63], a[96:103], v3
  ds_read_b128 v[96:99], v4 offset:2048
  s_waitcnt lgkmcnt(6)
  v_smfmac_f32_16x16x64_bf16 v[20:23], v[64:67], v[168:175], v3
  ds_read_b128 v[56:59], v2 offset:23552
  v_smfmac_f32_16x16x64_bf16 v[24:27], v[64:67], a[40:47], v3
  ds_read_b128 v[100:103], v4 offset:3072
  s_waitcnt lgkmcnt(7)
  v_smfmac_f32_16x16x64_bf16 v[20:23], v[68:71], v[232:239], v3
  ds_read_b128 v[60:63], v0 offset:23552
  v_smfmac_f32_16x16x64_bf16 v[24:27], v[68:71], a[104:111], v3
  ds_read_b128 v[104:107], v4 offset:4096
  s_waitcnt lgkmcnt(7)
  v_smfmac_f32_16x16x64_bf16 v[20:23], v[48:51], v[176:183], v3
  ds_read_b128 v[64:67], v2 offset:18432
  v_smfmac_f32_16x16x64_bf16 v[24:27], v[48:51], a[48:55], v3
  ds_read_b128 v[108:111], v4 offset:5120
  s_waitcnt lgkmcnt(7)
  v_smfmac_f32_16x16x64_bf16 v[20:23], v[52:55], v[240:247], v3
  ds_read_b128 v[68:71], v0 offset:18432
  v_smfmac_f32_16x16x64_bf16 v[24:27], v[52:55], a[112:119], v3
  ds_read_b128 v[112:115], v4 offset:6144
  s_waitcnt lgkmcnt(7)
  v_smfmac_f32_16x16x64_bf16 v[20:23], v[56:59], v[184:191], v3
  ds_read_b128 v[48:51], v2 offset:19456
  v_smfmac_f32_16x16x64_bf16 v[24:27], v[56:59], a[56:63], v3
  ds_read_b128 v[116:119], v4 offset:7168
  s_waitcnt lgkmcnt(7)
  v_smfmac_f32_16x16x64_bf16 v[20:23], v[60:63], v[248:255], v3
  ds_read_b128 v[52:55], v0 offset:19456
  v_smfmac_f32_16x16x64_bf16 v[24:27], v[60:63], a[120:127], v3
  s_waitcnt lgkmcnt(6)
  v_smfmac_f32_16x16x64_bf16 v[28:31], v[64:67], a[144:151], v3
  ds_read_b128 v[56:59], v2 offset:20480
  s_waitcnt lgkmcnt(5)
  v_smfmac_f32_16x16x64_bf16 v[28:31], v[68:71], a[208:215], v3
  ds_read_b128 v[60:63], v0 offset:20480
  s_waitcnt lgkmcnt(4)
  v_smfmac_f32_16x16x64_bf16 v[28:31], v[48:51], a[152:159], v3
  ds_read_b128 v[64:67], v2 offset:21504
  v_cvt_pk_bf16_f32 v12, v20, v21
  v_cvt_pk_bf16_f32 v13, v22, v23
  v_cvt_pk_bf16_f32 v24, v24, v25
  v_cvt_pk_bf16_f32 v25, v26, v27
  ds_write_b64 v5, v[12:13] offset:24576
  ds_write_b64 v5, v[24:25] offset:26624
  s_waitcnt lgkmcnt(5)
  v_smfmac_f32_16x16x64_bf16 v[28:31], v[52:55], a[216:223], v3
  ds_read_b128 v[68:71], v0 offset:21504
  s_waitcnt lgkmcnt(5)
  v_smfmac_f32_16x16x64_bf16 v[28:31], v[56:59], a[160:167], v3
  ds_read_b128 v[48:51], v2 offset:22528
  s_waitcnt lgkmcnt(5)
  v_smfmac_f32_16x16x64_bf16 v[28:31], v[60:63], a[224:231], v3
  ds_read_b128 v[52:55], v0 offset:22528
  s_waitcnt lgkmcnt(3)
  s_barrier
  v_smfmac_f32_16x16x64_bf16 v[28:31], v[64:67], a[168:175], v3
  ds_read_b64_tr_b16 v[72:73], v6 offset:24576
  ds_read_b64_tr_b16 v[74:75], v6 offset:24832
  ds_read_b64_tr_b16 v[76:77], v6 offset:25088
  ds_read_b64_tr_b16 v[78:79], v6 offset:25344
  ds_read_b128 v[56:59], v2 offset:23552
  s_waitcnt lgkmcnt(7)
  v_smfmac_f32_16x16x64_bf16 v[28:31], v[68:71], a[232:239], v3
  ds_read_b64_tr_b16 v[80:81], v6 offset:25600
  ds_read_b64_tr_b16 v[82:83], v6 offset:25856
  ds_read_b64_tr_b16 v[84:85], v6 offset:26112
  ds_read_b64_tr_b16 v[86:87], v6 offset:26368
  ds_read_b128 v[60:63], v0 offset:23552
  s_waitcnt lgkmcnt(11)
  v_smfmac_f32_16x16x64_bf16 v[28:31], v[48:51], a[176:183], v3
  ds_read_b64_tr_b16 v[64:65], v6 offset:26624
  ds_read_b64_tr_b16 v[66:67], v6 offset:26880
  s_waitcnt lgkmcnt(12)
  v_smfmac_f32_16x16x64_bf16 v[28:31], v[52:55], a[240:247], v3
  ds_read_b64_tr_b16 v[68:69], v6 offset:27136
  ds_read_b64_tr_b16 v[70:71], v6 offset:27392
  s_waitcnt lgkmcnt(9)
  v_smfmac_f32_16x16x64_bf16 v[28:31], v[56:59], a[184:191], v3
  ds_read_b64_tr_b16 v[48:49], v6 offset:27648
  ds_read_b64_tr_b16 v[50:51], v6 offset:27904
  s_waitcnt lgkmcnt(6)
  v_smfmac_f32_16x16x64_bf16 v[28:31], v[60:63], a[248:255], v3
  ds_read_b64_tr_b16 v[52:53], v6 offset:28160
  ds_read_b64_tr_b16 v[54:55], v6 offset:28416
  v_mfma_f32_16x16x32_bf16 v[120:123], v[88:91], v[72:75], 0
  v_mfma_f32_16x16x32_bf16 v[120:123], v[92:95], v[76:79], v[120:123]
  v_mfma_f32_16x16x32_bf16 v[120:123], v[96:99], v[80:83], v[120:123]
  v_mfma_f32_16x16x32_bf16 v[120:123], v[100:103], v[84:87], v[120:123]
  s_nop 1
  v_cvt_pk_bf16_f32 v28, v28, v29
  v_cvt_pk_bf16_f32 v29, v30, v31
  ds_write_b64 v7, v[28:29] offset:28672
  v_mfma_f32_16x16x32_bf16 v[124:127], v[104:107], v[72:75], 0
  ds_read_b128 v[88:91], v10 offset:0
  v_mfma_f32_16x16x32_bf16 v[124:127], v[108:111], v[76:79], v[124:127]
  ds_read_b128 v[92:95], v10 offset:1024
  v_mfma_f32_16x16x32_bf16 v[124:127], v[112:115], v[80:83], v[124:127]
  ds_read_b128 v[96:99], v10 offset:2048
  v_mfma_f32_16x16x32_bf16 v[124:127], v[116:119], v[84:87], v[124:127]
  ds_read_b128 v[100:103], v10 offset:3072
  v_max3_f32 v24, v120, v121, v122
  s_waitcnt lgkmcnt(5)
  v_mfma_f32_16x16x32_bf16 v[20:23], v[64:67], v[72:75], 0
  v_mfma_f32_16x16x32_bf16 v[20:23], v[68:71], v[76:79], v[20:23]
  v_mfma_f32_16x16x32_bf16 v[20:23], v[48:51], v[80:83], v[20:23]
  s_nop 1
  v_max3_f32 v24, v24, v123, v124
  v_max3_f32 v24, v24, v125, v126
  v_mfma_f32_16x16x32_bf16 v[20:23], v[52:55], v[84:87], v[20:23]
  ds_read_b128 v[48:51], v10 offset:4096
  ds_read_b128 v[52:55], v10 offset:5120
  ds_read_b128 v[56:59], v10 offset:6144
  ds_read_b128 v[60:63], v10 offset:7168
  ds_read_b128 v[64:67], v1 offset:22528
  ds_read_b128 v[68:71], v1 offset:23552
  s_nop 1
  v_max3_f32 v24, v24, v127, v20
  v_max3_f32 v24, v24, v21, v22
  v_max_f32 v12, v24, v23
  v_max_f32 v24, v24, v23
  s_cmp_eq_u32 s45, 63
  s_cbranch_scc1 K1_R0_FIN
  s_nop 0
  v_permlane16_swap_b32 v24, v12
  v_max_f32 v13, v24, v12
  v_max_f32 v24, v24, v12
  s_nop 1
  v_permlane32_swap_b32 v24, v13
  v_max_f32 v12, v24, v13
  v_pk_add_f32 v[120:121], v[120:121], v[12:13] op_sel_hi:[1,0] neg_lo:[0,1] neg_hi:[0,1]
  v_pk_add_f32 v[122:123], v[122:123], v[12:13] op_sel_hi:[1,0] neg_lo:[0,1] neg_hi:[0,1]
  v_pk_add_f32 v[124:125], v[124:125], v[12:13] op_sel_hi:[1,0] neg_lo:[0,1] neg_hi:[0,1]
  v_pk_add_f32 v[126:127], v[126:127], v[12:13] op_sel_hi:[1,0] neg_lo:[0,1] neg_hi:[0,1]
  v_pk_mul_f32 v[120:121], v[120:121], s[94:95]
  v_pk_mul_f32 v[122:123], v[122:123], s[94:95]
  v_pk_mul_f32 v[124:125], v[124:125], s[94:95]
  v_pk_mul_f32 v[126:127], v[126:127], s[94:95]
  v_exp_f32 v120, v120
  v_exp_f32 v121, v121
  v_exp_f32 v122, v122
  v_exp_f32 v123, v123
  v_exp_f32 v124, v124
  v_exp_f32 v125, v125
  v_exp_f32 v126, v126
  v_exp_f32 v127, v127
  v_cvt_pk_bf16_f32 v24, v120, v121
  v_cvt_pk_bf16_f32 v25, v122, v123
  v_cvt_pk_bf16_f32 v26, v124, v125
  v_cvt_pk_bf16_f32 v27, v126, v127
  v_cndmask_b32 v72, 0, v24, s[58:59]
  v_cndmask_b32 v73, 0, v25, s[58:59]
  v_cndmask_b32 v74, 0, v26, s[58:59]
  v_cndmask_b32 v75, 0, v27, s[58:59]
  v_cndmask_b32 v76, 0, v24, s[60:61]
  v_cndmask_b32 v77, 0, v25, s[60:61]
  v_cndmask_b32 v78, 0, v26, s[60:61]
  v_cndmask_b32 v79, 0, v27, s[60:61]
  s_waitcnt lgkmcnt(2)
  s_barrier
  v_mfma_f32_16x16x32_bf16 v[84:87], v[16:19], v[24:27], 0
  ds_read_b64 v[120:121], v7 offset:28672
  ds_read_b64 v[122:123], v7 offset:29184
  v_sub_f32 v20, v20, v12
  v_sub_f32 v21, v21, v12
  v_mfma_f32_16x16x32_bf16 v[104:107], v[88:91], v[72:75], 0
  ds_read_b64 v[124:125], v7 offset:29696
  ds_read_b64 v[126:127], v7 offset:30208
  v_sub_f32 v22, v22, v12
  v_sub_f32 v23, v23, v12
  v_mfma_f32_16x16x32_bf16 v[104:107], v[92:95], v[76:79], v[104:107]
  s_nop 0
  s_nop 0
  v_mul_f32 v20, s94, v20
  v_mul_f32 v21, s94, v21
  v_mfma_f32_16x16x32_bf16 v[108:111], v[96:99], v[72:75], 0
  ds_read_b128 v[88:91], v1 offset:8192
  ds_read_b128 v[92:95], v1 offset:9216
  v_mul_f32 v22, s94, v22
  v_mul_f32 v23, s94, v23
  v_mfma_f32_16x16x32_bf16 v[108:111], v[100:103], v[76:79], v[108:111]
  ds_read_b128 v[96:99], v1 offset:24576
  ds_read_b128 v[100:103], v1 offset:25600
  v_exp_f32 v20, v20
  v_exp_f32 v21, v21
  v_mfma_f32_16x16x32_bf16 v[112:115], v[48:51], v[72:75], 0
  v_exp_f32 v22, v22
  v_exp_f32 v23, v23
  v_mfma_f32_16x16x32_bf16 v[112:115], v[52:55], v[76:79], v[112:115]
  v_cvt_pk_bf16_f32 v12, v20, v21
  v_cvt_pk_bf16_f32 v13, v22, v23
  v_mfma_f32_16x16x32_bf16 v[116:119], v[56:59], v[72:75], 0
  v_cndmask_b32 v80, 0, v12, s[62:63]
  v_cndmask_b32 v81, 0, v13, s[62:63]
  v_mfma_f32_16x16x32_bf16 v[116:119], v[60:63], v[76:79], v[116:119]
  s_waitcnt lgkmcnt(4)
  v_mfma_f32_16x16x16_bf16 v[84:87], v[16:17], v[80:81], v[84:87]
  ds_read_b128 v[48:51], v1 offset:10240
  ds_read_b128 v[52:55], v1 offset:11264
  v_mov_b64 v[20:21], 0
  v_mov_b64 v[22:23], 0
  v_mfma_f32_16x16x16_bf16 v[104:107], v[120:121], v[80:81], v[104:107]
  ds_read_b128 v[56:59], v1 offset:26624
  ds_read_b128 v[60:63], v1 offset:27648
  v_mov_b64 v[24:25], 0
  v_mov_b64 v[26:27], 0
  v_mfma_f32_16x16x16_bf16 v[108:111], v[122:123], v[80:81], v[108:111]
  v_mov_b64 v[28:29], 0
  v_mov_b64 v[30:31], 0
  v_mfma_f32_16x16x16_bf16 v[112:115], v[124:125], v[80:81], v[112:115]
  v_mfma_f32_16x16x16_bf16 v[116:119], v[126:127], v[80:81], v[116:119]
  ds_read_b128 v[120:123], v1 offset:12288
  ds_read_b128 v[124:127], v1 offset:13312
  v_rcp_f32 v12, v84
  s_nop 0
  v_pk_mul_f32 v[104:105], v[104:105], v[12:13] op_sel_hi:[1,0]
  v_pk_mul_f32 v[106:107], v[106:107], v[12:13] op_sel_hi:[1,0]
  v_pk_mul_f32 v[108:109], v[108:109], v[12:13] op_sel_hi:[1,0]
  v_pk_mul_f32 v[110:111], v[110:111], v[12:13] op_sel_hi:[1,0]
  v_pk_mul_f32 v[112:113], v[112:113], v[12:13] op_sel_hi:[1,0]
  v_pk_mul_f32 v[114:115], v[114:115], v[12:13] op_sel_hi:[1,0]
  v_pk_mul_f32 v[116:117], v[116:117], v[12:13] op_sel_hi:[1,0]
  v_pk_mul_f32 v[118:119], v[118:119], v[12:13] op_sel_hi:[1,0]
  v_cvt_pk_bf16_f32 v72, v104, v105
  v_cvt_pk_bf16_f32 v73, v106, v107
  v_cvt_pk_bf16_f32 v74, v108, v109
  v_cvt_pk_bf16_f32 v75, v110, v111
  v_cvt_pk_bf16_f32 v76, v112, v113
  v_cvt_pk_bf16_f32 v77, v114, v115
  v_cvt_pk_bf16_f32 v78, v116, v117
  v_cvt_pk_bf16_f32 v79, v118, v119
  v_smfmac_f32_16x16x64_bf16 v[20:23], v[72:75], v[192:199], v3
  ds_read_b128 v[104:107], v1 offset:14336
  ds_read_b128 v[108:111], v1 offset:15360
  v_mov_b32_dpp v80, v72 row_ror:8 row_mask:0xf bank_mask:0xf
  v_mov_b32_dpp v81, v73 row_ror:8 row_mask:0xf bank_mask:0xf
  v_mov_b32_dpp v82, v74 row_ror:8 row_mask:0xf bank_mask:0xf
  v_mov_b32_dpp v83, v75 row_ror:8 row_mask:0xf bank_mask:0xf
  v_smfmac_f32_16x16x64_bf16 v[20:23], v[76:79], v[200:207], v3
  v_mov_b32_dpp v84, v76 row_ror:8 row_mask:0xf bank_mask:0xf
  v_mov_b32_dpp v85, v77 row_ror:8 row_mask:0xf bank_mask:0xf
  v_mov_b32_dpp v86, v78 row_ror:8 row_mask:0xf bank_mask:0xf
  v_mov_b32_dpp v87, v79 row_ror:8 row_mask:0xf bank_mask:0xf
  v_smfmac_f32_16x16x64_bf16 v[20:23], v[80:83], v[144:151], v3
  v_mov_b64 v[112:113], 0
  v_smfmac_f32_16x16x64_bf16 v[20:23], v[84:87], v[208:215], v3
  v_mov_b64 v[114:115], 0
  v_smfmac_f32_16x16x64_bf16 v[24:27], v[72:75], v[152:159], v3
  v_smfmac_f32_16x16x64_bf16 v[24:27], v[76:79], v[216:223], v3
  s_nop 4
  v_cvt_pk_bf16_f32 v20, v20, v21
  v_cvt_pk_bf16_f32 v21, v22, v23
  v_smfmac_f32_16x16x64_bf16 v[24:27], v[80:83], v[160:167], v3
  v_max_u32 v20, 1, v20
  v_max_u32 v21, 1, v21
  s_waitcnt lgkmcnt(2)
  v_smfmac_f32_16x16x64_bf16 v[24:27], v[84:87], v[64:71], v3
  buffer_store_dwordx2 v[20:21], v8, s[4:7], s50 offen
  v_smfmac_f32_16x16x64_bf16 v[28:31], v[72:75], v[88:95], v3
  v_smfmac_f32_16x16x64_bf16 v[28:31], v[76:79], v[96:103], v3
  s_nop 4
  v_cvt_pk_bf16_f32 v24, v24, v25
  v_cvt_pk_bf16_f32 v25, v26, v27
  v_smfmac_f32_16x16x64_bf16 v[28:31], v[80:83], v[48:55], v3
  v_max_u32 v24, 1, v24
  v_max_u32 v25, 1, v25
  v_smfmac_f32_16x16x64_bf16 v[28:31], v[84:87], v[56:63], v3
  buffer_store_dwordx2 v[24:25], v8, s[4:7], s51 offen
  v_smfmac_f32_16x16x64_bf16 v[112:115], v[72:75], v[120:127], v3
  v_smfmac_f32_16x16x64_bf16 v[112:115], v[76:79], v[32:39], v3
  s_nop 4
  v_cvt_pk_bf16_f32 v28, v28, v29
  v_cvt_pk_bf16_f32 v29, v30, v31
  s_waitcnt lgkmcnt(0)
  v_smfmac_f32_16x16x64_bf16 v[112:115], v[80:83], v[104:111], v3
  v_max_u32 v28, 1, v28
  v_max_u32 v29, 1, v29
  v_smfmac_f32_16x16x64_bf16 v[112:115], v[84:87], v[40:47], v3
  buffer_store_dwordx2 v[28:29], v8, s[4:7], s52 offen
  s_nop 6
  v_cvt_pk_bf16_f32 v112, v112, v113
  v_cvt_pk_bf16_f32 v113, v114, v115
  v_max_u32 v112, 1, v112
  v_max_u32 v113, 1, v113
  buffer_store_dwordx2 v[112:113], v8, s[4:7], s53 offen
  s_add_u32 s45, s45, 1
  s_add_u32 s56, s56, 262144
  s_add_u32 s46, s46, 8192
  s_add_u32 s36, s46, s55
  v_mov_b64 v[20:21], 0
  v_mov_b64 v[22:23], 0
  v_mov_b64 v[24:25], 0
  v_mov_b64 v[26:27], 0
  v_mov_b64 v[28:29], 0
  v_mov_b64 v[30:31], 0
  v_xor_b32 v4, 0x27000, v4
  v_xor_b32 v10, 0x35000, v10
  s_xor_b32 s50, s50, 2048
  s_xor_b32 s51, s51, 2048
  s_xor_b32 s52, s52, 2048
  s_xor_b32 s53, s53, 2048
  s_nop 7
  s_nop 7
  ds_read_b128 v[64:67], v2 offset:30720
  buffer_load_dwordx4 v[48:51], v9, s[4:7], s54 offen offset:0 sc1
  buffer_load_dwordx4 v[52:55], v9, s[4:7], s54 offen offset:1024 sc1
  s_nop 7
  s_nop 7
  s_nop 7
  s_waitcnt lgkmcnt(0)
K1_R0_W0M0_P1:
  buffer_load_dwordx4 v[56:59], v9, s[4:7], s54 offen offset:0 sc1
  buffer_load_dwordx4 v[60:63], v9, s[4:7], s54 offen offset:1024 sc1
  s_sub_u32 s57, s57, 1
  s_cbranch_scc1 K1_END
  s_waitcnt vmcnt(2)
  v_mfma_f32_16x16x32_bf16 v[68:71], v[64:67], v[48:51], 0
  v_mfma_f32_16x16x32_bf16 v[68:71], v[64:67], v[52:55], v[68:71]
  v_min3_u32 v12, v48, v49, v50
  v_min3_u32 v13, v51, v52, v53
  v_min3_u32 v12, v12, v54, v55
  v_min_u32 v12, v12, v13
  v_cmp_eq_u32 vcc, 0, v12
  s_nop 3
  s_cbranch_vccz K1_R0_W0M0_P1OK
  buffer_load_dwordx4 v[48:51], v9, s[4:7], s54 offen offset:0 sc1
  buffer_load_dwordx4 v[52:55], v9, s[4:7], s54 offen offset:1024 sc1
  s_waitcnt vmcnt(2)
  v_mfma_f32_16x16x32_bf16 v[68:71], v[64:67], v[56:59], 0
  v_mfma_f32_16x16x32_bf16 v[68:71], v[64:67], v[60:63], v[68:71]
  v_min3_u32 v12, v56, v57, v58
  v_min3_u32 v13, v59, v60, v61
  v_min3_u32 v12, v12, v62, v63
  v_min_u32 v12, v12, v13
  v_cmp_eq_u32 vcc, 0, v12
  s_nop 3
  s_cbranch_vccnz K1_R0_W0M0_P1
K1_R0_W0M0_P1OK:
  v_add_f32_dpp v68, v68, v68 row_ror:8 row_mask:0xf bank_mask:0xf
  v_add_f32_dpp v69, v69, v69 row_ror:8 row_mask:0xf bank_mask:0xf
  s_nop 0
  v_add_f32_dpp v68, v68, v68 row_ror:4 row_mask:0xf bank_mask:0xf
  v_add_f32_dpp v69, v69, v69 row_ror:4 row_mask:0xf bank_mask:0xf
  v_cvt_pk_bf16_f32 v68, v68, v69
  v_min_u32 v68, -2, v68
  s_mov_b64 exec, s[92:93]
  buffer_store_dword v68, v11, s[4:7], s36 offen
  s_mov_b64 exec, -1
  s_mov_b32 s47, s54
  s_xor_b32 s54, s54, 2048
  s_add_u32 s49, s49, 128
  v_cmp_ne_u32 vcc, 0, v15
  s_cmp_ge_u32 s45, 63
  s_nop 2
  s_cbranch_scc1 K1_R0_W0M0_LOOP
  s_cmp_eq_u64 vcc, exec
  s_cbranch_scc1 K1_R0_W0M0_FOK
  v_mov_b32 v68, 0
  s_mov_b32 s3, 0x100000
  s_branch WF4
WS4:
  s_sleep 1
WF4:
  buffer_load_dword v69, v68, s[4:7], s97 offen sc1
  s_sub_u32 s3, s3, 1
  s_cbranch_scc1 K1_END
  s_waitcnt vmcnt(0)
  v_cmp_eq_u32 vcc, 0, v69
  s_nop 3
  s_cbranch_vccnz WS4
K1_R0_W0M0_FOK:
  s_add_u32 s97, s97, 128
  s_branch K1_R0_W0M0_LOOP
K1_R0_W1M0:
  ds_read_b128 v[72:75], v1 offset:49152
  ds_read_b128 v[76:79], v1 offset:50176
  ds_read_b128 v[80:83], v1 offset:51200
  ds_read_b128 v[84:87], v1 offset:52224
  ds_read_b128 v[88:91], v1 offset:36864
  ds_read_b128 v[92:95], v1 offset:37888
  ds_read_b128 v[96:99], v1 offset:53248
  ds_read_b128 v[100:103], v1 offset:54272
  ds_read_b128 v[104:107], v1 offset:38912
  ds_read_b128 v[108:111], v1 offset:39936
  ds_read_b128 v[112:115], v1 offset:55296
  ds_read_b128 v[116:119], v1 offset:56320
  ds_read_b128 v[120:123], v1 offset:40960
  ds_read_b128 v[124:127], v1 offset:41984
  ds_read_b128 v[32:35], v1 offset:32768
  ds_read_b128 v[36:39], v1 offset:33792
  ds_read_b128 v[40:43], v1 offset:34816
  ds_read_b128 v[44:47], v1 offset:35840
  s_waitcnt lgkmcnt(0)
  ds_write_b128 v1, v[208:211] offset:49152
  ds_write_b128 v1, v[212:215] offset:50176
  ds_write_b128 v1, v[216:219] offset:51200
  ds_write_b128 v1, v[220:223] offset:52224
  ds_write_b128 v1, v[160:163] offset:36864
  ds_write_b128 v1, v[164:167] offset:37888
  ds_write_b128 v1, v[224:227] offset:53248
  ds_write_b128 v1, v[228:231] offset:54272
  ds_write_b128 v1, v[168:171] offset:38912
  ds_write_b128 v1, v[172:175] offset:39936
  ds_write_b128 v1, v[232:235] offset:55296
  ds_write_b128 v1, v[236:239] offset:56320
  ds_write_b128 v1, v[176:179] offset:40960
  ds_write_b128 v1, v[180:183] offset:41984
  s_waitcnt lgkmcnt(0)
  v_mov_b64 v[208:209], v[72:73]
  v_mov_b64 v[210:211], v[74:75]
  v_mov_b64 v[212:213], v[76:77]
  v_mov_b64 v[214:215], v[78:79]
  v_mov_b64 v[216:217], v[80:81]
  v_mov_b64 v[218:219], v[82:83]
  v_mov_b64 v[220:221], v[84:85]
  v_mov_b64 v[222:223], v[86:87]
  v_mov_b64 v[160:161], v[88:89]
  v_mov_b64 v[162:163], v[90:91]
  v_mov_b64 v[164:165], v[92:93]
  v_mov_b64 v[166:167], v[94:95]
  v_mov_b64 v[224:225], v[96:97]
  v_mov_b64 v[226:227], v[98:99]
  v_mov_b64 v[228:229], v[100:101]
  v_mov_b64 v[230:231], v[102:103]
  v_mov_b64 v[168:169], v[104:105]
  v_mov_b64 v[170:171], v[106:107]
  v_mov_b64 v[172:173], v[108:109]
  v_mov_b64 v[174:175], v[110:111]
  v_mov_b64 v[232:233], v[112:113]
  v_mov_b64 v[234:235], v[114:115]
  v_mov_b64 v[236:237], v[116:117]
  v_mov_b64 v[238:239], v[118:119]
  v_mov_b64 v[176:177], v[120:121]
  v_mov_b64 v[178:179], v[122:123]
  v_mov_b64 v[180:181], v[124:125]
  v_mov_b64 v[182:183], v[126:127]
  v_mov_b64 v[20:21], 0
  v_mov_b64 v[22:23], 0
  v_mov_b64 v[24:25], 0
  v_mov_b64 v[26:27], 0
  v_mov_b64 v[28:29], 0
  v_mov_b64 v[30:31], 0
  s_mov_b32 s42, 32768
  ds_read_b128 v[88:91], v1 offset:49152
  ds_read_b128 v[92:95], v1 offset:50176
  ds_read_b128 v[96:99], v1 offset:51200
  ds_read_b128 v[100:103], v1 offset:52224
  ds_read_b128 v[104:107], v1 offset:36864
  ds_read_b128 v[108:111], v1 offset:37888
  ds_read_b128 v[112:115], v1 offset:53248
  ds_read_b128 v[116:119], v1 offset:54272
  ds_read_b128 v[72:75], v1 offset:38912
  ds_read_b128 v[76:79], v1 offset:39936
  ds_read_b128 v[80:83], v1 offset:55296
  ds_read_b128 v[84:87], v1 offset:56320
  ds_read_b128 v[120:123], v1 offset:40960
  ds_read_b128 v[124:127], v1 offset:41984
  s_branch K1_R0_W1M0_P2OK
K1_R0_W1M0_LOOP:
  ds_read_b128 v[88:91], v1 offset:49152
  ds_read_b128 v[92:95], v1 offset:50176
  ds_read_b128 v[96:99], v1 offset:51200
  ds_read_b128 v[100:103], v1 offset:52224
  ds_read_b128 v[104:107], v1 offset:36864
  ds_read_b128 v[108:111], v1 offset:37888
  ds_read_b128 v[112:115], v1 offset:53248
  ds_read_b128 v[116:119], v1 offset:54272
  ds_read_b128 v[72:75], v1 offset:38912
  ds_read_b128 v[76:79], v1 offset:39936
  ds_read_b128 v[80:83], v1 offset:55296
  ds_read_b128 v[84:87], v1 offset:56320
  ds_read_b128 v[120:123], v1 offset:40960
  ds_read_b128 v[124:127], v1 offset:41984
  buffer_load_dwordx4 v[48:51], v9, s[4:7], s46 offen offset:0 sc1
  buffer_load_dwordx4 v[52:55], v9, s[4:7], s46 offen offset:1024 sc1
  s_nop 7
  s_nop 7
  s_nop 7
  s_nop 7
K1_R0_W1M0_P2:
  buffer_load_dwordx4 v[64:67], v9, s[4:7], s46 offen offset:0 sc1
  buffer_load_dwordx4 v[68:71], v9, s[4:7], s46 offen offset:1024 sc1
  s_sub_u32 s57, s57, 1
  s_cbranch_scc1 K1_END
  s_waitcnt vmcnt(2)
  v_max3_u32 v12, v48, v49, v50
  v_max3_u32 v13, v51, v52, v53
  v_max3_u32 v12, v12, v54, v55
  v_max_u32 v12, v12, v13
  v_cmp_eq_u32 vcc, -1, v12
  s_nop 3
  s_cbranch_vccz K1_R0_W1M0_P2OK
  buffer_load_dwordx4 v[48:51], v9, s[4:7], s46 offen offset:0 sc1
  buffer_load_dwordx4 v[52:55], v9, s[4:7], s46 offen offset:1024 sc1
  s_waitcnt vmcnt(2)
  v_max3_u32 v12, v64, v65, v66
  v_max3_u32 v13, v67, v68, v69
  v_max3_u32 v12, v12, v70, v71
  v_max_u32 v12, v12, v13
  v_cmp_eq_u32 vcc, -1, v12
  s_nop 3
  s_cbranch_vccnz K1_R0_W1M0_P2
  v_mov_b64 v[48:49], v[64:65]
  v_mov_b64 v[50:51], v[66:67]
  v_mov_b64 v[52:53], v[68:69]
  v_mov_b64 v[54:55], v[70:71]
  s_nop 1
K1_R0_W1M0_P2OK:
  ds_write_b128 v2, v[48:51] offset:18432
  ds_write_b128 v2, v[52:55] offset:19456
  v_smfmac_f32_16x16x64_bf16 v[20:23], v[48:51], v[144:151], v3
  s_add_u32 s38, s56, -126976
  v_mov_b32_dpp v56, v48 row_ror:8 row_mask:0xf bank_mask:0xf
  v_smfmac_f32_16x16x64_bf16 v[24:27], v[48:51], a[16:23], v3
  buffer_store_dwordx4 v[28:31], v9, s[4:7], s47 offen offset:0
  v_mov_b32_dpp v57, v49 row_ror:8 row_mask:0xf bank_mask:0xf
  v_smfmac_f32_16x16x64_bf16 v[20:23], v[52:55], v[152:159], v3
  buffer_store_dwordx4 v[28:31], v9, s[4:7], s47 offen offset:1024
  v_mov_b32_dpp v58, v50 row_ror:8 row_mask:0xf bank_mask:0xf
  v_smfmac_f32_16x16x64_bf16 v[24:27], v[52:55], a[24:31], v3
  v_mov_b32_dpp v59, v51 row_ror:8 row_mask:0xf bank_mask:0xf
  s_waitcnt vmcnt(2)
  v_smfmac_f32_16x16x64_bf16 v[28:31], v[48:51], a[144:151], v3
  ds_read_b64_tr_b16 v[64:65], v6 offset:27136
  ds_read_b64_tr_b16 v[66:67], v6 offset:27392
  v_mov_b32_dpp v60, v52 row_ror:8 row_mask:0xf bank_mask:0xf
  v_mov_b32_dpp v61, v53 row_ror:8 row_mask:0xf bank_mask:0xf
  v_smfmac_f32_16x16x64_bf16 v[28:31], v[52:55], a[152:159], v3
  ds_read_b64 v[68:69], v7 offset:29184
  v_mov_b32_dpp v62, v54 row_ror:8 row_mask:0xf bank_mask:0xf
  v_mov_b32_dpp v63, v55 row_ror:8 row_mask:0xf bank_mask:0xf
  s_waitcnt lgkmcnt(0)
  s_barrier
  buffer_store_dwordx4 v[64:67], v9, s[4:7], s56 offen offset:1024 sc1
  buffer_store_dwordx2 v[68:69], v7, s[4:7], s38 offen offset:512 sc1
  ds_read_b128 v[64:67], v2 offset:20480
  ds_read_b128 v[68:71], v0 offset:20480
  ds_read_b128 v[48:51], v2 offset:21504
  ds_read_b128 v[52:55], v0 offset:21504
  v_smfmac_f32_16x16x64_bf16 v[20:23], v[56:59], v[88:95], v3
  s_add_u32 s37, s46, s41
  s_mov_b64 exec, 0x1111
  buffer_load_dword v14, v9, s[4:7], s37 offen
  s_mov_b64 exec, -1
  v_smfmac_f32_16x16x64_bf16 v[24:27], v[56:59], a[80:87], v3
  v_smfmac_f32_16x16x64_bf16 v[28:31], v[56:59], a[208:215], v3
  v_smfmac_f32_16x16x64_bf16 v[20:23], v[60:63], v[96:103], v3
  v_smfmac_f32_16x16x64_bf16 v[24:27], v[60:63], a[88:95], v3
  v_smfmac_f32_16x16x64_bf16 v[28:31], v[60:63], a[216:223], v3
  s_waitcnt lgkmcnt(3)
  v_smfmac_f32_16x16x64_bf16 v[20:23], v[64:67], v[104:111], v3
  ds_read_b128 v[56:59], v2 offset:22528
  v_smfmac_f32_16x16x64_bf16 v[24:27], v[64:67], a[32:39], v3
  s_waitcnt lgkmcnt(3)
  v_smfmac_f32_16x16x64_bf16 v[20:23], v[68:71], v[112:119], v3
  ds_read_b128 v[60:63], v0 offset:22528
  v_smfmac_f32_16x16x64_bf16 v[24:27], v[68:71], a[96:103], v3
  s_waitcnt lgkmcnt(3)
  v_smfmac_f32_16x16x64_bf16 v[20:23], v[48:51], v[72:79], v3
  ds_read_b128 v[64:67], v2 offset:23552
  v_smfmac_f32_16x16x64_bf16 v[24:27], v[48:51], a[40:47], v3
  s_add_u32 s48, s48, 524288
  s_mov_b32 m0, s42
  s_xor_b32 s42, s42, 167936
  buffer_load_dwordx4 v9, s[4:7], s48 offen offset:0 lds
  buffer_load_dwordx4 v9, s[4:7], s48 offen offset:1024 lds
  buffer_load_dwordx4 v9, s[4:7], s48 offen offset:2048 lds
  buffer_load_dwordx4 v9, s[4:7], s48 offen offset:3072 lds
  s_waitcnt lgkmcnt(3)
  v_smfmac_f32_16x16x64_bf16 v[20:23], v[52:55], v[80:87], v3
  ds_read_b128 v[68:71], v0 offset:23552
  v_smfmac_f32_16x16x64_bf16 v[24:27], v[52:55], a[104:111], v3
  ds_read_b128 v[88:91], v4 offset:0
  s_waitcnt lgkmcnt(4)
  v_smfmac_f32_16x16x64_bf16 v[20:23], v[56:59], v[120:127], v3
  ds_read_b128 v[48:51], v2 offset:16384
  v_smfmac_f32_16x16x64_bf16 v[24:27], v[56:59], a[48:55], v3
  ds_read_b128 v[92:95], v4 offset:1024
  s_waitcnt lgkmcnt(5)
  v_smfmac_f32_16x16x64_bf16 v[20:23], v[60:63], v[240:247], v3
  ds_read_b128 v[52:55], v0 offset:16384
  v_smfmac_f32_16x16x64_bf16 v[24:27], v[60:63], a[112:119], v3
  ds_read_b128 v[96:99], v4 offset:2048
  s_waitcnt lgkmcnt(6)
  v_smfmac_f32_16x16x64_bf16 v[20:23], v[64:67], v[184:191], v3
  ds_read_b128 v[56:59], v2 offset:17408
  v_smfmac_f32_16x16x64_bf16 v[24:27], v[64:67], a[56:63], v3
  ds_read_b128 v[100:103], v4 offset:3072
  s_waitcnt lgkmcnt(7)
  v_smfmac_f32_16x16x64_bf16 v[20:23], v[68:71], v[248:255], v3
  ds_read_b128 v[60:63], v0 offset:17408
  v_smfmac_f32_16x16x64_bf16 v[24:27], v[68:71], a[120:127], v3
  ds_read_b128 v[104:107], v4 offset:4096
  s_waitcnt lgkmcnt(7)
  v_smfmac_f32_16x16x64_bf16 v[20:23], v[48:51], v[128:135], v3
  ds_read_b128 v[64:67], v2 offset:20480
  v_smfmac_f32_16x16x64_bf16 v[24:27], v[48:51], a[0:7], v3
  ds_read_b128 v[108:111], v4 offset:5120
  s_waitcnt lgkmcnt(7)
  v_smfmac_f32_16x16x64_bf16 v[20:23], v[52:55], v[192:199], v3
  ds_read_b128 v[68:71], v0 offset:20480
  v_smfmac_f32_16x16x64_bf16 v[24:27], v[52:55], a[64:71], v3
  ds_read_b128 v[112:115], v4 offset:6144
  s_waitcnt lgkmcnt(7)
  v_smfmac_f32_16x16x64_bf16 v[20:23], v[56:59], v[136:143], v3
  ds_read_b128 v[48:51], v2 offset:21504
  v_smfmac_f32_16x16x64_bf16 v[24:27], v[56:59], a[8:15], v3
  ds_read_b128 v[116:119], v4 offset:7168
  s_waitcnt lgkmcnt(7)
  v_smfmac_f32_16x16x64_bf16 v[20:23], v[60:63], v[200:207], v3
  ds_read_b128 v[52:55], v0 offset:21504
  v_smfmac_f32_16x16x64_bf16 v[24:27], v[60:63], a[72:79], v3
  s_waitcnt lgkmcnt(6)
  v_smfmac_f32_16x16x64_bf16 v[28:31], v[64:67], a[160:167], v3
  ds_read_b128 v[56:59], v2 offset:22528
  s_waitcnt lgkmcnt(5)
  v_smfmac_f32_16x16x64_bf16 v[28:31], v[68:71], a[224:231], v3
  ds_read_b128 v[60:63], v0 offset:22528
  s_waitcnt lgkmcnt(4)
  v_smfmac_f32_16x16x64_bf16 v[28:31], v[48:51], a[168:175], v3
  ds_read_b128 v[64:67], v2 offset:23552
  v_cvt_pk_bf16_f32 v12, v20, v21
  v_cvt_pk_bf16_f32 v13, v22, v23
  v_cvt_pk_bf16_f32 v24, v24, v25
  v_cvt_pk_bf16_f32 v25, v26, v27
  ds_write_b64 v5, v[12:13] offset:25088
  ds_write_b64 v5, v[24:25] offset:27136
  s_waitcnt lgkmcnt(5)
  v_smfmac_f32_16x16x64_bf16 v[28:31], v[52:55], a[232:239], v3
  ds_read_b128 v[68:71], v0 offset:23552
  s_waitcnt lgkmcnt(5)
  v_smfmac_f32_16x16x64_bf16 v[28:31], v[56:59], a[176:183], v3
  ds_read_b128 v[48:51], v2 offset:16384
  s_waitcnt lgkmcnt(5)
  v_smfmac_f32_16x16x64_bf16 v[28:31], v[60:63], a[240:247], v3
  ds_read_b128 v[52:55], v0 offset:16384
  s_waitcnt lgkmcnt(3)
  s_barrier
  v_smfmac_f32_16x16x64_bf16 v[28:31], v[64:67], a[184:191], v3
  ds_read_b64_tr_b16 v[72:73], v6 offset:24576
  ds_read_b64_tr_b16 v[74:75], v6 offset:24832
  ds_read_b64_tr_b16 v[76:77], v6 offset:25088
  ds_read_b64_tr_b16 v[78:79], v6 offset:25344
  ds_read_b128 v[56:59], v2 offset:17408
  s_waitcnt lgkmcnt(7)
  v_smfmac_f32_16x16x64_bf16 v[28:31], v[68:71], a[248:255], v3
  ds_read_b64_tr_b16 v[80:81], v6 offset:25600
  ds_read_b64_tr_b16 v[82:83], v6 offset:25856
  ds_read_b64_tr_b16 v[84:85], v6 offset:26112
  ds_read_b64_tr_b16 v[86:87], v6 offset:26368
  ds_read_b128 v[60:63], v0 offset:17408
  s_waitcnt lgkmcnt(11)
  v_smfmac_f32_16x16x64_bf16 v[28:31], v[48:51], a[128:135], v3
  ds_read_b64_tr_b16 v[64:65], v6 offset:26624
  ds_read_b64_tr_b16 v[66:67], v6 offset:26880
  s_waitcnt lgkmcnt(12)
  v_smfmac_f32_16x16x64_bf16 v[28:31], v[52:55], a[192:199], v3
  ds_read_b64_tr_b16 v[68:69], v6 offset:27136
  ds_read_b64_tr_b16 v[70:71], v6 offset:27392
  s_waitcnt lgkmcnt(9)
  v_smfmac_f32_16x16x64_bf16 v[28:31], v[56:59], a[136:143], v3
  ds_read_b64_tr_b16 v[48:49], v6 offset:27648
  ds_read_b64_tr_b16 v[50:51], v6 offset:27904
  s_waitcnt lgkmcnt(6)
  v_smfmac_f32_16x16x64_bf16 v[28:31], v[60:63], a[200:207], v3
  ds_read_b64_tr_b16 v[52:53], v6 offset:28160
  ds_read_b64_tr_b16 v[54:55], v6 offset:28416
  v_mfma_f32_16x16x32_bf16 v[120:123], v[88:91], v[72:75], 0
  v_mfma_f32_16x16x32_bf16 v[120:123], v[92:95], v[76:79], v[120:123]
  v_mfma_f32_16x16x32_bf16 v[120:123], v[96:99], v[80:83], v[120:123]
  v_mfma_f32_16x16x32_bf16 v[120:123], v[100:103], v[84:87], v[120:123]
  s_nop 1
  v_cvt_pk_bf16_f32 v28, v28, v29
  v_cvt_pk_bf16_f32 v29, v30, v31
  ds_write_b64 v7, v[28:29] offset:29184
  v_mfma_f32_16x16x32_bf16 v[124:127], v[104:107], v[72:75], 0
  ds_read_b128 v[88:91], v10 offset:0
  v_mfma_f32_16x16x32_bf16 v[124:127], v[108:111], v[76:79], v[124:127]
  ds_read_b128 v[92:95], v10 offset:1024
  v_mfma_f32_16x16x32_bf16 v[124:127], v[112:115], v[80:83], v[124:127]
  ds_read_b128 v[96:99], v10 offset:2048
  v_mfma_f32_16x16x32_bf16 v[124:127], v[116:119], v[84:87], v[124:127]
  ds_read_b128 v[100:103], v10 offset:3072
  v_max3_f32 v24, v120, v121, v122
  s_waitcnt lgkmcnt(5)
  v_mfma_f32_16x16x32_bf16 v[20:23], v[64:67], v[72:75], 0
  v_mfma_f32_16x16x32_bf16 v[20:23], v[68:71], v[76:79], v[20:23]
  v_mfma_f32_16x16x32_bf16 v[20:23], v[48:51], v[80:83], v[20:23]
  s_nop 1
  v_max3_f32 v24, v24, v123, v124
  v_max3_f32 v24, v24, v125, v126
  v_mfma_f32_16x16x32_bf16 v[20:23], v[52:55], v[84:87], v[20:23]
  ds_read_b128 v[48:51], v10 offset:4096
  ds_read_b128 v[52:55], v10 offset:5120
  ds_read_b128 v[56:59], v10 offset:6144
  ds_read_b128 v[60:63], v10 offset:7168
  ds_read_b128 v[64:67], v1 offset:57344
  ds_read_b128 v[68:71], v1 offset:58368
  s_nop 1
  v_max3_f32 v24, v24, v127, v20
  v_max3_f32 v24, v24, v21, v22
  v_max_f32 v12, v24, v23
  v_max_f32 v24, v24, v23
  s_cmp_eq_u32 s45, 63
  s_cbranch_scc1 K1_R0_FIN
  s_nop 0
  v_permlane16_swap_b32 v24, v12
  v_max_f32 v13, v24, v12
  v_max_f32 v24, v24, v12
  s_nop 1
  v_permlane32_swap_b32 v24, v13
  v_max_f32 v12, v24, v13
  v_pk_add_f32 v[120:121], v[120:121], v[12:13] op_sel_hi:[1,0] neg_lo:[0,1] neg_hi:[0,1]
  v_pk_add_f32 v[122:123], v[122:123], v[12:13] op_sel_hi:[1,0] neg_lo:[0,1] neg_hi:[0,1]
  v_pk_add_f32 v[124:125], v[124:125], v[12:13] op_sel_hi:[1,0] neg_lo:[0,1] neg_hi:[0,1]
  v_pk_add_f32 v[126:127], v[126:127], v[12:13] op_sel_hi:[1,0] neg_lo:[0,1] neg_hi:[0,1]
  v_pk_mul_f32 v[120:121], v[120:121], s[94:95]
  v_pk_mul_f32 v[122:123], v[122:123], s[94:95]
  v_pk_mul_f32 v[124:125], v[124:125], s[94:95]
  v_pk_mul_f32 v[126:127], v[126:127], s[94:95]
  v_exp_f32 v120, v120
  v_exp_f32 v121, v121
  v_exp_f32 v122, v122
  v_exp_f32 v123, v123
  v_exp_f32 v124, v124
  v_exp_f32 v125, v125
  v_exp_f32 v126, v126
  v_exp_f32 v127, v127
  v_cvt_pk_bf16_f32 v24, v120, v121
  v_cvt_pk_bf16_f32 v25, v122, v123
  v_cvt_pk_bf16_f32 v26, v124, v125
  v_cvt_pk_bf16_f32 v27, v126, v127
  v_cndmask_b32 v72, 0, v24, s[58:59]
  v_cndmask_b32 v73, 0, v25, s[58:59]
  v_cndmask_b32 v74, 0, v26, s[58:59]
  v_cndmask_b32 v75, 0, v27, s[58:59]
  v_cndmask_b32 v76, 0, v24, s[60:61]
  v_cndmask_b32 v77, 0, v25, s[60:61]
  v_cndmask_b32 v78, 0, v26, s[60:61]
  v_cndmask_b32 v79, 0, v27, s[60:61]
  s_waitcnt lgkmcnt(2)
  s_barrier
  v_mfma_f32_16x16x32_bf16 v[84:87], v[16:19], v[24:27], 0
  ds_read_b64 v[120:121], v7 offset:28672
  ds_read_b64 v[122:123], v7 offset:29184
  v_sub_f32 v20, v20, v12
  v_sub_f32 v21, v21, v12
  v_mfma_f32_16x16x32_bf16 v[104:107], v[88:91], v[72:75], 0
  ds_read_b64 v[124:125], v7 offset:29696
  ds_read_b64 v[126:127], v7 offset:30208
  v_sub_f32 v22, v22, v12
  v_sub_f32 v23, v23, v12
  v_mfma_f32_16x16x32_bf16 v[104:107], v[92:95], v[76:79], v[104:107]
  s_nop 0
  s_nop 0
  v_mul_f32 v20, s94, v20
  v_mul_f32 v21, s94, v21
  v_mfma_f32_16x16x32_bf16 v[108:111], v[96:99], v[72:75], 0
  ds_read_b128 v[88:91], v1 offset:43008
  ds_read_b128 v[92:95], v1 offset:44032
  v_mul_f32 v22, s94, v22
  v_mul_f32 v23, s94, v23
  v_mfma_f32_16x16x32_bf16 v[108:111], v[100:103], v[76:79], v[108:111]
  ds_read_b128 v[96:99], v1 offset:59392
  ds_read_b128 v[100:103], v1 offset:60416
  v_exp_f32 v20, v20
  v_exp_f32 v21, v21
  v_mfma_f32_16x16x32_bf16 v[112:115], v[48:51], v[72:75], 0
  v_exp_f32 v22, v22
  v_exp_f32 v23, v23
  v_mfma_f32_16x16x32_bf16 v[112:115], v[52:55], v[76:79], v[112:115]
  v_cvt_pk_bf16_f32 v12, v20, v21
  v_cvt_pk_bf16_f32 v13, v22, v23
  v_mfma_f32_16x16x32_bf16 v[116:119], v[56:59], v[72:75], 0
  v_cndmask_b32 v80, 0, v12, s[62:63]
  v_cndmask_b32 v81, 0, v13, s[62:63]
  v_mfma_f32_16x16x32_bf16 v[116:119], v[60:63], v[76:79], v[116:119]
  s_waitcnt lgkmcnt(4)
  v_mfma_f32_16x16x16_bf16 v[84:87], v[16:17], v[80:81], v[84:87]
  ds_read_b128 v[48:51], v1 offset:45056
  ds_read_b128 v[52:55], v1 offset:46080
  v_mov_b64 v[20:21], 0
  v_mov_b64 v[22:23], 0
  v_mfma_f32_16x16x16_bf16 v[104:107], v[120:121], v[80:81], v[104:107]
  ds_read_b128 v[56:59], v1 offset:61440
  ds_read_b128 v[60:63], v1 offset:62464
  v_mov_b64 v[24:25], 0
  v_mov_b64 v[26:27], 0
  v_mfma_f32_16x16x16_bf16 v[108:111], v[122:123], v[80:81], v[108:111]
  v_mov_b64 v[28:29], 0
  v_mov_b64 v[30:31], 0
  v_mfma_f32_16x16x16_bf16 v[112:115], v[124:125], v[80:81], v[112:115]
  v_mfma_f32_16x16x16_bf16 v[116:119], v[126:127], v[80:81], v[116:119]
  ds_read_b128 v[120:123], v1 offset:47104
  ds_read_b128 v[124:127], v1 offset:48128
  v_rcp_f32 v12, v84
  s_nop 0
  v_pk_mul_f32 v[104:105], v[104:105], v[12:13] op_sel_hi:[1,0]
  v_pk_mul_f32 v[106:107], v[106:107], v[12:13] op_sel_hi:[1,0]
  v_pk_mul_f32 v[108:109], v[108:109], v[12:13] op_sel_hi:[1,0]
  v_pk_mul_f32 v[110:111], v[110:111], v[12:13] op_sel_hi:[1,0]
  v_pk_mul_f32 v[112:113], v[112:113], v[12:13] op_sel_hi:[1,0]
  v_pk_mul_f32 v[114:115], v[114:115], v[12:13] op_sel_hi:[1,0]
  v_pk_mul_f32 v[116:117], v[116:117], v[12:13] op_sel_hi:[1,0]
  v_pk_mul_f32 v[118:119], v[118:119], v[12:13] op_sel_hi:[1,0]
  v_cvt_pk_bf16_f32 v72, v104, v105
  v_cvt_pk_bf16_f32 v73, v106, v107
  v_cvt_pk_bf16_f32 v74, v108, v109
  v_cvt_pk_bf16_f32 v75, v110, v111
  v_cvt_pk_bf16_f32 v76, v112, v113
  v_cvt_pk_bf16_f32 v77, v114, v115
  v_cvt_pk_bf16_f32 v78, v116, v117
  v_cvt_pk_bf16_f32 v79, v118, v119
  v_smfmac_f32_16x16x64_bf16 v[20:23], v[72:75], v[32:39], v3
  ds_read_b128 v[104:107], v1 offset:63488
  ds_read_b128 v[108:111], v1 offset:64512
  v_mov_b32_dpp v80, v72 row_ror:8 row_mask:0xf bank_mask:0xf
  v_mov_b32_dpp v81, v73 row_ror:8 row_mask:0xf bank_mask:0xf
  v_mov_b32_dpp v82, v74 row_ror:8 row_mask:0xf bank_mask:0xf
  v_mov_b32_dpp v83, v75 row_ror:8 row_mask:0xf bank_mask:0xf
  v_smfmac_f32_16x16x64_bf16 v[20:23], v[76:79], v[208:215], v3
  v_mov_b32_dpp v84, v76 row_ror:8 row_mask:0xf bank_mask:0xf
  v_mov_b32_dpp v85, v77 row_ror:8 row_mask:0xf bank_mask:0xf
  v_mov_b32_dpp v86, v78 row_ror:8 row_mask:0xf bank_mask:0xf
  v_mov_b32_dpp v87, v79 row_ror:8 row_mask:0xf bank_mask:0xf
  v_smfmac_f32_16x16x64_bf16 v[20:23], v[80:83], v[40:47], v3
  v_mov_b64 v[112:113], 0
  v_smfmac_f32_16x16x64_bf16 v[20:23], v[84:87], v[216:223], v3
  v_mov_b64 v[114:115], 0
  v_smfmac_f32_16x16x64_bf16 v[24:27], v[72:75], v[160:167], v3
  v_smfmac_f32_16x16x64_bf16 v[24:27], v[76:79], v[224:231], v3
  s_nop 4
  v_cvt_pk_bf16_f32 v20, v20, v21
  v_cvt_pk_bf16_f32 v21, v22, v23
  v_smfmac_f32_16x16x64_bf16 v[24:27], v[80:83], v[168:175], v3
  v_max_u32 v20, 1, v20
  v_max_u32 v21, 1, v21
  s_waitcnt lgkmcnt(2)
  v_smfmac_f32_16x16x64_bf16 v[24:27], v[84:87], v[232:239], v3
  buffer_store_dwordx2 v[20:21], v8, s[4:7], s50 offen
  v_smfmac_f32_16x16x64_bf16 v[28:31], v[72:75], v[176:183], v3
  v_smfmac_f32_16x16x64_bf16 v[28:31], v[76:79], v[64:71], v3
  s_nop 4
  v_cvt_pk_bf16_f32 v24, v24, v25
  v_cvt_pk_bf16_f32 v25, v26, v27
  v_smfmac_f32_16x16x64_bf16 v[28:31], v[80:83], v[88:95], v3
  v_max_u32 v24, 1, v24
  v_max_u32 v25, 1, v25
  v_smfmac_f32_16x16x64_bf16 v[28:31], v[84:87], v[96:103], v3
  buffer_store_dwordx2 v[24:25], v8, s[4:7], s51 offen
  v_smfmac_f32_16x16x64_bf16 v[112:115], v[72:75], v[48:55], v3
  v_smfmac_f32_16x16x64_bf16 v[112:115], v[76:79], v[56:63], v3
  s_nop 4
  v_cvt_pk_bf16_f32 v28, v28, v29
  v_cvt_pk_bf16_f32 v29, v30, v31
  s_waitcnt lgkmcnt(0)
  v_smfmac_f32_16x16x64_bf16 v[112:115], v[80:83], v[120:127], v3
  v_max_u32 v28, 1, v28
  v_max_u32 v29, 1, v29
  v_smfmac_f32_16x16x64_bf16 v[112:115], v[84:87], v[104:111], v3
  buffer_store_dwordx2 v[28:29], v8, s[4:7], s52 offen
  s_nop 6
  v_cvt_pk_bf16_f32 v112, v112, v113
  v_cvt_pk_bf16_f32 v113, v114, v115
  v_max_u32 v112, 1, v112
  v_max_u32 v113, 1, v113
  buffer_store_dwordx2 v[112:113], v8, s[4:7], s53 offen
  s_add_u32 s45, s45, 1
  s_add_u32 s56, s56, 262144
  s_add_u32 s46, s46, 8192
  s_add_u32 s36, s46, s55
  v_mov_b64 v[20:21], 0
  v_mov_b64 v[22:23], 0
  v_mov_b64 v[24:25], 0
  v_mov_b64 v[26:27], 0
  v_mov_b64 v[28:29], 0
  v_mov_b64 v[30:31], 0
  v_xor_b32 v4, 0x27000, v4
  v_xor_b32 v10, 0x35000, v10
  s_xor_b32 s50, s50, 2048
  s_xor_b32 s51, s51, 2048
  s_xor_b32 s52, s52, 2048
  s_xor_b32 s53, s53, 2048
  s_nop 7
  s_nop 7
  ds_read_b128 v[64:67], v2 offset:30720
  buffer_load_dwordx4 v[48:51], v9, s[4:7], s54 offen offset:0 sc1
  buffer_load_dwordx4 v[52:55], v9, s[4:7], s54 offen offset:1024 sc1
  s_nop 7
  s_nop 7
  s_nop 7
  s_waitcnt lgkmcnt(0)
K1_R0_W1M0_P1:
  buffer_load_dwordx4 v[56:59], v9, s[4:7], s54 offen offset:0 sc1
  buffer_load_dwordx4 v[60:63], v9, s[4:7], s54 offen offset:1024 sc1
  s_sub_u32 s57, s57, 1
  s_cbranch_scc1 K1_END
  s_waitcnt vmcnt(2)
  v_mfma_f32_16x16x32_bf16 v[68:71], v[64:67], v[48:51], 0
  v_mfma_f32_16x16x32_bf16 v[68:71], v[64:67], v[52:55], v[68:71]
  v_min3_u32 v12, v48, v49, v50
  v_min3_u32 v13, v51, v52, v53
  v_min3_u32 v12, v12, v54, v55
  v_min_u32 v12, v12, v13
  v_cmp_eq_u32 vcc, 0, v12
  s_nop 3
  s_cbranch_vccz K1_R0_W1M0_P1OK
  buffer_load_dwordx4 v[48:51], v9, s[4:7], s54 offen offset:0 sc1
  buffer_load_dwordx4 v[52:55], v9, s[4:7], s54 offen offset:1024 sc1
  s_waitcnt vmcnt(2)
  v_mfma_f32_16x16x32_bf16 v[68:71], v[64:67], v[56:59], 0
  v_mfma_f32_16x16x32_bf16 v[68:71], v[64:67], v[60:63], v[68:71]
  v_min3_u32 v12, v56, v57, v58
  v_min3_u32 v13, v59, v60, v61
  v_min3_u32 v12, v12, v62, v63
  v_min_u32 v12, v12, v13
  v_cmp_eq_u32 vcc, 0, v12
  s_nop 3
  s_cbranch_vccnz K1_R0_W1M0_P1
K1_R0_W1M0_P1OK:
  v_add_f32_dpp v68, v68, v68 row_ror:8 row_mask:0xf bank_mask:0xf
  v_add_f32_dpp v69, v69, v69 row_ror:8 row_mask:0xf bank_mask:0xf
  s_nop 0
  v_add_f32_dpp v68, v68, v68 row_ror:4 row_mask:0xf bank_mask:0xf
  v_add_f32_dpp v69, v69, v69 row_ror:4 row_mask:0xf bank_mask:0xf
  v_cvt_pk_bf16_f32 v68, v68, v69
  v_min_u32 v68, -2, v68
  s_mov_b64 exec, s[92:93]
  buffer_store_dword v68, v11, s[4:7], s36 offen
  s_mov_b64 exec, -1
  s_mov_b32 s47, s54
  s_xor_b32 s54, s54, 2048
  s_add_u32 s49, s49, 128
  s_branch K1_R0_W1M0_LOOP
K1_R0_W2M0:
  ds_read_b128 v[72:75], v1 offset:0
  ds_read_b128 v[76:79], v1 offset:1024
  ds_read_b128 v[80:83], v1 offset:16384
  ds_read_b128 v[84:87], v1 offset:17408
  ds_read_b128 v[88:91], v1 offset:2048
  ds_read_b128 v[92:95], v1 offset:3072
  ds_read_b128 v[96:99], v1 offset:18432
  ds_read_b128 v[100:103], v1 offset:19456
  ds_read_b128 v[104:107], v1 offset:4096
  ds_read_b128 v[108:111], v1 offset:5120
  ds_read_b128 v[112:115], v1 offset:20480
  ds_read_b128 v[116:119], v1 offset:21504
  ds_read_b128 v[120:123], v1 offset:6144
  ds_read_b128 v[124:127], v1 offset:7168
  ds_read_b128 v[32:35], v1 offset:28672
  ds_read_b128 v[36:39], v1 offset:29696
  ds_read_b128 v[40:43], v1 offset:30720
  ds_read_b128 v[44:47], v1 offset:31744
  s_waitcnt lgkmcnt(0)
  ds_write_b128 v1, v[224:227] offset:0
  ds_write_b128 v1, v[228:231] offset:1024
  ds_write_b128 v1, v[232:235] offset:16384
  ds_write_b128 v1, v[236:239] offset:17408
  ds_write_b128 v1, v[176:179] offset:2048
  ds_write_b128 v1, v[180:183] offset:3072
  ds_write_b128 v1, v[240:243] offset:18432
  ds_write_b128 v1, v[244:247] offset:19456
  ds_write_b128 v1, v[184:187] offset:4096
  ds_write_b128 v1, v[188:191] offset:5120
  ds_write_b128 v1, v[248:251] offset:20480
  ds_write_b128 v1, v[252:255] offset:21504
  ds_write_b128 v1, v[128:131] offset:6144
  ds_write_b128 v1, v[132:135] offset:7168
  s_waitcnt lgkmcnt(0)
  v_mov_b64 v[224:225], v[72:73]
  v_mov_b64 v[226:227], v[74:75]
  v_mov_b64 v[228:229], v[76:77]
  v_mov_b64 v[230:231], v[78:79]
  v_mov_b64 v[232:233], v[80:81]
  v_mov_b64 v[234:235], v[82:83]
  v_mov_b64 v[236:237], v[84:85]
  v_mov_b64 v[238:239], v[86:87]
  v_mov_b64 v[176:177], v[88:89]
  v_mov_b64 v[178:179], v[90:91]
  v_mov_b64 v[180:181], v[92:93]
  v_mov_b64 v[182:183], v[94:95]
  v_mov_b64 v[240:241], v[96:97]
  v_mov_b64 v[242:243], v[98:99]
  v_mov_b64 v[244:245], v[100:101]
  v_mov_b64 v[246:247], v[102:103]
  v_mov_b64 v[184:185], v[104:105]
  v_mov_b64 v[186:187], v[106:107]
  v_mov_b64 v[188:189], v[108:109]
  v_mov_b64 v[190:191], v[110:111]
  v_mov_b64 v[248:249], v[112:113]
  v_mov_b64 v[250:251], v[114:115]
  v_mov_b64 v[252:253], v[116:117]
  v_mov_b64 v[254:255], v[118:119]
  v_mov_b64 v[128:129], v[120:121]
  v_mov_b64 v[130:131], v[122:123]
  v_mov_b64 v[132:133], v[124:125]
  v_mov_b64 v[134:135], v[126:127]
  v_mov_b64 v[20:21], 0
  v_mov_b64 v[22:23], 0
  v_mov_b64 v[24:25], 0
  v_mov_b64 v[26:27], 0
  v_mov_b64 v[28:29], 0
  v_mov_b64 v[30:31], 0
  s_mov_b32 s42, 94208
  ds_read_b128 v[88:91], v1 offset:0
  ds_read_b128 v[92:95], v1 offset:1024
  ds_read_b128 v[96:99], v1 offset:16384
  ds_read_b128 v[100:103], v1 offset:17408
  ds_read_b128 v[104:107], v1 offset:2048
  ds_read_b128 v[108:111], v1 offset:3072
  ds_read_b128 v[112:115], v1 offset:18432
  ds_read_b128 v[116:119], v1 offset:19456
  ds_read_b128 v[72:75], v1 offset:4096
  ds_read_b128 v[76:79], v1 offset:5120
  ds_read_b128 v[80:83], v1 offset:20480
  ds_read_b128 v[84:87], v1 offset:21504
  ds_read_b128 v[120:123], v1 offset:6144
  ds_read_b128 v[124:127], v1 offset:7168
  s_branch K1_R0_W2M0_P2OK
K1_R0_W2M0_LOOP:
  ds_read_b128 v[88:91], v1 offset:0
  ds_read_b128 v[92:95], v1 offset:1024
  ds_read_b128 v[96:99], v1 offset:16384
  ds_read_b128 v[100:103], v1 offset:17408
  ds_read_b128 v[104:107], v1 offset:2048
  ds_read_b128 v[108:111], v1 offset:3072
  ds_read_b128 v[112:115], v1 offset:18432
  ds_read_b128 v[116:119], v1 offset:19456
  ds_read_b128 v[72:75], v1 offset:4096
  ds_read_b128 v[76:79], v1 offset:5120
  ds_read_b128 v[80:83], v1 offset:20480
  ds_read_b128 v[84:87], v1 offset:21504
  ds_read_b128 v[120:123], v1 offset:6144
  ds_read_b128 v[124:127], v1 offset:7168
  buffer_load_dwordx4 v[48:51], v9, s[4:7], s46 offen offset:0 sc1
  buffer_load_dwordx4 v[52:55], v9, s[4:7], s46 offen offset:1024 sc1
  s_nop 7
  s_nop 7
  s_nop 7
  s_nop 7
K1_R0_W2M0_P2:
  buffer_load_dwordx4 v[64:67], v9, s[4:7], s46 offen offset:0 sc1
  buffer_load_dwordx4 v[68:71], v9, s[4:7], s46 offen offset:1024 sc1
  s_sub_u32 s57, s57, 1
  s_cbranch_scc1 K1_END
  s_waitcnt vmcnt(2)
  v_max3_u32 v12, v48, v49, v50
  v_max3_u32 v13, v51, v52, v53
  v_max3_u32 v12, v12, v54, v55
  v_max_u32 v12, v12, v13
  v_cmp_eq_u32 vcc, -1, v12
  s_nop 3
  s_cbranch_vccz K1_R0_W2M0_P2OK
  buffer_load_dwordx4 v[48:51], v9, s[4:7], s46 offen offset:0 sc1
  buffer_load_dwordx4 v[52:55], v9, s[4:7], s46 offen offset:1024 sc1
  s_waitcnt vmcnt(2)
  v_max3_u32 v12, v64, v65, v66
  v_max3_u32 v13, v67, v68, v69
  v_max3_u32 v12, v12, v70, v71
  v_max_u32 v12, v12, v13
  v_cmp_eq_u32 vcc, -1, v12
  s_nop 3
  s_cbranch_vccnz K1_R0_W2M0_P2
  v_mov_b64 v[48:49], v[64:65]
  v_mov_b64 v[50:51], v[66:67]
  v_mov_b64 v[52:53], v[68:69]
  v_mov_b64 v[54:55], v[70:71]
  s_nop 1
K1_R0_W2M0_P2OK:
  ds_write_b128 v2, v[48:51] offset:20480
  ds_write_b128 v2, v[52:55] offset:21504
  v_smfmac_f32_16x16x64_bf16 v[20:23], v[48:51], v[160:167], v3
  s_add_u32 s38, s56, -126976
  v_mov_b32_dpp v56, v48 row_ror:8 row_mask:0xf bank_mask:0xf
  v_smfmac_f32_16x16x64_bf16 v[24:27], v[48:51], a[32:39], v3
  buffer_store_dwordx4 v[28:31], v9, s[4:7], s47 offen offset:0
  v_mov_b32_dpp v57, v49 row_ror:8 row_mask:0xf bank_mask:0xf
  v_smfmac_f32_16x16x64_bf16 v[20:23], v[52:55], v[168:175], v3
  buffer_store_dwordx4 v[28:31], v9, s[4:7], s47 offen offset:1024
  v_mov_b32_dpp v58, v50 row_ror:8 row_mask:0xf bank_mask:0xf
  v_smfmac_f32_16x16x64_bf16 v[24:27], v[52:55], a[40:47], v3
  v_mov_b32_dpp v59, v51 row_ror:8 row_mask:0xf bank_mask:0xf
  s_waitcnt vmcnt(2)
  v_smfmac_f32_16x16x64_bf16 v[28:31], v[48:51], a[160:167], v3
  ds_read_b64_tr_b16 v[64:65], v6 offset:27648
  ds_read_b64_tr_b16 v[66:67], v6 offset:27904
  v_mov_b32_dpp v60, v52 row_ror:8 row_mask:0xf bank_mask:0xf
  v_mov_b32_dpp v61, v53 row_ror:8 row_mask:0xf bank_mask:0xf
  v_smfmac_f32_16x16x64_bf16 v[28:31], v[52:55], a[168:175], v3
  ds_read_b64 v[68:69], v7 offset:29696
  v_mov_b32_dpp v62, v54 row_ror:8 row_mask:0xf bank_mask:0xf
  v_mov_b32_dpp v63, v55 row_ror:8 row_mask:0xf bank_mask:0xf
  s_waitcnt lgkmcnt(0)
  s_barrier
  buffer_store_dwordx4 v[64:67], v9, s[4:7], s56 offen offset:2048 sc1
  buffer_store_dwordx2 v[68:69], v7, s[4:7], s38 offen offset:1024 sc1
  ds_read_b128 v[64:67], v2 offset:22528
  ds_read_b128 v[68:71], v0 offset:22528
  ds_read_b128 v[48:51], v2 offset:23552
  ds_read_b128 v[52:55], v0 offset:23552
  v_smfmac_f32_16x16x64_bf16 v[20:23], v[56:59], v[88:95], v3
  v_smfmac_f32_16x16x64_bf16 v[24:27], v[56:59], a[96:103], v3
  v_smfmac_f32_16x16x64_bf16 v[28:31], v[56:59], a[224:231], v3
  v_smfmac_f32_16x16x64_bf16 v[20:23], v[60:63], v[96:103], v3
  v_smfmac_f32_16x16x64_bf16 v[24:27], v[60:63], a[104:111], v3
  v_smfmac_f32_16x16x64_bf16 v[28:31], v[60:63], a[232:239], v3
  s_waitcnt lgkmcnt(3)
  v_smfmac_f32_16x16x64_bf16 v[20:23], v[64:67], v[104:111], v3
  ds_read_b128 v[56:59], v2 offset:16384
  v_smfmac_f32_16x16x64_bf16 v[24:27], v[64:67], a[48:55], v3
  s_waitcnt lgkmcnt(3)
  v_smfmac_f32_16x16x64_bf16 v[20:23], v[68:71], v[112:119], v3
  ds_read_b128 v[60:63], v0 offset:16384
  v_smfmac_f32_16x16x64_bf16 v[24:27], v[68:71], a[112:119], v3
  s_waitcnt lgkmcnt(3)
  v_smfmac_f32_16x16x64_bf16 v[20:23], v[48:51], v[72:79], v3
  ds_read_b128 v[64:67], v2 offset:17408
  v_smfmac_f32_16x16x64_bf16 v[24:27], v[48:51], a[56:63], v3
  s_waitcnt lgkmcnt(3)
  v_smfmac_f32_16x16x64_bf16 v[20:23], v[52:55], v[80:87], v3
  ds_read_b128 v[68:71], v0 offset:17408
  v_smfmac_f32_16x16x64_bf16 v[24:27], v[52:55], a[120:127], v3
  ds_read_b128 v[88:91], v4 offset:0
  s_waitcnt lgkmcnt(4)
  v_smfmac_f32_16x16x64_bf16 v[20:23], v[56:59], v[120:127], v3
  ds_read_b128 v[48:51], v2 offset:18432
  v_smfmac_f32_16x16x64_bf16 v[24:27], v[56:59], a[0:7], v3
  ds_read_b128 v[92:95], v4 offset:1024
  s_waitcnt lgkmcnt(5)
  v_smfmac_f32_16x16x64_bf16 v[20:23], v[60:63], v[192:199], v3
  ds_read_b128 v[52:55], v0 offset:18432
  v_smfmac_f32_16x16x64_bf16 v[24:27], v[60:63], a[64:71], v3
  ds_read_b128 v[96:99], v4 offset:2048
  s_add_u32 s48, s48, 524288
  s_mov_b32 m0, s42
  s_xor_b32 s42, s42, 217088
  buffer_load_dwordx4 v9, s[4:7], s48 offen offset:0 lds
  buffer_load_dwordx4 v9, s[4:7], s48 offen offset:1024 lds
  buffer_load_dwordx4 v9, s[4:7], s48 offen offset:2048 lds
  buffer_load_dwordx4 v9, s[4:7], s48 offen offset:3072 lds
  s_waitcnt lgkmcnt(6)
  v_smfmac_f32_16x16x64_bf16 v[20:23], v[64:67], v[136:143], v3
  ds_read_b128 v[56:59], v2 offset:19456
  v_smfmac_f32_16x16x64_bf16 v[24:27], v[64:67], a[8:15], v3
  ds_read_b128 v[100:103], v4 offset:3072
  s_waitcnt lgkmcnt(7)
  v_smfmac_f32_16x16x64_bf16 v[20:23], v[68:71], v[200:207], v3
  ds_read_b128 v[60:63], v0 offset:19456
  v_smfmac_f32_16x16x64_bf16 v[24:27], v[68:71], a[72:79], v3
  ds_read_b128 v[104:107], v4 offset:4096
  s_waitcnt lgkmcnt(7)
  v_smfmac_f32_16x16x64_bf16 v[20:23], v[48:51], v[144:151], v3
  ds_read_b128 v[64:67], v2 offset:22528
  v_smfmac_f32_16x16x64_bf16 v[24:27], v[48:51], a[16:23], v3
  ds_read_b128 v[108:111], v4 offset:5120
  s_waitcnt lgkmcnt(7)
  v_smfmac_f32_16x16x64_bf16 v[20:23], v[52:55], v[208:215], v3
  ds_read_b128 v[68:71], v0 offset:22528
  v_smfmac_f32_16x16x64_bf16 v[24:27], v[52:55], a[80:87], v3
  ds_read_b128 v[112:115], v4 offset:6144
  s_waitcnt lgkmcnt(7)
  v_smfmac_f32_16x16x64_bf16 v[20:23], v[56:59], v[152:159], v3
  ds_read_b128 v[48:51], v2 offset:23552
  v_smfmac_f32_16x16x64_bf16 v[24:27], v[56:59], a[24:31], v3
  ds_read_b128 v[116:119], v4 offset:7168
  s_waitcnt lgkmcnt(7)
  v_smfmac_f32_16x16x64_bf16 v[20:23], v[60:63], v[216:223], v3
  ds_read_b128 v[52:55], v0 offset:23552
  v_smfmac_f32_16x16x64_bf16 v[24:27], v[60:63], a[88:95], v3
  s_waitcnt lgkmcnt(6)
  v_smfmac_f32_16x16x64_bf16 v[28:31], v[64:67], a[176:183], v3
  ds_read_b128 v[56:59], v2 offset:16384
  s_waitcnt lgkmcnt(5)
  v_smfmac_f32_16x16x64_bf16 v[28:31], v[68:71], a[240:247], v3
  ds_read_b128 v[60:63], v0 offset:16384
  s_waitcnt lgkmcnt(4)
  v_smfmac_f32_16x16x64_bf16 v[28:31], v[48:51], a[184:191], v3
  ds_read_b128 v[64:67], v2 offset:17408
  v_cvt_pk_bf16_f32 v12, v20, v21
  v_cvt_pk_bf16_f32 v13, v22, v23
  v_cvt_pk_bf16_f32 v24, v24, v25
  v_cvt_pk_bf16_f32 v25, v26, v27
  ds_write_b64 v5, v[12:13] offset:25600
  ds_write_b64 v5, v[24:25] offset:27648
  s_waitcnt lgkmcnt(5)
  v_smfmac_f32_16x16x64_bf16 v[28:31], v[52:55], a[248:255], v3
  ds_read_b128 v[68:71], v0 offset:17408
  s_waitcnt lgkmcnt(5)
  v_smfmac_f32_16x16x64_bf16 v[28:31], v[56:59], a[128:135], v3
  ds_read_b128 v[48:51], v2 offset:18432
  s_waitcnt lgkmcnt(5)
  v_smfmac_f32_16x16x64_bf16 v[28:31], v[60:63], a[192:199], v3
  ds_read_b128 v[52:55], v0 offset:18432
  s_waitcnt lgkmcnt(3)
  s_barrier
  v_smfmac_f32_16x16x64_bf16 v[28:31], v[64:67], a[136:143], v3
  ds_read_b64_tr_b16 v[72:73], v6 offset:24576
  ds_read_b64_tr_b16 v[74:75], v6 offset:24832
  ds_read_b64_tr_b16 v[76:77], v6 offset:25088
  ds_read_b64_tr_b16 v[78:79], v6 offset:25344
  ds_read_b128 v[56:59], v2 offset:19456
  s_waitcnt lgkmcnt(7)
  v_smfmac_f32_16x16x64_bf16 v[28:31], v[68:71], a[200:207], v3
  ds_read_b64_tr_b16 v[80:81], v6 offset:25600
  ds_read_b64_tr_b16 v[82:83], v6 offset:25856
  ds_read_b64_tr_b16 v[84:85], v6 offset:26112
  ds_read_b64_tr_b16 v[86:87], v6 offset:26368
  ds_read_b128 v[60:63], v0 offset:19456
  s_waitcnt lgkmcnt(11)
  v_smfmac_f32_16x16x64_bf16 v[28:31], v[48:51], a[144:151], v3
  ds_read_b64_tr_b16 v[64:65], v6 offset:26624
  ds_read_b64_tr_b16 v[66:67], v6 offset:26880
  s_waitcnt lgkmcnt(12)
  v_smfmac_f32_16x16x64_bf16 v[28:31], v[52:55], a[208:215], v3
  ds_read_b64_tr_b16 v[68:69], v6 offset:27136
  ds_read_b64_tr_b16 v[70:71], v6 offset:27392
  s_waitcnt lgkmcnt(9)
  v_smfmac_f32_16x16x64_bf16 v[28:31], v[56:59], a[152:159], v3
  ds_read_b64_tr_b16 v[48:49], v6 offset:27648
  ds_read_b64_tr_b16 v[50:51], v6 offset:27904
  s_waitcnt lgkmcnt(6)
  v_smfmac_f32_16x16x64_bf16 v[28:31], v[60:63], a[216:223], v3
  ds_read_b64_tr_b16 v[52:53], v6 offset:28160
  ds_read_b64_tr_b16 v[54:55], v6 offset:28416
  v_mfma_f32_16x16x32_bf16 v[120:123], v[88:91], v[72:75], 0
  v_mfma_f32_16x16x32_bf16 v[120:123], v[92:95], v[76:79], v[120:123]
  v_mfma_f32_16x16x32_bf16 v[120:123], v[96:99], v[80:83], v[120:123]
  v_mfma_f32_16x16x32_bf16 v[120:123], v[100:103], v[84:87], v[120:123]
  s_nop 1
  v_cvt_pk_bf16_f32 v28, v28, v29
  v_cvt_pk_bf16_f32 v29, v30, v31
  ds_write_b64 v7, v[28:29] offset:29696
  v_mfma_f32_16x16x32_bf16 v[124:127], v[104:107], v[72:75], 0
  ds_read_b128 v[88:91], v10 offset:0
  v_mfma_f32_16x16x32_bf16 v[124:127], v[108:111], v[76:79], v[124:127]
  ds_read_b128 v[92:95], v10 offset:1024
  v_mfma_f32_16x16x32_bf16 v[124:127], v[112:115], v[80:83], v[124:127]
  ds_read_b128 v[96:99], v10 offset:2048
  v_mfma_f32_16x16x32_bf16 v[124:127], v[116:119], v[84:87], v[124:127]
  ds_read_b128 v[100:103], v10 offset:3072
  v_max3_f32 v24, v120, v121, v122
  s_waitcnt lgkmcnt(5)
  v_mfma_f32_16x16x32_bf16 v[20:23], v[64:67], v[72:75], 0
  v_mfma_f32_16x16x32_bf16 v[20:23], v[68:71], v[76:79], v[20:23]
  v_mfma_f32_16x16x32_bf16 v[20:23], v[48:51], v[80:83], v[20:23]
  s_nop 1
  v_max3_f32 v24, v24, v123, v124
  v_max3_f32 v24, v24, v125, v126
  v_mfma_f32_16x16x32_bf16 v[20:23], v[52:55], v[84:87], v[20:23]
  ds_read_b128 v[48:51], v10 offset:4096
  ds_read_b128 v[52:55], v10 offset:5120
  ds_read_b128 v[56:59], v10 offset:6144
  ds_read_b128 v[60:63], v10 offset:7168
  ds_read_b128 v[64:67], v1 offset:22528
  ds_read_b128 v[68:71], v1 offset:23552
  s_nop 1
  v_max3_f32 v24, v24, v127, v20
  v_max3_f32 v24, v24, v21, v22
  v_max_f32 v12, v24, v23
  v_max_f32 v24, v24, v23
  s_cmp_eq_u32 s45, 63
  s_cbranch_scc1 K1_R0_FIN
  s_nop 0
  v_permlane16_swap_b32 v24, v12
  v_max_f32 v13, v24, v12
  v_max_f32 v24, v24, v12
  s_nop 1
  v_permlane32_swap_b32 v24, v13
  v_max_f32 v12, v24, v13
  v_pk_add_f32 v[120:121], v[120:121], v[12:13] op_sel_hi:[1,0] neg_lo:[0,1] neg_hi:[0,1]
  v_pk_add_f32 v[122:123], v[122:123], v[12:13] op_sel_hi:[1,0] neg_lo:[0,1] neg_hi:[0,1]
  v_pk_add_f32 v[124:125], v[124:125], v[12:13] op_sel_hi:[1,0] neg_lo:[0,1] neg_hi:[0,1]
  v_pk_add_f32 v[126:127], v[126:127], v[12:13] op_sel_hi:[1,0] neg_lo:[0,1] neg_hi:[0,1]
  v_pk_mul_f32 v[120:121], v[120:121], s[94:95]
  v_pk_mul_f32 v[122:123], v[122:123], s[94:95]
  v_pk_mul_f32 v[124:125], v[124:125], s[94:95]
  v_pk_mul_f32 v[126:127], v[126:127], s[94:95]
  v_exp_f32 v120, v120
  v_exp_f32 v121, v121
  v_exp_f32 v122, v122
  v_exp_f32 v123, v123
  v_exp_f32 v124, v124
  v_exp_f32 v125, v125
  v_exp_f32 v126, v126
  v_exp_f32 v127, v127
  v_cvt_pk_bf16_f32 v24, v120, v121
  v_cvt_pk_bf16_f32 v25, v122, v123
  v_cvt_pk_bf16_f32 v26, v124, v125
  v_cvt_pk_bf16_f32 v27, v126, v127
  v_cndmask_b32 v72, 0, v24, s[58:59]
  v_cndmask_b32 v73, 0, v25, s[58:59]
  v_cndmask_b32 v74, 0, v26, s[58:59]
  v_cndmask_b32 v75, 0, v27, s[58:59]
  v_cndmask_b32 v76, 0, v24, s[60:61]
  v_cndmask_b32 v77, 0, v25, s[60:61]
  v_cndmask_b32 v78, 0, v26, s[60:61]
  v_cndmask_b32 v79, 0, v27, s[60:61]
  s_waitcnt lgkmcnt(2)
  s_barrier
  v_mfma_f32_16x16x32_bf16 v[84:87], v[16:19], v[24:27], 0
  ds_read_b64 v[120:121], v7 offset:28672
  ds_read_b64 v[122:123], v7 offset:29184
  v_sub_f32 v20, v20, v12
  v_sub_f32 v21, v21, v12
  v_mfma_f32_16x16x32_bf16 v[104:107], v[88:91], v[72:75], 0
  ds_read_b64 v[124:125], v7 offset:29696
  ds_read_b64 v[126:127], v7 offset:30208
  v_sub_f32 v22, v22, v12
  v_sub_f32 v23, v23, v12
  v_mfma_f32_16x16x32_bf16 v[104:107], v[92:95], v[76:79], v[104:107]
  s_nop 0
  s_nop 0
  v_mul_f32 v20, s94, v20
  v_mul_f32 v21, s94, v21
  v_mfma_f32_16x16x32_bf16 v[108:111], v[96:99], v[72:75], 0
  ds_read_b128 v[88:91], v1 offset:8192
  ds_read_b128 v[92:95], v1 offset:9216
  v_mul_f32 v22, s94, v22
  v_mul_f32 v23, s94, v23
  v_mfma_f32_16x16x32_bf16 v[108:111], v[100:103], v[76:79], v[108:111]
  ds_read_b128 v[96:99], v1 offset:24576
  ds_read_b128 v[100:103], v1 offset:25600
  v_exp_f32 v20, v20
  v_exp_f32 v21, v21
  v_mfma_f32_16x16x32_bf16 v[112:115], v[48:51], v[72:75], 0
  v_exp_f32 v22, v22
  v_exp_f32 v23, v23
  v_mfma_f32_16x16x32_bf16 v[112:115], v[52:55], v[76:79], v[112:115]
  v_cvt_pk_bf16_f32 v12, v20, v21
  v_cvt_pk_bf16_f32 v13, v22, v23
  v_mfma_f32_16x16x32_bf16 v[116:119], v[56:59], v[72:75], 0
  v_cndmask_b32 v80, 0, v12, s[62:63]
  v_cndmask_b32 v81, 0, v13, s[62:63]
  v_mfma_f32_16x16x32_bf16 v[116:119], v[60:63], v[76:79], v[116:119]
  s_waitcnt lgkmcnt(4)
  v_mfma_f32_16x16x16_bf16 v[84:87], v[16:17], v[80:81], v[84:87]
  ds_read_b128 v[48:51], v1 offset:10240
  ds_read_b128 v[52:55], v1 offset:11264
  v_mov_b64 v[20:21], 0
  v_mov_b64 v[22:23], 0
  v_mfma_f32_16x16x16_bf16 v[104:107], v[120:121], v[80:81], v[104:107]
  ds_read_b128 v[56:59], v1 offset:26624
  ds_read_b128 v[60:63], v1 offset:27648
  v_mov_b64 v[24:25], 0
  v_mov_b64 v[26:27], 0
  v_mfma_f32_16x16x16_bf16 v[108:111], v[122:123], v[80:81], v[108:111]
  v_mov_b64 v[28:29], 0
  v_mov_b64 v[30:31], 0
  v_mfma_f32_16x16x16_bf16 v[112:115], v[124:125], v[80:81], v[112:115]
  v_mfma_f32_16x16x16_bf16 v[116:119], v[126:127], v[80:81], v[116:119]
  ds_read_b128 v[120:123], v1 offset:12288
  ds_read_b128 v[124:127], v1 offset:13312
  v_rcp_f32 v12, v84
  s_nop 0
  v_pk_mul_f32 v[104:105], v[104:105], v[12:13] op_sel_hi:[1,0]
  v_pk_mul_f32 v[106:107], v[106:107], v[12:13] op_sel_hi:[1,0]
  v_pk_mul_f32 v[108:109], v[108:109], v[12:13] op_sel_hi:[1,0]
  v_pk_mul_f32 v[110:111], v[110:111], v[12:13] op_sel_hi:[1,0]
  v_pk_mul_f32 v[112:113], v[112:113], v[12:13] op_sel_hi:[1,0]
  v_pk_mul_f32 v[114:115], v[114:115], v[12:13] op_sel_hi:[1,0]
  v_pk_mul_f32 v[116:117], v[116:117], v[12:13] op_sel_hi:[1,0]
  v_pk_mul_f32 v[118:119], v[118:119], v[12:13] op_sel_hi:[1,0]
  v_cvt_pk_bf16_f32 v72, v104, v105
  v_cvt_pk_bf16_f32 v73, v106, v107
  v_cvt_pk_bf16_f32 v74, v108, v109
  v_cvt_pk_bf16_f32 v75, v110, v111
  v_cvt_pk_bf16_f32 v76, v112, v113
  v_cvt_pk_bf16_f32 v77, v114, v115
  v_cvt_pk_bf16_f32 v78, v116, v117
  v_cvt_pk_bf16_f32 v79, v118, v119
  v_smfmac_f32_16x16x64_bf16 v[20:23], v[72:75], v[224:231], v3
  ds_read_b128 v[104:107], v1 offset:14336
  ds_read_b128 v[108:111], v1 offset:15360
  v_mov_b32_dpp v80, v72 row_ror:8 row_mask:0xf bank_mask:0xf
  v_mov_b32_dpp v81, v73 row_ror:8 row_mask:0xf bank_mask:0xf
  v_mov_b32_dpp v82, v74 row_ror:8 row_mask:0xf bank_mask:0xf
  v_mov_b32_dpp v83, v75 row_ror:8 row_mask:0xf bank_mask:0xf
  v_smfmac_f32_16x16x64_bf16 v[20:23], v[76:79], v[232:239], v3
  v_mov_b32_dpp v84, v76 row_ror:8 row_mask:0xf bank_mask:0xf
  v_mov_b32_dpp v85, v77 row_ror:8 row_mask:0xf bank_mask:0xf
  v_mov_b32_dpp v86, v78 row_ror:8 row_mask:0xf bank_mask:0xf
  v_mov_b32_dpp v87, v79 row_ror:8 row_mask:0xf bank_mask:0xf
  v_smfmac_f32_16x16x64_bf16 v[20:23], v[80:83], v[176:183], v3
  v_mov_b64 v[112:113], 0
  v_smfmac_f32_16x16x64_bf16 v[20:23], v[84:87], v[240:247], v3
  v_mov_b64 v[114:115], 0
  v_smfmac_f32_16x16x64_bf16 v[24:27], v[72:75], v[184:191], v3
  v_smfmac_f32_16x16x64_bf16 v[24:27], v[76:79], v[248:255], v3
  s_nop 4
  v_cvt_pk_bf16_f32 v20, v20, v21
  v_cvt_pk_bf16_f32 v21, v22, v23
  v_smfmac_f32_16x16x64_bf16 v[24:27], v[80:83], v[128:135], v3
  v_max_u32 v20, 1, v20
  v_max_u32 v21, 1, v21
  s_waitcnt lgkmcnt(2)
  v_smfmac_f32_16x16x64_bf16 v[24:27], v[84:87], v[64:71], v3
  buffer_store_dwordx2 v[20:21], v8, s[4:7], s50 offen
  v_smfmac_f32_16x16x64_bf16 v[28:31], v[72:75], v[88:95], v3
  v_smfmac_f32_16x16x64_bf16 v[28:31], v[76:79], v[96:103], v3
  s_nop 4
  v_cvt_pk_bf16_f32 v24, v24, v25
  v_cvt_pk_bf16_f32 v25, v26, v27
  v_smfmac_f32_16x16x64_bf16 v[28:31], v[80:83], v[48:55], v3
  v_max_u32 v24, 1, v24
  v_max_u32 v25, 1, v25
  v_smfmac_f32_16x16x64_bf16 v[28:31], v[84:87], v[56:63], v3
  buffer_store_dwordx2 v[24:25], v8, s[4:7], s51 offen
  v_smfmac_f32_16x16x64_bf16 v[112:115], v[72:75], v[120:127], v3
  v_smfmac_f32_16x16x64_bf16 v[112:115], v[76:79], v[32:39], v3
  s_nop 4
  v_cvt_pk_bf16_f32 v28, v28, v29
  v_cvt_pk_bf16_f32 v29, v30, v31
  s_waitcnt lgkmcnt(0)
  v_smfmac_f32_16x16x64_bf16 v[112:115], v[80:83], v[104:111], v3
  v_max_u32 v28, 1, v28
  v_max_u32 v29, 1, v29
  v_smfmac_f32_16x16x64_bf16 v[112:115], v[84:87], v[40:47], v3
  buffer_store_dwordx2 v[28:29], v8, s[4:7], s52 offen
  s_nop 6
  v_cvt_pk_bf16_f32 v112, v112, v113
  v_cvt_pk_bf16_f32 v113, v114, v115
  v_max_u32 v112, 1, v112
  v_max_u32 v113, 1, v113
  buffer_store_dwordx2 v[112:113], v8, s[4:7], s53 offen
  s_add_u32 s45, s45, 1
  s_add_u32 s56, s56, 262144
  s_add_u32 s46, s46, 8192
  s_add_u32 s36, s46, s55
  v_mov_b64 v[20:21], 0
  v_mov_b64 v[22:23], 0
  v_mov_b64 v[24:25], 0
  v_mov_b64 v[26:27], 0
  v_mov_b64 v[28:29], 0
  v_mov_b64 v[30:31], 0
  v_xor_b32 v4, 0x27000, v4
  v_xor_b32 v10, 0x35000, v10
  s_xor_b32 s50, s50, 2048
  s_xor_b32 s51, s51, 2048
  s_xor_b32 s52, s52, 2048
  s_xor_b32 s53, s53, 2048
  s_nop 7
  s_nop 7
  ds_read_b128 v[64:67], v2 offset:30720
  buffer_load_dwordx4 v[48:51], v9, s[4:7], s54 offen offset:0 sc1
  buffer_load_dwordx4 v[52:55], v9, s[4:7], s54 offen offset:1024 sc1
  s_nop 7
  s_nop 7
  s_nop 7
  s_waitcnt lgkmcnt(0)
K1_R0_W2M0_P1:
  buffer_load_dwordx4 v[56:59], v9, s[4:7], s54 offen offset:0 sc1
  buffer_load_dwordx4 v[60:63], v9, s[4:7], s54 offen offset:1024 sc1
  s_sub_u32 s57, s57, 1
  s_cbranch_scc1 K1_END
  s_waitcnt vmcnt(2)
  v_mfma_f32_16x16x32_bf16 v[68:71], v[64:67], v[48:51], 0
  v_mfma_f32_16x16x32_bf16 v[68:71], v[64:67], v[52:55], v[68:71]
  v_min3_u32 v12, v48, v49, v50
  v_min3_u32 v13, v51, v52, v53
  v_min3_u32 v12, v12, v54, v55
  v_min_u32 v12, v12, v13
  v_cmp_eq_u32 vcc, 0, v12
  s_nop 3
  s_cbranch_vccz K1_R0_W2M0_P1OK
  buffer_load_dwordx4 v[48:51], v9, s[4:7], s54 offen offset:0 sc1
  buffer_load_dwordx4 v[52:55], v9, s[4:7], s54 offen offset:1024 sc1
  s_waitcnt vmcnt(2)
  v_mfma_f32_16x16x32_bf16 v[68:71], v[64:67], v[56:59], 0
  v_mfma_f32_16x16x32_bf16 v[68:71], v[64:67], v[60:63], v[68:71]
  v_min3_u32 v12, v56, v57, v58
  v_min3_u32 v13, v59, v60, v61
  v_min3_u32 v12, v12, v62, v63
  v_min_u32 v12, v12, v13
  v_cmp_eq_u32 vcc, 0, v12
  s_nop 3
  s_cbranch_vccnz K1_R0_W2M0_P1
K1_R0_W2M0_P1OK:
  v_add_f32_dpp v68, v68, v68 row_ror:8 row_mask:0xf bank_mask:0xf
  v_add_f32_dpp v69, v69, v69 row_ror:8 row_mask:0xf bank_mask:0xf
  s_nop 0
  v_add_f32_dpp v68, v68, v68 row_ror:4 row_mask:0xf bank_mask:0xf
  v_add_f32_dpp v69, v69, v69 row_ror:4 row_mask:0xf bank_mask:0xf
  v_cvt_pk_bf16_f32 v68, v68, v69
  v_min_u32 v68, -2, v68
  s_mov_b64 exec, s[92:93]
  buffer_store_dword v68, v11, s[4:7], s36 offen
  s_mov_b64 exec, -1
  s_mov_b32 s47, s54
  s_xor_b32 s54, s54, 2048
  s_add_u32 s49, s49, 128
  s_branch K1_R0_W2M0_LOOP
K1_R0_W3M0:
  ds_read_b128 v[72:75], v1 offset:49152
  ds_read_b128 v[76:79], v1 offset:50176
  ds_read_b128 v[80:83], v1 offset:51200
  ds_read_b128 v[84:87], v1 offset:52224
  ds_read_b128 v[88:91], v1 offset:36864
  ds_read_b128 v[92:95], v1 offset:37888
  ds_read_b128 v[96:99], v1 offset:53248
  ds_read_b128 v[100:103], v1 offset:54272
  ds_read_b128 v[104:107], v1 offset:38912
  ds_read_b128 v[108:111], v1 offset:39936
  ds_read_b128 v[112:115], v1 offset:55296
  ds_read_b128 v[116:119], v1 offset:56320
  ds_read_b128 v[120:123], v1 offset:40960
  ds_read_b128 v[124:127], v1 offset:41984
  ds_read_b128 v[32:35], v1 offset:32768
  ds_read_b128 v[36:39], v1 offset:33792
  ds_read_b128 v[40:43], v1 offset:34816
  ds_read_b128 v[44:47], v1 offset:35840
  s_waitcnt lgkmcnt(0)
  ds_write_b128 v1, v[240:243] offset:49152
  ds_write_b128 v1, v[244:247] offset:50176
  ds_write_b128 v1, v[248:251] offset:51200
  ds_write_b128 v1, v[252:255] offset:52224
  ds_write_b128 v1, v[128:131] offset:36864
  ds_write_b128 v1, v[132:135] offset:37888
  ds_write_b128 v1, v[192:195] offset:53248
  ds_write_b128 v1, v[196:199] offset:54272
  ds_write_b128 v1, v[136:139] offset:38912
  ds_write_b128 v1, v[140:143] offset:39936
  ds_write_b128 v1, v[200:203] offset:55296
  ds_write_b128 v1, v[204:207] offset:56320
  ds_write_b128 v1, v[144:147] offset:40960
  ds_write_b128 v1, v[148:151] offset:41984
  s_waitcnt lgkmcnt(0)
  v_mov_b64 v[240:241], v[72:73]
  v_mov_b64 v[242:243], v[74:75]
  v_mov_b64 v[244:245], v[76:77]
  v_mov_b64 v[246:247], v[78:79]
  v_mov_b64 v[248:249], v[80:81]
  v_mov_b64 v[250:251], v[82:83]
  v_mov_b64 v[252:253], v[84:85]
  v_mov_b64 v[254:255], v[86:87]
  v_mov_b64 v[128:129], v[88:89]
  v_mov_b64 v[130:131], v[90:91]
  v_mov_b64 v[132:133], v[92:93]
  v_mov_b64 v[134:135], v[94:95]
  v_mov_b64 v[192:193], v[96:97]
  v_mov_b64 v[194:195], v[98:99]
  v_mov_b64 v[196:197], v[100:101]
  v_mov_b64 v[198:199], v[102:103]
  v_mov_b64 v[136:137], v[104:105]
  v_mov_b64 v[138:139], v[106:107]
  v_mov_b64 v[140:141], v[108:109]
  v_mov_b64 v[142:143], v[110:111]
  v_mov_b64 v[200:201], v[112:113]
  v_mov_b64 v[202:203], v[114:115]
  v_mov_b64 v[204:205], v[116:117]
  v_mov_b64 v[206:207], v[118:119]
  v_mov_b64 v[144:145], v[120:121]
  v_mov_b64 v[146:147], v[122:123]
  v_mov_b64 v[148:149], v[124:125]
  v_mov_b64 v[150:151], v[126:127]
  v_mov_b64 v[20:21], 0
  v_mov_b64 v[22:23], 0
  v_mov_b64 v[24:25], 0
  v_mov_b64 v[26:27], 0
  v_mov_b64 v[28:29], 0
  v_mov_b64 v[30:31], 0
  s_mov_b32 s42, 98304
  ds_read_b128 v[88:91], v1 offset:49152
  ds_read_b128 v[92:95], v1 offset:50176
  ds_read_b128 v[96:99], v1 offset:51200
  ds_read_b128 v[100:103], v1 offset:52224
  ds_read_b128 v[104:107], v1 offset:36864
  ds_read_b128 v[108:111], v1 offset:37888
  ds_read_b128 v[112:115], v1 offset:53248
  ds_read_b128 v[116:119], v1 offset:54272
  ds_read_b128 v[72:75], v1 offset:38912
  ds_read_b128 v[76:79], v1 offset:39936
  ds_read_b128 v[80:83], v1 offset:55296
  ds_read_b128 v[84:87], v1 offset:56320
  ds_read_b128 v[120:123], v1 offset:40960
  ds_read_b128 v[124:127], v1 offset:41984
  s_branch K1_R0_W3M0_P2OK
K1_R0_W3M0_LOOP:
  ds_read_b128 v[88:91], v1 offset:49152
  ds_read_b128 v[92:95], v1 offset:50176
  ds_read_b128 v[96:99], v1 offset:51200
  ds_read_b128 v[100:103], v1 offset:52224
  ds_read_b128 v[104:107], v1 offset:36864
  ds_read_b128 v[108:111], v1 offset:37888
  ds_read_b128 v[112:115], v1 offset:53248
  ds_read_b128 v[116:119], v1 offset:54272
  ds_read_b128 v[72:75], v1 offset:38912
  ds_read_b128 v[76:79], v1 offset:39936
  ds_read_b128 v[80:83], v1 offset:55296
  ds_read_b128 v[84:87], v1 offset:56320
  ds_read_b128 v[120:123], v1 offset:40960
  ds_read_b128 v[124:127], v1 offset:41984
  buffer_load_dwordx4 v[48:51], v9, s[4:7], s46 offen offset:0 sc1
  buffer_load_dwordx4 v[52:55], v9, s[4:7], s46 offen offset:1024 sc1
  s_nop 7
  s_nop 7
  s_nop 7
  s_nop 7
K1_R0_W3M0_P2:
  buffer_load_dwordx4 v[64:67], v9, s[4:7], s46 offen offset:0 sc1
  buffer_load_dwordx4 v[68:71], v9, s[4:7], s46 offen offset:1024 sc1
  s_sub_u32 s57, s57, 1
  s_cbranch_scc1 K1_END
  s_waitcnt vmcnt(2)
  v_max3_u32 v12, v48, v49, v50
  v_max3_u32 v13, v51, v52, v53
  v_max3_u32 v12, v12, v54, v55
  v_max_u32 v12, v12, v13
  v_cmp_eq_u32 vcc, -1, v12
  s_nop 3
  s_cbranch_vccz K1_R0_W3M0_P2OK
  buffer_load_dwordx4 v[48:51], v9, s[4:7], s46 offen offset:0 sc1
  buffer_load_dwordx4 v[52:55], v9, s[4:7], s46 offen offset:1024 sc1
  s_waitcnt vmcnt(2)
  v_max3_u32 v12, v64, v65, v66
  v_max3_u32 v13, v67, v68, v69
  v_max3_u32 v12, v12, v70, v71
  v_max_u32 v12, v12, v13
  v_cmp_eq_u32 vcc, -1, v12
  s_nop 3
  s_cbranch_vccnz K1_R0_W3M0_P2
  v_mov_b64 v[48:49], v[64:65]
  v_mov_b64 v[50:51], v[66:67]
  v_mov_b64 v[52:53], v[68:69]
  v_mov_b64 v[54:55], v[70:71]
  s_nop 1
K1_R0_W3M0_P2OK:
  ds_write_b128 v2, v[48:51] offset:22528
  ds_write_b128 v2, v[52:55] offset:23552
  v_smfmac_f32_16x16x64_bf16 v[20:23], v[48:51], v[176:183], v3
  s_add_u32 s38, s56, -126976
  v_mov_b32_dpp v56, v48 row_ror:8 row_mask:0xf bank_mask:0xf
  v_smfmac_f32_16x16x64_bf16 v[24:27], v[48:51], a[48:55], v3
  buffer_store_dwordx4 v[28:31], v9, s[4:7], s47 offen offset:0
  v_mov_b32_dpp v57, v49 row_ror:8 row_mask:0xf bank_mask:0xf
  v_smfmac_f32_16x16x64_bf16 v[20:23], v[52:55], v[184:191], v3
  buffer_store_dwordx4 v[28:31], v9, s[4:7], s47 offen offset:1024
  v_mov_b32_dpp v58, v50 row_ror:8 row_mask:0xf bank_mask:0xf
  v_smfmac_f32_16x16x64_bf16 v[24:27], v[52:55], a[56:63], v3
  v_mov_b32_dpp v59, v51 row_ror:8 row_mask:0xf bank_mask:0xf
  s_waitcnt vmcnt(2)
  v_smfmac_f32_16x16x64_bf16 v[28:31], v[48:51], a[176:183], v3
  ds_read_b64_tr_b16 v[64:65], v6 offset:28160
  ds_read_b64_tr_b16 v[66:67], v6 offset:28416
  v_mov_b32_dpp v60, v52 row_ror:8 row_mask:0xf bank_mask:0xf
  v_mov_b32_dpp v61, v53 row_ror:8 row_mask:0xf bank_mask:0xf
  v_smfmac_f32_16x16x64_bf16 v[28:31], v[52:55], a[184:191], v3
  ds_read_b64 v[68:69], v7 offset:30208
  v_mov_b32_dpp v62, v54 row_ror:8 row_mask:0xf bank_mask:0xf
  v_mov_b32_dpp v63, v55 row_ror:8 row_mask:0xf bank_mask:0xf
  s_waitcnt lgkmcnt(0)
  s_barrier
  buffer_store_dwordx4 v[64:67], v9, s[4:7], s56 offen offset:3072 sc1
  buffer_store_dwordx2 v[68:69], v7, s[4:7], s38 offen offset:1536 sc1
  ds_read_b128 v[64:67], v2 offset:16384
  ds_read_b128 v[68:71], v0 offset:16384
  ds_read_b128 v[48:51], v2 offset:17408
  ds_read_b128 v[52:55], v0 offset:17408
  v_smfmac_f32_16x16x64_bf16 v[20:23], v[56:59], v[88:95], v3
  v_smfmac_f32_16x16x64_bf16 v[24:27], v[56:59], a[112:119], v3
  v_smfmac_f32_16x16x64_bf16 v[28:31], v[56:59], a[240:247], v3
  v_smfmac_f32_16x16x64_bf16 v[20:23], v[60:63], v[96:103], v3
  v_smfmac_f32_16x16x64_bf16 v[24:27], v[60:63], a[120:127], v3
  v_smfmac_f32_16x16x64_bf16 v[28:31], v[60:63], a[248:255], v3
  s_waitcnt lgkmcnt(3)
  v_smfmac_f32_16x16x64_bf16 v[20:23], v[64:67], v[104:111], v3
  ds_read_b128 v[56:59], v2 offset:18432
  v_smfmac_f32_16x16x64_bf16 v[24:27], v[64:67], a[0:7], v3
  s_waitcnt lgkmcnt(3)
  v_smfmac_f32_16x16x64_bf16 v[20:23], v[68:71], v[112:119], v3
  ds_read_b128 v[60:63], v0 offset:18432
  v_smfmac_f32_16x16x64_bf16 v[24:27], v[68:71], a[64:71], v3
  s_waitcnt lgkmcnt(3)
  v_smfmac_f32_16x16x64_bf16 v[20:23], v[48:51], v[72:79], v3
  ds_read_b128 v[64:67], v2 offset:19456
  v_smfmac_f32_16x16x64_bf16 v[24:27], v[48:51], a[8:15], v3
  s_waitcnt lgkmcnt(3)
  v_smfmac_f32_16x16x64_bf16 v[20:23], v[52:55], v[80:87], v3
  ds_read_b128 v[68:71], v0 offset:19456
  v_smfmac_f32_16x16x64_bf16 v[24:27], v[52:55], a[72:79], v3
  ds_read_b128 v[88:91], v4 offset:0
  s_waitcnt lgkmcnt(4)
  v_smfmac_f32_16x16x64_bf16 v[20:23], v[56:59], v[120:127], v3
  ds_read_b128 v[48:51], v2 offset:20480
  v_smfmac_f32_16x16x64_bf16 v[24:27], v[56:59], a[16:23], v3
  ds_read_b128 v[92:95], v4 offset:1024
  s_waitcnt lgkmcnt(5)
  v_smfmac_f32_16x16x64_bf16 v[20:23], v[60:63], v[208:215], v3
  ds_read_b128 v[52:55], v0 offset:20480
  v_smfmac_f32_16x16x64_bf16 v[24:27], v[60:63], a[80:87], v3
  ds_read_b128 v[96:99], v4 offset:2048
  s_waitcnt lgkmcnt(6)
  v_smfmac_f32_16x16x64_bf16 v[20:23], v[64:67], v[152:159], v3
  ds_read_b128 v[56:59], v2 offset:21504
  v_smfmac_f32_16x16x64_bf16 v[24:27], v[64:67], a[24:31], v3
  ds_read_b128 v[100:103], v4 offset:3072
  s_waitcnt lgkmcnt(7)
  v_smfmac_f32_16x16x64_bf16 v[20:23], v[68:71], v[216:223], v3
  ds_read_b128 v[60:63], v0 offset:21504
  v_smfmac_f32_16x16x64_bf16 v[24:27], v[68:71], a[88:95], v3
  ds_read_b128 v[104:107], v4 offset:4096
  s_waitcnt lgkmcnt(7)
  v_smfmac_f32_16x16x64_bf16 v[20:23], v[48:51], v[160:167], v3
  ds_read_b128 v[64:67], v2 offset:16384
  v_smfmac_f32_16x16x64_bf16 v[24:27], v[48:51], a[32:39], v3
  ds_read_b128 v[108:111], v4 offset:5120
  s_add_u32 s48, s48, 524288
  s_mov_b32 m0, s42
  s_xor_b32 s42, s42, 241664
  buffer_load_dwordx4 v9, s[4:7], s48 offen offset:0 lds
  buffer_load_dwordx4 v9, s[4:7], s48 offen offset:1024 lds
  buffer_load_dwordx4 v9, s[4:7], s48 offen offset:2048 lds
  buffer_load_dwordx4 v9, s[4:7], s48 offen offset:3072 lds
  s_waitcnt lgkmcnt(7)
  v_smfmac_f32_16x16x64_bf16 v[20:23], v[52:55], v[224:231], v3
  ds_read_b128 v[68:71], v0 offset:16384
  v_smfmac_f32_16x16x64_bf16 v[24:27], v[52:55], a[96:103], v3
  ds_read_b128 v[112:115], v4 offset:6144
  s_waitcnt lgkmcnt(7)
  v_smfmac_f32_16x16x64_bf16 v[20:23], v[56:59], v[168:175], v3
  ds_read_b128 v[48:51], v2 offset:17408
  v_smfmac_f32_16x16x64_bf16 v[24:27], v[56:59], a[40:47], v3
  ds_read_b128 v[116:119], v4 offset:7168
  s_waitcnt lgkmcnt(7)
  v_smfmac_f32_16x16x64_bf16 v[20:23], v[60:63], v[232:239], v3
  ds_read_b128 v[52:55], v0 offset:17408
  v_smfmac_f32_16x16x64_bf16 v[24:27], v[60:63], a[104:111], v3
  s_waitcnt lgkmcnt(6)
  v_smfmac_f32_16x16x64_bf16 v[28:31], v[64:67], a[128:135], v3
  ds_read_b128 v[56:59], v2 offset:18432
  s_waitcnt lgkmcnt(5)
  v_smfmac_f32_16x16x64_bf16 v[28:31], v[68:71], a[192:199], v3
  ds_read_b128 v[60:63], v0 offset:18432
  s_waitcnt lgkmcnt(4)
  v_smfmac_f32_16x16x64_bf16 v[28:31], v[48:51], a[136:143], v3
  ds_read_b128 v[64:67], v2 offset:19456
  v_cvt_pk_bf16_f32 v12, v20, v21
  v_cvt_pk_bf16_f32 v13, v22, v23
  v_cvt_pk_bf16_f32 v24, v24, v25
  v_cvt_pk_bf16_f32 v25, v26, v27
  ds_write_b64 v5, v[12:13] offset:26112
  ds_write_b64 v5, v[24:25] offset:28160
  s_waitcnt lgkmcnt(5)
  v_smfmac_f32_16x16x64_bf16 v[28:31], v[52:55], a[200:207], v3
  ds_read_b128 v[68:71], v0 offset:19456
  s_waitcnt lgkmcnt(5)
  v_smfmac_f32_16x16x64_bf16 v[28:31], v[56:59], a[144:151], v3
  ds_read_b128 v[48:51], v2 offset:20480
  s_waitcnt lgkmcnt(5)
  v_smfmac_f32_16x16x64_bf16 v[28:31], v[60:63], a[208:215], v3
  ds_read_b128 v[52:55], v0 offset:20480
  s_waitcnt lgkmcnt(3)
  s_barrier
  v_smfmac_f32_16x16x64_bf16 v[28:31], v[64:67], a[152:159], v3
  ds_read_b64_tr_b16 v[72:73], v6 offset:24576
  ds_read_b64_tr_b16 v[74:75], v6 offset:24832
  ds_read_b64_tr_b16 v[76:77], v6 offset:25088
  ds_read_b64_tr_b16 v[78:79], v6 offset:25344
  ds_read_b128 v[56:59], v2 offset:21504
  s_waitcnt lgkmcnt(7)
  v_smfmac_f32_16x16x64_bf16 v[28:31], v[68:71], a[216:223], v3
  ds_read_b64_tr_b16 v[80:81], v6 offset:25600
  ds_read_b64_tr_b16 v[82:83], v6 offset:25856
  ds_read_b64_tr_b16 v[84:85], v6 offset:26112
  ds_read_b64_tr_b16 v[86:87], v6 offset:26368
  ds_read_b128 v[60:63], v0 offset:21504
  s_waitcnt lgkmcnt(11)
  v_smfmac_f32_16x16x64_bf16 v[28:31], v[48:51], a[160:167], v3
  ds_read_b64_tr_b16 v[64:65], v6 offset:26624
  ds_read_b64_tr_b16 v[66:67], v6 offset:26880
  s_waitcnt lgkmcnt(12)
  v_smfmac_f32_16x16x64_bf16 v[28:31], v[52:55], a[224:231], v3
  ds_read_b64_tr_b16 v[68:69], v6 offset:27136
  ds_read_b64_tr_b16 v[70:71], v6 offset:27392
  s_waitcnt lgkmcnt(9)
  v_smfmac_f32_16x16x64_bf16 v[28:31], v[56:59], a[168:175], v3
  ds_read_b64_tr_b16 v[48:49], v6 offset:27648
  ds_read_b64_tr_b16 v[50:51], v6 offset:27904
  s_waitcnt lgkmcnt(6)
  v_smfmac_f32_16x16x64_bf16 v[28:31], v[60:63], a[232:239], v3
  ds_read_b64_tr_b16 v[52:53], v6 offset:28160
  ds_read_b64_tr_b16 v[54:55], v6 offset:28416
  v_mfma_f32_16x16x32_bf16 v[120:123], v[88:91], v[72:75], 0
  v_mfma_f32_16x16x32_bf16 v[120:123], v[92:95], v[76:79], v[120:123]
  v_mfma_f32_16x16x32_bf16 v[120:123], v[96:99], v[80:83], v[120:123]
  v_mfma_f32_16x16x32_bf16 v[120:123], v[100:103], v[84:87], v[120:123]
  s_nop 1
  v_cvt_pk_bf16_f32 v28, v28, v29
  v_cvt_pk_bf16_f32 v29, v30, v31
  ds_write_b64 v7, v[28:29] offset:30208
  v_mfma_f32_16x16x32_bf16 v[124:127], v[104:107], v[72:75], 0
  ds_read_b128 v[88:91], v10 offset:0
  v_mfma_f32_16x16x32_bf16 v[124:127], v[108:111], v[76:79], v[124:127]
  ds_read_b128 v[92:95], v10 offset:1024
  v_mfma_f32_16x16x32_bf16 v[124:127], v[112:115], v[80:83], v[124:127]
  ds_read_b128 v[96:99], v10 offset:2048
  v_mfma_f32_16x16x32_bf16 v[124:127], v[116:119], v[84:87], v[124:127]
  ds_read_b128 v[100:103], v10 offset:3072
  v_max3_f32 v24, v120, v121, v122
  s_waitcnt lgkmcnt(5)
  v_mfma_f32_16x16x32_bf16 v[20:23], v[64:67], v[72:75], 0
  v_mfma_f32_16x16x32_bf16 v[20:23], v[68:71], v[76:79], v[20:23]
  v_mfma_f32_16x16x32_bf16 v[20:23], v[48:51], v[80:83], v[20:23]
  s_nop 1
  v_max3_f32 v24, v24, v123, v124
  v_max3_f32 v24, v24, v125, v126
  v_mfma_f32_16x16x32_bf16 v[20:23], v[52:55], v[84:87], v[20:23]
  ds_read_b128 v[48:51], v10 offset:4096
  ds_read_b128 v[52:55], v10 offset:5120
  ds_read_b128 v[56:59], v10 offset:6144
  ds_read_b128 v[60:63], v10 offset:7168
  ds_read_b128 v[64:67], v1 offset:57344
  ds_read_b128 v[68:71], v1 offset:58368
  s_nop 1
  v_max3_f32 v24, v24, v127, v20
  v_max3_f32 v24, v24, v21, v22
  v_max_f32 v12, v24, v23
  v_max_f32 v24, v24, v23
  s_cmp_eq_u32 s45, 63
  s_cbranch_scc1 K1_R0_FIN
  s_nop 0
  v_permlane16_swap_b32 v24, v12
  v_max_f32 v13, v24, v12
  v_max_f32 v24, v24, v12
  s_nop 1
  v_permlane32_swap_b32 v24, v13
  v_max_f32 v12, v24, v13
  v_pk_add_f32 v[120:121], v[120:121], v[12:13] op_sel_hi:[1,0] neg_lo:[0,1] neg_hi:[0,1]
  v_pk_add_f32 v[122:123], v[122:123], v[12:13] op_sel_hi:[1,0] neg_lo:[0,1] neg_hi:[0,1]
  v_pk_add_f32 v[124:125], v[124:125], v[12:13] op_sel_hi:[1,0] neg_lo:[0,1] neg_hi:[0,1]
  v_pk_add_f32 v[126:127], v[126:127], v[12:13] op_sel_hi:[1,0] neg_lo:[0,1] neg_hi:[0,1]
  v_pk_mul_f32 v[120:121], v[120:121], s[94:95]
  v_pk_mul_f32 v[122:123], v[122:123], s[94:95]
  v_pk_mul_f32 v[124:125], v[124:125], s[94:95]
  v_pk_mul_f32 v[126:127], v[126:127], s[94:95]
  v_exp_f32 v120, v120
  v_exp_f32 v121, v121
  v_exp_f32 v122, v122
  v_exp_f32 v123, v123
  v_exp_f32 v124, v124
  v_exp_f32 v125, v125
  v_exp_f32 v126, v126
  v_exp_f32 v127, v127
  v_cvt_pk_bf16_f32 v24, v120, v121
  v_cvt_pk_bf16_f32 v25, v122, v123
  v_cvt_pk_bf16_f32 v26, v124, v125
  v_cvt_pk_bf16_f32 v27, v126, v127
  v_cndmask_b32 v72, 0, v24, s[58:59]
  v_cndmask_b32 v73, 0, v25, s[58:59]
  v_cndmask_b32 v74, 0, v26, s[58:59]
  v_cndmask_b32 v75, 0, v27, s[58:59]
  v_cndmask_b32 v76, 0, v24, s[60:61]
  v_cndmask_b32 v77, 0, v25, s[60:61]
  v_cndmask_b32 v78, 0, v26, s[60:61]
  v_cndmask_b32 v79, 0, v27, s[60:61]
  s_waitcnt lgkmcnt(2)
  s_barrier
  v_mfma_f32_16x16x32_bf16 v[84:87], v[16:19], v[24:27], 0
  ds_read_b64 v[120:121], v7 offset:28672
  ds_read_b64 v[122:123], v7 offset:29184
  v_sub_f32 v20, v20, v12
  v_sub_f32 v21, v21, v12
  v_mfma_f32_16x16x32_bf16 v[104:107], v[88:91], v[72:75], 0
  ds_read_b64 v[124:125], v7 offset:29696
  ds_read_b64 v[126:127], v7 offset:30208
  v_sub_f32 v22, v22, v12
  v_sub_f32 v23, v23, v12
  v_mfma_f32_16x16x32_bf16 v[104:107], v[92:95], v[76:79], v[104:107]
  s_nop 0
  s_nop 0
  v_mul_f32 v20, s94, v20
  v_mul_f32 v21, s94, v21
  v_mfma_f32_16x16x32_bf16 v[108:111], v[96:99], v[72:75], 0
  ds_read_b128 v[88:91], v1 offset:43008
  ds_read_b128 v[92:95], v1 offset:44032
  v_mul_f32 v22, s94, v22
  v_mul_f32 v23, s94, v23
  v_mfma_f32_16x16x32_bf16 v[108:111], v[100:103], v[76:79], v[108:111]
  ds_read_b128 v[96:99], v1 offset:59392
  ds_read_b128 v[100:103], v1 offset:60416
  v_exp_f32 v20, v20
  v_exp_f32 v21, v21
  v_mfma_f32_16x16x32_bf16 v[112:115], v[48:51], v[72:75], 0
  v_exp_f32 v22, v22
  v_exp_f32 v23, v23
  v_mfma_f32_16x16x32_bf16 v[112:115], v[52:55], v[76:79], v[112:115]
  v_cvt_pk_bf16_f32 v12, v20, v21
  v_cvt_pk_bf16_f32 v13, v22, v23
  v_mfma_f32_16x16x32_bf16 v[116:119], v[56:59], v[72:75], 0
  v_cndmask_b32 v80, 0, v12, s[62:63]
  v_cndmask_b32 v81, 0, v13, s[62:63]
  v_mfma_f32_16x16x32_bf16 v[116:119], v[60:63], v[76:79], v[116:119]
  s_waitcnt lgkmcnt(4)
  v_mfma_f32_16x16x16_bf16 v[84:87], v[16:17], v[80:81], v[84:87]
  ds_read_b128 v[48:51], v1 offset:45056
  ds_read_b128 v[52:55], v1 offset:46080
  v_mov_b64 v[20:21], 0
  v_mov_b64 v[22:23], 0
  v_mfma_f32_16x16x16_bf16 v[104:107], v[120:121], v[80:81], v[104:107]
  ds_read_b128 v[56:59], v1 offset:61440
  ds_read_b128 v[60:63], v1 offset:62464
  v_mov_b64 v[24:25], 0
  v_mov_b64 v[26:27], 0
  v_mfma_f32_16x16x16_bf16 v[108:111], v[122:123], v[80:81], v[108:111]
  v_mov_b64 v[28:29], 0
  v_mov_b64 v[30:31], 0
  v_mfma_f32_16x16x16_bf16 v[112:115], v[124:125], v[80:81], v[112:115]
  v_mfma_f32_16x16x16_bf16 v[116:119], v[126:127], v[80:81], v[116:119]
  ds_read_b128 v[120:123], v1 offset:47104
  ds_read_b128 v[124:127], v1 offset:48128
  v_rcp_f32 v12, v84
  s_nop 0
  v_pk_mul_f32 v[104:105], v[104:105], v[12:13] op_sel_hi:[1,0]
  v_pk_mul_f32 v[106:107], v[106:107], v[12:13] op_sel_hi:[1,0]
  v_pk_mul_f32 v[108:109], v[108:109], v[12:13] op_sel_hi:[1,0]
  v_pk_mul_f32 v[110:111], v[110:111], v[12:13] op_sel_hi:[1,0]
  v_pk_mul_f32 v[112:113], v[112:113], v[12:13] op_sel_hi:[1,0]
  v_pk_mul_f32 v[114:115], v[114:115], v[12:13] op_sel_hi:[1,0]
  v_pk_mul_f32 v[116:117], v[116:117], v[12:13] op_sel_hi:[1,0]
  v_pk_mul_f32 v[118:119], v[118:119], v[12:13] op_sel_hi:[1,0]
  v_cvt_pk_bf16_f32 v72, v104, v105
  v_cvt_pk_bf16_f32 v73, v106, v107
  v_cvt_pk_bf16_f32 v74, v108, v109
  v_cvt_pk_bf16_f32 v75, v110, v111
  v_cvt_pk_bf16_f32 v76, v112, v113
  v_cvt_pk_bf16_f32 v77, v114, v115
  v_cvt_pk_bf16_f32 v78, v116, v117
  v_cvt_pk_bf16_f32 v79, v118, v119
  v_smfmac_f32_16x16x64_bf16 v[20:23], v[72:75], v[32:39], v3
  ds_read_b128 v[104:107], v1 offset:63488
  ds_read_b128 v[108:111], v1 offset:64512
  v_mov_b32_dpp v80, v72 row_ror:8 row_mask:0xf bank_mask:0xf
  v_mov_b32_dpp v81, v73 row_ror:8 row_mask:0xf bank_mask:0xf
  v_mov_b32_dpp v82, v74 row_ror:8 row_mask:0xf bank_mask:0xf
  v_mov_b32_dpp v83, v75 row_ror:8 row_mask:0xf bank_mask:0xf
  v_smfmac_f32_16x16x64_bf16 v[20:23], v[76:79], v[240:247], v3
  v_mov_b32_dpp v84, v76 row_ror:8 row_mask:0xf bank_mask:0xf
  v_mov_b32_dpp v85, v77 row_ror:8 row_mask:0xf bank_mask:0xf
  v_mov_b32_dpp v86, v78 row_ror:8 row_mask:0xf bank_mask:0xf
  v_mov_b32_dpp v87, v79 row_ror:8 row_mask:0xf bank_mask:0xf
  v_smfmac_f32_16x16x64_bf16 v[20:23], v[80:83], v[40:47], v3
  v_mov_b64 v[112:113], 0
  v_smfmac_f32_16x16x64_bf16 v[20:23], v[84:87], v[248:255], v3
  v_mov_b64 v[114:115], 0
  v_smfmac_f32_16x16x64_bf16 v[24:27], v[72:75], v[128:135], v3
  v_smfmac_f32_16x16x64_bf16 v[24:27], v[76:79], v[192:199], v3
  s_nop 4
  v_cvt_pk_bf16_f32 v20, v20, v21
  v_cvt_pk_bf16_f32 v21, v22, v23
  v_smfmac_f32_16x16x64_bf16 v[24:27], v[80:83], v[136:143], v3
  v_max_u32 v20, 1, v20
  v_max_u32 v21, 1, v21
  s_waitcnt lgkmcnt(2)
  v_smfmac_f32_16x16x64_bf16 v[24:27], v[84:87], v[200:207], v3
  buffer_store_dwordx2 v[20:21], v8, s[4:7], s50 offen
  v_smfmac_f32_16x16x64_bf16 v[28:31], v[72:75], v[144:151], v3
  v_smfmac_f32_16x16x64_bf16 v[28:31], v[76:79], v[64:71], v3
  s_nop 4
  v_cvt_pk_bf16_f32 v24, v24, v25
  v_cvt_pk_bf16_f32 v25, v26, v27
  v_smfmac_f32_16x16x64_bf16 v[28:31], v[80:83], v[88:95], v3
  v_max_u32 v24, 1, v24
  v_max_u32 v25, 1, v25
  v_smfmac_f32_16x16x64_bf16 v[28:31], v[84:87], v[96:103], v3
  buffer_store_dwordx2 v[24:25], v8, s[4:7], s51 offen
  v_smfmac_f32_16x16x64_bf16 v[112:115], v[72:75], v[48:55], v3
  v_smfmac_f32_16x16x64_bf16 v[112:115], v[76:79], v[56:63], v3
  s_nop 4
  v_cvt_pk_bf16_f32 v28, v28, v29
  v_cvt_pk_bf16_f32 v29, v30, v31
  s_waitcnt lgkmcnt(0)
  v_smfmac_f32_16x16x64_bf16 v[112:115], v[80:83], v[120:127], v3
  v_max_u32 v28, 1, v28
  v_max_u32 v29, 1, v29
  v_smfmac_f32_16x16x64_bf16 v[112:115], v[84:87], v[104:111], v3
  buffer_store_dwordx2 v[28:29], v8, s[4:7], s52 offen
  s_nop 6
  v_cvt_pk_bf16_f32 v112, v112, v113
  v_cvt_pk_bf16_f32 v113, v114, v115
  v_max_u32 v112, 1, v112
  v_max_u32 v113, 1, v113
  buffer_store_dwordx2 v[112:113], v8, s[4:7], s53 offen
  s_add_u32 s45, s45, 1
  s_add_u32 s56, s56, 262144
  s_add_u32 s46, s46, 8192
  s_add_u32 s36, s46, s55
  v_mov_b64 v[20:21], 0
  v_mov_b64 v[22:23], 0
  v_mov_b64 v[24:25], 0
  v_mov_b64 v[26:27], 0
  v_mov_b64 v[28:29], 0
  v_mov_b64 v[30:31], 0
  v_xor_b32 v4, 0x27000, v4
  v_xor_b32 v10, 0x35000, v10
  s_xor_b32 s50, s50, 2048
  s_xor_b32 s51, s51, 2048
  s_xor_b32 s52, s52, 2048
  s_xor_b32 s53, s53, 2048
  s_nop 7
  s_nop 7
  ds_read_b128 v[64:67], v2 offset:30720
  buffer_load_dwordx4 v[48:51], v9, s[4:7], s54 offen offset:0 sc1
  buffer_load_dwordx4 v[52:55], v9, s[4:7], s54 offen offset:1024 sc1
  s_nop 7
  s_nop 7
  s_nop 7
  s_waitcnt lgkmcnt(0)
K1_R0_W3M0_P1:
  buffer_load_dwordx4 v[56:59], v9, s[4:7], s54 offen offset:0 sc1
  buffer_load_dwordx4 v[60:63], v9, s[4:7], s54 offen offset:1024 sc1
  s_sub_u32 s57, s57, 1
  s_cbranch_scc1 K1_END
  s_waitcnt vmcnt(2)
  v_mfma_f32_16x16x32_bf16 v[68:71], v[64:67], v[48:51], 0
  v_mfma_f32_16x16x32_bf16 v[68:71], v[64:67], v[52:55], v[68:71]
  v_min3_u32 v12, v48, v49, v50
  v_min3_u32 v13, v51, v52, v53
  v_min3_u32 v12, v12, v54, v55
  v_min_u32 v12, v12, v13
  v_cmp_eq_u32 vcc, 0, v12
  s_nop 3
  s_cbranch_vccz K1_R0_W3M0_P1OK
  buffer_load_dwordx4 v[48:51], v9, s[4:7], s54 offen offset:0 sc1
  buffer_load_dwordx4 v[52:55], v9, s[4:7], s54 offen offset:1024 sc1
  s_waitcnt vmcnt(2)
  v_mfma_f32_16x16x32_bf16 v[68:71], v[64:67], v[56:59], 0
  v_mfma_f32_16x16x32_bf16 v[68:71], v[64:67], v[60:63], v[68:71]
  v_min3_u32 v12, v56, v57, v58
  v_min3_u32 v13, v59, v60, v61
  v_min3_u32 v12, v12, v62, v63
  v_min_u32 v12, v12, v13
  v_cmp_eq_u32 vcc, 0, v12
  s_nop 3
  s_cbranch_vccnz K1_R0_W3M0_P1
K1_R0_W3M0_P1OK:
  v_add_f32_dpp v68, v68, v68 row_ror:8 row_mask:0xf bank_mask:0xf
  v_add_f32_dpp v69, v69, v69 row_ror:8 row_mask:0xf bank_mask:0xf
  s_nop 0
  v_add_f32_dpp v68, v68, v68 row_ror:4 row_mask:0xf bank_mask:0xf
  v_add_f32_dpp v69, v69, v69 row_ror:4 row_mask:0xf bank_mask:0xf
  v_cvt_pk_bf16_f32 v68, v68, v69
  v_min_u32 v68, -2, v68
  s_mov_b64 exec, s[92:93]
  buffer_store_dword v68, v11, s[4:7], s36 offen
  s_mov_b64 exec, -1
  s_mov_b32 s47, s54
  s_xor_b32 s54, s54, 2048
  s_add_u32 s49, s49, 128
  s_branch K1_R0_W3M0_LOOP
K1_R0_SLOW:
  s_cmp_eq_u32 s32, 1
  s_cbranch_scc1 K1_R0_W1M1
  s_cmp_eq_u32 s32, 2
  s_cbranch_scc1 K1_R0_W2M1
  s_cmp_eq_u32 s32, 3
  s_cbranch_scc1 K1_R0_W3M1
K1_R0_W0M1:
  ds_read_b128 v[72:75], v1 offset:0
  ds_read_b128 v[76:79], v1 offset:1024
  ds_read_b128 v[80:83], v1 offset:16384
  ds_read_b128 v[84:87], v1 offset:17408
  ds_read_b128 v[88:91], v1 offset:2048
  ds_read_b128 v[92:95], v1 offset:3072
  ds_read_b128 v[96:99], v1 offset:18432
  ds_read_b128 v[100:103], v1 offset:19456
  ds_read_b128 v[104:107], v1 offset:4096
  ds_read_b128 v[108:111], v1 offset:5120
  ds_read_b128 v[112:115], v1 offset:20480
  ds_read_b128 v[116:119], v1 offset:21504
  ds_read_b128 v[120:123], v1 offset:6144
  ds_read_b128 v[124:127], v1 offset:7168
  ds_read_b128 v[32:35], v1 offset:28672
  ds_read_b128 v[36:39], v1 offset:29696
  ds_read_b128 v[40:43], v1 offset:30720
  ds_read_b128 v[44:47], v1 offset:31744
  s_waitcnt lgkmcnt(0)
  ds_write_b128 v1, v[192:195] offset:0
  ds_write_b128 v1, v[196:199] offset:1024
  ds_write_b128 v1, v[200:203] offset:16384
  ds_write_b128 v1, v[204:207] offset:17408
  ds_write_b128 v1, v[144:147] offset:2048
  ds_write_b128 v1, v[148:151] offset:3072
  ds_write_b128 v1, v[208:211] offset:18432
  ds_write_b128 v1, v[212:215] offset:19456
  ds_write_b128 v1, v[152:155] offset:4096
  ds_write_b128 v1, v[156:159] offset:5120
  ds_write_b128 v1, v[216:219] offset:20480
  ds_write_b128 v1, v[220:223] offset:21504
  ds_write_b128 v1, v[160:163] offset:6144
  ds_write_b128 v1, v[164:167] offset:7168
  s_waitcnt lgkmcnt(0)
  v_mov_b64 v[192:193], v[72:73]
  v_mov_b64 v[194:195], v[74:75]
  v_mov_b64 v[196:197], v[76:77]
  v_mov_b64 v[198:199], v[78:79]
  v_mov_b64 v[200:201], v[80:81]
  v_mov_b64 v[202:203], v[82:83]
  v_mov_b64 v[204:205], v[84:85]
  v_mov_b64 v[206:207], v[86:87]
  v_mov_b64 v[144:145], v[88:89]
  v_mov_b64 v[146:147], v[90:91]
  v_mov_b64 v[148:149], v[92:93]
  v_mov_b64 v[150:151], v[94:95]
  v_mov_b64 v[208:209], v[96:97]
  v_mov_b64 v[210:211], v[98:99]
  v_mov_b64 v[212:213], v[100:101]
  v_mov_b64 v[214:215], v[102:103]
  v_mov_b64 v[152:153], v[104:105]
  v_mov_b64 v[154:155], v[106:107]
  v_mov_b64 v[156:157], v[108:109]
  v_mov_b64 v[158:159], v[110:111]
  v_mov_b64 v[216:217], v[112:113]
  v_mov_b64 v[218:219], v[114:115]
  v_mov_b64 v[220:221], v[116:117]
  v_mov_b64 v[222:223], v[118:119]
  v_mov_b64 v[160:161], v[120:121]
  v_mov_b64 v[162:163], v[122:123]
  v_mov_b64 v[164:165], v[124:125]
  v_mov_b64 v[166:167], v[126:127]
  v_mov_b64 v[20:21], 0
  v_mov_b64 v[22:23], 0
  v_mov_b64 v[24:25], 0
  v_mov_b64 v[26:27], 0
  v_mov_b64 v[28:29], 0
  v_mov_b64 v[30:31], 0
  s_mov_b32 s42, 28672
  ds_read_b128 v[88:91], v1 offset:0
  ds_read_b128 v[92:95], v1 offset:1024
  ds_read_b128 v[96:99], v1 offset:16384
  ds_read_b128 v[100:103], v1 offset:17408
  ds_read_b128 v[104:107], v1 offset:2048
  ds_read_b128 v[108:111], v1 offset:3072
  ds_read_b128 v[112:115], v1 offset:18432
  ds_read_b128 v[116:119], v1 offset:19456
  ds_read_b128 v[72:75], v1 offset:4096
  ds_read_b128 v[76:79], v1 offset:5120
  ds_read_b128 v[80:83], v1 offset:20480
  ds_read_b128 v[84:87], v1 offset:21504
  ds_read_b128 v[120:123], v1 offset:6144
  ds_read_b128 v[124:127], v1 offset:7168
  s_branch K1_R0_W0M1_P2OK
K1_R0_W0M1_LOOP:
  ds_read_b128 v[88:91], v1 offset:0
  ds_read_b128 v[92:95], v1 offset:1024
  ds_read_b128 v[96:99], v1 offset:16384
  ds_read_b128 v[100:103], v1 offset:17408
  ds_read_b128 v[104:107], v1 offset:2048
  ds_read_b128 v[108:111], v1 offset:3072
  ds_read_b128 v[112:115], v1 offset:18432
  ds_read_b128 v[116:119], v1 offset:19456
  ds_read_b128 v[72:75], v1 offset:4096
  ds_read_b128 v[76:79], v1 offset:5120
  ds_read_b128 v[80:83], v1 offset:20480
  ds_read_b128 v[84:87], v1 offset:21504
  ds_read_b128 v[120:123], v1 offset:6144
  ds_read_b128 v[124:127], v1 offset:7168
  buffer_load_dwordx4 v[48:51], v9, s[4:7], s46 offen offset:0 sc1
  buffer_load_dwordx4 v[52:55], v9, s[4:7], s46 offen offset:1024 sc1
  s_nop 7
  s_nop 7
  s_nop 7
  s_nop 7
K1_R0_W0M1_P2:
  buffer_load_dwordx4 v[64:67], v9, s[4:7], s46 offen offset:0 sc1
  buffer_load_dwordx4 v[68:71], v9, s[4:7], s46 offen offset:1024 sc1
  s_sub_u32 s57, s57, 1
  s_cbranch_scc1 K1_END
  s_waitcnt vmcnt(2)
  v_max3_u32 v12, v48, v49, v50
  v_max3_u32 v13, v51, v52, v53
  v_max3_u32 v12, v12, v54, v55
  v_max_u32 v12, v12, v13
  v_cmp_eq_u32 vcc, -1, v12
  s_nop 3
  s_cbranch_vccz K1_R0_W0M1_P2OK
  buffer_load_dwordx4 v[48:51], v9, s[4:7], s46 offen offset:0 sc1
  buffer_load_dwordx4 v[52:55], v9, s[4:7], s46 offen offset:1024 sc1
  s_waitcnt vmcnt(2)
  v_max3_u32 v12, v64, v65, v66
  v_max3_u32 v13, v67, v68, v69
  v_max3_u32 v12, v12, v70, v71
  v_max_u32 v12, v12, v13
  v_cmp_eq_u32 vcc, -1, v12
  s_nop 3
  s_cbranch_vccnz K1_R0_W0M1_P2
  v_mov_b64 v[48:49], v[64:65]
  v_mov_b64 v[50:51], v[66:67]
  v_mov_b64 v[52:53], v[68:69]
  v_mov_b64 v[54:55], v[70:71]
  s_nop 1
K1_R0_W0M1_P2OK:
  ds_write_b128 v2, v[48:51] offset:16384
  ds_write_b128 v2, v[52:55] offset:17408
  v_smfmac_f32_16x16x64_bf16 v[20:23], v[48:51], v[128:135], v3
  s_add_u32 s38, s56, -126976
  v_mov_b32_dpp v56, v48 row_ror:8 row_mask:0xf bank_mask:0xf
  v_smfmac_f32_16x16x64_bf16 v[24:27], v[48:51], a[0:7], v3
  buffer_store_dwordx4 v[28:31], v9, s[4:7], s47 offen offset:0 sc1
  v_mov_b32_dpp v57, v49 row_ror:8 row_mask:0xf bank_mask:0xf
  v_smfmac_f32_16x16x64_bf16 v[20:23], v[52:55], v[136:143], v3
  buffer_store_dwordx4 v[28:31], v9, s[4:7], s47 offen offset:1024 sc1
  v_mov_b32_dpp v58, v50 row_ror:8 row_mask:0xf bank_mask:0xf
  v_smfmac_f32_16x16x64_bf16 v[24:27], v[52:55], a[8:15], v3
  v_mov_b32_dpp v59, v51 row_ror:8 row_mask:0xf bank_mask:0xf
  s_waitcnt vmcnt(2)
  v_smfmac_f32_16x16x64_bf16 v[28:31], v[48:51], a[128:135], v3
  ds_read_b64_tr_b16 v[64:65], v6 offset:26624
  ds_read_b64_tr_b16 v[66:67], v6 offset:26880
  v_mov_b32_dpp v60, v52 row_ror:8 row_mask:0xf bank_mask:0xf
  v_mov_b32_dpp v61, v53 row_ror:8 row_mask:0xf bank_mask:0xf
  v_smfmac_f32_16x16x64_bf16 v[28:31], v[52:55], a[136:143], v3
  ds_read_b64 v[68:69], v7 offset:28672
  v_mov_b32_dpp v62, v54 row_ror:8 row_mask:0xf bank_mask:0xf
  v_mov_b32_dpp v63, v55 row_ror:8 row_mask:0xf bank_mask:0xf
  s_waitcnt lgkmcnt(0)
  s_barrier
  buffer_store_dwordx4 v[64:67], v9, s[4:7], s56 offen offset:0 sc1
  buffer_store_dwordx2 v[68:69], v7, s[4:7], s38 offen offset:0 sc1
  ds_read_b128 v[64:67], v2 offset:18432
  ds_read_b128 v[68:71], v0 offset:18432
  ds_read_b128 v[48:51], v2 offset:19456
  ds_read_b128 v[52:55], v0 offset:19456
  v_smfmac_f32_16x16x64_bf16 v[20:23], v[56:59], v[88:95], v3
  s_mov_b64 exec, 1
  buffer_load_dword v15, v9, s[4:7], s97 offen sc1
  buffer_store_dword v3, v9, s[4:7], s49 offen sc1
  s_mov_b64 exec, -1
  v_smfmac_f32_16x16x64_bf16 v[24:27], v[56:59], a[64:71], v3
  s_add_u32 s48, s48, 524288
  s_mov_b32 m0, s42
  s_xor_b32 s42, s42, 159744
  buffer_load_dwordx4 v9, s[4:7], s48 offen offset:0 lds
  buffer_load_dwordx4 v9, s[4:7], s48 offen offset:1024 lds
  buffer_load_dwordx4 v9, s[4:7], s48 offen offset:2048 lds
  buffer_load_dwordx4 v9, s[4:7], s48 offen offset:3072 lds
  v_smfmac_f32_16x16x64_bf16 v[28:31], v[56:59], a[192:199], v3
  v_smfmac_f32_16x16x64_bf16 v[20:23], v[60:63], v[96:103], v3
  v_smfmac_f32_16x16x64_bf16 v[24:27], v[60:63], a[72:79], v3
  v_smfmac_f32_16x16x64_bf16 v[28:31], v[60:63], a[200:207], v3
  s_waitcnt lgkmcnt(3)
  v_smfmac_f32_16x16x64_bf16 v[20:23], v[64:67], v[104:111], v3
  ds_read_b128 v[56:59], v2 offset:20480
  v_smfmac_f32_16x16x64_bf16 v[24:27], v[64:67], a[16:23], v3
  s_waitcnt lgkmcnt(3)
  v_smfmac_f32_16x16x64_bf16 v[20:23], v[68:71], v[112:119], v3
  ds_read_b128 v[60:63], v0 offset:20480
  v_smfmac_f32_16x16x64_bf16 v[24:27], v[68:71], a[80:87], v3
  s_waitcnt lgkmcnt(3)
  v_smfmac_f32_16x16x64_bf16 v[20:23], v[48:51], v[72:79], v3
  ds_read_b128 v[64:67], v2 offset:21504
  v_smfmac_f32_16x16x64_bf16 v[24:27], v[48:51], a[24:31], v3
  s_waitcnt lgkmcnt(3)
  v_smfmac_f32_16x16x64_bf16 v[20:23], v[52:55], v[80:87], v3
  ds_read_b128 v[68:71], v0 offset:21504
  v_smfmac_f32_16x16x64_bf16 v[24:27], v[52:55], a[88:95], v3
  ds_read_b128 v[88:91], v4 offset:0
  s_waitcnt lgkmcnt(4)
  v_smfmac_f32_16x16x64_bf16 v[20:23], v[56:59], v[120:127], v3
  ds_read_b128 v[48:51], v2 offset:22528
  v_smfmac_f32_16x16x64_bf16 v[24:27], v[56:59], a[32:39], v3
  ds_read_b128 v[92:95], v4 offset:1024
  s_waitcnt lgkmcnt(5)
  v_smfmac_f32_16x16x64_bf16 v[20:23], v[60:63], v[224:231], v3
  ds_read_b128 v[52:55], v0 offset:22528
  v_smfmac_f32_16x16x64_bf16 v[24:27], v[60:63], a[96:103], v3
  ds_read_b128 v[96:99], v4 offset:2048
  s_waitcnt lgkmcnt(6)
  v_smfmac_f32_16x16x64_bf16 v[20:23], v[64:67], v[168:175], v3
  ds_read_b128 v[56:59], v2 offset:23552
  v_smfmac_f32_16x16x64_bf16 v[24:27], v[64:67], a[40:47], v3
  ds_read_b128 v[100:103], v4 offset:3072
  s_waitcnt lgkmcnt(7)
  v_smfmac_f32_16x16x64_bf16 v[20:23], v[68:71], v[232:239], v3
  ds_read_b128 v[60:63], v0 offset:23552
  v_smfmac_f32_16x16x64_bf16 v[24:27], v[68:71], a[104:111], v3
  ds_read_b128 v[104:107], v4 offset:4096
  s_waitcnt lgkmcnt(7)
  v_smfmac_f32_16x16x64_bf16 v[20:23], v[48:51], v[176:183], v3
  ds_read_b128 v[64:67], v2 offset:18432
  v_smfmac_f32_16x16x64_bf16 v[24:27], v[48:51], a[48:55], v3
  ds_read_b128 v[108:111], v4 offset:5120
  s_waitcnt lgkmcnt(7)
  v_smfmac_f32_16x16x64_bf16 v[20:23], v[52:55], v[240:247], v3
  ds_read_b128 v[68:71], v0 offset:18432
  v_smfmac_f32_16x16x64_bf16 v[24:27], v[52:55], a[112:119], v3
  ds_read_b128 v[112:115], v4 offset:6144
  s_waitcnt lgkmcnt(7)
  v_smfmac_f32_16x16x64_bf16 v[20:23], v[56:59], v[184:191], v3
  ds_read_b128 v[48:51], v2 offset:19456
  v_smfmac_f32_16x16x64_bf16 v[24:27], v[56:59], a[56:63], v3
  ds_read_b128 v[116:119], v4 offset:7168
  s_waitcnt lgkmcnt(7)
  v_smfmac_f32_16x16x64_bf16 v[20:23], v[60:63], v[248:255], v3
  ds_read_b128 v[52:55], v0 offset:19456
  v_smfmac_f32_16x16x64_bf16 v[24:27], v[60:63], a[120:127], v3
  s_waitcnt lgkmcnt(6)
  v_smfmac_f32_16x16x64_bf16 v[28:31], v[64:67], a[144:151], v3
  ds_read_b128 v[56:59], v2 offset:20480
  s_waitcnt lgkmcnt(5)
  v_smfmac_f32_16x16x64_bf16 v[28:31], v[68:71], a[208:215], v3
  ds_read_b128 v[60:63], v0 offset:20480
  s_waitcnt lgkmcnt(4)
  v_smfmac_f32_16x16x64_bf16 v[28:31], v[48:51], a[152:159], v3
  ds_read_b128 v[64:67], v2 offset:21504
  v_cvt_pk_bf16_f32 v12, v20, v21
  v_cvt_pk_bf16_f32 v13, v22, v23
  v_cvt_pk_bf16_f32 v24, v24, v25
  v_cvt_pk_bf16_f32 v25, v26, v27
  ds_write_b64 v5, v[12:13] offset:24576
  ds_write_b64 v5, v[24:25] offset:26624
  s_waitcnt lgkmcnt(5)
  v_smfmac_f32_16x16x64_bf16 v[28:31], v[52:55], a[216:223], v3
  ds_read_b128 v[68:71], v0 offset:21504
  s_waitcnt lgkmcnt(5)
  v_smfmac_f32_16x16x64_bf16 v[28:31], v[56:59], a[160:167], v3
  ds_read_b128 v[48:51], v2 offset:22528
  s_waitcnt lgkmcnt(5)
  v_smfmac_f32_16x16x64_bf16 v[28:31], v[60:63], a[224:231], v3
  ds_read_b128 v[52:55], v0 offset:22528
  s_waitcnt lgkmcnt(3)
  s_barrier
  v_smfmac_f32_16x16x64_bf16 v[28:31], v[64:67], a[168:175], v3
  ds_read_b64_tr_b16 v[72:73], v6 offset:24576
  ds_read_b64_tr_b16 v[74:75], v6 offset:24832
  ds_read_b64_tr_b16 v[76:77], v6 offset:25088
  ds_read_b64_tr_b16 v[78:79], v6 offset:25344
  ds_read_b128 v[56:59], v2 offset:23552
  s_waitcnt lgkmcnt(7)
  v_smfmac_f32_16x16x64_bf16 v[28:31], v[68:71], a[232:239], v3
  ds_read_b64_tr_b16 v[80:81], v6 offset:25600
  ds_read_b64_tr_b16 v[82:83], v6 offset:25856
  ds_read_b64_tr_b16 v[84:85], v6 offset:26112
  ds_read_b64_tr_b16 v[86:87], v6 offset:26368
  ds_read_b128 v[60:63], v0 offset:23552
  s_waitcnt lgkmcnt(11)
  v_smfmac_f32_16x16x64_bf16 v[28:31], v[48:51], a[176:183], v3
  ds_read_b64_tr_b16 v[64:65], v6 offset:26624
  ds_read_b64_tr_b16 v[66:67], v6 offset:26880
  s_waitcnt lgkmcnt(12)
  v_smfmac_f32_16x16x64_bf16 v[28:31], v[52:55], a[240:247], v3
  ds_read_b64_tr_b16 v[68:69], v6 offset:27136
  ds_read_b64_tr_b16 v[70:71], v6 offset:27392
  s_waitcnt lgkmcnt(9)
  v_smfmac_f32_16x16x64_bf16 v[28:31], v[56:59], a[184:191], v3
  ds_read_b64_tr_b16 v[48:49], v6 offset:27648
  ds_read_b64_tr_b16 v[50:51], v6 offset:27904
  s_waitcnt lgkmcnt(6)
  v_smfmac_f32_16x16x64_bf16 v[28:31], v[60:63], a[248:255], v3
  ds_read_b64_tr_b16 v[52:53], v6 offset:28160
  ds_read_b64_tr_b16 v[54:55], v6 offset:28416
  v_mfma_f32_16x16x32_bf16 v[120:123], v[88:91], v[72:75], 0
  v_mfma_f32_16x16x32_bf16 v[120:123], v[92:95], v[76:79], v[120:123]
  v_mfma_f32_16x16x32_bf16 v[120:123], v[96:99], v[80:83], v[120:123]
  v_mfma_f32_16x16x32_bf16 v[120:123], v[100:103], v[84:87], v[120:123]
  s_nop 1
  v_cvt_pk_bf16_f32 v28, v28, v29
  v_cvt_pk_bf16_f32 v29, v30, v31
  ds_write_b64 v7, v[28:29] offset:28672
  v_mfma_f32_16x16x32_bf16 v[124:127], v[104:107], v[72:75], 0
  ds_read_b128 v[88:91], v10 offset:0
  v_mfma_f32_16x16x32_bf16 v[124:127], v[108:111], v[76:79], v[124:127]
  ds_read_b128 v[92:95], v10 offset:1024
  v_mfma_f32_16x16x32_bf16 v[124:127], v[112:115], v[80:83], v[124:127]
  ds_read_b128 v[96:99], v10 offset:2048
  v_mfma_f32_16x16x32_bf16 v[124:127], v[116:119], v[84:87], v[124:127]
  ds_read_b128 v[100:103], v10 offset:3072
  v_max3_f32 v24, v120, v121, v122
  s_waitcnt lgkmcnt(5)
  v_mfma_f32_16x16x32_bf16 v[20:23], v[64:67], v[72:75], 0
  v_mfma_f32_16x16x32_bf16 v[20:23], v[68:71], v[76:79], v[20:23]
  v_mfma_f32_16x16x32_bf16 v[20:23], v[48:51], v[80:83], v[20:23]
  s_nop 1
  v_max3_f32 v24, v24, v123, v124
  v_max3_f32 v24, v24, v125, v126
  v_mfma_f32_16x16x32_bf16 v[20:23], v[52:55], v[84:87], v[20:23]
  ds_read_b128 v[48:51], v10 offset:4096
  ds_read_b128 v[52:55], v10 offset:5120
  ds_read_b128 v[56:59], v10 offset:6144
  ds_read_b128 v[60:63], v10 offset:7168
  ds_read_b128 v[64:67], v1 offset:22528
  ds_read_b128 v[68:71], v1 offset:23552
  s_nop 1
  v_max3_f32 v24, v24, v127, v20
  v_max3_f32 v24, v24, v21, v22
  v_max_f32 v12, v24, v23
  v_max_f32 v24, v24, v23
  s_cmp_eq_u32 s45, 63
  s_cbranch_scc1 K1_R0_FIN
  s_nop 0
  v_permlane16_swap_b32 v24, v12
  v_max_f32 v13, v24, v12
  v_max_f32 v24, v24, v12
  s_nop 1
  v_permlane32_swap_b32 v24, v13
  v_max_f32 v12, v24, v13
  v_pk_add_f32 v[120:121], v[120:121], v[12:13] op_sel_hi:[1,0] neg_lo:[0,1] neg_hi:[0,1]
  v_pk_add_f32 v[122:123], v[122:123], v[12:13] op_sel_hi:[1,0] neg_lo:[0,1] neg_hi:[0,1]
  v_pk_add_f32 v[124:125], v[124:125], v[12:13] op_sel_hi:[1,0] neg_lo:[0,1] neg_hi:[0,1]
  v_pk_add_f32 v[126:127], v[126:127], v[12:13] op_sel_hi:[1,0] neg_lo:[0,1] neg_hi:[0,1]
  v_pk_mul_f32 v[120:121], v[120:121], s[94:95]
  v_pk_mul_f32 v[122:123], v[122:123], s[94:95]
  v_pk_mul_f32 v[124:125], v[124:125], s[94:95]
  v_pk_mul_f32 v[126:127], v[126:127], s[94:95]
  v_exp_f32 v120, v120
  v_exp_f32 v121, v121
  v_exp_f32 v122, v122
  v_exp_f32 v123, v123
  v_exp_f32 v124, v124
  v_exp_f32 v125, v125
  v_exp_f32 v126, v126
  v_exp_f32 v127, v127
  v_cvt_pk_bf16_f32 v24, v120, v121
  v_cvt_pk_bf16_f32 v25, v122, v123
  v_cvt_pk_bf16_f32 v26, v124, v125
  v_cvt_pk_bf16_f32 v27, v126, v127
  v_cndmask_b32 v72, 0, v24, s[58:59]
  v_cndmask_b32 v73, 0, v25, s[58:59]
  v_cndmask_b32 v74, 0, v26, s[58:59]
  v_cndmask_b32 v75, 0, v27, s[58:59]
  v_cndmask_b32 v76, 0, v24, s[60:61]
  v_cndmask_b32 v77, 0, v25, s[60:61]
  v_cndmask_b32 v78, 0, v26, s[60:61]
  v_cndmask_b32 v79, 0, v27, s[60:61]
  s_waitcnt lgkmcnt(2)
  s_barrier
  v_mfma_f32_16x16x32_bf16 v[84:87], v[16:19], v[24:27], 0
  ds_read_b64 v[120:121], v7 offset:28672
  ds_read_b64 v[122:123], v7 offset:29184
  v_sub_f32 v20, v20, v12
  v_sub_f32 v21, v21, v12
  v_mfma_f32_16x16x32_bf16 v[104:107], v[88:91], v[72:75], 0
  ds_read_b64 v[124:125], v7 offset:29696
  ds_read_b64 v[126:127], v7 offset:30208
  v_sub_f32 v22, v22, v12
  v_sub_f32 v23, v23, v12
  v_mfma_f32_16x16x32_bf16 v[104:107], v[92:95], v[76:79], v[104:107]
  s_nop 0
  s_nop 0
  v_mul_f32 v20, s94, v20
  v_mul_f32 v21, s94, v21
  v_mfma_f32_16x16x32_bf16 v[108:111], v[96:99], v[72:75], 0
  ds_read_b128 v[88:91], v1 offset:8192
  ds_read_b128 v[92:95], v1 offset:9216
  v_mul_f32 v22, s94, v22
  v_mul_f32 v23, s94, v23
  v_mfma_f32_16x16x32_bf16 v[108:111], v[100:103], v[76:79], v[108:111]
  ds_read_b128 v[96:99], v1 offset:24576
  ds_read_b128 v[100:103], v1 offset:25600
  v_exp_f32 v20, v20
  v_exp_f32 v21, v21
  v_mfma_f32_16x16x32_bf16 v[112:115], v[48:51], v[72:75], 0
  v_exp_f32 v22, v22
  v_exp_f32 v23, v23
  v_mfma_f32_16x16x32_bf16 v[112:115], v[52:55], v[76:79], v[112:115]
  v_cvt_pk_bf16_f32 v12, v20, v21
  v_cvt_pk_bf16_f32 v13, v22, v23
  v_mfma_f32_16x16x32_bf16 v[116:119], v[56:59], v[72:75], 0
  v_cndmask_b32 v80, 0, v12, s[62:63]
  v_cndmask_b32 v81, 0, v13, s[62:63]
  v_mfma_f32_16x16x32_bf16 v[116:119], v[60:63], v[76:79], v[116:119]
  s_waitcnt lgkmcnt(4)
  v_mfma_f32_16x16x16_bf16 v[84:87], v[16:17], v[80:81], v[84:87]
  ds_read_b128 v[48:51], v1 offset:10240
  ds_read_b128 v[52:55], v1 offset:11264
  v_mov_b64 v[20:21], 0
  v_mov_b64 v[22:23], 0
  v_mfma_f32_16x16x16_bf16 v[104:107], v[120:121], v[80:81], v[104:107]
  ds_read_b128 v[56:59], v1 offset:26624
  ds_read_b128 v[60:63], v1 offset:27648
  v_mov_b64 v[24:25], 0
  v_mov_b64 v[26:27], 0
  v_mfma_f32_16x16x16_bf16 v[108:111], v[122:123], v[80:81], v[108:111]
  v_mov_b64 v[28:29], 0
  v_mov_b64 v[30:31], 0
  v_mfma_f32_16x16x16_bf16 v[112:115], v[124:125], v[80:81], v[112:115]
  v_mfma_f32_16x16x16_bf16 v[116:119], v[126:127], v[80:81], v[116:119]
  ds_read_b128 v[120:123], v1 offset:12288
  ds_read_b128 v[124:127], v1 offset:13312
  v_rcp_f32 v12, v84
  s_nop 0
  v_pk_mul_f32 v[104:105], v[104:105], v[12:13] op_sel_hi:[1,0]
  v_pk_mul_f32 v[106:107], v[106:107], v[12:13] op_sel_hi:[1,0]
  v_pk_mul_f32 v[108:109], v[108:109], v[12:13] op_sel_hi:[1,0]
  v_pk_mul_f32 v[110:111], v[110:111], v[12:13] op_sel_hi:[1,0]
  v_pk_mul_f32 v[112:113], v[112:113], v[12:13] op_sel_hi:[1,0]
  v_pk_mul_f32 v[114:115], v[114:115], v[12:13] op_sel_hi:[1,0]
  v_pk_mul_f32 v[116:117], v[116:117], v[12:13] op_sel_hi:[1,0]
  v_pk_mul_f32 v[118:119], v[118:119], v[12:13] op_sel_hi:[1,0]
  v_cvt_pk_bf16_f32 v72, v104, v105
  v_cvt_pk_bf16_f32 v73, v106, v107
  v_cvt_pk_bf16_f32 v74, v108, v109
  v_cvt_pk_bf16_f32 v75, v110, v111
  v_cvt_pk_bf16_f32 v76, v112, v113
  v_cvt_pk_bf16_f32 v77, v114, v115
  v_cvt_pk_bf16_f32 v78, v116, v117
  v_cvt_pk_bf16_f32 v79, v118, v119
  v_smfmac_f32_16x16x64_bf16 v[20:23], v[72:75], v[192:199], v3
  ds_read_b128 v[104:107], v1 offset:14336
  ds_read_b128 v[108:111], v1 offset:15360
  v_mov_b32_dpp v80, v72 row_ror:8 row_mask:0xf bank_mask:0xf
  v_mov_b32_dpp v81, v73 row_ror:8 row_mask:0xf bank_mask:0xf
  v_mov_b32_dpp v82, v74 row_ror:8 row_mask:0xf bank_mask:0xf
  v_mov_b32_dpp v83, v75 row_ror:8 row_mask:0xf bank_mask:0xf
  v_smfmac_f32_16x16x64_bf16 v[20:23], v[76:79], v[200:207], v3
  v_mov_b32_dpp v84, v76 row_ror:8 row_mask:0xf bank_mask:0xf
  v_mov_b32_dpp v85, v77 row_ror:8 row_mask:0xf bank_mask:0xf
  v_mov_b32_dpp v86, v78 row_ror:8 row_mask:0xf bank_mask:0xf
  v_mov_b32_dpp v87, v79 row_ror:8 row_mask:0xf bank_mask:0xf
  v_smfmac_f32_16x16x64_bf16 v[20:23], v[80:83], v[144:151], v3
  v_mov_b64 v[112:113], 0
  v_smfmac_f32_16x16x64_bf16 v[20:23], v[84:87], v[208:215], v3
  v_mov_b64 v[114:115], 0
  v_smfmac_f32_16x16x64_bf16 v[24:27], v[72:75], v[152:159], v3
  v_smfmac_f32_16x16x64_bf16 v[24:27], v[76:79], v[216:223], v3
  s_nop 4
  v_cvt_pk_bf16_f32 v20, v20, v21
  v_cvt_pk_bf16_f32 v21, v22, v23
  v_smfmac_f32_16x16x64_bf16 v[24:27], v[80:83], v[160:167], v3
  v_max_u32 v20, 1, v20
  v_max_u32 v21, 1, v21
  s_waitcnt lgkmcnt(2)
  v_smfmac_f32_16x16x64_bf16 v[24:27], v[84:87], v[64:71], v3
  buffer_store_dwordx2 v[20:21], v8, s[4:7], s50 offen sc1
  v_smfmac_f32_16x16x64_bf16 v[28:31], v[72:75], v[88:95], v3
  v_smfmac_f32_16x16x64_bf16 v[28:31], v[76:79], v[96:103], v3
  s_nop 4
  v_cvt_pk_bf16_f32 v24, v24, v25
  v_cvt_pk_bf16_f32 v25, v26, v27
  v_smfmac_f32_16x16x64_bf16 v[28:31], v[80:83], v[48:55], v3
  v_max_u32 v24, 1, v24
  v_max_u32 v25, 1, v25
  v_smfmac_f32_16x16x64_bf16 v[28:31], v[84:87], v[56:63], v3
  buffer_store_dwordx2 v[24:25], v8, s[4:7], s51 offen sc1
  v_smfmac_f32_16x16x64_bf16 v[112:115], v[72:75], v[120:127], v3
  v_smfmac_f32_16x16x64_bf16 v[112:115], v[76:79], v[32:39], v3
  s_nop 4
  v_cvt_pk_bf16_f32 v28, v28, v29
  v_cvt_pk_bf16_f32 v29, v30, v31
  s_waitcnt lgkmcnt(0)
  v_smfmac_f32_16x16x64_bf16 v[112:115], v[80:83], v[104:111], v3
  v_max_u32 v28, 1, v28
  v_max_u32 v29, 1, v29
  v_smfmac_f32_16x16x64_bf16 v[112:115], v[84:87], v[40:47], v3
  buffer_store_dwordx2 v[28:29], v8, s[4:7], s52 offen sc1
  s_nop 6
  v_cvt_pk_bf16_f32 v112, v112, v113
  v_cvt_pk_bf16_f32 v113, v114, v115
  v_max_u32 v112, 1, v112
  v_max_u32 v113, 1, v113
  buffer_store_dwordx2 v[112:113], v8, s[4:7], s53 offen sc1
  s_add_u32 s45, s45, 1
  s_add_u32 s56, s56, 262144
  s_add_u32 s46, s46, 8192
  s_add_u32 s36, s46, s55
  v_mov_b64 v[20:21], 0
  v_mov_b64 v[22:23], 0
  v_mov_b64 v[24:25], 0
  v_mov_b64 v[26:27], 0
  v_mov_b64 v[28:29], 0
  v_mov_b64 v[30:31], 0
  v_xor_b32 v4, 0x27000, v4
  v_xor_b32 v10, 0x35000, v10
  s_xor_b32 s50, s50, 2048
  s_xor_b32 s51, s51, 2048
  s_xor_b32 s52, s52, 2048
  s_xor_b32 s53, s53, 2048
  s_nop 7
  s_nop 7
  ds_read_b128 v[64:67], v2 offset:30720
  buffer_load_dwordx4 v[48:51], v9, s[4:7], s54 offen offset:0 sc1
  buffer_load_dwordx4 v[52:55], v9, s[4:7], s54 offen offset:1024 sc1
  s_nop 7
  s_nop 7
  s_nop 7
  s_waitcnt lgkmcnt(0)
K1_R0_W0M1_P1:
  buffer_load_dwordx4 v[56:59], v9, s[4:7], s54 offen offset:0 sc1
  buffer_load_dwordx4 v[60:63], v9, s[4:7], s54 offen offset:1024 sc1
  s_sub_u32 s57, s57, 1
  s_cbranch_scc1 K1_END
  s_waitcnt vmcnt(2)
  v_mfma_f32_16x16x32_bf16 v[68:71], v[64:67], v[48:51], 0
  v_mfma_f32_16x16x32_bf16 v[68:71], v[64:67], v[52:55], v[68:71]
  v_min3_u32 v12, v48, v49, v50
  v_min3_u32 v13, v51, v52, v53
  v_min3_u32 v12, v12, v54, v55
  v_min_u32 v12, v12, v13
  v_cmp_eq_u32 vcc, 0, v12
  s_nop 3
  s_cbranch_vccz K1_R0_W0M1_P1OK
  buffer_load_dwordx4 v[48:51], v9, s[4:7], s54 offen offset:0 sc1
  buffer_load_dwordx4 v[52:55], v9, s[4:7], s54 offen offset:1024 sc1
  s_waitcnt vmcnt(2)
  v_mfma_f32_16x16x32_bf16 v[68:71], v[64:67], v[56:59], 0
  v_mfma_f32_16x16x32_bf16 v[68:71], v[64:67], v[60:63], v[68:71]
  v_min3_u32 v12, v56, v57, v58
  v_min3_u32 v13, v59, v60, v61
  v_min3_u32 v12, v12, v62, v63
  v_min_u32 v12, v12, v13
  v_cmp_eq_u32 vcc, 0, v12
  s_nop 3
  s_cbranch_vccnz K1_R0_W0M1_P1
K1_R0_W0M1_P1OK:
  v_add_f32_dpp v68, v68, v68 row_ror:8 row_mask:0xf bank_mask:0xf
  v_add_f32_dpp v69, v69, v69 row_ror:8 row_mask:0xf bank_mask:0xf
  s_nop 0
  v_add_f32_dpp v68, v68, v68 row_ror:4 row_mask:0xf bank_mask:0xf
  v_add_f32_dpp v69, v69, v69 row_ror:4 row_mask:0xf bank_mask:0xf
  v_cvt_pk_bf16_f32 v68, v68, v69
  v_min_u32 v68, -2, v68
  s_mov_b64 exec, s[92:93]
  buffer_store_dword v68, v11, s[4:7], s36 offen sc1
  s_mov_b64 exec, -1
  s_mov_b32 s47, s54
  s_xor_b32 s54, s54, 2048
  s_add_u32 s49, s49, 128
  v_cmp_ne_u32 vcc, 0, v15
  s_cmp_ge_u32 s45, 63
  s_nop 2
  s_cbranch_scc1 K1_R0_W0M1_LOOP
  s_cmp_eq_u64 vcc, exec
  s_cbranch_scc1 K1_R0_W0M1_FOK
  v_mov_b32 v68, 0
  s_mov_b32 s3, 0x100000
  s_branch WF5
WS5:
  s_sleep 1
WF5:
  buffer_load_dword v69, v68, s[4:7], s97 offen sc1
  s_sub_u32 s3, s3, 1
  s_cbranch_scc1 K1_END
  s_waitcnt vmcnt(0)
  v_cmp_eq_u32 vcc, 0, v69
  s_nop 3
  s_cbranch_vccnz WS5
K1_R0_W0M1_FOK:
  s_add_u32 s97, s97, 128
  s_branch K1_R0_W0M1_LOOP
K1_R0_W1M1:
  ds_read_b128 v[72:75], v1 offset:49152
  ds_read_b128 v[76:79], v1 offset:50176
  ds_read_b128 v[80:83], v1 offset:51200
  ds_read_b128 v[84:87], v1 offset:52224
  ds_read_b128 v[88:91], v1 offset:36864
  ds_read_b128 v[92:95], v1 offset:37888
  ds_read_b128 v[96:99], v1 offset:53248
  ds_read_b128 v[100:103], v1 offset:54272
  ds_read_b128 v[104:107], v1 offset:38912
  ds_read_b128 v[108:111], v1 offset:39936
  ds_read_b128 v[112:115], v1 offset:55296
  ds_read_b128 v[116:119], v1 offset:56320
  ds_read_b128 v[120:123], v1 offset:40960
  ds_read_b128 v[124:127], v1 offset:41984
  ds_read_b128 v[32:35], v1 offset:32768
  ds_read_b128 v[36:39], v1 offset:33792
  ds_read_b128 v[40:43], v1 offset:34816
  ds_read_b128 v[44:47], v1 offset:35840
  s_waitcnt lgkmcnt(0)
  ds_write_b128 v1, v[208:211] offset:49152
  ds_write_b128 v1, v[212:215] offset:50176
  ds_write_b128 v1, v[216:219] offset:51200
  ds_write_b128 v1, v[220:223] offset:52224
  ds_write_b128 v1, v[160:163] offset:36864
  ds_write_b128 v1, v[164:167] offset:37888
  ds_write_b128 v1, v[224:227] offset:53248
  ds_write_b128 v1, v[228:231] offset:54272
  ds_write_b128 v1, v[168:171] offset:38912
  ds_write_b128 v1, v[172:175] offset:39936
  ds_write_b128 v1, v[232:235] offset:55296
  ds_write_b128 v1, v[236:239] offset:56320
  ds_write_b128 v1, v[176:179] offset:40960
  ds_write_b128 v1, v[180:183] offset:41984
  s_waitcnt lgkmcnt(0)
  v_mov_b64 v[208:209], v[72:73]
  v_mov_b64 v[210:211], v[74:75]
  v_mov_b64 v[212:213], v[76:77]
  v_mov_b64 v[214:215], v[78:79]
  v_mov_b64 v[216:217], v[80:81]
  v_mov_b64 v[218:219], v[82:83]
  v_mov_b64 v[220:221], v[84:85]
  v_mov_b64 v[222:223], v[86:87]
  v_mov_b64 v[160:161], v[88:89]
  v_mov_b64 v[162:163], v[90:91]
  v_mov_b64 v[164:165], v[92:93]
  v_mov_b64 v[166:167], v[94:95]
  v_mov_b64 v[224:225], v[96:97]
  v_mov_b64 v[226:227], v[98:99]
  v_mov_b64 v[228:229], v[100:101]
  v_mov_b64 v[230:231], v[102:103]
  v_mov_b64 v[168:169], v[104:105]
  v_mov_b64 v[170:171], v[106:107]
  v_mov_b64 v[172:173], v[108:109]
  v_mov_b64 v[174:175], v[110:111]
  v_mov_b64 v[232:233], v[112:113]
  v_mov_b64 v[234:235], v[114:115]
  v_mov_b64 v[236:237], v[116:117]
  v_mov_b64 v[238:239], v[118:119]
  v_mov_b64 v[176:177], v[120:121]
  v_mov_b64 v[178:179], v[122:123]
  v_mov_b64 v[180:181], v[124:125]
  v_mov_b64 v[182:183], v[126:127]
  v_mov_b64 v[20:21], 0
  v_mov_b64 v[22:23], 0
  v_mov_b64 v[24:25], 0
  v_mov_b64 v[26:27], 0
  v_mov_b64 v[28:29], 0
  v_mov_b64 v[30:31], 0
  s_mov_b32 s42, 32768
  ds_read_b128 v[88:91], v1 offset:49152
  ds_read_b128 v[92:95], v1 offset:50176
  ds_read_b128 v[96:99], v1 offset:51200
  ds_read_b128 v[100:103], v1 offset:52224
  ds_read_b128 v[104:107], v1 offset:36864
  ds_read_b128 v[108:111], v1 offset:37888
  ds_read_b128 v[112:115], v1 offset:53248
  ds_read_b128 v[116:119], v1 offset:54272
  ds_read_b128 v[72:75], v1 offset:38912
  ds_read_b128 v[76:79], v1 offset:39936
  ds_read_b128 v[80:83], v1 offset:55296
  ds_read_b128 v[84:87], v1 offset:56320
  ds_read_b128 v[120:123], v1 offset:40960
  ds_read_b128 v[124:127], v1 offset:41984
  s_branch K1_R0_W1M1_P2OK
K1_R0_W1M1_LOOP:
  ds_read_b128 v[88:91], v1 offset:49152
  ds_read_b128 v[92:95], v1 offset:50176
  ds_read_b128 v[96:99], v1 offset:51200
  ds_read_b128 v[100:103], v1 offset:52224
  ds_read_b128 v[104:107], v1 offset:36864
  ds_read_b128 v[108:111], v1 offset:37888
  ds_read_b128 v[112:115], v1 offset:53248
  ds_read_b128 v[116:119], v1 offset:54272
  ds_read_b128 v[72:75], v1 offset:38912
  ds_read_b128 v[76:79], v1 offset:39936
  ds_read_b128 v[80:83], v1 offset:55296
  ds_read_b128 v[84:87], v1 offset:56320
  ds_read_b128 v[120:123], v1 offset:40960
  ds_read_b128 v[124:127], v1 offset:41984
  buffer_load_dwordx4 v[48:51], v9, s[4:7], s46 offen offset:0 sc1
  buffer_load_dwordx4 v[52:55], v9, s[4:7], s46 offen offset:1024 sc1
  s_nop 7
  s_nop 7
  s_nop 7
  s_nop 7
K1_R0_W1M1_P2:
  buffer_load_dwordx4 v[64:67], v9, s[4:7], s46 offen offset:0 sc1
  buffer_load_dwordx4 v[68:71], v9, s[4:7], s46 offen offset:1024 sc1
  s_sub_u32 s57, s57, 1
  s_cbranch_scc1 K1_END
  s_waitcnt vmcnt(2)
  v_max3_u32 v12, v48, v49, v50
  v_max3_u32 v13, v51, v52, v53
  v_max3_u32 v12, v12, v54, v55
  v_max_u32 v12, v12, v13
  v_cmp_eq_u32 vcc, -1, v12
  s_nop 3
  s_cbranch_vccz K1_R0_W1M1_P2OK
  buffer_load_dwordx4 v[48:51], v9, s[4:7], s46 offen offset:0 sc1
  buffer_load_dwordx4 v[52:55], v9, s[4:7], s46 offen offset:1024 sc1
  s_waitcnt vmcnt(2)
  v_max3_u32 v12, v64, v65, v66
  v_max3_u32 v13, v67, v68, v69
  v_max3_u32 v12, v12, v70, v71
  v_max_u32 v12, v12, v13
  v_cmp_eq_u32 vcc, -1, v12
  s_nop 3
  s_cbranch_vccnz K1_R0_W1M1_P2
  v_mov_b64 v[48:49], v[64:65]
  v_mov_b64 v[50:51], v[66:67]
  v_mov_b64 v[52:53], v[68:69]
  v_mov_b64 v[54:55], v[70:71]
  s_nop 1
K1_R0_W1M1_P2OK:
  ds_write_b128 v2, v[48:51] offset:18432
  ds_write_b128 v2, v[52:55] offset:19456
  v_smfmac_f32_16x16x64_bf16 v[20:23], v[48:51], v[144:151], v3
  s_add_u32 s38, s56, -126976
  v_mov_b32_dpp v56, v48 row_ror:8 row_mask:0xf bank_mask:0xf
  v_smfmac_f32_16x16x64_bf16 v[24:27], v[48:51], a[16:23], v3
  buffer_store_dwordx4 v[28:31], v9, s[4:7], s47 offen offset:0 sc1
  v_mov_b32_dpp v57, v49 row_ror:8 row_mask:0xf bank_mask:0xf
  v_smfmac_f32_16x16x64_bf16 v[20:23], v[52:55], v[152:159], v3
  buffer_store_dwordx4 v[28:31], v9, s[4:7], s47 offen offset:1024 sc1
  v_mov_b32_dpp v58, v50 row_ror:8 row_mask:0xf bank_mask:0xf
  v_smfmac_f32_16x16x64_bf16 v[24:27], v[52:55], a[24:31], v3
  v_mov_b32_dpp v59, v51 row_ror:8 row_mask:0xf bank_mask:0xf
  s_waitcnt vmcnt(2)
  v_smfmac_f32_16x16x64_bf16 v[28:31], v[48:51], a[144:151], v3
  ds_read_b64_tr_b16 v[64:65], v6 offset:27136
  ds_read_b64_tr_b16 v[66:67], v6 offset:27392
  v_mov_b32_dpp v60, v52 row_ror:8 row_mask:0xf bank_mask:0xf
  v_mov_b32_dpp v61, v53 row_ror:8 row_mask:0xf bank_mask:0xf
  v_smfmac_f32_16x16x64_bf16 v[28:31], v[52:55], a[152:159], v3
  ds_read_b64 v[68:69], v7 offset:29184
  v_mov_b32_dpp v62, v54 row_ror:8 row_mask:0xf bank_mask:0xf
  v_mov_b32_dpp v63, v55 row_ror:8 row_mask:0xf bank_mask:0xf
  s_waitcnt lgkmcnt(0)
  s_barrier
  buffer_store_dwordx4 v[64:67], v9, s[4:7], s56 offen offset:1024 sc1
  buffer_store_dwordx2 v[68:69], v7, s[4:7], s38 offen offset:512 sc1
  ds_read_b128 v[64:67], v2 offset:20480
  ds_read_b128 v[68:71], v0 offset:20480
  ds_read_b128 v[48:51], v2 offset:21504
  ds_read_b128 v[52:55], v0 offset:21504
  v_smfmac_f32_16x16x64_bf16 v[20:23], v[56:59], v[88:95], v3
  s_add_u32 s37, s46, s41
  s_mov_b64 exec, 0x1111
  buffer_load_dword v14, v9, s[4:7], s37 offen
  s_mov_b64 exec, -1
  v_smfmac_f32_16x16x64_bf16 v[24:27], v[56:59], a[80:87], v3
  v_smfmac_f32_16x16x64_bf16 v[28:31], v[56:59], a[208:215], v3
  v_smfmac_f32_16x16x64_bf16 v[20:23], v[60:63], v[96:103], v3
  v_smfmac_f32_16x16x64_bf16 v[24:27], v[60:63], a[88:95], v3
  v_smfmac_f32_16x16x64_bf16 v[28:31], v[60:63], a[216:223], v3
  s_waitcnt lgkmcnt(3)
  v_smfmac_f32_16x16x64_bf16 v[20:23], v[64:67], v[104:111], v3
  ds_read_b128 v[56:59], v2 offset:22528
  v_smfmac_f32_16x16x64_bf16 v[24:27], v[64:67], a[32:39], v3
  s_waitcnt lgkmcnt(3)
  v_smfmac_f32_16x16x64_bf16 v[20:23], v[68:71], v[112:119], v3
  ds_read_b128 v[60:63], v0 offset:22528
  v_smfmac_f32_16x16x64_bf16 v[24:27], v[68:71], a[96:103], v3
  s_waitcnt lgkmcnt(3)
  v_smfmac_f32_16x16x64_bf16 v[20:23], v[48:51], v[72:79], v3
  ds_read_b128 v[64:67], v2 offset:23552
  v_smfmac_f32_16x16x64_bf16 v[24:27], v[48:51], a[40:47], v3
  s_add_u32 s48, s48, 524288
  s_mov_b32 m0, s42
  s_xor_b32 s42, s42, 167936
  buffer_load_dwordx4 v9, s[4:7], s48 offen offset:0 lds
  buffer_load_dwordx4 v9, s[4:7], s48 offen offset:1024 lds
  buffer_load_dwordx4 v9, s[4:7], s48 offen offset:2048 lds
  buffer_load_dwordx4 v9, s[4:7], s48 offen offset:3072 lds
  s_waitcnt lgkmcnt(3)
  v_smfmac_f32_16x16x64_bf16 v[20:23], v[52:55], v[80:87], v3
  ds_read_b128 v[68:71], v0 offset:23552
  v_smfmac_f32_16x16x64_bf16 v[24:27], v[52:55], a[104:111], v3
  ds_read_b128 v[88:91], v4 offset:0
  s_waitcnt lgkmcnt(4)
  v_smfmac_f32_16x16x64_bf16 v[20:23], v[56:59], v[120:127], v3
  ds_read_b128 v[48:51], v2 offset:16384
  v_smfmac_f32_16x16x64_bf16 v[24:27], v[56:59], a[48:55], v3
  ds_read_b128 v[92:95], v4 offset:1024
  s_waitcnt lgkmcnt(5)
  v_smfmac_f32_16x16x64_bf16 v[20:23], v[60:63], v[240:247], v3
  ds_read_b128 v[52:55], v0 offset:16384
  v_smfmac_f32_16x16x64_bf16 v[24:27], v[60:63], a[112:119], v3
  ds_read_b128 v[96:99], v4 offset:2048
  s_waitcnt lgkmcnt(6)
  v_smfmac_f32_16x16x64_bf16 v[20:23], v[64:67], v[184:191], v3
  ds_read_b128 v[56:59], v2 offset:17408
  v_smfmac_f32_16x16x64_bf16 v[24:27], v[64:67], a[56:63], v3
  ds_read_b128 v[100:103], v4 offset:3072
  s_waitcnt lgkmcnt(7)
  v_smfmac_f32_16x16x64_bf16 v[20:23], v[68:71], v[248:255], v3
  ds_read_b128 v[60:63], v0 offset:17408
  v_smfmac_f32_16x16x64_bf16 v[24:27], v[68:71], a[120:127], v3
  ds_read_b128 v[104:107], v4 offset:4096
  s_waitcnt lgkmcnt(7)
  v_smfmac_f32_16x16x64_bf16 v[20:23], v[48:51], v[128:135], v3
  ds_read_b128 v[64:67], v2 offset:20480
  v_smfmac_f32_16x16x64_bf16 v[24:27], v[48:51], a[0:7], v3
  ds_read_b128 v[108:111], v4 offset:5120
  s_waitcnt lgkmcnt(7)
  v_smfmac_f32_16x16x64_bf16 v[20:23], v[52:55], v[192:199], v3
  ds_read_b128 v[68:71], v0 offset:20480
  v_smfmac_f32_16x16x64_bf16 v[24:27], v[52:55], a[64:71], v3
  ds_read_b128 v[112:115], v4 offset:6144
  s_waitcnt lgkmcnt(7)
  v_smfmac_f32_16x16x64_bf16 v[20:23], v[56:59], v[136:143], v3
  ds_read_b128 v[48:51], v2 offset:21504
  v_smfmac_f32_16x16x64_bf16 v[24:27], v[56:59], a[8:15], v3
  ds_read_b128 v[116:119], v4 offset:7168
  s_waitcnt lgkmcnt(7)
  v_smfmac_f32_16x16x64_bf16 v[20:23], v[60:63], v[200:207], v3
  ds_read_b128 v[52:55], v0 offset:21504
  v_smfmac_f32_16x16x64_bf16 v[24:27], v[60:63], a[72:79], v3
  s_waitcnt lgkmcnt(6)
  v_smfmac_f32_16x16x64_bf16 v[28:31], v[64:67], a[160:167], v3
  ds_read_b128 v[56:59], v2 offset:22528
  s_waitcnt lgkmcnt(5)
  v_smfmac_f32_16x16x64_bf16 v[28:31], v[68:71], a[224:231], v3
  ds_read_b128 v[60:63], v0 offset:22528
  s_waitcnt lgkmcnt(4)
  v_smfmac_f32_16x16x64_bf16 v[28:31], v[48:51], a[168:175], v3
  ds_read_b128 v[64:67], v2 offset:23552
  v_cvt_pk_bf16_f32 v12, v20, v21
  v_cvt_pk_bf16_f32 v13, v22, v23
  v_cvt_pk_bf16_f32 v24, v24, v25
  v_cvt_pk_bf16_f32 v25, v26, v27
  ds_write_b64 v5, v[12:13] offset:25088
  ds_write_b64 v5, v[24:25] offset:27136
  s_waitcnt lgkmcnt(5)
  v_smfmac_f32_16x16x64_bf16 v[28:31], v[52:55], a[232:239], v3
  ds_read_b128 v[68:71], v0 offset:23552
  s_waitcnt lgkmcnt(5)
  v_smfmac_f32_16x16x64_bf16 v[28:31], v[56:59], a[176:183], v3
  ds_read_b128 v[48:51], v2 offset:16384
  s_waitcnt lgkmcnt(5)
  v_smfmac_f32_16x16x64_bf16 v[28:31], v[60:63], a[240:247], v3
  ds_read_b128 v[52:55], v0 offset:16384
  s_waitcnt lgkmcnt(3)
  s_barrier
  v_smfmac_f32_16x16x64_bf16 v[28:31], v[64:67], a[184:191], v3
  ds_read_b64_tr_b16 v[72:73], v6 offset:24576
  ds_read_b64_tr_b16 v[74:75], v6 offset:24832
  ds_read_b64_tr_b16 v[76:77], v6 offset:25088
  ds_read_b64_tr_b16 v[78:79], v6 offset:25344
  ds_read_b128 v[56:59], v2 offset:17408
  s_waitcnt lgkmcnt(7)
  v_smfmac_f32_16x16x64_bf16 v[28:31], v[68:71], a[248:255], v3
  ds_read_b64_tr_b16 v[80:81], v6 offset:25600
  ds_read_b64_tr_b16 v[82:83], v6 offset:25856
  ds_read_b64_tr_b16 v[84:85], v6 offset:26112
  ds_read_b64_tr_b16 v[86:87], v6 offset:26368
  ds_read_b128 v[60:63], v0 offset:17408
  s_waitcnt lgkmcnt(11)
  v_smfmac_f32_16x16x64_bf16 v[28:31], v[48:51], a[128:135], v3
  ds_read_b64_tr_b16 v[64:65], v6 offset:26624
  ds_read_b64_tr_b16 v[66:67], v6 offset:26880
  s_waitcnt lgkmcnt(12)
  v_smfmac_f32_16x16x64_bf16 v[28:31], v[52:55], a[192:199], v3
  ds_read_b64_tr_b16 v[68:69], v6 offset:27136
  ds_read_b64_tr_b16 v[70:71], v6 offset:27392
  s_waitcnt lgkmcnt(9)
  v_smfmac_f32_16x16x64_bf16 v[28:31], v[56:59], a[136:143], v3
  ds_read_b64_tr_b16 v[48:49], v6 offset:27648
  ds_read_b64_tr_b16 v[50:51], v6 offset:27904
  s_waitcnt lgkmcnt(6)
  v_smfmac_f32_16x16x64_bf16 v[28:31], v[60:63], a[200:207], v3
  ds_read_b64_tr_b16 v[52:53], v6 offset:28160
  ds_read_b64_tr_b16 v[54:55], v6 offset:28416
  v_mfma_f32_16x16x32_bf16 v[120:123], v[88:91], v[72:75], 0
  v_mfma_f32_16x16x32_bf16 v[120:123], v[92:95], v[76:79], v[120:123]
  v_mfma_f32_16x16x32_bf16 v[120:123], v[96:99], v[80:83], v[120:123]
  v_mfma_f32_16x16x32_bf16 v[120:123], v[100:103], v[84:87], v[120:123]
  s_nop 1
  v_cvt_pk_bf16_f32 v28, v28, v29
  v_cvt_pk_bf16_f32 v29, v30, v31
  ds_write_b64 v7, v[28:29] offset:29184
  v_mfma_f32_16x16x32_bf16 v[124:127], v[104:107], v[72:75], 0
  ds_read_b128 v[88:91], v10 offset:0
  v_mfma_f32_16x16x32_bf16 v[124:127], v[108:111], v[76:79], v[124:127]
  ds_read_b128 v[92:95], v10 offset:1024
  v_mfma_f32_16x16x32_bf16 v[124:127], v[112:115], v[80:83], v[124:127]
  ds_read_b128 v[96:99], v10 offset:2048
  v_mfma_f32_16x16x32_bf16 v[124:127], v[116:119], v[84:87], v[124:127]
  ds_read_b128 v[100:103], v10 offset:3072
  v_max3_f32 v24, v120, v121, v122
  s_waitcnt lgkmcnt(5)
  v_mfma_f32_16x16x32_bf16 v[20:23], v[64:67], v[72:75], 0
  v_mfma_f32_16x16x32_bf16 v[20:23], v[68:71], v[76:79], v[20:23]
  v_mfma_f32_16x16x32_bf16 v[20:23], v[48:51], v[80:83], v[20:23]
  s_nop 1
  v_max3_f32 v24, v24, v123, v124
  v_max3_f32 v24, v24, v125, v126
  v_mfma_f32_16x16x32_bf16 v[20:23], v[52:55], v[84:87], v[20:23]
  ds_read_b128 v[48:51], v10 offset:4096
  ds_read_b128 v[52:55], v10 offset:5120
  ds_read_b128 v[56:59], v10 offset:6144
  ds_read_b128 v[60:63], v10 offset:7168
  ds_read_b128 v[64:67], v1 offset:57344
  ds_read_b128 v[68:71], v1 offset:58368
  s_nop 1
  v_max3_f32 v24, v24, v127, v20
  v_max3_f32 v24, v24, v21, v22
  v_max_f32 v12, v24, v23
  v_max_f32 v24, v24, v23
  s_cmp_eq_u32 s45, 63
  s_cbranch_scc1 K1_R0_FIN
  s_nop 0
  v_permlane16_swap_b32 v24, v12
  v_max_f32 v13, v24, v12
  v_max_f32 v24, v24, v12
  s_nop 1
  v_permlane32_swap_b32 v24, v13
  v_max_f32 v12, v24, v13
  v_pk_add_f32 v[120:121], v[120:121], v[12:13] op_sel_hi:[1,0] neg_lo:[0,1] neg_hi:[0,1]
  v_pk_add_f32 v[122:123], v[122:123], v[12:13] op_sel_hi:[1,0] neg_lo:[0,1] neg_hi:[0,1]
  v_pk_add_f32 v[124:125], v[124:125], v[12:13] op_sel_hi:[1,0] neg_lo:[0,1] neg_hi:[0,1]
  v_pk_add_f32 v[126:127], v[126:127], v[12:13] op_sel_hi:[1,0] neg_lo:[0,1] neg_hi:[0,1]
  v_pk_mul_f32 v[120:121], v[120:121], s[94:95]
  v_pk_mul_f32 v[122:123], v[122:123], s[94:95]
  v_pk_mul_f32 v[124:125], v[124:125], s[94:95]
  v_pk_mul_f32 v[126:127], v[126:127], s[94:95]
  v_exp_f32 v120, v120
  v_exp_f32 v121, v121
  v_exp_f32 v122, v122
  v_exp_f32 v123, v123
  v_exp_f32 v124, v124
  v_exp_f32 v125, v125
  v_exp_f32 v126, v126
  v_exp_f32 v127, v127
  v_cvt_pk_bf16_f32 v24, v120, v121
  v_cvt_pk_bf16_f32 v25, v122, v123
  v_cvt_pk_bf16_f32 v26, v124, v125
  v_cvt_pk_bf16_f32 v27, v126, v127
  v_cndmask_b32 v72, 0, v24, s[58:59]
  v_cndmask_b32 v73, 0, v25, s[58:59]
  v_cndmask_b32 v74, 0, v26, s[58:59]
  v_cndmask_b32 v75, 0, v27, s[58:59]
  v_cndmask_b32 v76, 0, v24, s[60:61]
  v_cndmask_b32 v77, 0, v25, s[60:61]
  v_cndmask_b32 v78, 0, v26, s[60:61]
  v_cndmask_b32 v79, 0, v27, s[60:61]
  s_waitcnt lgkmcnt(2)
  s_barrier
  v_mfma_f32_16x16x32_bf16 v[84:87], v[16:19], v[24:27], 0
  ds_read_b64 v[120:121], v7 offset:28672
  ds_read_b64 v[122:123], v7 offset:29184
  v_sub_f32 v20, v20, v12
  v_sub_f32 v21, v21, v12
  v_mfma_f32_16x16x32_bf16 v[104:107], v[88:91], v[72:75], 0
  ds_read_b64 v[124:125], v7 offset:29696
  ds_read_b64 v[126:127], v7 offset:30208
  v_sub_f32 v22, v22, v12
  v_sub_f32 v23, v23, v12
  v_mfma_f32_16x16x32_bf16 v[104:107], v[92:95], v[76:79], v[104:107]
  s_nop 0
  s_nop 0
  v_mul_f32 v20, s94, v20
  v_mul_f32 v21, s94, v21
  v_mfma_f32_16x16x32_bf16 v[108:111], v[96:99], v[72:75], 0
  ds_read_b128 v[88:91], v1 offset:43008
  ds_read_b128 v[92:95], v1 offset:44032
  v_mul_f32 v22, s94, v22
  v_mul_f32 v23, s94, v23
  v_mfma_f32_16x16x32_bf16 v[108:111], v[100:103], v[76:79], v[108:111]
  ds_read_b128 v[96:99], v1 offset:59392
  ds_read_b128 v[100:103], v1 offset:60416
  v_exp_f32 v20, v20
  v_exp_f32 v21, v21
  v_mfma_f32_16x16x32_bf16 v[112:115], v[48:51], v[72:75], 0
  v_exp_f32 v22, v22
  v_exp_f32 v23, v23
  v_mfma_f32_16x16x32_bf16 v[112:115], v[52:55], v[76:79], v[112:115]
  v_cvt_pk_bf16_f32 v12, v20, v21
  v_cvt_pk_bf16_f32 v13, v22, v23
  v_mfma_f32_16x16x32_bf16 v[116:119], v[56:59], v[72:75], 0
  v_cndmask_b32 v80, 0, v12, s[62:63]
  v_cndmask_b32 v81, 0, v13, s[62:63]
  v_mfma_f32_16x16x32_bf16 v[116:119], v[60:63], v[76:79], v[116:119]
  s_waitcnt lgkmcnt(4)
  v_mfma_f32_16x16x16_bf16 v[84:87], v[16:17], v[80:81], v[84:87]
  ds_read_b128 v[48:51], v1 offset:45056
  ds_read_b128 v[52:55], v1 offset:46080
  v_mov_b64 v[20:21], 0
  v_mov_b64 v[22:23], 0
  v_mfma_f32_16x16x16_bf16 v[104:107], v[120:121], v[80:81], v[104:107]
  ds_read_b128 v[56:59], v1 offset:61440
  ds_read_b128 v[60:63], v1 offset:62464
  v_mov_b64 v[24:25], 0
  v_mov_b64 v[26:27], 0
  v_mfma_f32_16x16x16_bf16 v[108:111], v[122:123], v[80:81], v[108:111]
  v_mov_b64 v[28:29], 0
  v_mov_b64 v[30:31], 0
  v_mfma_f32_16x16x16_bf16 v[112:115], v[124:125], v[80:81], v[112:115]
  v_mfma_f32_16x16x16_bf16 v[116:119], v[126:127], v[80:81], v[116:119]
  ds_read_b128 v[120:123], v1 offset:47104
  ds_read_b128 v[124:127], v1 offset:48128
  v_rcp_f32 v12, v84
  s_nop 0
  v_pk_mul_f32 v[104:105], v[104:105], v[12:13] op_sel_hi:[1,0]
  v_pk_mul_f32 v[106:107], v[106:107], v[12:13] op_sel_hi:[1,0]
  v_pk_mul_f32 v[108:109], v[108:109], v[12:13] op_sel_hi:[1,0]
  v_pk_mul_f32 v[110:111], v[110:111], v[12:13] op_sel_hi:[1,0]
  v_pk_mul_f32 v[112:113], v[112:113], v[12:13] op_sel_hi:[1,0]
  v_pk_mul_f32 v[114:115], v[114:115], v[12:13] op_sel_hi:[1,0]
  v_pk_mul_f32 v[116:117], v[116:117], v[12:13] op_sel_hi:[1,0]
  v_pk_mul_f32 v[118:119], v[118:119], v[12:13] op_sel_hi:[1,0]
  v_cvt_pk_bf16_f32 v72, v104, v105
  v_cvt_pk_bf16_f32 v73, v106, v107
  v_cvt_pk_bf16_f32 v74, v108, v109
  v_cvt_pk_bf16_f32 v75, v110, v111
  v_cvt_pk_bf16_f32 v76, v112, v113
  v_cvt_pk_bf16_f32 v77, v114, v115
  v_cvt_pk_bf16_f32 v78, v116, v117
  v_cvt_pk_bf16_f32 v79, v118, v119
  v_smfmac_f32_16x16x64_bf16 v[20:23], v[72:75], v[32:39], v3
  ds_read_b128 v[104:107], v1 offset:63488
  ds_read_b128 v[108:111], v1 offset:64512
  v_mov_b32_dpp v80, v72 row_ror:8 row_mask:0xf bank_mask:0xf
  v_mov_b32_dpp v81, v73 row_ror:8 row_mask:0xf bank_mask:0xf
  v_mov_b32_dpp v82, v74 row_ror:8 row_mask:0xf bank_mask:0xf
  v_mov_b32_dpp v83, v75 row_ror:8 row_mask:0xf bank_mask:0xf
  v_smfmac_f32_16x16x64_bf16 v[20:23], v[76:79], v[208:215], v3
  v_mov_b32_dpp v84, v76 row_ror:8 row_mask:0xf bank_mask:0xf
  v_mov_b32_dpp v85, v77 row_ror:8 row_mask:0xf bank_mask:0xf
  v_mov_b32_dpp v86, v78 row_ror:8 row_mask:0xf bank_mask:0xf
  v_mov_b32_dpp v87, v79 row_ror:8 row_mask:0xf bank_mask:0xf
  v_smfmac_f32_16x16x64_bf16 v[20:23], v[80:83], v[40:47], v3
  v_mov_b64 v[112:113], 0
  v_smfmac_f32_16x16x64_bf16 v[20:23], v[84:87], v[216:223], v3
  v_mov_b64 v[114:115], 0
  v_smfmac_f32_16x16x64_bf16 v[24:27], v[72:75], v[160:167], v3
  v_smfmac_f32_16x16x64_bf16 v[24:27], v[76:79], v[224:231], v3
  s_nop 4
  v_cvt_pk_bf16_f32 v20, v20, v21
  v_cvt_pk_bf16_f32 v21, v22, v23
  v_smfmac_f32_16x16x64_bf16 v[24:27], v[80:83], v[168:175], v3
  v_max_u32 v20, 1, v20
  v_max_u32 v21, 1, v21
  s_waitcnt lgkmcnt(2)
  v_smfmac_f32_16x16x64_bf16 v[24:27], v[84:87], v[232:239], v3
  buffer_store_dwordx2 v[20:21], v8, s[4:7], s50 offen sc1
  v_smfmac_f32_16x16x64_bf16 v[28:31], v[72:75], v[176:183], v3
  v_smfmac_f32_16x16x64_bf16 v[28:31], v[76:79], v[64:71], v3
  s_nop 4
  v_cvt_pk_bf16_f32 v24, v24, v25
  v_cvt_pk_bf16_f32 v25, v26, v27
  v_smfmac_f32_16x16x64_bf16 v[28:31], v[80:83], v[88:95], v3
  v_max_u32 v24, 1, v24
  v_max_u32 v25, 1, v25
  v_smfmac_f32_16x16x64_bf16 v[28:31], v[84:87], v[96:103], v3
  buffer_store_dwordx2 v[24:25], v8, s[4:7], s51 offen sc1
  v_smfmac_f32_16x16x64_bf16 v[112:115], v[72:75], v[48:55], v3
  v_smfmac_f32_16x16x64_bf16 v[112:115], v[76:79], v[56:63], v3
  s_nop 4
  v_cvt_pk_bf16_f32 v28, v28, v29
  v_cvt_pk_bf16_f32 v29, v30, v31
  s_waitcnt lgkmcnt(0)
  v_smfmac_f32_16x16x64_bf16 v[112:115], v[80:83], v[120:127], v3
  v_max_u32 v28, 1, v28
  v_max_u32 v29, 1, v29
  v_smfmac_f32_16x16x64_bf16 v[112:115], v[84:87], v[104:111], v3
  buffer_store_dwordx2 v[28:29], v8, s[4:7], s52 offen sc1
  s_nop 6
  v_cvt_pk_bf16_f32 v112, v112, v113
  v_cvt_pk_bf16_f32 v113, v114, v115
  v_max_u32 v112, 1, v112
  v_max_u32 v113, 1, v113
  buffer_store_dwordx2 v[112:113], v8, s[4:7], s53 offen sc1
  s_add_u32 s45, s45, 1
  s_add_u32 s56, s56, 262144
  s_add_u32 s46, s46, 8192
  s_add_u32 s36, s46, s55
  v_mov_b64 v[20:21], 0
  v_mov_b64 v[22:23], 0
  v_mov_b64 v[24:25], 0
  v_mov_b64 v[26:27], 0
  v_mov_b64 v[28:29], 0
  v_mov_b64 v[30:31], 0
  v_xor_b32 v4, 0x27000, v4
  v_xor_b32 v10, 0x35000, v10
  s_xor_b32 s50, s50, 2048
  s_xor_b32 s51, s51, 2048
  s_xor_b32 s52, s52, 2048
  s_xor_b32 s53, s53, 2048
  s_nop 7
  s_nop 7
  ds_read_b128 v[64:67], v2 offset:30720
  buffer_load_dwordx4 v[48:51], v9, s[4:7], s54 offen offset:0 sc1
  buffer_load_dwordx4 v[52:55], v9, s[4:7], s54 offen offset:1024 sc1
  s_nop 7
  s_nop 7
  s_nop 7
  s_waitcnt lgkmcnt(0)
K1_R0_W1M1_P1:
  buffer_load_dwordx4 v[56:59], v9, s[4:7], s54 offen offset:0 sc1
  buffer_load_dwordx4 v[60:63], v9, s[4:7], s54 offen offset:1024 sc1
  s_sub_u32 s57, s57, 1
  s_cbranch_scc1 K1_END
  s_waitcnt vmcnt(2)
  v_mfma_f32_16x16x32_bf16 v[68:71], v[64:67], v[48:51], 0
  v_mfma_f32_16x16x32_bf16 v[68:71], v[64:67], v[52:55], v[68:71]
  v_min3_u32 v12, v48, v49, v50
  v_min3_u32 v13, v51, v52, v53
  v_min3_u32 v12, v12, v54, v55
  v_min_u32 v12, v12, v13
  v_cmp_eq_u32 vcc, 0, v12
  s_nop 3
  s_cbranch_vccz K1_R0_W1M1_P1OK
  buffer_load_dwordx4 v[48:51], v9, s[4:7], s54 offen offset:0 sc1
  buffer_load_dwordx4 v[52:55], v9, s[4:7], s54 offen offset:1024 sc1
  s_waitcnt vmcnt(2)
  v_mfma_f32_16x16x32_bf16 v[68:71], v[64:67], v[56:59], 0
  v_mfma_f32_16x16x32_bf16 v[68:71], v[64:67], v[60:63], v[68:71]
  v_min3_u32 v12, v56, v57, v58
  v_min3_u32 v13, v59, v60, v61
  v_min3_u32 v12, v12, v62, v63
  v_min_u32 v12, v12, v13
  v_cmp_eq_u32 vcc, 0, v12
  s_nop 3
  s_cbranch_vccnz K1_R0_W1M1_P1
K1_R0_W1M1_P1OK:
  v_add_f32_dpp v68, v68, v68 row_ror:8 row_mask:0xf bank_mask:0xf
  v_add_f32_dpp v69, v69, v69 row_ror:8 row_mask:0xf bank_mask:0xf
  s_nop 0
  v_add_f32_dpp v68, v68, v68 row_ror:4 row_mask:0xf bank_mask:0xf
  v_add_f32_dpp v69, v69, v69 row_ror:4 row_mask:0xf bank_mask:0xf
  v_cvt_pk_bf16_f32 v68, v68, v69
  v_min_u32 v68, -2, v68
  s_mov_b64 exec, s[92:93]
  buffer_store_dword v68, v11, s[4:7], s36 offen sc1
  s_mov_b64 exec, -1
  s_mov_b32 s47, s54
  s_xor_b32 s54, s54, 2048
  s_add_u32 s49, s49, 128
  s_branch K1_R0_W1M1_LOOP
K1_R0_W2M1:
  ds_read_b128 v[72:75], v1 offset:0
  ds_read_b128 v[76:79], v1 offset:1024
  ds_read_b128 v[80:83], v1 offset:16384
  ds_read_b128 v[84:87], v1 offset:17408
  ds_read_b128 v[88:91], v1 offset:2048
  ds_read_b128 v[92:95], v1 offset:3072
  ds_read_b128 v[96:99], v1 offset:18432
  ds_read_b128 v[100:103], v1 offset:19456
  ds_read_b128 v[104:107], v1 offset:4096
  ds_read_b128 v[108:111], v1 offset:5120
  ds_read_b128 v[112:115], v1 offset:20480
  ds_read_b128 v[116:119], v1 offset:21504
  ds_read_b128 v[120:123], v1 offset:6144
  ds_read_b128 v[124:127], v1 offset:7168
  ds_read_b128 v[32:35], v1 offset:28672
  ds_read_b128 v[36:39], v1 offset:29696
  ds_read_b128 v[40:43], v1 offset:30720
  ds_read_b128 v[44:47], v1 offset:31744
  s_waitcnt lgkmcnt(0)
  ds_write_b128 v1, v[224:227] offset:0
  ds_write_b128 v1, v[228:231] offset:1024
  ds_write_b128 v1, v[232:235] offset:16384
  ds_write_b128 v1, v[236:239] offset:17408
  ds_write_b128 v1, v[176:179] offset:2048
  ds_write_b128 v1, v[180:183] offset:3072
  ds_write_b128 v1, v[240:243] offset:18432
  ds_write_b128 v1, v[244:247] offset:19456
  ds_write_b128 v1, v[184:187] offset:4096
  ds_write_b128 v1, v[188:191] offset:5120
  ds_write_b128 v1, v[248:251] offset:20480
  ds_write_b128 v1, v[252:255] offset:21504
  ds_write_b128 v1, v[128:131] offset:6144
  ds_write_b128 v1, v[132:135] offset:7168
  s_waitcnt lgkmcnt(0)
  v_mov_b64 v[224:225], v[72:73]
  v_mov_b64 v[226:227], v[74:75]
  v_mov_b64 v[228:229], v[76:77]
  v_mov_b64 v[230:231], v[78:79]
  v_mov_b64 v[232:233], v[80:81]
  v_mov_b64 v[234:235], v[82:83]
  v_mov_b64 v[236:237], v[84:85]
  v_mov_b64 v[238:239], v[86:87]
  v_mov_b64 v[176:177], v[88:89]
  v_mov_b64 v[178:179], v[90:91]
  v_mov_b64 v[180:181], v[92:93]
  v_mov_b64 v[182:183], v[94:95]
  v_mov_b64 v[240:241], v[96:97]
  v_mov_b64 v[242:243], v[98:99]
  v_mov_b64 v[244:245], v[100:101]
  v_mov_b64 v[246:247], v[102:103]
  v_mov_b64 v[184:185], v[104:105]
  v_mov_b64 v[186:187], v[106:107]
  v_mov_b64 v[188:189], v[108:109]
  v_mov_b64 v[190:191], v[110:111]
  v_mov_b64 v[248:249], v[112:113]
  v_mov_b64 v[250:251], v[114:115]
  v_mov_b64 v[252:253], v[116:117]
  v_mov_b64 v[254:255], v[118:119]
  v_mov_b64 v[128:129], v[120:121]
  v_mov_b64 v[130:131], v[122:123]
  v_mov_b64 v[132:133], v[124:125]
  v_mov_b64 v[134:135], v[126:127]
  v_mov_b64 v[20:21], 0
  v_mov_b64 v[22:23], 0
  v_mov_b64 v[24:25], 0
  v_mov_b64 v[26:27], 0
  v_mov_b64 v[28:29], 0
  v_mov_b64 v[30:31], 0
  s_mov_b32 s42, 94208
  ds_read_b128 v[88:91], v1 offset:0
  ds_read_b128 v[92:95], v1 offset:1024
  ds_read_b128 v[96:99], v1 offset:16384
  ds_read_b128 v[100:103], v1 offset:17408
  ds_read_b128 v[104:107], v1 offset:2048
  ds_read_b128 v[108:111], v1 offset:3072
  ds_read_b128 v[112:115], v1 offset:18432
  ds_read_b128 v[116:119], v1 offset:19456
  ds_read_b128 v[72:75], v1 offset:4096
  ds_read_b128 v[76:79], v1 offset:5120
  ds_read_b128 v[80:83], v1 offset:20480
  ds_read_b128 v[84:87], v1 offset:21504
  ds_read_b128 v[120:123], v1 offset:6144
  ds_read_b128 v[124:127], v1 offset:7168
  s_branch K1_R0_W2M1_P2OK
K1_R0_W2M1_LOOP:
  ds_read_b128 v[88:91], v1 offset:0
  ds_read_b128 v[92:95], v1 offset:1024
  ds_read_b128 v[96:99], v1 offset:16384
  ds_read_b128 v[100:103], v1 offset:17408
  ds_read_b128 v[104:107], v1 offset:2048
  ds_read_b128 v[108:111], v1 offset:3072
  ds_read_b128 v[112:115], v1 offset:18432
  ds_read_b128 v[116:119], v1 offset:19456
  ds_read_b128 v[72:75], v1 offset:4096
  ds_read_b128 v[76:79], v1 offset:5120
  ds_read_b128 v[80:83], v1 offset:20480
  ds_read_b128 v[84:87], v1 offset:21504
  ds_read_b128 v[120:123], v1 offset:6144
  ds_read_b128 v[124:127], v1 offset:7168
  buffer_load_dwordx4 v[48:51], v9, s[4:7], s46 offen offset:0 sc1
  buffer_load_dwordx4 v[52:55], v9, s[4:7], s46 offen offset:1024 sc1
  s_nop 7
  s_nop 7
  s_nop 7
  s_nop 7
K1_R0_W2M1_P2:
  buffer_load_dwordx4 v[64:67], v9, s[4:7], s46 offen offset:0 sc1
  buffer_load_dwordx4 v[68:71], v9, s[4:7], s46 offen offset:1024 sc1
  s_sub_u32 s57, s57, 1
  s_cbranch_scc1 K1_END
  s_waitcnt vmcnt(2)
  v_max3_u32 v12, v48, v49, v50
  v_max3_u32 v13, v51, v52, v53
  v_max3_u32 v12, v12, v54, v55
  v_max_u32 v12, v12, v13
  v_cmp_eq_u32 vcc, -1, v12
  s_nop 3
  s_cbranch_vccz K1_R0_W2M1_P2OK
  buffer_load_dwordx4 v[48:51], v9, s[4:7], s46 offen offset:0 sc1
  buffer_load_dwordx4 v[52:55], v9, s[4:7], s46 offen offset:1024 sc1
  s_waitcnt vmcnt(2)
  v_max3_u32 v12, v64, v65, v66
  v_max3_u32 v13, v67, v68, v69
  v_max3_u32 v12, v12, v70, v71
  v_max_u32 v12, v12, v13
  v_cmp_eq_u32 vcc, -1, v12
  s_nop 3
  s_cbranch_vccnz K1_R0_W2M1_P2
  v_mov_b64 v[48:49], v[64:65]
  v_mov_b64 v[50:51], v[66:67]
  v_mov_b64 v[52:53], v[68:69]
  v_mov_b64 v[54:55], v[70:71]
  s_nop 1
K1_R0_W2M1_P2OK:
  ds_write_b128 v2, v[48:51] offset:20480
  ds_write_b128 v2, v[52:55] offset:21504
  v_smfmac_f32_16x16x64_bf16 v[20:23], v[48:51], v[160:167], v3
  s_add_u32 s38, s56, -126976
  v_mov_b32_dpp v56, v48 row_ror:8 row_mask:0xf bank_mask:0xf
  v_smfmac_f32_16x16x64_bf16 v[24:27], v[48:51], a[32:39], v3
  buffer_store_dwordx4 v[28:31], v9, s[4:7], s47 offen offset:0 sc1
  v_mov_b32_dpp v57, v49 row_ror:8 row_mask:0xf bank_mask:0xf
  v_smfmac_f32_16x16x64_bf16 v[20:23], v[52:55], v[168:175], v3
  buffer_store_dwordx4 v[28:31], v9, s[4:7], s47 offen offset:1024 sc1
  v_mov_b32_dpp v58, v50 row_ror:8 row_mask:0xf bank_mask:0xf
  v_smfmac_f32_16x16x64_bf16 v[24:27], v[52:55], a[40:47], v3
  v_mov_b32_dpp v59, v51 row_ror:8 row_mask:0xf bank_mask:0xf
  s_waitcnt vmcnt(2)
  v_smfmac_f32_16x16x64_bf16 v[28:31], v[48:51], a[160:167], v3
  ds_read_b64_tr_b16 v[64:65], v6 offset:27648
  ds_read_b64_tr_b16 v[66:67], v6 offset:27904
  v_mov_b32_dpp v60, v52 row_ror:8 row_mask:0xf bank_mask:0xf
  v_mov_b32_dpp v61, v53 row_ror:8 row_mask:0xf bank_mask:0xf
  v_smfmac_f32_16x16x64_bf16 v[28:31], v[52:55], a[168:175], v3
  ds_read_b64 v[68:69], v7 offset:29696
  v_mov_b32_dpp v62, v54 row_ror:8 row_mask:0xf bank_mask:0xf
  v_mov_b32_dpp v63, v55 row_ror:8 row_mask:0xf bank_mask:0xf
  s_waitcnt lgkmcnt(0)
  s_barrier
  buffer_store_dwordx4 v[64:67], v9, s[4:7], s56 offen offset:2048 sc1
  buffer_store_dwordx2 v[68:69], v7, s[4:7], s38 offen offset:1024 sc1
  ds_read_b128 v[64:67], v2 offset:22528
  ds_read_b128 v[68:71], v0 offset:22528
  ds_read_b128 v[48:51], v2 offset:23552
  ds_read_b128 v[52:55], v0 offset:23552
  v_smfmac_f32_16x16x64_bf16 v[20:23], v[56:59], v[88:95], v3
  v_smfmac_f32_16x16x64_bf16 v[24:27], v[56:59], a[96:103], v3
  v_smfmac_f32_16x16x64_bf16 v[28:31], v[56:59], a[224:231], v3
  v_smfmac_f32_16x16x64_bf16 v[20:23], v[60:63], v[96:103], v3
  v_smfmac_f32_16x16x64_bf16 v[24:27], v[60:63], a[104:111], v3
  v_smfmac_f32_16x16x64_bf16 v[28:31], v[60:63], a[232:239], v3
  s_waitcnt lgkmcnt(3)
  v_smfmac_f32_16x16x64_bf16 v[20:23], v[64:67], v[104:111], v3
  ds_read_b128 v[56:59], v2 offset:16384
  v_smfmac_f32_16x16x64_bf16 v[24:27], v[64:67], a[48:55], v3
  s_waitcnt lgkmcnt(3)
  v_smfmac_f32_16x16x64_bf16 v[20:23], v[68:71], v[112:119], v3
  ds_read_b128 v[60:63], v0 offset:16384
  v_smfmac_f32_16x16x64_bf16 v[24:27], v[68:71], a[112:119], v3
  s_waitcnt lgkmcnt(3)
  v_smfmac_f32_16x16x64_bf16 v[20:23], v[48:51], v[72:79], v3
  ds_read_b128 v[64:67], v2 offset:17408
  v_smfmac_f32_16x16x64_bf16 v[24:27], v[48:51], a[56:63], v3
  s_waitcnt lgkmcnt(3)
  v_smfmac_f32_16x16x64_bf16 v[20:23], v[52:55], v[80:87], v3
  ds_read_b128 v[68:71], v0 offset:17408
  v_smfmac_f32_16x16x64_bf16 v[24:27], v[52:55], a[120:127], v3
  ds_read_b128 v[88:91], v4 offset:0
  s_waitcnt lgkmcnt(4)
  v_smfmac_f32_16x16x64_bf16 v[20:23], v[56:59], v[120:127], v3
  ds_read_b128 v[48:51], v2 offset:18432
  v_smfmac_f32_16x16x64_bf16 v[24:27], v[56:59], a[0:7], v3
  ds_read_b128 v[92:95], v4 offset:1024
  s_waitcnt lgkmcnt(5)
  v_smfmac_f32_16x16x64_bf16 v[20:23], v[60:63], v[192:199], v3
  ds_read_b128 v[52:55], v0 offset:18432
  v_smfmac_f32_16x16x64_bf16 v[24:27], v[60:63], a[64:71], v3
  ds_read_b128 v[96:99], v4 offset:2048
  s_add_u32 s48, s48, 524288
  s_mov_b32 m0, s42
  s_xor_b32 s42, s42, 217088
  buffer_load_dwordx4 v9, s[4:7], s48 offen offset:0 lds
  buffer_load_dwordx4 v9, s[4:7], s48 offen offset:1024 lds
  buffer_load_dwordx4 v9, s[4:7], s48 offen offset:2048 lds
  buffer_load_dwordx4 v9, s[4:7], s48 offen offset:3072 lds
  s_waitcnt lgkmcnt(6)
  v_smfmac_f32_16x16x64_bf16 v[20:23], v[64:67], v[136:143], v3
  ds_read_b128 v[56:59], v2 offset:19456
  v_smfmac_f32_16x16x64_bf16 v[24:27], v[64:67], a[8:15], v3
  ds_read_b128 v[100:103], v4 offset:3072
  s_waitcnt lgkmcnt(7)
  v_smfmac_f32_16x16x64_bf16 v[20:23], v[68:71], v[200:207], v3
  ds_read_b128 v[60:63], v0 offset:19456
  v_smfmac_f32_16x16x64_bf16 v[24:27], v[68:71], a[72:79], v3
  ds_read_b128 v[104:107], v4 offset:4096
  s_waitcnt lgkmcnt(7)
  v_smfmac_f32_16x16x64_bf16 v[20:23], v[48:51], v[144:151], v3
  ds_read_b128 v[64:67], v2 offset:22528
  v_smfmac_f32_16x16x64_bf16 v[24:27], v[48:51], a[16:23], v3
  ds_read_b128 v[108:111], v4 offset:5120
  s_waitcnt lgkmcnt(7)
  v_smfmac_f32_16x16x64_bf16 v[20:23], v[52:55], v[208:215], v3
  ds_read_b128 v[68:71], v0 offset:22528
  v_smfmac_f32_16x16x64_bf16 v[24:27], v[52:55], a[80:87], v3
  ds_read_b128 v[112:115], v4 offset:6144
  s_waitcnt lgkmcnt(7)
  v_smfmac_f32_16x16x64_bf16 v[20:23], v[56:59], v[152:159], v3
  ds_read_b128 v[48:51], v2 offset:23552
  v_smfmac_f32_16x16x64_bf16 v[24:27], v[56:59], a[24:31], v3
  ds_read_b128 v[116:119], v4 offset:7168
  s_waitcnt lgkmcnt(7)
  v_smfmac_f32_16x16x64_bf16 v[20:23], v[60:63], v[216:223], v3
  ds_read_b128 v[52:55], v0 offset:23552
  v_smfmac_f32_16x16x64_bf16 v[24:27], v[60:63], a[88:95], v3
  s_waitcnt lgkmcnt(6)
  v_smfmac_f32_16x16x64_bf16 v[28:31], v[64:67], a[176:183], v3
  ds_read_b128 v[56:59], v2 offset:16384
  s_waitcnt lgkmcnt(5)
  v_smfmac_f32_16x16x64_bf16 v[28:31], v[68:71], a[240:247], v3
  ds_read_b128 v[60:63], v0 offset:16384
  s_waitcnt lgkmcnt(4)
  v_smfmac_f32_16x16x64_bf16 v[28:31], v[48:51], a[184:191], v3
  ds_read_b128 v[64:67], v2 offset:17408
  v_cvt_pk_bf16_f32 v12, v20, v21
  v_cvt_pk_bf16_f32 v13, v22, v23
  v_cvt_pk_bf16_f32 v24, v24, v25
  v_cvt_pk_bf16_f32 v25, v26, v27
  ds_write_b64 v5, v[12:13] offset:25600
  ds_write_b64 v5, v[24:25] offset:27648
  s_waitcnt lgkmcnt(5)
  v_smfmac_f32_16x16x64_bf16 v[28:31], v[52:55], a[248:255], v3
  ds_read_b128 v[68:71], v0 offset:17408
  s_waitcnt lgkmcnt(5)
  v_smfmac_f32_16x16x64_bf16 v[28:31], v[56:59], a[128:135], v3
  ds_read_b128 v[48:51], v2 offset:18432
  s_waitcnt lgkmcnt(5)
  v_smfmac_f32_16x16x64_bf16 v[28:31], v[60:63], a[192:199], v3
  ds_read_b128 v[52:55], v0 offset:18432
  s_waitcnt lgkmcnt(3)
  s_barrier
  v_smfmac_f32_16x16x64_bf16 v[28:31], v[64:67], a[136:143], v3
  ds_read_b64_tr_b16 v[72:73], v6 offset:24576
  ds_read_b64_tr_b16 v[74:75], v6 offset:24832
  ds_read_b64_tr_b16 v[76:77], v6 offset:25088
  ds_read_b64_tr_b16 v[78:79], v6 offset:25344
  ds_read_b128 v[56:59], v2 offset:19456
  s_waitcnt lgkmcnt(7)
  v_smfmac_f32_16x16x64_bf16 v[28:31], v[68:71], a[200:207], v3
  ds_read_b64_tr_b16 v[80:81], v6 offset:25600
  ds_read_b64_tr_b16 v[82:83], v6 offset:25856
  ds_read_b64_tr_b16 v[84:85], v6 offset:26112
  ds_read_b64_tr_b16 v[86:87], v6 offset:26368
  ds_read_b128 v[60:63], v0 offset:19456
  s_waitcnt lgkmcnt(11)
  v_smfmac_f32_16x16x64_bf16 v[28:31], v[48:51], a[144:151], v3
  ds_read_b64_tr_b16 v[64:65], v6 offset:26624
  ds_read_b64_tr_b16 v[66:67], v6 offset:26880
  s_waitcnt lgkmcnt(12)
  v_smfmac_f32_16x16x64_bf16 v[28:31], v[52:55], a[208:215], v3
  ds_read_b64_tr_b16 v[68:69], v6 offset:27136
  ds_read_b64_tr_b16 v[70:71], v6 offset:27392
  s_waitcnt lgkmcnt(9)
  v_smfmac_f32_16x16x64_bf16 v[28:31], v[56:59], a[152:159], v3
  ds_read_b64_tr_b16 v[48:49], v6 offset:27648
  ds_read_b64_tr_b16 v[50:51], v6 offset:27904
  s_waitcnt lgkmcnt(6)
  v_smfmac_f32_16x16x64_bf16 v[28:31], v[60:63], a[216:223], v3
  ds_read_b64_tr_b16 v[52:53], v6 offset:28160
  ds_read_b64_tr_b16 v[54:55], v6 offset:28416
  v_mfma_f32_16x16x32_bf16 v[120:123], v[88:91], v[72:75], 0
  v_mfma_f32_16x16x32_bf16 v[120:123], v[92:95], v[76:79], v[120:123]
  v_mfma_f32_16x16x32_bf16 v[120:123], v[96:99], v[80:83], v[120:123]
  v_mfma_f32_16x16x32_bf16 v[120:123], v[100:103], v[84:87], v[120:123]
  s_nop 1
  v_cvt_pk_bf16_f32 v28, v28, v29
  v_cvt_pk_bf16_f32 v29, v30, v31
  ds_write_b64 v7, v[28:29] offset:29696
  v_mfma_f32_16x16x32_bf16 v[124:127], v[104:107], v[72:75], 0
  ds_read_b128 v[88:91], v10 offset:0
  v_mfma_f32_16x16x32_bf16 v[124:127], v[108:111], v[76:79], v[124:127]
  ds_read_b128 v[92:95], v10 offset:1024
  v_mfma_f32_16x16x32_bf16 v[124:127], v[112:115], v[80:83], v[124:127]
  ds_read_b128 v[96:99], v10 offset:2048
  v_mfma_f32_16x16x32_bf16 v[124:127], v[116:119], v[84:87], v[124:127]
  ds_read_b128 v[100:103], v10 offset:3072
  v_max3_f32 v24, v120, v121, v122
  s_waitcnt lgkmcnt(5)
  v_mfma_f32_16x16x32_bf16 v[20:23], v[64:67], v[72:75], 0
  v_mfma_f32_16x16x32_bf16 v[20:23], v[68:71], v[76:79], v[20:23]
  v_mfma_f32_16x16x32_bf16 v[20:23], v[48:51], v[80:83], v[20:23]
  s_nop 1
  v_max3_f32 v24, v24, v123, v124
  v_max3_f32 v24, v24, v125, v126
  v_mfma_f32_16x16x32_bf16 v[20:23], v[52:55], v[84:87], v[20:23]
  ds_read_b128 v[48:51], v10 offset:4096
  ds_read_b128 v[52:55], v10 offset:5120
  ds_read_b128 v[56:59], v10 offset:6144
  ds_read_b128 v[60:63], v10 offset:7168
  ds_read_b128 v[64:67], v1 offset:22528
  ds_read_b128 v[68:71], v1 offset:23552
  s_nop 1
  v_max3_f32 v24, v24, v127, v20
  v_max3_f32 v24, v24, v21, v22
  v_max_f32 v12, v24, v23
  v_max_f32 v24, v24, v23
  s_cmp_eq_u32 s45, 63
  s_cbranch_scc1 K1_R0_FIN
  s_nop 0
  v_permlane16_swap_b32 v24, v12
  v_max_f32 v13, v24, v12
  v_max_f32 v24, v24, v12
  s_nop 1
  v_permlane32_swap_b32 v24, v13
  v_max_f32 v12, v24, v13
  v_pk_add_f32 v[120:121], v[120:121], v[12:13] op_sel_hi:[1,0] neg_lo:[0,1] neg_hi:[0,1]
  v_pk_add_f32 v[122:123], v[122:123], v[12:13] op_sel_hi:[1,0] neg_lo:[0,1] neg_hi:[0,1]
  v_pk_add_f32 v[124:125], v[124:125], v[12:13] op_sel_hi:[1,0] neg_lo:[0,1] neg_hi:[0,1]
  v_pk_add_f32 v[126:127], v[126:127], v[12:13] op_sel_hi:[1,0] neg_lo:[0,1] neg_hi:[0,1]
  v_pk_mul_f32 v[120:121], v[120:121], s[94:95]
  v_pk_mul_f32 v[122:123], v[122:123], s[94:95]
  v_pk_mul_f32 v[124:125], v[124:125], s[94:95]
  v_pk_mul_f32 v[126:127], v[126:127], s[94:95]
  v_exp_f32 v120, v120
  v_exp_f32 v121, v121
  v_exp_f32 v122, v122
  v_exp_f32 v123, v123
  v_exp_f32 v124, v124
  v_exp_f32 v125, v125
  v_exp_f32 v126, v126
  v_exp_f32 v127, v127
  v_cvt_pk_bf16_f32 v24, v120, v121
  v_cvt_pk_bf16_f32 v25, v122, v123
  v_cvt_pk_bf16_f32 v26, v124, v125
  v_cvt_pk_bf16_f32 v27, v126, v127
  v_cndmask_b32 v72, 0, v24, s[58:59]
  v_cndmask_b32 v73, 0, v25, s[58:59]
  v_cndmask_b32 v74, 0, v26, s[58:59]
  v_cndmask_b32 v75, 0, v27, s[58:59]
  v_cndmask_b32 v76, 0, v24, s[60:61]
  v_cndmask_b32 v77, 0, v25, s[60:61]
  v_cndmask_b32 v78, 0, v26, s[60:61]
  v_cndmask_b32 v79, 0, v27, s[60:61]
  s_waitcnt lgkmcnt(2)
  s_barrier
  v_mfma_f32_16x16x32_bf16 v[84:87], v[16:19], v[24:27], 0
  ds_read_b64 v[120:121], v7 offset:28672
  ds_read_b64 v[122:123], v7 offset:29184
  v_sub_f32 v20, v20, v12
  v_sub_f32 v21, v21, v12
  v_mfma_f32_16x16x32_bf16 v[104:107], v[88:91], v[72:75], 0
  ds_read_b64 v[124:125], v7 offset:29696
  ds_read_b64 v[126:127], v7 offset:30208
  v_sub_f32 v22, v22, v12
  v_sub_f32 v23, v23, v12
  v_mfma_f32_16x16x32_bf16 v[104:107], v[92:95], v[76:79], v[104:107]
  s_nop 0
  s_nop 0
  v_mul_f32 v20, s94, v20
  v_mul_f32 v21, s94, v21
  v_mfma_f32_16x16x32_bf16 v[108:111], v[96:99], v[72:75], 0
  ds_read_b128 v[88:91], v1 offset:8192
  ds_read_b128 v[92:95], v1 offset:9216
  v_mul_f32 v22, s94, v22
  v_mul_f32 v23, s94, v23
  v_mfma_f32_16x16x32_bf16 v[108:111], v[100:103], v[76:79], v[108:111]
  ds_read_b128 v[96:99], v1 offset:24576
  ds_read_b128 v[100:103], v1 offset:25600
  v_exp_f32 v20, v20
  v_exp_f32 v21, v21
  v_mfma_f32_16x16x32_bf16 v[112:115], v[48:51], v[72:75], 0
  v_exp_f32 v22, v22
  v_exp_f32 v23, v23
  v_mfma_f32_16x16x32_bf16 v[112:115], v[52:55], v[76:79], v[112:115]
  v_cvt_pk_bf16_f32 v12, v20, v21
  v_cvt_pk_bf16_f32 v13, v22, v23
  v_mfma_f32_16x16x32_bf16 v[116:119], v[56:59], v[72:75], 0
  v_cndmask_b32 v80, 0, v12, s[62:63]
  v_cndmask_b32 v81, 0, v13, s[62:63]
  v_mfma_f32_16x16x32_bf16 v[116:119], v[60:63], v[76:79], v[116:119]
  s_waitcnt lgkmcnt(4)
  v_mfma_f32_16x16x16_bf16 v[84:87], v[16:17], v[80:81], v[84:87]
  ds_read_b128 v[48:51], v1 offset:10240
  ds_read_b128 v[52:55], v1 offset:11264
  v_mov_b64 v[20:21], 0
  v_mov_b64 v[22:23], 0
  v_mfma_f32_16x16x16_bf16 v[104:107], v[120:121], v[80:81], v[104:107]
  ds_read_b128 v[56:59], v1 offset:26624
  ds_read_b128 v[60:63], v1 offset:27648
  v_mov_b64 v[24:25], 0
  v_mov_b64 v[26:27], 0
  v_mfma_f32_16x16x16_bf16 v[108:111], v[122:123], v[80:81], v[108:111]
  v_mov_b64 v[28:29], 0
  v_mov_b64 v[30:31], 0
  v_mfma_f32_16x16x16_bf16 v[112:115], v[124:125], v[80:81], v[112:115]
  v_mfma_f32_16x16x16_bf16 v[116:119], v[126:127], v[80:81], v[116:119]
  ds_read_b128 v[120:123], v1 offset:12288
  ds_read_b128 v[124:127], v1 offset:13312
  v_rcp_f32 v12, v84
  s_nop 0
  v_pk_mul_f32 v[104:105], v[104:105], v[12:13] op_sel_hi:[1,0]
  v_pk_mul_f32 v[106:107], v[106:107], v[12:13] op_sel_hi:[1,0]
  v_pk_mul_f32 v[108:109], v[108:109], v[12:13] op_sel_hi:[1,0]
  v_pk_mul_f32 v[110:111], v[110:111], v[12:13] op_sel_hi:[1,0]
  v_pk_mul_f32 v[112:113], v[112:113], v[12:13] op_sel_hi:[1,0]
  v_pk_mul_f32 v[114:115], v[114:115], v[12:13] op_sel_hi:[1,0]
  v_pk_mul_f32 v[116:117], v[116:117], v[12:13] op_sel_hi:[1,0]
  v_pk_mul_f32 v[118:119], v[118:119], v[12:13] op_sel_hi:[1,0]
  v_cvt_pk_bf16_f32 v72, v104, v105
  v_cvt_pk_bf16_f32 v73, v106, v107
  v_cvt_pk_bf16_f32 v74, v108, v109
  v_cvt_pk_bf16_f32 v75, v110, v111
  v_cvt_pk_bf16_f32 v76, v112, v113
  v_cvt_pk_bf16_f32 v77, v114, v115
  v_cvt_pk_bf16_f32 v78, v116, v117
  v_cvt_pk_bf16_f32 v79, v118, v119
  v_smfmac_f32_16x16x64_bf16 v[20:23], v[72:75], v[224:231], v3
  ds_read_b128 v[104:107], v1 offset:14336
  ds_read_b128 v[108:111], v1 offset:15360
  v_mov_b32_dpp v80, v72 row_ror:8 row_mask:0xf bank_mask:0xf
  v_mov_b32_dpp v81, v73 row_ror:8 row_mask:0xf bank_mask:0xf
  v_mov_b32_dpp v82, v74 row_ror:8 row_mask:0xf bank_mask:0xf
  v_mov_b32_dpp v83, v75 row_ror:8 row_mask:0xf bank_mask:0xf
  v_smfmac_f32_16x16x64_bf16 v[20:23], v[76:79], v[232:239], v3
  v_mov_b32_dpp v84, v76 row_ror:8 row_mask:0xf bank_mask:0xf
  v_mov_b32_dpp v85, v77 row_ror:8 row_mask:0xf bank_mask:0xf
  v_mov_b32_dpp v86, v78 row_ror:8 row_mask:0xf bank_mask:0xf
  v_mov_b32_dpp v87, v79 row_ror:8 row_mask:0xf bank_mask:0xf
  v_smfmac_f32_16x16x64_bf16 v[20:23], v[80:83], v[176:183], v3
  v_mov_b64 v[112:113], 0
  v_smfmac_f32_16x16x64_bf16 v[20:23], v[84:87], v[240:247], v3
  v_mov_b64 v[114:115], 0
  v_smfmac_f32_16x16x64_bf16 v[24:27], v[72:75], v[184:191], v3
  v_smfmac_f32_16x16x64_bf16 v[24:27], v[76:79], v[248:255], v3
  s_nop 4
  v_cvt_pk_bf16_f32 v20, v20, v21
  v_cvt_pk_bf16_f32 v21, v22, v23
  v_smfmac_f32_16x16x64_bf16 v[24:27], v[80:83], v[128:135], v3
  v_max_u32 v20, 1, v20
  v_max_u32 v21, 1, v21
  s_waitcnt lgkmcnt(2)
  v_smfmac_f32_16x16x64_bf16 v[24:27], v[84:87], v[64:71], v3
  buffer_store_dwordx2 v[20:21], v8, s[4:7], s50 offen sc1
  v_smfmac_f32_16x16x64_bf16 v[28:31], v[72:75], v[88:95], v3
  v_smfmac_f32_16x16x64_bf16 v[28:31], v[76:79], v[96:103], v3
  s_nop 4
  v_cvt_pk_bf16_f32 v24, v24, v25
  v_cvt_pk_bf16_f32 v25, v26, v27
  v_smfmac_f32_16x16x64_bf16 v[28:31], v[80:83], v[48:55], v3
  v_max_u32 v24, 1, v24
  v_max_u32 v25, 1, v25
  v_smfmac_f32_16x16x64_bf16 v[28:31], v[84:87], v[56:63], v3
  buffer_store_dwordx2 v[24:25], v8, s[4:7], s51 offen sc1
  v_smfmac_f32_16x16x64_bf16 v[112:115], v[72:75], v[120:127], v3
  v_smfmac_f32_16x16x64_bf16 v[112:115], v[76:79], v[32:39], v3
  s_nop 4
  v_cvt_pk_bf16_f32 v28, v28, v29
  v_cvt_pk_bf16_f32 v29, v30, v31
  s_waitcnt lgkmcnt(0)
  v_smfmac_f32_16x16x64_bf16 v[112:115], v[80:83], v[104:111], v3
  v_max_u32 v28, 1, v28
  v_max_u32 v29, 1, v29
  v_smfmac_f32_16x16x64_bf16 v[112:115], v[84:87], v[40:47], v3
  buffer_store_dwordx2 v[28:29], v8, s[4:7], s52 offen sc1
  s_nop 6
  v_cvt_pk_bf16_f32 v112, v112, v113
  v_cvt_pk_bf16_f32 v113, v114, v115
  v_max_u32 v112, 1, v112
  v_max_u32 v113, 1, v113
  buffer_store_dwordx2 v[112:113], v8, s[4:7], s53 offen sc1
  s_add_u32 s45, s45, 1
  s_add_u32 s56, s56, 262144
  s_add_u32 s46, s46, 8192
  s_add_u32 s36, s46, s55
  v_mov_b64 v[20:21], 0
  v_mov_b64 v[22:23], 0
  v_mov_b64 v[24:25], 0
  v_mov_b64 v[26:27], 0
  v_mov_b64 v[28:29], 0
  v_mov_b64 v[30:31], 0
  v_xor_b32 v4, 0x27000, v4
  v_xor_b32 v10, 0x35000, v10
  s_xor_b32 s50, s50, 2048
  s_xor_b32 s51, s51, 2048
  s_xor_b32 s52, s52, 2048
  s_xor_b32 s53, s53, 2048
  s_nop 7
  s_nop 7
  ds_read_b128 v[64:67], v2 offset:30720
  buffer_load_dwordx4 v[48:51], v9, s[4:7], s54 offen offset:0 sc1
  buffer_load_dwordx4 v[52:55], v9, s[4:7], s54 offen offset:1024 sc1
  s_nop 7
  s_nop 7
  s_nop 7
  s_waitcnt lgkmcnt(0)
K1_R0_W2M1_P1:
  buffer_load_dwordx4 v[56:59], v9, s[4:7], s54 offen offset:0 sc1
  buffer_load_dwordx4 v[60:63], v9, s[4:7], s54 offen offset:1024 sc1
  s_sub_u32 s57, s57, 1
  s_cbranch_scc1 K1_END
  s_waitcnt vmcnt(2)
  v_mfma_f32_16x16x32_bf16 v[68:71], v[64:67], v[48:51], 0
  v_mfma_f32_16x16x32_bf16 v[68:71], v[64:67], v[52:55], v[68:71]
  v_min3_u32 v12, v48, v49, v50
  v_min3_u32 v13, v51, v52, v53
  v_min3_u32 v12, v12, v54, v55
  v_min_u32 v12, v12, v13
  v_cmp_eq_u32 vcc, 0, v12
  s_nop 3
  s_cbranch_vccz K1_R0_W2M1_P1OK
  buffer_load_dwordx4 v[48:51], v9, s[4:7], s54 offen offset:0 sc1
  buffer_load_dwordx4 v[52:55], v9, s[4:7], s54 offen offset:1024 sc1
  s_waitcnt vmcnt(2)
  v_mfma_f32_16x16x32_bf16 v[68:71], v[64:67], v[56:59], 0
  v_mfma_f32_16x16x32_bf16 v[68:71], v[64:67], v[60:63], v[68:71]
  v_min3_u32 v12, v56, v57, v58
  v_min3_u32 v13, v59, v60, v61
  v_min3_u32 v12, v12, v62, v63
  v_min_u32 v12, v12, v13
  v_cmp_eq_u32 vcc, 0, v12
  s_nop 3
  s_cbranch_vccnz K1_R0_W2M1_P1
K1_R0_W2M1_P1OK:
  v_add_f32_dpp v68, v68, v68 row_ror:8 row_mask:0xf bank_mask:0xf
  v_add_f32_dpp v69, v69, v69 row_ror:8 row_mask:0xf bank_mask:0xf
  s_nop 0
  v_add_f32_dpp v68, v68, v68 row_ror:4 row_mask:0xf bank_mask:0xf
  v_add_f32_dpp v69, v69, v69 row_ror:4 row_mask:0xf bank_mask:0xf
  v_cvt_pk_bf16_f32 v68, v68, v69
  v_min_u32 v68, -2, v68
  s_mov_b64 exec, s[92:93]
  buffer_store_dword v68, v11, s[4:7], s36 offen sc1
  s_mov_b64 exec, -1
  s_mov_b32 s47, s54
  s_xor_b32 s54, s54, 2048
  s_add_u32 s49, s49, 128
  s_branch K1_R0_W2M1_LOOP
K1_R0_W3M1:
  ds_read_b128 v[72:75], v1 offset:49152
  ds_read_b128 v[76:79], v1 offset:50176
  ds_read_b128 v[80:83], v1 offset:51200
  ds_read_b128 v[84:87], v1 offset:52224
  ds_read_b128 v[88:91], v1 offset:36864
  ds_read_b128 v[92:95], v1 offset:37888
  ds_read_b128 v[96:99], v1 offset:53248
  ds_read_b128 v[100:103], v1 offset:54272
  ds_read_b128 v[104:107], v1 offset:38912
  ds_read_b128 v[108:111], v1 offset:39936
  ds_read_b128 v[112:115], v1 offset:55296
  ds_read_b128 v[116:119], v1 offset:56320
  ds_read_b128 v[120:123], v1 offset:40960
  ds_read_b128 v[124:127], v1 offset:41984
  ds_read_b128 v[32:35], v1 offset:32768
  ds_read_b128 v[36:39], v1 offset:33792
  ds_read_b128 v[40:43], v1 offset:34816
  ds_read_b128 v[44:47], v1 offset:35840
  s_waitcnt lgkmcnt(0)
  ds_write_b128 v1, v[240:243] offset:49152
  ds_write_b128 v1, v[244:247] offset:50176
  ds_write_b128 v1, v[248:251] offset:51200
  ds_write_b128 v1, v[252:255] offset:52224
  ds_write_b128 v1, v[128:131] offset:36864
  ds_write_b128 v1, v[132:135] offset:37888
  ds_write_b128 v1, v[192:195] offset:53248
  ds_write_b128 v1, v[196:199] offset:54272
  ds_write_b128 v1, v[136:139] offset:38912
  ds_write_b128 v1, v[140:143] offset:39936
  ds_write_b128 v1, v[200:203] offset:55296
  ds_write_b128 v1, v[204:207] offset:56320
  ds_write_b128 v1, v[144:147] offset:40960
  ds_write_b128 v1, v[148:151] offset:41984
  s_waitcnt lgkmcnt(0)
  v_mov_b64 v[240:241], v[72:73]
  v_mov_b64 v[242:243], v[74:75]
  v_mov_b64 v[244:245], v[76:77]
  v_mov_b64 v[246:247], v[78:79]
  v_mov_b64 v[248:249], v[80:81]
  v_mov_b64 v[250:251], v[82:83]
  v_mov_b64 v[252:253], v[84:85]
  v_mov_b64 v[254:255], v[86:87]
  v_mov_b64 v[128:129], v[88:89]
  v_mov_b64 v[130:131], v[90:91]
  v_mov_b64 v[132:133], v[92:93]
  v_mov_b64 v[134:135], v[94:95]
  v_mov_b64 v[192:193], v[96:97]
  v_mov_b64 v[194:195], v[98:99]
  v_mov_b64 v[196:197], v[100:101]
  v_mov_b64 v[198:199], v[102:103]
  v_mov_b64 v[136:137], v[104:105]
  v_mov_b64 v[138:139], v[106:107]
  v_mov_b64 v[140:141], v[108:109]
  v_mov_b64 v[142:143], v[110:111]
  v_mov_b64 v[200:201], v[112:113]
  v_mov_b64 v[202:203], v[114:115]
  v_mov_b64 v[204:205], v[116:117]
  v_mov_b64 v[206:207], v[118:119]
  v_mov_b64 v[144:145], v[120:121]
  v_mov_b64 v[146:147], v[122:123]
  v_mov_b64 v[148:149], v[124:125]
  v_mov_b64 v[150:151], v[126:127]
  v_mov_b64 v[20:21], 0
  v_mov_b64 v[22:23], 0
  v_mov_b64 v[24:25], 0
  v_mov_b64 v[26:27], 0
  v_mov_b64 v[28:29], 0
  v_mov_b64 v[30:31], 0
  s_mov_b32 s42, 98304
  ds_read_b128 v[88:91], v1 offset:49152
  ds_read_b128 v[92:95], v1 offset:50176
  ds_read_b128 v[96:99], v1 offset:51200
  ds_read_b128 v[100:103], v1 offset:52224
  ds_read_b128 v[104:107], v1 offset:36864
  ds_read_b128 v[108:111], v1 offset:37888
  ds_read_b128 v[112:115], v1 offset:53248
  ds_read_b128 v[116:119], v1 offset:54272
  ds_read_b128 v[72:75], v1 offset:38912
  ds_read_b128 v[76:79], v1 offset:39936
  ds_read_b128 v[80:83], v1 offset:55296
  ds_read_b128 v[84:87], v1 offset:56320
  ds_read_b128 v[120:123], v1 offset:40960
  ds_read_b128 v[124:127], v1 offset:41984
  s_branch K1_R0_W3M1_P2OK
K1_R0_W3M1_LOOP:
  ds_read_b128 v[88:91], v1 offset:49152
  ds_read_b128 v[92:95], v1 offset:50176
  ds_read_b128 v[96:99], v1 offset:51200
  ds_read_b128 v[100:103], v1 offset:52224
  ds_read_b128 v[104:107], v1 offset:36864
  ds_read_b128 v[108:111], v1 offset:37888
  ds_read_b128 v[112:115], v1 offset:53248
  ds_read_b128 v[116:119], v1 offset:54272
  ds_read_b128 v[72:75], v1 offset:38912
  ds_read_b128 v[76:79], v1 offset:39936
  ds_read_b128 v[80:83], v1 offset:55296
  ds_read_b128 v[84:87], v1 offset:56320
  ds_read_b128 v[120:123], v1 offset:40960
  ds_read_b128 v[124:127], v1 offset:41984
  buffer_load_dwordx4 v[48:51], v9, s[4:7], s46 offen offset:0 sc1
  buffer_load_dwordx4 v[52:55], v9, s[4:7], s46 offen offset:1024 sc1
  s_nop 7
  s_nop 7
  s_nop 7
  s_nop 7
K1_R0_W3M1_P2:
  buffer_load_dwordx4 v[64:67], v9, s[4:7], s46 offen offset:0 sc1
  buffer_load_dwordx4 v[68:71], v9, s[4:7], s46 offen offset:1024 sc1
  s_sub_u32 s57, s57, 1
  s_cbranch_scc1 K1_END
  s_waitcnt vmcnt(2)
  v_max3_u32 v12, v48, v49, v50
  v_max3_u32 v13, v51, v52, v53
  v_max3_u32 v12, v12, v54, v55
  v_max_u32 v12, v12, v13
  v_cmp_eq_u32 vcc, -1, v12
  s_nop 3
  s_cbranch_vccz K1_R0_W3M1_P2OK
  buffer_load_dwordx4 v[48:51], v9, s[4:7], s46 offen offset:0 sc1
  buffer_load_dwordx4 v[52:55], v9, s[4:7], s46 offen offset:1024 sc1
  s_waitcnt vmcnt(2)
  v_max3_u32 v12, v64, v65, v66
  v_max3_u32 v13, v67, v68, v69
  v_max3_u32 v12, v12, v70, v71
  v_max_u32 v12, v12, v13
  v_cmp_eq_u32 vcc, -1, v12
  s_nop 3
  s_cbranch_vccnz K1_R0_W3M1_P2
  v_mov_b64 v[48:49], v[64:65]
  v_mov_b64 v[50:51], v[66:67]
  v_mov_b64 v[52:53], v[68:69]
  v_mov_b64 v[54:55], v[70:71]
  s_nop 1
K1_R0_W3M1_P2OK:
  ds_write_b128 v2, v[48:51] offset:22528
  ds_write_b128 v2, v[52:55] offset:23552
  v_smfmac_f32_16x16x64_bf16 v[20:23], v[48:51], v[176:183], v3
  s_add_u32 s38, s56, -126976
  v_mov_b32_dpp v56, v48 row_ror:8 row_mask:0xf bank_mask:0xf
  v_smfmac_f32_16x16x64_bf16 v[24:27], v[48:51], a[48:55], v3
  buffer_store_dwordx4 v[28:31], v9, s[4:7], s47 offen offset:0 sc1
  v_mov_b32_dpp v57, v49 row_ror:8 row_mask:0xf bank_mask:0xf
  v_smfmac_f32_16x16x64_bf16 v[20:23], v[52:55], v[184:191], v3
  buffer_store_dwordx4 v[28:31], v9, s[4:7], s47 offen offset:1024 sc1
  v_mov_b32_dpp v58, v50 row_ror:8 row_mask:0xf bank_mask:0xf
  v_smfmac_f32_16x16x64_bf16 v[24:27], v[52:55], a[56:63], v3
  v_mov_b32_dpp v59, v51 row_ror:8 row_mask:0xf bank_mask:0xf
  s_waitcnt vmcnt(2)
  v_smfmac_f32_16x16x64_bf16 v[28:31], v[48:51], a[176:183], v3
  ds_read_b64_tr_b16 v[64:65], v6 offset:28160
  ds_read_b64_tr_b16 v[66:67], v6 offset:28416
  v_mov_b32_dpp v60, v52 row_ror:8 row_mask:0xf bank_mask:0xf
  v_mov_b32_dpp v61, v53 row_ror:8 row_mask:0xf bank_mask:0xf
  v_smfmac_f32_16x16x64_bf16 v[28:31], v[52:55], a[184:191], v3
  ds_read_b64 v[68:69], v7 offset:30208
  v_mov_b32_dpp v62, v54 row_ror:8 row_mask:0xf bank_mask:0xf
  v_mov_b32_dpp v63, v55 row_ror:8 row_mask:0xf bank_mask:0xf
  s_waitcnt lgkmcnt(0)
  s_barrier
  buffer_store_dwordx4 v[64:67], v9, s[4:7], s56 offen offset:3072 sc1
  buffer_store_dwordx2 v[68:69], v7, s[4:7], s38 offen offset:1536 sc1
  ds_read_b128 v[64:67], v2 offset:16384
  ds_read_b128 v[68:71], v0 offset:16384
  ds_read_b128 v[48:51], v2 offset:17408
  ds_read_b128 v[52:55], v0 offset:17408
  v_smfmac_f32_16x16x64_bf16 v[20:23], v[56:59], v[88:95], v3
  v_smfmac_f32_16x16x64_bf16 v[24:27], v[56:59], a[112:119], v3
  v_smfmac_f32_16x16x64_bf16 v[28:31], v[56:59], a[240:247], v3
  v_smfmac_f32_16x16x64_bf16 v[20:23], v[60:63], v[96:103], v3
  v_smfmac_f32_16x16x64_bf16 v[24:27], v[60:63], a[120:127], v3
  v_smfmac_f32_16x16x64_bf16 v[28:31], v[60:63], a[248:255], v3
  s_waitcnt lgkmcnt(3)
  v_smfmac_f32_16x16x64_bf16 v[20:23], v[64:67], v[104:111], v3
  ds_read_b128 v[56:59], v2 offset:18432
  v_smfmac_f32_16x16x64_bf16 v[24:27], v[64:67], a[0:7], v3
  s_waitcnt lgkmcnt(3)
  v_smfmac_f32_16x16x64_bf16 v[20:23], v[68:71], v[112:119], v3
  ds_read_b128 v[60:63], v0 offset:18432
  v_smfmac_f32_16x16x64_bf16 v[24:27], v[68:71], a[64:71], v3
  s_waitcnt lgkmcnt(3)
  v_smfmac_f32_16x16x64_bf16 v[20:23], v[48:51], v[72:79], v3
  ds_read_b128 v[64:67], v2 offset:19456
  v_smfmac_f32_16x16x64_bf16 v[24:27], v[48:51], a[8:15], v3
  s_waitcnt lgkmcnt(3)
  v_smfmac_f32_16x16x64_bf16 v[20:23], v[52:55], v[80:87], v3
  ds_read_b128 v[68:71], v0 offset:19456
  v_smfmac_f32_16x16x64_bf16 v[24:27], v[52:55], a[72:79], v3
  ds_read_b128 v[88:91], v4 offset:0
  s_waitcnt lgkmcnt(4)
  v_smfmac_f32_16x16x64_bf16 v[20:23], v[56:59], v[120:127], v3
  ds_read_b128 v[48:51], v2 offset:20480
  v_smfmac_f32_16x16x64_bf16 v[24:27], v[56:59], a[16:23], v3
  ds_read_b128 v[92:95], v4 offset:1024
  s_waitcnt lgkmcnt(5)
  v_smfmac_f32_16x16x64_bf16 v[20:23], v[60:63], v[208:215], v3
  ds_read_b128 v[52:55], v0 offset:20480
  v_smfmac_f32_16x16x64_bf16 v[24:27], v[60:63], a[80:87], v3
  ds_read_b128 v[96:99], v4 offset:2048
  s_waitcnt lgkmcnt(6)
  v_smfmac_f32_16x16x64_bf16 v[20:23], v[64:67], v[152:159], v3
  ds_read_b128 v[56:59], v2 offset:21504
  v_smfmac_f32_16x16x64_bf16 v[24:27], v[64:67], a[24:31], v3
  ds_read_b128 v[100:103], v4 offset:3072
  s_waitcnt lgkmcnt(7)
  v_smfmac_f32_16x16x64_bf16 v[20:23], v[68:71], v[216:223], v3
  ds_read_b128 v[60:63], v0 offset:21504
  v_smfmac_f32_16x16x64_bf16 v[24:27], v[68:71], a[88:95], v3
  ds_read_b128 v[104:107], v4 offset:4096
  s_waitcnt lgkmcnt(7)
  v_smfmac_f32_16x16x64_bf16 v[20:23], v[48:51], v[160:167], v3
  ds_read_b128 v[64:67], v2 offset:16384
  v_smfmac_f32_16x16x64_bf16 v[24:27], v[48:51], a[32:39], v3
  ds_read_b128 v[108:111], v4 offset:5120
  s_add_u32 s48, s48, 524288
  s_mov_b32 m0, s42
  s_xor_b32 s42, s42, 241664
  buffer_load_dwordx4 v9, s[4:7], s48 offen offset:0 lds
  buffer_load_dwordx4 v9, s[4:7], s48 offen offset:1024 lds
  buffer_load_dwordx4 v9, s[4:7], s48 offen offset:2048 lds
  buffer_load_dwordx4 v9, s[4:7], s48 offen offset:3072 lds
  s_waitcnt lgkmcnt(7)
  v_smfmac_f32_16x16x64_bf16 v[20:23], v[52:55], v[224:231], v3
  ds_read_b128 v[68:71], v0 offset:16384
  v_smfmac_f32_16x16x64_bf16 v[24:27], v[52:55], a[96:103], v3
  ds_read_b128 v[112:115], v4 offset:6144
  s_waitcnt lgkmcnt(7)
  v_smfmac_f32_16x16x64_bf16 v[20:23], v[56:59], v[168:175], v3
  ds_read_b128 v[48:51], v2 offset:17408
  v_smfmac_f32_16x16x64_bf16 v[24:27], v[56:59], a[40:47], v3
  ds_read_b128 v[116:119], v4 offset:7168
  s_waitcnt lgkmcnt(7)
  v_smfmac_f32_16x16x64_bf16 v[20:23], v[60:63], v[232:239], v3
  ds_read_b128 v[52:55], v0 offset:17408
  v_smfmac_f32_16x16x64_bf16 v[24:27], v[60:63], a[104:111], v3
  s_waitcnt lgkmcnt(6)
  v_smfmac_f32_16x16x64_bf16 v[28:31], v[64:67], a[128:135], v3
  ds_read_b128 v[56:59], v2 offset:18432
  s_waitcnt lgkmcnt(5)
  v_smfmac_f32_16x16x64_bf16 v[28:31], v[68:71], a[192:199], v3
  ds_read_b128 v[60:63], v0 offset:18432
  s_waitcnt lgkmcnt(4)
  v_smfmac_f32_16x16x64_bf16 v[28:31], v[48:51], a[136:143], v3
  ds_read_b128 v[64:67], v2 offset:19456
  v_cvt_pk_bf16_f32 v12, v20, v21
  v_cvt_pk_bf16_f32 v13, v22, v23
  v_cvt_pk_bf16_f32 v24, v24, v25
  v_cvt_pk_bf16_f32 v25, v26, v27
  ds_write_b64 v5, v[12:13] offset:26112
  ds_write_b64 v5, v[24:25] offset:28160
  s_waitcnt lgkmcnt(5)
  v_smfmac_f32_16x16x64_bf16 v[28:31], v[52:55], a[200:207], v3
  ds_read_b128 v[68:71], v0 offset:19456
  s_waitcnt lgkmcnt(5)
  v_smfmac_f32_16x16x64_bf16 v[28:31], v[56:59], a[144:151], v3
  ds_read_b128 v[48:51], v2 offset:20480
  s_waitcnt lgkmcnt(5)
  v_smfmac_f32_16x16x64_bf16 v[28:31], v[60:63], a[208:215], v3
  ds_read_b128 v[52:55], v0 offset:20480
  s_waitcnt lgkmcnt(3)
  s_barrier
  v_smfmac_f32_16x16x64_bf16 v[28:31], v[64:67], a[152:159], v3
  ds_read_b64_tr_b16 v[72:73], v6 offset:24576
  ds_read_b64_tr_b16 v[74:75], v6 offset:24832
  ds_read_b64_tr_b16 v[76:77], v6 offset:25088
  ds_read_b64_tr_b16 v[78:79], v6 offset:25344
  ds_read_b128 v[56:59], v2 offset:21504
  s_waitcnt lgkmcnt(7)
  v_smfmac_f32_16x16x64_bf16 v[28:31], v[68:71], a[216:223], v3
  ds_read_b64_tr_b16 v[80:81], v6 offset:25600
  ds_read_b64_tr_b16 v[82:83], v6 offset:25856
  ds_read_b64_tr_b16 v[84:85], v6 offset:26112
  ds_read_b64_tr_b16 v[86:87], v6 offset:26368
  ds_read_b128 v[60:63], v0 offset:21504
  s_waitcnt lgkmcnt(11)
  v_smfmac_f32_16x16x64_bf16 v[28:31], v[48:51], a[160:167], v3
  ds_read_b64_tr_b16 v[64:65], v6 offset:26624
  ds_read_b64_tr_b16 v[66:67], v6 offset:26880
  s_waitcnt lgkmcnt(12)
  v_smfmac_f32_16x16x64_bf16 v[28:31], v[52:55], a[224:231], v3
  ds_read_b64_tr_b16 v[68:69], v6 offset:27136
  ds_read_b64_tr_b16 v[70:71], v6 offset:27392
  s_waitcnt lgkmcnt(9)
  v_smfmac_f32_16x16x64_bf16 v[28:31], v[56:59], a[168:175], v3
  ds_read_b64_tr_b16 v[48:49], v6 offset:27648
  ds_read_b64_tr_b16 v[50:51], v6 offset:27904
  s_waitcnt lgkmcnt(6)
  v_smfmac_f32_16x16x64_bf16 v[28:31], v[60:63], a[232:239], v3
  ds_read_b64_tr_b16 v[52:53], v6 offset:28160
  ds_read_b64_tr_b16 v[54:55], v6 offset:28416
  v_mfma_f32_16x16x32_bf16 v[120:123], v[88:91], v[72:75], 0
  v_mfma_f32_16x16x32_bf16 v[120:123], v[92:95], v[76:79], v[120:123]
  v_mfma_f32_16x16x32_bf16 v[120:123], v[96:99], v[80:83], v[120:123]
  v_mfma_f32_16x16x32_bf16 v[120:123], v[100:103], v[84:87], v[120:123]
  s_nop 1
  v_cvt_pk_bf16_f32 v28, v28, v29
  v_cvt_pk_bf16_f32 v29, v30, v31
  ds_write_b64 v7, v[28:29] offset:30208
  v_mfma_f32_16x16x32_bf16 v[124:127], v[104:107], v[72:75], 0
  ds_read_b128 v[88:91], v10 offset:0
  v_mfma_f32_16x16x32_bf16 v[124:127], v[108:111], v[76:79], v[124:127]
  ds_read_b128 v[92:95], v10 offset:1024
  v_mfma_f32_16x16x32_bf16 v[124:127], v[112:115], v[80:83], v[124:127]
  ds_read_b128 v[96:99], v10 offset:2048
  v_mfma_f32_16x16x32_bf16 v[124:127], v[116:119], v[84:87], v[124:127]
  ds_read_b128 v[100:103], v10 offset:3072
  v_max3_f32 v24, v120, v121, v122
  s_waitcnt lgkmcnt(5)
  v_mfma_f32_16x16x32_bf16 v[20:23], v[64:67], v[72:75], 0
  v_mfma_f32_16x16x32_bf16 v[20:23], v[68:71], v[76:79], v[20:23]
  v_mfma_f32_16x16x32_bf16 v[20:23], v[48:51], v[80:83], v[20:23]
  s_nop 1
  v_max3_f32 v24, v24, v123, v124
  v_max3_f32 v24, v24, v125, v126
  v_mfma_f32_16x16x32_bf16 v[20:23], v[52:55], v[84:87], v[20:23]
  ds_read_b128 v[48:51], v10 offset:4096
  ds_read_b128 v[52:55], v10 offset:5120
  ds_read_b128 v[56:59], v10 offset:6144
  ds_read_b128 v[60:63], v10 offset:7168
  ds_read_b128 v[64:67], v1 offset:57344
  ds_read_b128 v[68:71], v1 offset:58368
  s_nop 1
  v_max3_f32 v24, v24, v127, v20
  v_max3_f32 v24, v24, v21, v22
  v_max_f32 v12, v24, v23
  v_max_f32 v24, v24, v23
  s_cmp_eq_u32 s45, 63
  s_cbranch_scc1 K1_R0_FIN
  s_nop 0
  v_permlane16_swap_b32 v24, v12
  v_max_f32 v13, v24, v12
  v_max_f32 v24, v24, v12
  s_nop 1
  v_permlane32_swap_b32 v24, v13
  v_max_f32 v12, v24, v13
  v_pk_add_f32 v[120:121], v[120:121], v[12:13] op_sel_hi:[1,0] neg_lo:[0,1] neg_hi:[0,1]
  v_pk_add_f32 v[122:123], v[122:123], v[12:13] op_sel_hi:[1,0] neg_lo:[0,1] neg_hi:[0,1]
  v_pk_add_f32 v[124:125], v[124:125], v[12:13] op_sel_hi:[1,0] neg_lo:[0,1] neg_hi:[0,1]
  v_pk_add_f32 v[126:127], v[126:127], v[12:13] op_sel_hi:[1,0] neg_lo:[0,1] neg_hi:[0,1]
  v_pk_mul_f32 v[120:121], v[120:121], s[94:95]
  v_pk_mul_f32 v[122:123], v[122:123], s[94:95]
  v_pk_mul_f32 v[124:125], v[124:125], s[94:95]
  v_pk_mul_f32 v[126:127], v[126:127], s[94:95]
  v_exp_f32 v120, v120
  v_exp_f32 v121, v121
  v_exp_f32 v122, v122
  v_exp_f32 v123, v123
  v_exp_f32 v124, v124
  v_exp_f32 v125, v125
  v_exp_f32 v126, v126
  v_exp_f32 v127, v127
  v_cvt_pk_bf16_f32 v24, v120, v121
  v_cvt_pk_bf16_f32 v25, v122, v123
  v_cvt_pk_bf16_f32 v26, v124, v125
  v_cvt_pk_bf16_f32 v27, v126, v127
  v_cndmask_b32 v72, 0, v24, s[58:59]
  v_cndmask_b32 v73, 0, v25, s[58:59]
  v_cndmask_b32 v74, 0, v26, s[58:59]
  v_cndmask_b32 v75, 0, v27, s[58:59]
  v_cndmask_b32 v76, 0, v24, s[60:61]
  v_cndmask_b32 v77, 0, v25, s[60:61]
  v_cndmask_b32 v78, 0, v26, s[60:61]
  v_cndmask_b32 v79, 0, v27, s[60:61]
  s_waitcnt lgkmcnt(2)
  s_barrier
  v_mfma_f32_16x16x32_bf16 v[84:87], v[16:19], v[24:27], 0
  ds_read_b64 v[120:121], v7 offset:28672
  ds_read_b64 v[122:123], v7 offset:29184
  v_sub_f32 v20, v20, v12
  v_sub_f32 v21, v21, v12
  v_mfma_f32_16x16x32_bf16 v[104:107], v[88:91], v[72:75], 0
  ds_read_b64 v[124:125], v7 offset:29696
  ds_read_b64 v[126:127], v7 offset:30208
  v_sub_f32 v22, v22, v12
  v_sub_f32 v23, v23, v12
  v_mfma_f32_16x16x32_bf16 v[104:107], v[92:95], v[76:79], v[104:107]
  s_nop 0
  s_nop 0
  v_mul_f32 v20, s94, v20
  v_mul_f32 v21, s94, v21
  v_mfma_f32_16x16x32_bf16 v[108:111], v[96:99], v[72:75], 0
  ds_read_b128 v[88:91], v1 offset:43008
  ds_read_b128 v[92:95], v1 offset:44032
  v_mul_f32 v22, s94, v22
  v_mul_f32 v23, s94, v23
  v_mfma_f32_16x16x32_bf16 v[108:111], v[100:103], v[76:79], v[108:111]
  ds_read_b128 v[96:99], v1 offset:59392
  ds_read_b128 v[100:103], v1 offset:60416
  v_exp_f32 v20, v20
  v_exp_f32 v21, v21
  v_mfma_f32_16x16x32_bf16 v[112:115], v[48:51], v[72:75], 0
  v_exp_f32 v22, v22
  v_exp_f32 v23, v23
  v_mfma_f32_16x16x32_bf16 v[112:115], v[52:55], v[76:79], v[112:115]
  v_cvt_pk_bf16_f32 v12, v20, v21
  v_cvt_pk_bf16_f32 v13, v22, v23
  v_mfma_f32_16x16x32_bf16 v[116:119], v[56:59], v[72:75], 0
  v_cndmask_b32 v80, 0, v12, s[62:63]
  v_cndmask_b32 v81, 0, v13, s[62:63]
  v_mfma_f32_16x16x32_bf16 v[116:119], v[60:63], v[76:79], v[116:119]
  s_waitcnt lgkmcnt(4)
  v_mfma_f32_16x16x16_bf16 v[84:87], v[16:17], v[80:81], v[84:87]
  ds_read_b128 v[48:51], v1 offset:45056
  ds_read_b128 v[52:55], v1 offset:46080
  v_mov_b64 v[20:21], 0
  v_mov_b64 v[22:23], 0
  v_mfma_f32_16x16x16_bf16 v[104:107], v[120:121], v[80:81], v[104:107]
  ds_read_b128 v[56:59], v1 offset:61440
  ds_read_b128 v[60:63], v1 offset:62464
  v_mov_b64 v[24:25], 0
  v_mov_b64 v[26:27], 0
  v_mfma_f32_16x16x16_bf16 v[108:111], v[122:123], v[80:81], v[108:111]
  v_mov_b64 v[28:29], 0
  v_mov_b64 v[30:31], 0
  v_mfma_f32_16x16x16_bf16 v[112:115], v[124:125], v[80:81], v[112:115]
  v_mfma_f32_16x16x16_bf16 v[116:119], v[126:127], v[80:81], v[116:119]
  ds_read_b128 v[120:123], v1 offset:47104
  ds_read_b128 v[124:127], v1 offset:48128
  v_rcp_f32 v12, v84
  s_nop 0
  v_pk_mul_f32 v[104:105], v[104:105], v[12:13] op_sel_hi:[1,0]
  v_pk_mul_f32 v[106:107], v[106:107], v[12:13] op_sel_hi:[1,0]
  v_pk_mul_f32 v[108:109], v[108:109], v[12:13] op_sel_hi:[1,0]
  v_pk_mul_f32 v[110:111], v[110:111], v[12:13] op_sel_hi:[1,0]
  v_pk_mul_f32 v[112:113], v[112:113], v[12:13] op_sel_hi:[1,0]
  v_pk_mul_f32 v[114:115], v[114:115], v[12:13] op_sel_hi:[1,0]
  v_pk_mul_f32 v[116:117], v[116:117], v[12:13] op_sel_hi:[1,0]
  v_pk_mul_f32 v[118:119], v[118:119], v[12:13] op_sel_hi:[1,0]
  v_cvt_pk_bf16_f32 v72, v104, v105
  v_cvt_pk_bf16_f32 v73, v106, v107
  v_cvt_pk_bf16_f32 v74, v108, v109
  v_cvt_pk_bf16_f32 v75, v110, v111
  v_cvt_pk_bf16_f32 v76, v112, v113
  v_cvt_pk_bf16_f32 v77, v114, v115
  v_cvt_pk_bf16_f32 v78, v116, v117
  v_cvt_pk_bf16_f32 v79, v118, v119
  v_smfmac_f32_16x16x64_bf16 v[20:23], v[72:75], v[32:39], v3
  ds_read_b128 v[104:107], v1 offset:63488
  ds_read_b128 v[108:111], v1 offset:64512
  v_mov_b32_dpp v80, v72 row_ror:8 row_mask:0xf bank_mask:0xf
  v_mov_b32_dpp v81, v73 row_ror:8 row_mask:0xf bank_mask:0xf
  v_mov_b32_dpp v82, v74 row_ror:8 row_mask:0xf bank_mask:0xf
  v_mov_b32_dpp v83, v75 row_ror:8 row_mask:0xf bank_mask:0xf
  v_smfmac_f32_16x16x64_bf16 v[20:23], v[76:79], v[240:247], v3
  v_mov_b32_dpp v84, v76 row_ror:8 row_mask:0xf bank_mask:0xf
  v_mov_b32_dpp v85, v77 row_ror:8 row_mask:0xf bank_mask:0xf
  v_mov_b32_dpp v86, v78 row_ror:8 row_mask:0xf bank_mask:0xf
  v_mov_b32_dpp v87, v79 row_ror:8 row_mask:0xf bank_mask:0xf
  v_smfmac_f32_16x16x64_bf16 v[20:23], v[80:83], v[40:47], v3
  v_mov_b64 v[112:113], 0
  v_smfmac_f32_16x16x64_bf16 v[20:23], v[84:87], v[248:255], v3
  v_mov_b64 v[114:115], 0
  v_smfmac_f32_16x16x64_bf16 v[24:27], v[72:75], v[128:135], v3
  v_smfmac_f32_16x16x64_bf16 v[24:27], v[76:79], v[192:199], v3
  s_nop 4
  v_cvt_pk_bf16_f32 v20, v20, v21
  v_cvt_pk_bf16_f32 v21, v22, v23
  v_smfmac_f32_16x16x64_bf16 v[24:27], v[80:83], v[136:143], v3
  v_max_u32 v20, 1, v20
  v_max_u32 v21, 1, v21
  s_waitcnt lgkmcnt(2)
  v_smfmac_f32_16x16x64_bf16 v[24:27], v[84:87], v[200:207], v3
  buffer_store_dwordx2 v[20:21], v8, s[4:7], s50 offen sc1
  v_smfmac_f32_16x16x64_bf16 v[28:31], v[72:75], v[144:151], v3
  v_smfmac_f32_16x16x64_bf16 v[28:31], v[76:79], v[64:71], v3
  s_nop 4
  v_cvt_pk_bf16_f32 v24, v24, v25
  v_cvt_pk_bf16_f32 v25, v26, v27
  v_smfmac_f32_16x16x64_bf16 v[28:31], v[80:83], v[88:95], v3
  v_max_u32 v24, 1, v24
  v_max_u32 v25, 1, v25
  v_smfmac_f32_16x16x64_bf16 v[28:31], v[84:87], v[96:103], v3
  buffer_store_dwordx2 v[24:25], v8, s[4:7], s51 offen sc1
  v_smfmac_f32_16x16x64_bf16 v[112:115], v[72:75], v[48:55], v3
  v_smfmac_f32_16x16x64_bf16 v[112:115], v[76:79], v[56:63], v3
  s_nop 4
  v_cvt_pk_bf16_f32 v28, v28, v29
  v_cvt_pk_bf16_f32 v29, v30, v31
  s_waitcnt lgkmcnt(0)
  v_smfmac_f32_16x16x64_bf16 v[112:115], v[80:83], v[120:127], v3
  v_max_u32 v28, 1, v28
  v_max_u32 v29, 1, v29
  v_smfmac_f32_16x16x64_bf16 v[112:115], v[84:87], v[104:111], v3
  buffer_store_dwordx2 v[28:29], v8, s[4:7], s52 offen sc1
  s_nop 6
  v_cvt_pk_bf16_f32 v112, v112, v113
  v_cvt_pk_bf16_f32 v113, v114, v115
  v_max_u32 v112, 1, v112
  v_max_u32 v113, 1, v113
  buffer_store_dwordx2 v[112:113], v8, s[4:7], s53 offen sc1
  s_add_u32 s45, s45, 1
  s_add_u32 s56, s56, 262144
  s_add_u32 s46, s46, 8192
  s_add_u32 s36, s46, s55
  v_mov_b64 v[20:21], 0
  v_mov_b64 v[22:23], 0
  v_mov_b64 v[24:25], 0
  v_mov_b64 v[26:27], 0
  v_mov_b64 v[28:29], 0
  v_mov_b64 v[30:31], 0
  v_xor_b32 v4, 0x27000, v4
  v_xor_b32 v10, 0x35000, v10
  s_xor_b32 s50, s50, 2048
  s_xor_b32 s51, s51, 2048
  s_xor_b32 s52, s52, 2048
  s_xor_b32 s53, s53, 2048
  s_nop 7
  s_nop 7
  ds_read_b128 v[64:67], v2 offset:30720
  buffer_load_dwordx4 v[48:51], v9, s[4:7], s54 offen offset:0 sc1
  buffer_load_dwordx4 v[52:55], v9, s[4:7], s54 offen offset:1024 sc1
  s_nop 7
  s_nop 7
  s_nop 7
  s_waitcnt lgkmcnt(0)
K1_R0_W3M1_P1:
  buffer_load_dwordx4 v[56:59], v9, s[4:7], s54 offen offset:0 sc1
  buffer_load_dwordx4 v[60:63], v9, s[4:7], s54 offen offset:1024 sc1
  s_sub_u32 s57, s57, 1
  s_cbranch_scc1 K1_END
  s_waitcnt vmcnt(2)
  v_mfma_f32_16x16x32_bf16 v[68:71], v[64:67], v[48:51], 0
  v_mfma_f32_16x16x32_bf16 v[68:71], v[64:67], v[52:55], v[68:71]
  v_min3_u32 v12, v48, v49, v50
  v_min3_u32 v13, v51, v52, v53
  v_min3_u32 v12, v12, v54, v55
  v_min_u32 v12, v12, v13
  v_cmp_eq_u32 vcc, 0, v12
  s_nop 3
  s_cbranch_vccz K1_R0_W3M1_P1OK
  buffer_load_dwordx4 v[48:51], v9, s[4:7], s54 offen offset:0 sc1
  buffer_load_dwordx4 v[52:55], v9, s[4:7], s54 offen offset:1024 sc1
  s_waitcnt vmcnt(2)
  v_mfma_f32_16x16x32_bf16 v[68:71], v[64:67], v[56:59], 0
  v_mfma_f32_16x16x32_bf16 v[68:71], v[64:67], v[60:63], v[68:71]
  v_min3_u32 v12, v56, v57, v58
  v_min3_u32 v13, v59, v60, v61
  v_min3_u32 v12, v12, v62, v63
  v_min_u32 v12, v12, v13
  v_cmp_eq_u32 vcc, 0, v12
  s_nop 3
  s_cbranch_vccnz K1_R0_W3M1_P1
K1_R0_W3M1_P1OK:
  v_add_f32_dpp v68, v68, v68 row_ror:8 row_mask:0xf bank_mask:0xf
  v_add_f32_dpp v69, v69, v69 row_ror:8 row_mask:0xf bank_mask:0xf
  s_nop 0
  v_add_f32_dpp v68, v68, v68 row_ror:4 row_mask:0xf bank_mask:0xf
  v_add_f32_dpp v69, v69, v69 row_ror:4 row_mask:0xf bank_mask:0xf
  v_cvt_pk_bf16_f32 v68, v68, v69
  v_min_u32 v68, -2, v68
  s_mov_b64 exec, s[92:93]
  buffer_store_dword v68, v11, s[4:7], s36 offen sc1
  s_mov_b64 exec, -1
  s_mov_b32 s47, s54
  s_xor_b32 s54, s54, 2048
  s_add_u32 s49, s49, 128
  s_branch K1_R0_W3M1_LOOP
K1_R0_FIN:
  s_lshl_b32 s36, s32, 9
  v_add_u32 v12, s36, v6
  v_add_u32 v13, s36, v7
  ds_read_b64_tr_b16 v[48:49], v12 offset:26624
  ds_read_b64_tr_b16 v[50:51], v12 offset:26880
  ds_read_b64 v[52:53], v13 offset:28672
  s_add_u32 s56, s56, 262144
  s_add_u32 s38, s56, -126976
  s_lshl_b32 s36, s32, 10
  s_add_u32 s56, s56, s36
  s_waitcnt lgkmcnt(0)
  buffer_store_dwordx4 v[48:51], v9, s[4:7], s56 offen sc1
  buffer_store_dwordx2 v[52:53], v13, s[4:7], s38 offen sc1
  s_waitcnt vmcnt(0)
  s_barrier
  s_add_u32 s49, s49, 128
  s_cmp_lg_u32 s32, 0
  s_cbranch_scc1 SF6
  v_mov_b32 v124, 0
  v_mov_b32 v125, 1
  s_mov_b64 exec, 1
  buffer_store_dword v125, v124, s[4:7], s49 offen sc1
  s_mov_b64 exec, -1
SF6:
  s_add_u32 s49, s49, 128
  s_cmp_lg_u32 s32, 0
  s_cbranch_scc1 SF7
  v_mov_b32 v124, 0
  v_mov_b32 v125, 1
  s_mov_b64 exec, 1
  buffer_store_dword v125, v124, s[4:7], s49 offen sc1
  s_mov_b64 exec, -1
SF7:
  s_branch K1_END
K1_N0:
  s_cmp_lt_u32 s34, 1
  s_cbranch_scc1 K1_N1
  s_cmp_gt_u32 s34, 4
  s_cbranch_scc1 K1_N1
  s_sub_u32 s36, s34, 1
  s_lshl_b32 s36, s36, 3
  s_and_b32 s37, s35, 7
  s_add_u32 s33, s36, s37
  s_lshr_b32 s45, s35, 3
  s_mov_b32 s12, s70
  s_and_b32 s13, s71, 0xffff
  s_mov_b32 s14, 0x400000
  s_mov_b32 s15, 0x20000
  s_mov_b32 s16, s72
  s_and_b32 s17, s73, 0xffff
  s_mov_b32 s18, 0x400000
  s_mov_b32 s19, 0x20000
  s_mov_b32 s24, s64
  s_and_b32 s25, s65, 0xffff
  s_mov_b32 s26, 0x200000
  s_mov_b32 s27, 0x20000
  s_lshl_b32 s49, s33, 8
  v_lshrrev_b32 v109, 4, v0
  v_bfe_u32 v107, v0, 1, 3
  v_xor_b32 v108, v107, v109
  v_lshlrev_b32 v108, 5, v108
  v_and_b32 v100, 1, v0
  v_lshl_add_u32 v108, v100, 4, v108
  s_mov_b32 s36, 8192
  v_mad_u32_u24 v100, v109, s36, v108
  v_xor_b32 v101, 0x80, v100
  v_bfe_u32 v110, v0, 2, 2
  v_and_b32 v111, 3, v0
  s_lshl_b32 s36, s32, 1
  v_and_b32 v112, 1, v109
  v_lshl_or_b32 v112, v112, 2, v110
  v_xor_b32 v107, s36, v112
  v_lshlrev_b32 v107, 5, v107
  v_lshl_add_u32 v107, v111, 3, v107
  v_lshl_add_u32 v108, v109, 3, v110
  v_lshl_add_u32 v103, v108, 8, v107
  v_xor_b32 v105, 32, v103
  v_add_u32 v104, 0x10000, v103
  v_add_u32 v106, 0x10000, v105
  s_mul_i32 s36, s32, 131072
  s_add_u32 s40, s49, s36
  s_add_u32 s41, s49, s36
  s_lshl_b32 s44, s32, 12
  s_add_u32 s36, s44, 0
  s_mov_b32 m0, s36
  s_add_u32 s37, s40, 0
  buffer_load_dwordx4 v100, s[12:15], s37 offen lds
  s_add_u32 s36, s44, 1024
  s_mov_b32 m0, s36
  s_add_u32 s37, s40, 32768
  buffer_load_dwordx4 v100, s[12:15], s37 offen lds
  s_add_u32 s36, s44, 2048
  s_mov_b32 m0, s36
  s_add_u32 s37, s40, 65536
  buffer_load_dwordx4 v101, s[12:15], s37 offen lds
  s_add_u32 s36, s44, 3072
  s_mov_b32 m0, s36
  s_add_u32 s37, s40, 98304
  buffer_load_dwordx4 v101, s[12:15], s37 offen lds
  s_add_u32 s36, s44, 16384
  s_mov_b32 m0, s36
  s_add_u32 s37, s40, 524288
  buffer_load_dwordx4 v100, s[12:15], s37 offen lds
  s_add_u32 s36, s44, 17408
  s_mov_b32 m0, s36
  s_add_u32 s37, s40, 557056
  buffer_load_dwordx4 v100, s[12:15], s37 offen lds
  s_add_u32 s36, s44, 18432
  s_mov_b32 m0, s36
  s_add_u32 s37, s40, 589824
  buffer_load_dwordx4 v101, s[12:15], s37 offen lds
  s_add_u32 s36, s44, 19456
  s_mov_b32 m0, s36
  s_add_u32 s37, s40, 622592
  buffer_load_dwordx4 v101, s[12:15], s37 offen lds
  s_add_u32 s36, s44, 32768
  s_mov_b32 m0, s36
  s_add_u32 s37, s40, 1048576
  buffer_load_dwordx4 v100, s[12:15], s37 offen lds
  s_add_u32 s36, s44, 33792
  s_mov_b32 m0, s36
  s_add_u32 s37, s40, 1081344
  buffer_load_dwordx4 v100, s[12:15], s37 offen lds
  s_add_u32 s36, s44, 34816
  s_mov_b32 m0, s36
  s_add_u32 s37, s40, 1114112
  buffer_load_dwordx4 v101, s[12:15], s37 offen lds
  s_add_u32 s36, s44, 35840
  s_mov_b32 m0, s36
  s_add_u32 s37, s40, 1146880
  buffer_load_dwordx4 v101, s[12:15], s37 offen lds
  s_add_u32 s36, s44, 49152
  s_mov_b32 m0, s36
  s_add_u32 s37, s40, 1572864
  buffer_load_dwordx4 v100, s[12:15], s37 offen lds
  s_add_u32 s36, s44, 50176
  s_mov_b32 m0, s36
  s_add_u32 s37, s40, 1605632
  buffer_load_dwordx4 v100, s[12:15], s37 offen lds
  s_add_u32 s36, s44, 51200
  s_mov_b32 m0, s36
  s_add_u32 s37, s40, 1638400
  buffer_load_dwordx4 v101, s[12:15], s37 offen lds
  s_add_u32 s36, s44, 52224
  s_mov_b32 m0, s36
  s_add_u32 s37, s40, 1671168
  buffer_load_dwordx4 v101, s[12:15], s37 offen lds
  s_add_u32 s36, s44, 65536
  s_mov_b32 m0, s36
  s_add_u32 s37, s40, 2097152
  buffer_load_dwordx4 v100, s[12:15], s37 offen lds
  s_add_u32 s36, s44, 66560
  s_mov_b32 m0, s36
  s_add_u32 s37, s40, 2129920
  buffer_load_dwordx4 v100, s[12:15], s37 offen lds
  s_add_u32 s36, s44, 67584
  s_mov_b32 m0, s36
  s_add_u32 s37, s40, 2162688
  buffer_load_dwordx4 v101, s[12:15], s37 offen lds
  s_add_u32 s36, s44, 68608
  s_mov_b32 m0, s36
  s_add_u32 s37, s40, 2195456
  buffer_load_dwordx4 v101, s[12:15], s37 offen lds
  s_add_u32 s36, s44, 81920
  s_mov_b32 m0, s36
  s_add_u32 s37, s40, 2621440
  buffer_load_dwordx4 v100, s[12:15], s37 offen lds
  s_add_u32 s36, s44, 82944
  s_mov_b32 m0, s36
  s_add_u32 s37, s40, 2654208
  buffer_load_dwordx4 v100, s[12:15], s37 offen lds
  s_add_u32 s36, s44, 83968
  s_mov_b32 m0, s36
  s_add_u32 s37, s40, 2686976
  buffer_load_dwordx4 v101, s[12:15], s37 offen lds
  s_add_u32 s36, s44, 84992
  s_mov_b32 m0, s36
  s_add_u32 s37, s40, 2719744
  buffer_load_dwordx4 v101, s[12:15], s37 offen lds
  s_add_u32 s36, s44, 98304
  s_mov_b32 m0, s36
  s_add_u32 s37, s40, 3145728
  buffer_load_dwordx4 v100, s[12:15], s37 offen lds
  s_add_u32 s36, s44, 99328
  s_mov_b32 m0, s36
  s_add_u32 s37, s40, 3178496
  buffer_load_dwordx4 v100, s[12:15], s37 offen lds
  s_add_u32 s36, s44, 100352
  s_mov_b32 m0, s36
  s_add_u32 s37, s40, 3211264
  buffer_load_dwordx4 v101, s[12:15], s37 offen lds
  s_add_u32 s36, s44, 101376
  s_mov_b32 m0, s36
  s_add_u32 s37, s40, 3244032
  buffer_load_dwordx4 v101, s[12:15], s37 offen lds
  s_waitcnt vmcnt(24)
  s_barrier
  s_add_u32 s36, s44, 114688
  s_mov_b32 m0, s36
  s_add_u32 s37, s40, 3670016
  buffer_load_dwordx4 v100, s[12:15], s37 offen lds
  s_add_u32 s36, s44, 115712
  s_mov_b32 m0, s36
  s_add_u32 s37, s40, 3702784
  buffer_load_dwordx4 v100, s[12:15], s37 offen lds
  s_add_u32 s36, s44, 116736
  s_mov_b32 m0, s36
  s_add_u32 s37, s40, 3735552
  buffer_load_dwordx4 v101, s[12:15], s37 offen lds
  s_add_u32 s36, s44, 117760
  s_mov_b32 m0, s36
  s_add_u32 s37, s40, 3768320
  buffer_load_dwordx4 v101, s[12:15], s37 offen lds
  ds_read_b64_tr_b16 a[0:1], v103 offset:0
  ds_read_b64_tr_b16 a[2:3], v103 offset:1024
  ds_read_b64_tr_b16 a[4:5], v103 offset:8192
  ds_read_b64_tr_b16 a[6:7], v103 offset:9216
  ds_read_b64_tr_b16 a[64:65], v105 offset:0
  ds_read_b64_tr_b16 a[66:67], v105 offset:1024
  ds_read_b64_tr_b16 a[68:69], v105 offset:8192
  ds_read_b64_tr_b16 a[70:71], v105 offset:9216
  s_waitcnt lgkmcnt(0)
  s_waitcnt vmcnt(24)
  s_barrier
  s_add_u32 s36, s44, 0
  s_mov_b32 m0, s36
  s_add_u32 s37, s41, 0
  buffer_load_dwordx4 v100, s[16:19], s37 offen lds
  s_add_u32 s36, s44, 1024
  s_mov_b32 m0, s36
  s_add_u32 s37, s41, 32768
  buffer_load_dwordx4 v100, s[16:19], s37 offen lds
  s_add_u32 s36, s44, 2048
  s_mov_b32 m0, s36
  s_add_u32 s37, s41, 65536
  buffer_load_dwordx4 v101, s[16:19], s37 offen lds
  s_add_u32 s36, s44, 3072
  s_mov_b32 m0, s36
  s_add_u32 s37, s41, 98304
  buffer_load_dwordx4 v101, s[16:19], s37 offen lds
  ds_read_b64_tr_b16 a[8:9], v103 offset:16384
  ds_read_b64_tr_b16 a[10:11], v103 offset:17408
  ds_read_b64_tr_b16 a[12:13], v103 offset:24576
  ds_read_b64_tr_b16 a[14:15], v103 offset:25600
  ds_read_b64_tr_b16 a[72:73], v105 offset:16384
  ds_read_b64_tr_b16 a[74:75], v105 offset:17408
  ds_read_b64_tr_b16 a[76:77], v105 offset:24576
  ds_read_b64_tr_b16 a[78:79], v105 offset:25600
  s_waitcnt lgkmcnt(0)
  s_waitcnt vmcnt(24)
  s_barrier
  s_add_u32 s36, s44, 16384
  s_mov_b32 m0, s36
  s_add_u32 s37, s41, 524288
  buffer_load_dwordx4 v100, s[16:19], s37 offen lds
  s_add_u32 s36, s44, 17408
  s_mov_b32 m0, s36
  s_add_u32 s37, s41, 557056
  buffer_load_dwordx4 v100, s[16:19], s37 offen lds
  s_add_u32 s36, s44, 18432
  s_mov_b32 m0, s36
  s_add_u32 s37, s41, 589824
  buffer_load_dwordx4 v101, s[16:19], s37 offen lds
  s_add_u32 s36, s44, 19456
  s_mov_b32 m0, s36
  s_add_u32 s37, s41, 622592
  buffer_load_dwordx4 v101, s[16:19], s37 offen lds
  ds_read_b64_tr_b16 a[16:17], v103 offset:32768
  ds_read_b64_tr_b16 a[18:19], v103 offset:33792
  ds_read_b64_tr_b16 a[20:21], v103 offset:40960
  ds_read_b64_tr_b16 a[22:23], v103 offset:41984
  ds_read_b64_tr_b16 a[80:81], v105 offset:32768
  ds_read_b64_tr_b16 a[82:83], v105 offset:33792
  ds_read_b64_tr_b16 a[84:85], v105 offset:40960
  ds_read_b64_tr_b16 a[86:87], v105 offset:41984
  s_waitcnt lgkmcnt(0)
  s_waitcnt vmcnt(24)
  s_barrier
  s_add_u32 s36, s44, 32768
  s_mov_b32 m0, s36
  s_add_u32 s37, s41, 1048576
  buffer_load_dwordx4 v100, s[16:19], s37 offen lds
  s_add_u32 s36, s44, 33792
  s_mov_b32 m0, s36
  s_add_u32 s37, s41, 1081344
  buffer_load_dwordx4 v100, s[16:19], s37 offen lds
  s_add_u32 s36, s44, 34816
  s_mov_b32 m0, s36
  s_add_u32 s37, s41, 1114112
  buffer_load_dwordx4 v101, s[16:19], s37 offen lds
  s_add_u32 s36, s44, 35840
  s_mov_b32 m0, s36
  s_add_u32 s37, s41, 1146880
  buffer_load_dwordx4 v101, s[16:19], s37 offen lds
  ds_read_b64_tr_b16 a[24:25], v103 offset:49152
  ds_read_b64_tr_b16 a[26:27], v103 offset:50176
  ds_read_b64_tr_b16 a[28:29], v103 offset:57344
  ds_read_b64_tr_b16 a[30:31], v103 offset:58368
  ds_read_b64_tr_b16 a[88:89], v105 offset:49152
  ds_read_b64_tr_b16 a[90:91], v105 offset:50176
  ds_read_b64_tr_b16 a[92:93], v105 offset:57344
  ds_read_b64_tr_b16 a[94:95], v105 offset:58368
  s_waitcnt lgkmcnt(0)
  s_waitcnt vmcnt(24)
  s_barrier
  s_add_u32 s36, s44, 49152
  s_mov_b32 m0, s36
  s_add_u32 s37, s41, 1572864
  buffer_load_dwordx4 v100, s[16:19], s37 offen lds
  s_add_u32 s36, s44, 50176
  s_mov_b32 m0, s36
  s_add_u32 s37, s41, 1605632
  buffer_load_dwordx4 v100, s[16:19], s37 offen lds
  s_add_u32 s36, s44, 51200
  s_mov_b32 m0, s36
  s_add_u32 s37, s41, 1638400
  buffer_load_dwordx4 v101, s[16:19], s37 offen lds
  s_add_u32 s36, s44, 52224
  s_mov_b32 m0, s36
  s_add_u32 s37, s41, 1671168
  buffer_load_dwordx4 v101, s[16:19], s37 offen lds
  ds_read_b64_tr_b16 a[32:33], v104 offset:0
  ds_read_b64_tr_b16 a[34:35], v104 offset:1024
  ds_read_b64_tr_b16 a[36:37], v104 offset:8192
  ds_read_b64_tr_b16 a[38:39], v104 offset:9216
  ds_read_b64_tr_b16 a[96:97], v106 offset:0
  ds_read_b64_tr_b16 a[98:99], v106 offset:1024
  ds_read_b64_tr_b16 a[100:101], v106 offset:8192
  ds_read_b64_tr_b16 a[102:103], v106 offset:9216
  s_waitcnt lgkmcnt(0)
  s_waitcnt vmcnt(24)
  s_barrier
  s_add_u32 s36, s44, 65536
  s_mov_b32 m0, s36
  s_add_u32 s37, s41, 2097152
  buffer_load_dwordx4 v100, s[16:19], s37 offen lds
  s_add_u32 s36, s44, 66560
  s_mov_b32 m0, s36
  s_add_u32 s37, s41, 2129920
  buffer_load_dwordx4 v100, s[16:19], s37 offen lds
  s_add_u32 s36, s44, 67584
  s_mov_b32 m0, s36
  s_add_u32 s37, s41, 2162688
  buffer_load_dwordx4 v101, s[16:19], s37 offen lds
  s_add_u32 s36, s44, 68608
  s_mov_b32 m0, s36
  s_add_u32 s37, s41, 2195456
  buffer_load_dwordx4 v101, s[16:19], s37 offen lds
  ds_read_b64_tr_b16 a[40:41], v104 offset:16384
  ds_read_b64_tr_b16 a[42:43], v104 offset:17408
  ds_read_b64_tr_b16 a[44:45], v104 offset:24576
  ds_read_b64_tr_b16 a[46:47], v104 offset:25600
  ds_read_b64_tr_b16 a[104:105], v106 offset:16384
  ds_read_b64_tr_b16 a[106:107], v106 offset:17408
  ds_read_b64_tr_b16 a[108:109], v106 offset:24576
  ds_read_b64_tr_b16 a[110:111], v106 offset:25600
  s_waitcnt lgkmcnt(0)
  s_waitcnt vmcnt(24)
  s_barrier
  s_add_u32 s36, s44, 81920
  s_mov_b32 m0, s36
  s_add_u32 s37, s41, 2621440
  buffer_load_dwordx4 v100, s[16:19], s37 offen lds
  s_add_u32 s36, s44, 82944
  s_mov_b32 m0, s36
  s_add_u32 s37, s41, 2654208
  buffer_load_dwordx4 v100, s[16:19], s37 offen lds
  s_add_u32 s36, s44, 83968
  s_mov_b32 m0, s36
  s_add_u32 s37, s41, 2686976
  buffer_load_dwordx4 v101, s[16:19], s37 offen lds
  s_add_u32 s36, s44, 84992
  s_mov_b32 m0, s36
  s_add_u32 s37, s41, 2719744
  buffer_load_dwordx4 v101, s[16:19], s37 offen lds
  ds_read_b64_tr_b16 a[48:49], v104 offset:32768
  ds_read_b64_tr_b16 a[50:51], v104 offset:33792
  ds_read_b64_tr_b16 a[52:53], v104 offset:40960
  ds_read_b64_tr_b16 a[54:55], v104 offset:41984
  ds_read_b64_tr_b16 a[112:113], v106 offset:32768
  ds_read_b64_tr_b16 a[114:115], v106 offset:33792
  ds_read_b64_tr_b16 a[116:117], v106 offset:40960
  ds_read_b64_tr_b16 a[118:119], v106 offset:41984
  s_waitcnt lgkmcnt(0)
  s_waitcnt vmcnt(24)
  s_barrier
  s_add_u32 s36, s44, 98304
  s_mov_b32 m0, s36
  s_add_u32 s37, s41, 3145728
  buffer_load_dwordx4 v100, s[16:19], s37 offen lds
  s_add_u32 s36, s44, 99328
  s_mov_b32 m0, s36
  s_add_u32 s37, s41, 3178496
  buffer_load_dwordx4 v100, s[16:19], s37 offen lds
  s_add_u32 s36, s44, 100352
  s_mov_b32 m0, s36
  s_add_u32 s37, s41, 3211264
  buffer_load_dwordx4 v101, s[16:19], s37 offen lds
  s_add_u32 s36, s44, 101376
  s_mov_b32 m0, s36
  s_add_u32 s37, s41, 3244032
  buffer_load_dwordx4 v101, s[16:19], s37 offen lds
  ds_read_b64_tr_b16 a[56:57], v104 offset:49152
  ds_read_b64_tr_b16 a[58:59], v104 offset:50176
  ds_read_b64_tr_b16 a[60:61], v104 offset:57344
  ds_read_b64_tr_b16 a[62:63], v104 offset:58368
  ds_read_b64_tr_b16 a[120:121], v106 offset:49152
  ds_read_b64_tr_b16 a[122:123], v106 offset:50176
  ds_read_b64_tr_b16 a[124:125], v106 offset:57344
  ds_read_b64_tr_b16 a[126:127], v106 offset:58368
  s_waitcnt lgkmcnt(0)
  s_waitcnt vmcnt(24)
  s_barrier
  s_add_u32 s36, s44, 114688
  s_mov_b32 m0, s36
  s_add_u32 s37, s41, 3670016
  buffer_load_dwordx4 v100, s[16:19], s37 offen lds
  s_add_u32 s36, s44, 115712
  s_mov_b32 m0, s36
  s_add_u32 s37, s41, 3702784
  buffer_load_dwordx4 v100, s[16:19], s37 offen lds
  s_add_u32 s36, s44, 116736
  s_mov_b32 m0, s36
  s_add_u32 s37, s41, 3735552
  buffer_load_dwordx4 v101, s[16:19], s37 offen lds
  s_add_u32 s36, s44, 117760
  s_mov_b32 m0, s36
  s_add_u32 s37, s41, 3768320
  buffer_load_dwordx4 v101, s[16:19], s37 offen lds
  ds_read_b64_tr_b16 a[128:129], v103 offset:0
  ds_read_b64_tr_b16 a[130:131], v103 offset:1024
  ds_read_b64_tr_b16 a[132:133], v103 offset:8192
  ds_read_b64_tr_b16 a[134:135], v103 offset:9216
  ds_read_b64_tr_b16 a[192:193], v105 offset:0
  ds_read_b64_tr_b16 a[194:195], v105 offset:1024
  ds_read_b64_tr_b16 a[196:197], v105 offset:8192
  ds_read_b64_tr_b16 a[198:199], v105 offset:9216
  s_waitcnt lgkmcnt(0)
  s_waitcnt vmcnt(24)
  s_barrier
  ds_read_b64_tr_b16 a[136:137], v103 offset:16384
  ds_read_b64_tr_b16 a[138:139], v103 offset:17408
  ds_read_b64_tr_b16 a[140:141], v103 offset:24576
  ds_read_b64_tr_b16 a[142:143], v103 offset:25600
  ds_read_b64_tr_b16 a[200:201], v105 offset:16384
  ds_read_b64_tr_b16 a[202:203], v105 offset:17408
  ds_read_b64_tr_b16 a[204:205], v105 offset:24576
  ds_read_b64_tr_b16 a[206:207], v105 offset:25600
  s_waitcnt lgkmcnt(0)
  s_waitcnt vmcnt(20)
  s_barrier
  ds_read_b64_tr_b16 a[144:145], v103 offset:32768
  ds_read_b64_tr_b16 a[146:147], v103 offset:33792
  ds_read_b64_tr_b16 a[148:149], v103 offset:40960
  ds_read_b64_tr_b16 a[150:151], v103 offset:41984
  ds_read_b64_tr_b16 a[208:209], v105 offset:32768
  ds_read_b64_tr_b16 a[210:211], v105 offset:33792
  ds_read_b64_tr_b16 a[212:213], v105 offset:40960
  ds_read_b64_tr_b16 a[214:215], v105 offset:41984
  s_waitcnt lgkmcnt(0)
  s_waitcnt vmcnt(16)
  s_barrier
  ds_read_b64_tr_b16 a[152:153], v103 offset:49152
  ds_read_b64_tr_b16 a[154:155], v103 offset:50176
  ds_read_b64_tr_b16 a[156:157], v103 offset:57344
  ds_read_b64_tr_b16 a[158:159], v103 offset:58368
  ds_read_b64_tr_b16 a[216:217], v105 offset:49152
  ds_read_b64_tr_b16 a[218:219], v105 offset:50176
  ds_read_b64_tr_b16 a[220:221], v105 offset:57344
  ds_read_b64_tr_b16 a[222:223], v105 offset:58368
  s_waitcnt lgkmcnt(0)
  s_waitcnt vmcnt(12)
  s_barrier
  ds_read_b64_tr_b16 a[160:161], v104 offset:0
  ds_read_b64_tr_b16 a[162:163], v104 offset:1024
  ds_read_b64_tr_b16 a[164:165], v104 offset:8192
  ds_read_b64_tr_b16 a[166:167], v104 offset:9216
  ds_read_b64_tr_b16 a[224:225], v106 offset:0
  ds_read_b64_tr_b16 a[226:227], v106 offset:1024
  ds_read_b64_tr_b16 a[228:229], v106 offset:8192
  ds_read_b64_tr_b16 a[230:231], v106 offset:9216
  s_waitcnt lgkmcnt(0)
  s_waitcnt vmcnt(8)
  s_barrier
  ds_read_b64_tr_b16 a[168:169], v104 offset:16384
  ds_read_b64_tr_b16 a[170:171], v104 offset:17408
  ds_read_b64_tr_b16 a[172:173], v104 offset:24576
  ds_read_b64_tr_b16 a[174:175], v104 offset:25600
  ds_read_b64_tr_b16 a[232:233], v106 offset:16384
  ds_read_b64_tr_b16 a[234:235], v106 offset:17408
  ds_read_b64_tr_b16 a[236:237], v106 offset:24576
  ds_read_b64_tr_b16 a[238:239], v106 offset:25600
  s_waitcnt lgkmcnt(0)
  s_waitcnt vmcnt(4)
  s_barrier
  ds_read_b64_tr_b16 a[176:177], v104 offset:32768
  ds_read_b64_tr_b16 a[178:179], v104 offset:33792
  ds_read_b64_tr_b16 a[180:181], v104 offset:40960
  ds_read_b64_tr_b16 a[182:183], v104 offset:41984
  ds_read_b64_tr_b16 a[240:241], v106 offset:32768
  ds_read_b64_tr_b16 a[242:243], v106 offset:33792
  ds_read_b64_tr_b16 a[244:245], v106 offset:40960
  ds_read_b64_tr_b16 a[246:247], v106 offset:41984
  s_waitcnt lgkmcnt(0)
  s_waitcnt vmcnt(0)
  s_barrier
  ds_read_b64_tr_b16 a[184:185], v104 offset:49152
  ds_read_b64_tr_b16 a[186:187], v104 offset:50176
  ds_read_b64_tr_b16 a[188:189], v104 offset:57344
  ds_read_b64_tr_b16 a[190:191], v104 offset:58368
  ds_read_b64_tr_b16 a[248:249], v106 offset:49152
  ds_read_b64_tr_b16 a[250:251], v106 offset:50176
  ds_read_b64_tr_b16 a[252:253], v106 offset:57344
  ds_read_b64_tr_b16 a[254:255], v106 offset:58368
  s_waitcnt lgkmcnt(0)
  s_barrier
  v_and_b32 v1, 15, v0
  v_lshlrev_b32 v1, 10, v1
  v_lshrrev_b32 v3, 4, v0
  v_lshl_add_u32 v1, v3, 4, v1
  v_lshlrev_b32 v2, 4, v0
  s_mov_b32 s46, s45
  s_cmp_ge_u32 s46, 64
  s_cbranch_scc1 K1_R1a_DONE
  s_lshl_b32 s36, s46, 15
  s_lshl_b32 s37, s32, 8
  s_add_u32 s36, s36, s37
  s_lshl_b32 s37, s32, 12
  s_add_u32 s38, s37, 0
  s_mov_b32 m0, s38
  s_add_u32 s39, s36, 0
  buffer_load_dwordx4 v1, s[24:27], s39 offen lds
  s_add_u32 s38, s37, 1024
  s_mov_b32 m0, s38
  s_add_u32 s39, s36, 64
  buffer_load_dwordx4 v1, s[24:27], s39 offen lds
  s_add_u32 s38, s37, 2048
  s_mov_b32 m0, s38
  s_add_u32 s39, s36, 128
  buffer_load_dwordx4 v1, s[24:27], s39 offen lds
  s_add_u32 s38, s37, 3072
  s_mov_b32 m0, s38
  s_add_u32 s39, s36, 192
  buffer_load_dwordx4 v1, s[24:27], s39 offen lds
  s_add_u32 s38, s37, 16384
  s_mov_b32 m0, s38
  s_add_u32 s39, s36, 16384
  buffer_load_dwordx4 v1, s[24:27], s39 offen lds
  s_add_u32 s38, s37, 17408
  s_mov_b32 m0, s38
  s_add_u32 s39, s36, 16448
  buffer_load_dwordx4 v1, s[24:27], s39 offen lds
  s_add_u32 s38, s37, 18432
  s_mov_b32 m0, s38
  s_add_u32 s39, s36, 16512
  buffer_load_dwordx4 v1, s[24:27], s39 offen lds
  s_add_u32 s38, s37, 19456
  s_mov_b32 m0, s38
  s_add_u32 s39, s36, 16576
  buffer_load_dwordx4 v1, s[24:27], s39 offen lds
  s_mov_b32 s48, 0
  s_waitcnt vmcnt(0)
  s_lshl_b32 s43, s46, 5
  s_add_u32 s43, s43, s33
  s_lshl_b32 s43, s43, 2
  s_add_u32 s43, s43, 87032064
K1_R1a_L0:
  s_waitcnt vmcnt(4)
  s_barrier
  s_add_u32 s47, s46, 4
  s_min_u32 s36, s47, 63
  s_mov_b32 s44, s36
  s_lshl_b32 s36, s44, 15
  s_lshl_b32 s37, s32, 8
  s_add_u32 s36, s36, s37
  s_lshl_b32 s37, s32, 12
  s_add_u32 s38, s37, 32768
  s_mov_b32 m0, s38
  s_add_u32 s39, s36, 0
  buffer_load_dwordx4 v1, s[24:27], s39 offen lds
  s_add_u32 s38, s37, 33792
  s_mov_b32 m0, s38
  s_add_u32 s39, s36, 64
  buffer_load_dwordx4 v1, s[24:27], s39 offen lds
  s_add_u32 s38, s37, 34816
  s_mov_b32 m0, s38
  s_add_u32 s39, s36, 128
  buffer_load_dwordx4 v1, s[24:27], s39 offen lds
  s_add_u32 s38, s37, 35840
  s_mov_b32 m0, s38
  s_add_u32 s39, s36, 192
  buffer_load_dwordx4 v1, s[24:27], s39 offen lds
  s_add_u32 s38, s37, 49152
  s_mov_b32 m0, s38
  s_add_u32 s39, s36, 16384
  buffer_load_dwordx4 v1, s[24:27], s39 offen lds
  s_add_u32 s38, s37, 50176
  s_mov_b32 m0, s38
  s_add_u32 s39, s36, 16448
  buffer_load_dwordx4 v1, s[24:27], s39 offen lds
  s_add_u32 s38, s37, 51200
  s_mov_b32 m0, s38
  s_add_u32 s39, s36, 16512
  buffer_load_dwordx4 v1, s[24:27], s39 offen lds
  s_add_u32 s38, s37, 52224
  s_mov_b32 m0, s38
  s_add_u32 s39, s36, 16576
  buffer_load_dwordx4 v1, s[24:27], s39 offen lds
  ds_read_b128 v[4:7], v2 offset:0
  ds_read_b128 v[8:11], v2 offset:1024
  ds_read_b128 v[12:15], v2 offset:2048
  ds_read_b128 v[16:19], v2 offset:3072
  s_waitcnt lgkmcnt(3)
  v_mfma_f32_16x16x32_bf16 v[32:35], a[0:3], v[4:7], 0
  v_mfma_f32_16x16x32_bf16 v[36:39], a[64:67], v[4:7], 0
  v_mfma_f32_16x16x32_bf16 v[48:51], v[4:7], a[128:131], 0
  v_mfma_f32_16x16x32_bf16 v[52:55], v[4:7], a[192:195], 0
  ds_read_b128 v[4:7], v2 offset:4096
  s_waitcnt lgkmcnt(3)
  v_mfma_f32_16x16x32_bf16 v[32:35], a[4:7], v[8:11], v[32:35]
  v_mfma_f32_16x16x32_bf16 v[36:39], a[68:71], v[8:11], v[36:39]
  v_mfma_f32_16x16x32_bf16 v[48:51], v[8:11], a[132:135], v[48:51]
  v_mfma_f32_16x16x32_bf16 v[52:55], v[8:11], a[196:199], v[52:55]
  ds_read_b128 v[8:11], v2 offset:5120
  s_waitcnt lgkmcnt(3)
  v_mfma_f32_16x16x32_bf16 v[32:35], a[8:11], v[12:15], v[32:35]
  v_mfma_f32_16x16x32_bf16 v[36:39], a[72:75], v[12:15], v[36:39]
  v_mfma_f32_16x16x32_bf16 v[48:51], v[12:15], a[136:139], v[48:51]
  v_mfma_f32_16x16x32_bf16 v[52:55], v[12:15], a[200:203], v[52:55]
  ds_read_b128 v[12:15], v2 offset:6144
  s_waitcnt lgkmcnt(3)
  v_mfma_f32_16x16x32_bf16 v[32:35], a[12:15], v[16:19], v[32:35]
  v_mfma_f32_16x16x32_bf16 v[36:39], a[76:79], v[16:19], v[36:39]
  v_mfma_f32_16x16x32_bf16 v[48:51], v[16:19], a[140:143], v[48:51]
  v_mfma_f32_16x16x32_bf16 v[52:55], v[16:19], a[204:207], v[52:55]
  ds_read_b128 v[16:19], v2 offset:7168
  s_waitcnt lgkmcnt(3)
  v_mfma_f32_16x16x32_bf16 v[32:35], a[16:19], v[4:7], v[32:35]
  v_mfma_f32_16x16x32_bf16 v[36:39], a[80:83], v[4:7], v[36:39]
  v_mfma_f32_16x16x32_bf16 v[48:51], v[4:7], a[144:147], v[48:51]
  v_mfma_f32_16x16x32_bf16 v[52:55], v[4:7], a[208:211], v[52:55]
  ds_read_b128 v[4:7], v2 offset:8192
  s_waitcnt lgkmcnt(3)
  v_mfma_f32_16x16x32_bf16 v[32:35], a[20:23], v[8:11], v[32:35]
  v_mfma_f32_16x16x32_bf16 v[36:39], a[84:87], v[8:11], v[36:39]
  v_mfma_f32_16x16x32_bf16 v[48:51], v[8:11], a[148:151], v[48:51]
  v_mfma_f32_16x16x32_bf16 v[52:55], v[8:11], a[212:215], v[52:55]
  ds_read_b128 v[8:11], v2 offset:9216
  s_waitcnt lgkmcnt(3)
  v_mfma_f32_16x16x32_bf16 v[32:35], a[24:27], v[12:15], v[32:35]
  v_mfma_f32_16x16x32_bf16 v[36:39], a[88:91], v[12:15], v[36:39]
  v_mfma_f32_16x16x32_bf16 v[48:51], v[12:15], a[152:155], v[48:51]
  v_mfma_f32_16x16x32_bf16 v[52:55], v[12:15], a[216:219], v[52:55]
  ds_read_b128 v[12:15], v2 offset:10240
  s_waitcnt lgkmcnt(3)
  v_mfma_f32_16x16x32_bf16 v[32:35], a[28:31], v[16:19], v[32:35]
  v_mfma_f32_16x16x32_bf16 v[36:39], a[92:95], v[16:19], v[36:39]
  v_mfma_f32_16x16x32_bf16 v[48:51], v[16:19], a[156:159], v[48:51]
  v_mfma_f32_16x16x32_bf16 v[52:55], v[16:19], a[220:223], v[52:55]
  ds_read_b128 v[16:19], v2 offset:11264
  s_waitcnt lgkmcnt(3)
  v_mfma_f32_16x16x32_bf16 v[32:35], a[32:35], v[4:7], v[32:35]
  v_mfma_f32_16x16x32_bf16 v[36:39], a[96:99], v[4:7], v[36:39]
  v_mfma_f32_16x16x32_bf16 v[48:51], v[4:7], a[160:163], v[48:51]
  v_mfma_f32_16x16x32_bf16 v[52:55], v[4:7], a[224:227], v[52:55]
  ds_read_b128 v[4:7], v2 offset:12288
  s_waitcnt lgkmcnt(3)
  v_mfma_f32_16x16x32_bf16 v[32:35], a[36:39], v[8:11], v[32:35]
  v_mfma_f32_16x16x32_bf16 v[36:39], a[100:103], v[8:11], v[36:39]
  v_mfma_f32_16x16x32_bf16 v[48:51], v[8:11], a[164:167], v[48:51]
  v_mfma_f32_16x16x32_bf16 v[52:55], v[8:11], a[228:231], v[52:55]
  ds_read_b128 v[8:11], v2 offset:13312
  s_waitcnt lgkmcnt(3)
  v_mfma_f32_16x16x32_bf16 v[32:35], a[40:43], v[12:15], v[32:35]
  v_mfma_f32_16x16x32_bf16 v[36:39], a[104:107], v[12:15], v[36:39]
  v_mfma_f32_16x16x32_bf16 v[48:51], v[12:15], a[168:171], v[48:51]
  v_mfma_f32_16x16x32_bf16 v[52:55], v[12:15], a[232:235], v[52:55]
  ds_read_b128 v[12:15], v2 offset:14336
  s_waitcnt lgkmcnt(3)
  v_mfma_f32_16x16x32_bf16 v[32:35], a[44:47], v[16:19], v[32:35]
  v_mfma_f32_16x16x32_bf16 v[36:39], a[108:111], v[16:19], v[36:39]
  v_mfma_f32_16x16x32_bf16 v[48:51], v[16:19], a[172:175], v[48:51]
  v_mfma_f32_16x16x32_bf16 v[52:55], v[16:19], a[236:239], v[52:55]
  ds_read_b128 v[16:19], v2 offset:15360
  s_waitcnt lgkmcnt(3)
  v_mfma_f32_16x16x32_bf16 v[32:35], a[48:51], v[4:7], v[32:35]
  v_mfma_f32_16x16x32_bf16 v[36:39], a[112:115], v[4:7], v[36:39]
  v_mfma_f32_16x16x32_bf16 v[48:51], v[4:7], a[176:179], v[48:51]
  v_mfma_f32_16x16x32_bf16 v[52:55], v[4:7], a[240:243], v[52:55]
  ds_read_b128 v[4:7], v2 offset:16384
  s_waitcnt lgkmcnt(3)
  v_mfma_f32_16x16x32_bf16 v[32:35], a[52:55], v[8:11], v[32:35]
  v_mfma_f32_16x16x32_bf16 v[36:39], a[116:119], v[8:11], v[36:39]
  v_mfma_f32_16x16x32_bf16 v[48:51], v[8:11], a[180:183], v[48:51]
  v_mfma_f32_16x16x32_bf16 v[52:55], v[8:11], a[244:247], v[52:55]
  ds_read_b128 v[8:11], v2 offset:17408
  s_waitcnt lgkmcnt(3)
  v_mfma_f32_16x16x32_bf16 v[32:35], a[56:59], v[12:15], v[32:35]
  v_mfma_f32_16x16x32_bf16 v[36:39], a[120:123], v[12:15], v[36:39]
  v_mfma_f32_16x16x32_bf16 v[48:51], v[12:15], a[184:187], v[48:51]
  v_mfma_f32_16x16x32_bf16 v[52:55], v[12:15], a[248:251], v[52:55]
  ds_read_b128 v[12:15], v2 offset:18432
  s_waitcnt lgkmcnt(3)
  v_mfma_f32_16x16x32_bf16 v[32:35], a[60:63], v[16:19], v[32:35]
  v_mfma_f32_16x16x32_bf16 v[36:39], a[124:127], v[16:19], v[36:39]
  v_mfma_f32_16x16x32_bf16 v[48:51], v[16:19], a[188:191], v[48:51]
  v_mfma_f32_16x16x32_bf16 v[52:55], v[16:19], a[252:255], v[52:55]
  s_waitcnt vmcnt(8)
  s_barrier
  s_cmp_eq_u32 s48, 0
  s_nop 3
  s_cbranch_scc1 PF8
  s_cmp_lg_u32 s48, s43
  s_cbranch_scc1 PG8
  s_mov_b32 s28, s88
  s_and_b32 s29, s89, 0xffff
  s_mov_b32 s30, 0x100
  s_mov_b32 s31, 0x20000
  v_and_b32 v124, 31, v0
  v_lshlrev_b32 v124, 2, v124
  s_mov_b32 s3, 0x100000
  s_nop 0
WI9:
  buffer_load_dword v125, v124, s[28:31], 0 offen sc1
  s_sub_u32 s3, s3, 1
  s_cbranch_scc1 K1_END
  s_waitcnt vmcnt(0)
  v_cmp_eq_u32 vcc, 0, v125
  s_nop 3
  s_cbranch_vccnz WI9
PG8:
  s_cmp_lg_u32 s32, 0
  s_cbranch_scc1 SF10
  v_mov_b32 v124, 0
  v_mov_b32 v125, 1
  s_mov_b64 exec, 1
  buffer_store_dword v125, v124, s[4:7], s48 offen sc1
  s_mov_b64 exec, -1
SF10:
PF8:
  ds_read_b128 v[16:19], v2 offset:19456
  s_waitcnt lgkmcnt(3)
  v_mfma_f32_16x16x32_bf16 v[40:43], a[0:3], v[4:7], 0
  v_mfma_f32_16x16x32_bf16 v[44:47], a[64:67], v[4:7], 0
  v_mfma_f32_16x16x32_bf16 v[56:59], v[4:7], a[128:131], 0
  v_mfma_f32_16x16x32_bf16 v[60:63], v[4:7], a[192:195], 0
  ds_read_b128 v[4:7], v2 offset:20480
  s_waitcnt lgkmcnt(3)
  v_mfma_f32_16x16x32_bf16 v[40:43], a[4:7], v[8:11], v[40:43]
  v_mfma_f32_16x16x32_bf16 v[44:47], a[68:71], v[8:11], v[44:47]
  v_mfma_f32_16x16x32_bf16 v[56:59], v[8:11], a[132:135], v[56:59]
  v_mfma_f32_16x16x32_bf16 v[60:63], v[8:11], a[196:199], v[60:63]
  ds_read_b128 v[8:11], v2 offset:21504
  s_waitcnt lgkmcnt(3)
  v_mfma_f32_16x16x32_bf16 v[40:43], a[8:11], v[12:15], v[40:43]
  v_mfma_f32_16x16x32_bf16 v[44:47], a[72:75], v[12:15], v[44:47]
  v_mfma_f32_16x16x32_bf16 v[56:59], v[12:15], a[136:139], v[56:59]
  v_mfma_f32_16x16x32_bf16 v[60:63], v[12:15], a[200:203], v[60:63]
  ds_read_b128 v[12:15], v2 offset:22528
  s_waitcnt lgkmcnt(3)
  v_mfma_f32_16x16x32_bf16 v[40:43], a[12:15], v[16:19], v[40:43]
  v_mfma_f32_16x16x32_bf16 v[44:47], a[76:79], v[16:19], v[44:47]
  v_mfma_f32_16x16x32_bf16 v[56:59], v[16:19], a[140:143], v[56:59]
  v_mfma_f32_16x16x32_bf16 v[60:63], v[16:19], a[204:207], v[60:63]
  ds_read_b128 v[16:19], v2 offset:23552
  s_waitcnt lgkmcnt(3)
  v_mfma_f32_16x16x32_bf16 v[40:43], a[16:19], v[4:7], v[40:43]
  v_mfma_f32_16x16x32_bf16 v[44:47], a[80:83], v[4:7], v[44:47]
  v_mfma_f32_16x16x32_bf16 v[56:59], v[4:7], a[144:147], v[56:59]
  v_mfma_f32_16x16x32_bf16 v[60:63], v[4:7], a[208:211], v[60:63]
  ds_read_b128 v[4:7], v2 offset:24576
  s_waitcnt lgkmcnt(3)
  v_mfma_f32_16x16x32_bf16 v[40:43], a[20:23], v[8:11], v[40:43]
  v_mfma_f32_16x16x32_bf16 v[44:47], a[84:87], v[8:11], v[44:47]
  v_mfma_f32_16x16x32_bf16 v[56:59], v[8:11], a[148:151], v[56:59]
  v_mfma_f32_16x16x32_bf16 v[60:63], v[8:11], a[212:215], v[60:63]
  ds_read_b128 v[8:11], v2 offset:25600
  s_waitcnt lgkmcnt(3)
  v_mfma_f32_16x16x32_bf16 v[40:43], a[24:27], v[12:15], v[40:43]
  v_mfma_f32_16x16x32_bf16 v[44:47], a[88:91], v[12:15], v[44:47]
  v_mfma_f32_16x16x32_bf16 v[56:59], v[12:15], a[152:155], v[56:59]
  v_mfma_f32_16x16x32_bf16 v[60:63], v[12:15], a[216:219], v[60:63]
  ds_read_b128 v[12:15], v2 offset:26624
  s_waitcnt lgkmcnt(3)
  v_mfma_f32_16x16x32_bf16 v[40:43], a[28:31], v[16:19], v[40:43]
  v_mfma_f32_16x16x32_bf16 v[44:47], a[92:95], v[16:19], v[44:47]
  v_mfma_f32_16x16x32_bf16 v[56:59], v[16:19], a[156:159], v[56:59]
  v_mfma_f32_16x16x32_bf16 v[60:63], v[16:19], a[220:223], v[60:63]
  ds_read_b128 v[16:19], v2 offset:27648
  s_waitcnt lgkmcnt(3)
  v_mfma_f32_16x16x32_bf16 v[40:43], a[32:35], v[4:7], v[40:43]
  v_mfma_f32_16x16x32_bf16 v[44:47], a[96:99], v[4:7], v[44:47]
  v_mfma_f32_16x16x32_bf16 v[56:59], v[4:7], a[160:163], v[56:59]
  v_mfma_f32_16x16x32_bf16 v[60:63], v[4:7], a[224:227], v[60:63]
  ds_read_b128 v[4:7], v2 offset:28672
  s_waitcnt lgkmcnt(3)
  v_mfma_f32_16x16x32_bf16 v[40:43], a[36:39], v[8:11], v[40:43]
  v_mfma_f32_16x16x32_bf16 v[44:47], a[100:103], v[8:11], v[44:47]
  v_mfma_f32_16x16x32_bf16 v[56:59], v[8:11], a[164:167], v[56:59]
  v_mfma_f32_16x16x32_bf16 v[60:63], v[8:11], a[228:231], v[60:63]
  ds_read_b128 v[8:11], v2 offset:29696
  s_waitcnt lgkmcnt(3)
  v_mfma_f32_16x16x32_bf16 v[40:43], a[40:43], v[12:15], v[40:43]
  v_mfma_f32_16x16x32_bf16 v[44:47], a[104:107], v[12:15], v[44:47]
  v_mfma_f32_16x16x32_bf16 v[56:59], v[12:15], a[168:171], v[56:59]
  v_mfma_f32_16x16x32_bf16 v[60:63], v[12:15], a[232:235], v[60:63]
  ds_read_b128 v[12:15], v2 offset:30720
  s_waitcnt lgkmcnt(3)
  v_mfma_f32_16x16x32_bf16 v[40:43], a[44:47], v[16:19], v[40:43]
  v_mfma_f32_16x16x32_bf16 v[44:47], a[108:111], v[16:19], v[44:47]
  v_mfma_f32_16x16x32_bf16 v[56:59], v[16:19], a[172:175], v[56:59]
  v_mfma_f32_16x16x32_bf16 v[60:63], v[16:19], a[236:239], v[60:63]
  ds_read_b128 v[16:19], v2 offset:31744
  s_waitcnt lgkmcnt(3)
  v_mfma_f32_16x16x32_bf16 v[40:43], a[48:51], v[4:7], v[40:43]
  v_mfma_f32_16x16x32_bf16 v[44:47], a[112:115], v[4:7], v[44:47]
  v_mfma_f32_16x16x32_bf16 v[56:59], v[4:7], a[176:179], v[56:59]
  v_mfma_f32_16x16x32_bf16 v[60:63], v[4:7], a[240:243], v[60:63]
  s_waitcnt lgkmcnt(2)
  v_mfma_f32_16x16x32_bf16 v[40:43], a[52:55], v[8:11], v[40:43]
  v_mfma_f32_16x16x32_bf16 v[44:47], a[116:119], v[8:11], v[44:47]
  v_mfma_f32_16x16x32_bf16 v[56:59], v[8:11], a[180:183], v[56:59]
  v_mfma_f32_16x16x32_bf16 v[60:63], v[8:11], a[244:247], v[60:63]
  s_waitcnt lgkmcnt(1)
  v_mfma_f32_16x16x32_bf16 v[40:43], a[56:59], v[12:15], v[40:43]
  v_mfma_f32_16x16x32_bf16 v[44:47], a[120:123], v[12:15], v[44:47]
  v_mfma_f32_16x16x32_bf16 v[56:59], v[12:15], a[184:187], v[56:59]
  v_mfma_f32_16x16x32_bf16 v[60:63], v[12:15], a[248:251], v[60:63]
  s_waitcnt lgkmcnt(0)
  v_mfma_f32_16x16x32_bf16 v[40:43], a[60:63], v[16:19], v[40:43]
  v_mfma_f32_16x16x32_bf16 v[44:47], a[124:127], v[16:19], v[44:47]
  v_mfma_f32_16x16x32_bf16 v[56:59], v[16:19], a[188:191], v[56:59]
  v_mfma_f32_16x16x32_bf16 v[60:63], v[16:19], a[252:255], v[60:63]
  s_lshl_b32 s36, s46, 5
  s_add_u32 s36, s36, s33
  s_lshl_b32 s36, s36, 14
  s_lshl_b32 s37, s32, 10
  s_add_u32 s38, s36, s37
  s_add_u32 s39, s38, s37
  s_add_u32 s39, s39, 8192
  v_cvt_pk_bf16_f32 v64, v32, v33
  v_cvt_pk_bf16_f32 v65, v34, v35
  v_cvt_pk_bf16_f32 v66, v36, v37
  v_cvt_pk_bf16_f32 v67, v38, v39
  v_cvt_pk_bf16_f32 v68, v40, v41
  v_cvt_pk_bf16_f32 v69, v42, v43
  v_cvt_pk_bf16_f32 v70, v44, v45
  v_cvt_pk_bf16_f32 v71, v46, v47
  v_cvt_pk_bf16_f32 v72, v48, v49
  v_cvt_pk_bf16_f32 v73, v50, v51
  v_cvt_pk_bf16_f32 v74, v56, v57
  v_cvt_pk_bf16_f32 v75, v58, v59
  v_cvt_pk_bf16_f32 v76, v52, v53
  v_cvt_pk_bf16_f32 v77, v54, v55
  v_cvt_pk_bf16_f32 v78, v60, v61
  v_cvt_pk_bf16_f32 v79, v62, v63
  buffer_store_dwordx4 v[64:67], v2, s[4:7], s38 offen sc1
  s_add_u32 s38, s38, 4096
  buffer_store_dwordx4 v[68:71], v2, s[4:7], s38 offen sc1
  buffer_store_dwordx4 v[72:75], v2, s[4:7], s39 offen sc1
  buffer_store_dwordx4 v[76:79], v2, s[4:7], s39 offen offset:1024 sc1
  s_lshl_b32 s48, s46, 5
  s_add_u32 s48, s48, s33
  s_lshl_b32 s48, s48, 2
  s_add_u32 s48, s48, 87032064
  s_mov_b32 s46, s47
  s_cmp_ge_u32 s46, 64
  s_cbranch_scc1 K1_R1a_LAST
K1_R1a_L1:
  s_waitcnt vmcnt(4)
  s_barrier
  s_add_u32 s47, s46, 4
  s_min_u32 s36, s47, 63
  s_mov_b32 s44, s36
  s_lshl_b32 s36, s44, 15
  s_lshl_b32 s37, s32, 8
  s_add_u32 s36, s36, s37
  s_lshl_b32 s37, s32, 12
  s_add_u32 s38, s37, 0
  s_mov_b32 m0, s38
  s_add_u32 s39, s36, 0
  buffer_load_dwordx4 v1, s[24:27], s39 offen lds
  s_add_u32 s38, s37, 1024
  s_mov_b32 m0, s38
  s_add_u32 s39, s36, 64
  buffer_load_dwordx4 v1, s[24:27], s39 offen lds
  s_add_u32 s38, s37, 2048
  s_mov_b32 m0, s38
  s_add_u32 s39, s36, 128
  buffer_load_dwordx4 v1, s[24:27], s39 offen lds
  s_add_u32 s38, s37, 3072
  s_mov_b32 m0, s38
  s_add_u32 s39, s36, 192
  buffer_load_dwordx4 v1, s[24:27], s39 offen lds
  s_add_u32 s38, s37, 16384
  s_mov_b32 m0, s38
  s_add_u32 s39, s36, 16384
  buffer_load_dwordx4 v1, s[24:27], s39 offen lds
  s_add_u32 s38, s37, 17408
  s_mov_b32 m0, s38
  s_add_u32 s39, s36, 16448
  buffer_load_dwordx4 v1, s[24:27], s39 offen lds
  s_add_u32 s38, s37, 18432
  s_mov_b32 m0, s38
  s_add_u32 s39, s36, 16512
  buffer_load_dwordx4 v1, s[24:27], s39 offen lds
  s_add_u32 s38, s37, 19456
  s_mov_b32 m0, s38
  s_add_u32 s39, s36, 16576
  buffer_load_dwordx4 v1, s[24:27], s39 offen lds
  ds_read_b128 v[4:7], v2 offset:32768
  ds_read_b128 v[8:11], v2 offset:33792
  ds_read_b128 v[12:15], v2 offset:34816
  ds_read_b128 v[16:19], v2 offset:35840
  s_waitcnt lgkmcnt(3)
  v_mfma_f32_16x16x32_bf16 v[32:35], a[0:3], v[4:7], 0
  v_mfma_f32_16x16x32_bf16 v[36:39], a[64:67], v[4:7], 0
  v_mfma_f32_16x16x32_bf16 v[48:51], v[4:7], a[128:131], 0
  v_mfma_f32_16x16x32_bf16 v[52:55], v[4:7], a[192:195], 0
  ds_read_b128 v[4:7], v2 offset:36864
  s_waitcnt lgkmcnt(3)
  v_mfma_f32_16x16x32_bf16 v[32:35], a[4:7], v[8:11], v[32:35]
  v_mfma_f32_16x16x32_bf16 v[36:39], a[68:71], v[8:11], v[36:39]
  v_mfma_f32_16x16x32_bf16 v[48:51], v[8:11], a[132:135], v[48:51]
  v_mfma_f32_16x16x32_bf16 v[52:55], v[8:11], a[196:199], v[52:55]
  ds_read_b128 v[8:11], v2 offset:37888
  s_waitcnt lgkmcnt(3)
  v_mfma_f32_16x16x32_bf16 v[32:35], a[8:11], v[12:15], v[32:35]
  v_mfma_f32_16x16x32_bf16 v[36:39], a[72:75], v[12:15], v[36:39]
  v_mfma_f32_16x16x32_bf16 v[48:51], v[12:15], a[136:139], v[48:51]
  v_mfma_f32_16x16x32_bf16 v[52:55], v[12:15], a[200:203], v[52:55]
  ds_read_b128 v[12:15], v2 offset:38912
  s_waitcnt lgkmcnt(3)
  v_mfma_f32_16x16x32_bf16 v[32:35], a[12:15], v[16:19], v[32:35]
  v_mfma_f32_16x16x32_bf16 v[36:39], a[76:79], v[16:19], v[36:39]
  v_mfma_f32_16x16x32_bf16 v[48:51], v[16:19], a[140:143], v[48:51]
  v_mfma_f32_16x16x32_bf16 v[52:55], v[16:19], a[204:207], v[52:55]
  ds_read_b128 v[16:19], v2 offset:39936
  s_waitcnt lgkmcnt(3)
  v_mfma_f32_16x16x32_bf16 v[32:35], a[16:19], v[4:7], v[32:35]
  v_mfma_f32_16x16x32_bf16 v[36:39], a[80:83], v[4:7], v[36:39]
  v_mfma_f32_16x16x32_bf16 v[48:51], v[4:7], a[144:147], v[48:51]
  v_mfma_f32_16x16x32_bf16 v[52:55], v[4:7], a[208:211], v[52:55]
  ds_read_b128 v[4:7], v2 offset:40960
  s_waitcnt lgkmcnt(3)
  v_mfma_f32_16x16x32_bf16 v[32:35], a[20:23], v[8:11], v[32:35]
  v_mfma_f32_16x16x32_bf16 v[36:39], a[84:87], v[8:11], v[36:39]
  v_mfma_f32_16x16x32_bf16 v[48:51], v[8:11], a[148:151], v[48:51]
  v_mfma_f32_16x16x32_bf16 v[52:55], v[8:11], a[212:215], v[52:55]
  ds_read_b128 v[8:11], v2 offset:41984
  s_waitcnt lgkmcnt(3)
  v_mfma_f32_16x16x32_bf16 v[32:35], a[24:27], v[12:15], v[32:35]
  v_mfma_f32_16x16x32_bf16 v[36:39], a[88:91], v[12:15], v[36:39]
  v_mfma_f32_16x16x32_bf16 v[48:51], v[12:15], a[152:155], v[48:51]
  v_mfma_f32_16x16x32_bf16 v[52:55], v[12:15], a[216:219], v[52:55]
  ds_read_b128 v[12:15], v2 offset:43008
  s_waitcnt lgkmcnt(3)
  v_mfma_f32_16x16x32_bf16 v[32:35], a[28:31], v[16:19], v[32:35]
  v_mfma_f32_16x16x32_bf16 v[36:39], a[92:95], v[16:19], v[36:39]
  v_mfma_f32_16x16x32_bf16 v[48:51], v[16:19], a[156:159], v[48:51]
  v_mfma_f32_16x16x32_bf16 v[52:55], v[16:19], a[220:223], v[52:55]
  ds_read_b128 v[16:19], v2 offset:44032
  s_waitcnt lgkmcnt(3)
  v_mfma_f32_16x16x32_bf16 v[32:35], a[32:35], v[4:7], v[32:35]
  v_mfma_f32_16x16x32_bf16 v[36:39], a[96:99], v[4:7], v[36:39]
  v_mfma_f32_16x16x32_bf16 v[48:51], v[4:7], a[160:163], v[48:51]
  v_mfma_f32_16x16x32_bf16 v[52:55], v[4:7], a[224:227], v[52:55]
  ds_read_b128 v[4:7], v2 offset:45056
  s_waitcnt lgkmcnt(3)
  v_mfma_f32_16x16x32_bf16 v[32:35], a[36:39], v[8:11], v[32:35]
  v_mfma_f32_16x16x32_bf16 v[36:39], a[100:103], v[8:11], v[36:39]
  v_mfma_f32_16x16x32_bf16 v[48:51], v[8:11], a[164:167], v[48:51]
  v_mfma_f32_16x16x32_bf16 v[52:55], v[8:11], a[228:231], v[52:55]
  ds_read_b128 v[8:11], v2 offset:46080
  s_waitcnt lgkmcnt(3)
  v_mfma_f32_16x16x32_bf16 v[32:35], a[40:43], v[12:15], v[32:35]
  v_mfma_f32_16x16x32_bf16 v[36:39], a[104:107], v[12:15], v[36:39]
  v_mfma_f32_16x16x32_bf16 v[48:51], v[12:15], a[168:171], v[48:51]
  v_mfma_f32_16x16x32_bf16 v[52:55], v[12:15], a[232:235], v[52:55]
  ds_read_b128 v[12:15], v2 offset:47104
  s_waitcnt lgkmcnt(3)
  v_mfma_f32_16x16x32_bf16 v[32:35], a[44:47], v[16:19], v[32:35]
  v_mfma_f32_16x16x32_bf16 v[36:39], a[108:111], v[16:19], v[36:39]
  v_mfma_f32_16x16x32_bf16 v[48:51], v[16:19], a[172:175], v[48:51]
  v_mfma_f32_16x16x32_bf16 v[52:55], v[16:19], a[236:239], v[52:55]
  ds_read_b128 v[16:19], v2 offset:48128
  s_waitcnt lgkmcnt(3)
  v_mfma_f32_16x16x32_bf16 v[32:35], a[48:51], v[4:7], v[32:35]
  v_mfma_f32_16x16x32_bf16 v[36:39], a[112:115], v[4:7], v[36:39]
  v_mfma_f32_16x16x32_bf16 v[48:51], v[4:7], a[176:179], v[48:51]
  v_mfma_f32_16x16x32_bf16 v[52:55], v[4:7], a[240:243], v[52:55]
  ds_read_b128 v[4:7], v2 offset:49152
  s_waitcnt lgkmcnt(3)
  v_mfma_f32_16x16x32_bf16 v[32:35], a[52:55], v[8:11], v[32:35]
  v_mfma_f32_16x16x32_bf16 v[36:39], a[116:119], v[8:11], v[36:39]
  v_mfma_f32_16x16x32_bf16 v[48:51], v[8:11], a[180:183], v[48:51]
  v_mfma_f32_16x16x32_bf16 v[52:55], v[8:11], a[244:247], v[52:55]
  ds_read_b128 v[8:11], v2 offset:50176
  s_waitcnt lgkmcnt(3)
  v_mfma_f32_16x16x32_bf16 v[32:35], a[56:59], v[12:15], v[32:35]
  v_mfma_f32_16x16x32_bf16 v[36:39], a[120:123], v[12:15], v[36:39]
  v_mfma_f32_16x16x32_bf16 v[48:51], v[12:15], a[184:187], v[48:51]
  v_mfma_f32_16x16x32_bf16 v[52:55], v[12:15], a[248:251], v[52:55]
  ds_read_b128 v[12:15], v2 offset:51200
  s_waitcnt lgkmcnt(3)
  v_mfma_f32_16x16x32_bf16 v[32:35], a[60:63], v[16:19], v[32:35]
  v_mfma_f32_16x16x32_bf16 v[36:39], a[124:127], v[16:19], v[36:39]
  v_mfma_f32_16x16x32_bf16 v[48:51], v[16:19], a[188:191], v[48:51]
  v_mfma_f32_16x16x32_bf16 v[52:55], v[16:19], a[252:255], v[52:55]
  s_waitcnt vmcnt(8)
  s_barrier
  s_cmp_eq_u32 s48, 0
  s_nop 3
  s_cbranch_scc1 PF11
  s_cmp_lg_u32 s48, s43
  s_cbranch_scc1 PG11
  s_mov_b32 s28, s88
  s_and_b32 s29, s89, 0xffff
  s_mov_b32 s30, 0x100
  s_mov_b32 s31, 0x20000
  v_and_b32 v124, 31, v0
  v_lshlrev_b32 v124, 2, v124
  s_mov_b32 s3, 0x100000
  s_nop 0
WI12:
  buffer_load_dword v125, v124, s[28:31], 0 offen sc1
  s_sub_u32 s3, s3, 1
  s_cbranch_scc1 K1_END
  s_waitcnt vmcnt(0)
  v_cmp_eq_u32 vcc, 0, v125
  s_nop 3
  s_cbranch_vccnz WI12
PG11:
  s_cmp_lg_u32 s32, 0
  s_cbranch_scc1 SF13
  v_mov_b32 v124, 0
  v_mov_b32 v125, 1
  s_mov_b64 exec, 1
  buffer_store_dword v125, v124, s[4:7], s48 offen sc1
  s_mov_b64 exec, -1
SF13:
PF11:
  ds_read_b128 v[16:19], v2 offset:52224
  s_waitcnt lgkmcnt(3)
  v_mfma_f32_16x16x32_bf16 v[40:43], a[0:3], v[4:7], 0
  v_mfma_f32_16x16x32_bf16 v[44:47], a[64:67], v[4:7], 0
  v_mfma_f32_16x16x32_bf16 v[56:59], v[4:7], a[128:131], 0
  v_mfma_f32_16x16x32_bf16 v[60:63], v[4:7], a[192:195], 0
  ds_read_b128 v[4:7], v2 offset:53248
  s_waitcnt lgkmcnt(3)
  v_mfma_f32_16x16x32_bf16 v[40:43], a[4:7], v[8:11], v[40:43]
  v_mfma_f32_16x16x32_bf16 v[44:47], a[68:71], v[8:11], v[44:47]
  v_mfma_f32_16x16x32_bf16 v[56:59], v[8:11], a[132:135], v[56:59]
  v_mfma_f32_16x16x32_bf16 v[60:63], v[8:11], a[196:199], v[60:63]
  ds_read_b128 v[8:11], v2 offset:54272
  s_waitcnt lgkmcnt(3)
  v_mfma_f32_16x16x32_bf16 v[40:43], a[8:11], v[12:15], v[40:43]
  v_mfma_f32_16x16x32_bf16 v[44:47], a[72:75], v[12:15], v[44:47]
  v_mfma_f32_16x16x32_bf16 v[56:59], v[12:15], a[136:139], v[56:59]
  v_mfma_f32_16x16x32_bf16 v[60:63], v[12:15], a[200:203], v[60:63]
  ds_read_b128 v[12:15], v2 offset:55296
  s_waitcnt lgkmcnt(3)
  v_mfma_f32_16x16x32_bf16 v[40:43], a[12:15], v[16:19], v[40:43]
  v_mfma_f32_16x16x32_bf16 v[44:47], a[76:79], v[16:19], v[44:47]
  v_mfma_f32_16x16x32_bf16 v[56:59], v[16:19], a[140:143], v[56:59]
  v_mfma_f32_16x16x32_bf16 v[60:63], v[16:19], a[204:207], v[60:63]
  ds_read_b128 v[16:19], v2 offset:56320
  s_waitcnt lgkmcnt(3)
  v_mfma_f32_16x16x32_bf16 v[40:43], a[16:19], v[4:7], v[40:43]
  v_mfma_f32_16x16x32_bf16 v[44:47], a[80:83], v[4:7], v[44:47]
  v_mfma_f32_16x16x32_bf16 v[56:59], v[4:7], a[144:147], v[56:59]
  v_mfma_f32_16x16x32_bf16 v[60:63], v[4:7], a[208:211], v[60:63]
  ds_read_b128 v[4:7], v2 offset:57344
  s_waitcnt lgkmcnt(3)
  v_mfma_f32_16x16x32_bf16 v[40:43], a[20:23], v[8:11], v[40:43]
  v_mfma_f32_16x16x32_bf16 v[44:47], a[84:87], v[8:11], v[44:47]
  v_mfma_f32_16x16x32_bf16 v[56:59], v[8:11], a[148:151], v[56:59]
  v_mfma_f32_16x16x32_bf16 v[60:63], v[8:11], a[212:215], v[60:63]
  ds_read_b128 v[8:11], v2 offset:58368
  s_waitcnt lgkmcnt(3)
  v_mfma_f32_16x16x32_bf16 v[40:43], a[24:27], v[12:15], v[40:43]
  v_mfma_f32_16x16x32_bf16 v[44:47], a[88:91], v[12:15], v[44:47]
  v_mfma_f32_16x16x32_bf16 v[56:59], v[12:15], a[152:155], v[56:59]
  v_mfma_f32_16x16x32_bf16 v[60:63], v[12:15], a[216:219], v[60:63]
  ds_read_b128 v[12:15], v2 offset:59392
  s_waitcnt lgkmcnt(3)
  v_mfma_f32_16x16x32_bf16 v[40:43], a[28:31], v[16:19], v[40:43]
  v_mfma_f32_16x16x32_bf16 v[44:47], a[92:95], v[16:19], v[44:47]
  v_mfma_f32_16x16x32_bf16 v[56:59], v[16:19], a[156:159], v[56:59]
  v_mfma_f32_16x16x32_bf16 v[60:63], v[16:19], a[220:223], v[60:63]
  ds_read_b128 v[16:19], v2 offset:60416
  s_waitcnt lgkmcnt(3)
  v_mfma_f32_16x16x32_bf16 v[40:43], a[32:35], v[4:7], v[40:43]
  v_mfma_f32_16x16x32_bf16 v[44:47], a[96:99], v[4:7], v[44:47]
  v_mfma_f32_16x16x32_bf16 v[56:59], v[4:7], a[160:163], v[56:59]
  v_mfma_f32_16x16x32_bf16 v[60:63], v[4:7], a[224:227], v[60:63]
  ds_read_b128 v[4:7], v2 offset:61440
  s_waitcnt lgkmcnt(3)
  v_mfma_f32_16x16x32_bf16 v[40:43], a[36:39], v[8:11], v[40:43]
  v_mfma_f32_16x16x32_bf16 v[44:47], a[100:103], v[8:11], v[44:47]
  v_mfma_f32_16x16x32_bf16 v[56:59], v[8:11], a[164:167], v[56:59]
  v_mfma_f32_16x16x32_bf16 v[60:63], v[8:11], a[228:231], v[60:63]
  ds_read_b128 v[8:11], v2 offset:62464
  s_waitcnt lgkmcnt(3)
  v_mfma_f32_16x16x32_bf16 v[40:43], a[40:43], v[12:15], v[40:43]
  v_mfma_f32_16x16x32_bf16 v[44:47], a[104:107], v[12:15], v[44:47]
  v_mfma_f32_16x16x32_bf16 v[56:59], v[12:15], a[168:171], v[56:59]
  v_mfma_f32_16x16x32_bf16 v[60:63], v[12:15], a[232:235], v[60:63]
  ds_read_b128 v[12:15], v2 offset:63488
  s_waitcnt lgkmcnt(3)
  v_mfma_f32_16x16x32_bf16 v[40:43], a[44:47], v[16:19], v[40:43]
  v_mfma_f32_16x16x32_bf16 v[44:47], a[108:111], v[16:19], v[44:47]
  v_mfma_f32_16x16x32_bf16 v[56:59], v[16:19], a[172:175], v[56:59]
  v_mfma_f32_16x16x32_bf16 v[60:63], v[16:19], a[236:239], v[60:63]
  ds_read_b128 v[16:19], v2 offset:64512
  s_waitcnt lgkmcnt(3)
  v_mfma_f32_16x16x32_bf16 v[40:43], a[48:51], v[4:7], v[40:43]
  v_mfma_f32_16x16x32_bf16 v[44:47], a[112:115], v[4:7], v[44:47]
  v_mfma_f32_16x16x32_bf16 v[56:59], v[4:7], a[176:179], v[56:59]
  v_mfma_f32_16x16x32_bf16 v[60:63], v[4:7], a[240:243], v[60:63]
  s_waitcnt lgkmcnt(2)
  v_mfma_f32_16x16x32_bf16 v[40:43], a[52:55], v[8:11], v[40:43]
  v_mfma_f32_16x16x32_bf16 v[44:47], a[116:119], v[8:11], v[44:47]
  v_mfma_f32_16x16x32_bf16 v[56:59], v[8:11], a[180:183], v[56:59]
  v_mfma_f32_16x16x32_bf16 v[60:63], v[8:11], a[244:247], v[60:63]
  s_waitcnt lgkmcnt(1)
  v_mfma_f32_16x16x32_bf16 v[40:43], a[56:59], v[12:15], v[40:43]
  v_mfma_f32_16x16x32_bf16 v[44:47], a[120:123], v[12:15], v[44:47]
  v_mfma_f32_16x16x32_bf16 v[56:59], v[12:15], a[184:187], v[56:59]
  v_mfma_f32_16x16x32_bf16 v[60:63], v[12:15], a[248:251], v[60:63]
  s_waitcnt lgkmcnt(0)
  v_mfma_f32_16x16x32_bf16 v[40:43], a[60:63], v[16:19], v[40:43]
  v_mfma_f32_16x16x32_bf16 v[44:47], a[124:127], v[16:19], v[44:47]
  v_mfma_f32_16x16x32_bf16 v[56:59], v[16:19], a[188:191], v[56:59]
  v_mfma_f32_16x16x32_bf16 v[60:63], v[16:19], a[252:255], v[60:63]
  s_lshl_b32 s36, s46, 5
  s_add_u32 s36, s36, s33
  s_lshl_b32 s36, s36, 14
  s_lshl_b32 s37, s32, 10
  s_add_u32 s38, s36, s37
  s_add_u32 s39, s38, s37
  s_add_u32 s39, s39, 8192
  v_cvt_pk_bf16_f32 v64, v32, v33
  v_cvt_pk_bf16_f32 v65, v34, v35
  v_cvt_pk_bf16_f32 v66, v36, v37
  v_cvt_pk_bf16_f32 v67, v38, v39
  v_cvt_pk_bf16_f32 v68, v40, v41
  v_cvt_pk_bf16_f32 v69, v42, v43
  v_cvt_pk_bf16_f32 v70, v44, v45
  v_cvt_pk_bf16_f32 v71, v46, v47
  v_cvt_pk_bf16_f32 v72, v48, v49
  v_cvt_pk_bf16_f32 v73, v50, v51
  v_cvt_pk_bf16_f32 v74, v56, v57
  v_cvt_pk_bf16_f32 v75, v58, v59
  v_cvt_pk_bf16_f32 v76, v52, v53
  v_cvt_pk_bf16_f32 v77, v54, v55
  v_cvt_pk_bf16_f32 v78, v60, v61
  v_cvt_pk_bf16_f32 v79, v62, v63
  buffer_store_dwordx4 v[64:67], v2, s[4:7], s38 offen sc1
  s_add_u32 s38, s38, 4096
  buffer_store_dwordx4 v[68:71], v2, s[4:7], s38 offen sc1
  buffer_store_dwordx4 v[72:75], v2, s[4:7], s39 offen sc1
  buffer_store_dwordx4 v[76:79], v2, s[4:7], s39 offen offset:1024 sc1
  s_lshl_b32 s48, s46, 5
  s_add_u32 s48, s48, s33
  s_lshl_b32 s48, s48, 2
  s_add_u32 s48, s48, 87032064
  s_mov_b32 s46, s47
  s_cmp_ge_u32 s46, 64
  s_cbranch_scc1 K1_R1a_LAST
  s_branch K1_R1a_L0
K1_R1a_LAST:
  s_waitcnt vmcnt(0)
  s_barrier
  s_cmp_eq_u32 s48, 0
  s_cbranch_scc1 PF14
  s_cmp_lg_u32 s48, s43
  s_cbranch_scc1 PG14
  s_mov_b32 s28, s88
  s_and_b32 s29, s89, 0xffff
  s_mov_b32 s30, 0x100
  s_mov_b32 s31, 0x20000
  v_and_b32 v124, 31, v0
  v_lshlrev_b32 v124, 2, v124
  s_mov_b32 s3, 0x100000
  s_nop 0
WI15:
  buffer_load_dword v125, v124, s[28:31], 0 offen sc1
  s_sub_u32 s3, s3, 1
  s_cbranch_scc1 K1_END
  s_waitcnt vmcnt(0)
  v_cmp_eq_u32 vcc, 0, v125
  s_nop 3
  s_cbranch_vccnz WI15
PG14:
  s_cmp_lg_u32 s32, 0
  s_cbranch_scc1 SF16
  v_mov_b32 v124, 0
  v_mov_b32 v125, 1
  s_mov_b64 exec, 1
  buffer_store_dword v125, v124, s[4:7], s48 offen sc1
  s_mov_b64 exec, -1
SF16:
PF14:
K1_R1a_DONE:
  s_sub_u32 s36, s34, 1
  s_lshl_b32 s36, s36, 3
  s_and_b32 s37, s35, 7
  s_add_u32 s33, s36, s37
  s_lshr_b32 s45, s35, 3
  s_mov_b32 s8, s68
  s_and_b32 s9, s69, 0xffff
  s_mov_b32 s10, 0x400000
  s_mov_b32 s11, 0x20000
  s_mov_b32 s24, s64
  s_and_b32 s25, s65, 0xffff
  s_mov_b32 s26, 0x200000
  s_mov_b32 s27, 0x20000
  s_lshl_b32 s49, s33, 8
  v_lshrrev_b32 v109, 4, v0
  v_bfe_u32 v107, v0, 1, 3
  v_xor_b32 v108, v107, v109
  v_lshlrev_b32 v108, 5, v108
  v_and_b32 v100, 1, v0
  v_lshl_add_u32 v108, v100, 4, v108
  s_mov_b32 s36, 8192
  v_mad_u32_u24 v100, v109, s36, v108
  v_xor_b32 v101, 0x80, v100
  v_bfe_u32 v110, v0, 2, 2
  v_and_b32 v111, 3, v0
  s_lshl_b32 s36, s32, 1
  v_and_b32 v112, 1, v109
  v_lshl_or_b32 v112, v112, 2, v110
  v_xor_b32 v107, s36, v112
  v_lshlrev_b32 v107, 5, v107
  v_lshl_add_u32 v107, v111, 3, v107
  v_lshl_add_u32 v108, v109, 3, v110
  v_lshl_add_u32 v103, v108, 8, v107
  v_xor_b32 v105, 32, v103
  v_add_u32 v104, 0x10000, v103
  v_add_u32 v106, 0x10000, v105
  s_mul_i32 s36, s32, 131072
  s_add_u32 s40, s49, s36
  s_lshl_b32 s44, s32, 12
  s_add_u32 s36, s44, 0
  s_mov_b32 m0, s36
  s_add_u32 s37, s40, 0
  buffer_load_dwordx4 v100, s[8:11], s37 offen lds
  s_add_u32 s36, s44, 1024
  s_mov_b32 m0, s36
  s_add_u32 s37, s40, 32768
  buffer_load_dwordx4 v100, s[8:11], s37 offen lds
  s_add_u32 s36, s44, 2048
  s_mov_b32 m0, s36
  s_add_u32 s37, s40, 65536
  buffer_load_dwordx4 v101, s[8:11], s37 offen lds
  s_add_u32 s36, s44, 3072
  s_mov_b32 m0, s36
  s_add_u32 s37, s40, 98304
  buffer_load_dwordx4 v101, s[8:11], s37 offen lds
  s_add_u32 s36, s44, 16384
  s_mov_b32 m0, s36
  s_add_u32 s37, s40, 524288
  buffer_load_dwordx4 v100, s[8:11], s37 offen lds
  s_add_u32 s36, s44, 17408
  s_mov_b32 m0, s36
  s_add_u32 s37, s40, 557056
  buffer_load_dwordx4 v100, s[8:11], s37 offen lds
  s_add_u32 s36, s44, 18432
  s_mov_b32 m0, s36
  s_add_u32 s37, s40, 589824
  buffer_load_dwordx4 v101, s[8:11], s37 offen lds
  s_add_u32 s36, s44, 19456
  s_mov_b32 m0, s36
  s_add_u32 s37, s40, 622592
  buffer_load_dwordx4 v101, s[8:11], s37 offen lds
  s_add_u32 s36, s44, 32768
  s_mov_b32 m0, s36
  s_add_u32 s37, s40, 1048576
  buffer_load_dwordx4 v100, s[8:11], s37 offen lds
  s_add_u32 s36, s44, 33792
  s_mov_b32 m0, s36
  s_add_u32 s37, s40, 1081344
  buffer_load_dwordx4 v100, s[8:11], s37 offen lds
  s_add_u32 s36, s44, 34816
  s_mov_b32 m0, s36
  s_add_u32 s37, s40, 1114112
  buffer_load_dwordx4 v101, s[8:11], s37 offen lds
  s_add_u32 s36, s44, 35840
  s_mov_b32 m0, s36
  s_add_u32 s37, s40, 1146880
  buffer_load_dwordx4 v101, s[8:11], s37 offen lds
  s_add_u32 s36, s44, 49152
  s_mov_b32 m0, s36
  s_add_u32 s37, s40, 1572864
  buffer_load_dwordx4 v100, s[8:11], s37 offen lds
  s_add_u32 s36, s44, 50176
  s_mov_b32 m0, s36
  s_add_u32 s37, s40, 1605632
  buffer_load_dwordx4 v100, s[8:11], s37 offen lds
  s_add_u32 s36, s44, 51200
  s_mov_b32 m0, s36
  s_add_u32 s37, s40, 1638400
  buffer_load_dwordx4 v101, s[8:11], s37 offen lds
  s_add_u32 s36, s44, 52224
  s_mov_b32 m0, s36
  s_add_u32 s37, s40, 1671168
  buffer_load_dwordx4 v101, s[8:11], s37 offen lds
  s_add_u32 s36, s44, 65536
  s_mov_b32 m0, s36
  s_add_u32 s37, s40, 2097152
  buffer_load_dwordx4 v100, s[8:11], s37 offen lds
  s_add_u32 s36, s44, 66560
  s_mov_b32 m0, s36
  s_add_u32 s37, s40, 2129920
  buffer_load_dwordx4 v100, s[8:11], s37 offen lds
  s_add_u32 s36, s44, 67584
  s_mov_b32 m0, s36
  s_add_u32 s37, s40, 2162688
  buffer_load_dwordx4 v101, s[8:11], s37 offen lds
  s_add_u32 s36, s44, 68608
  s_mov_b32 m0, s36
  s_add_u32 s37, s40, 2195456
  buffer_load_dwordx4 v101, s[8:11], s37 offen lds
  s_add_u32 s36, s44, 81920
  s_mov_b32 m0, s36
  s_add_u32 s37, s40, 2621440
  buffer_load_dwordx4 v100, s[8:11], s37 offen lds
  s_add_u32 s36, s44, 82944
  s_mov_b32 m0, s36
  s_add_u32 s37, s40, 2654208
  buffer_load_dwordx4 v100, s[8:11], s37 offen lds
  s_add_u32 s36, s44, 83968
  s_mov_b32 m0, s36
  s_add_u32 s37, s40, 2686976
  buffer_load_dwordx4 v101, s[8:11], s37 offen lds
  s_add_u32 s36, s44, 84992
  s_mov_b32 m0, s36
  s_add_u32 s37, s40, 2719744
  buffer_load_dwordx4 v101, s[8:11], s37 offen lds
  s_add_u32 s36, s44, 98304
  s_mov_b32 m0, s36
  s_add_u32 s37, s40, 3145728
  buffer_load_dwordx4 v100, s[8:11], s37 offen lds
  s_add_u32 s36, s44, 99328
  s_mov_b32 m0, s36
  s_add_u32 s37, s40, 3178496
  buffer_load_dwordx4 v100, s[8:11], s37 offen lds
  s_add_u32 s36, s44, 100352
  s_mov_b32 m0, s36
  s_add_u32 s37, s40, 3211264
  buffer_load_dwordx4 v101, s[8:11], s37 offen lds
  s_add_u32 s36, s44, 101376
  s_mov_b32 m0, s36
  s_add_u32 s37, s40, 3244032
  buffer_load_dwordx4 v101, s[8:11], s37 offen lds
  s_waitcnt vmcnt(24)
  s_barrier
  s_add_u32 s36, s44, 114688
  s_mov_b32 m0, s36
  s_add_u32 s37, s40, 3670016
  buffer_load_dwordx4 v100, s[8:11], s37 offen lds
  s_add_u32 s36, s44, 115712
  s_mov_b32 m0, s36
  s_add_u32 s37, s40, 3702784
  buffer_load_dwordx4 v100, s[8:11], s37 offen lds
  s_add_u32 s36, s44, 116736
  s_mov_b32 m0, s36
  s_add_u32 s37, s40, 3735552
  buffer_load_dwordx4 v101, s[8:11], s37 offen lds
  s_add_u32 s36, s44, 117760
  s_mov_b32 m0, s36
  s_add_u32 s37, s40, 3768320
  buffer_load_dwordx4 v101, s[8:11], s37 offen lds
  ds_read_b64_tr_b16 v[128:129], v103 offset:0
  ds_read_b64_tr_b16 v[130:131], v103 offset:1024
  ds_read_b64_tr_b16 v[132:133], v103 offset:8192
  ds_read_b64_tr_b16 v[134:135], v103 offset:9216
  ds_read_b64_tr_b16 v[192:193], v105 offset:0
  ds_read_b64_tr_b16 v[194:195], v105 offset:1024
  ds_read_b64_tr_b16 v[196:197], v105 offset:8192
  ds_read_b64_tr_b16 v[198:199], v105 offset:9216
  s_waitcnt lgkmcnt(0)
  s_waitcnt vmcnt(24)
  s_barrier
  ds_read_b64_tr_b16 v[136:137], v103 offset:16384
  ds_read_b64_tr_b16 v[138:139], v103 offset:17408
  ds_read_b64_tr_b16 v[140:141], v103 offset:24576
  ds_read_b64_tr_b16 v[142:143], v103 offset:25600
  ds_read_b64_tr_b16 v[200:201], v105 offset:16384
  ds_read_b64_tr_b16 v[202:203], v105 offset:17408
  ds_read_b64_tr_b16 v[204:205], v105 offset:24576
  ds_read_b64_tr_b16 v[206:207], v105 offset:25600
  s_waitcnt lgkmcnt(0)
  s_waitcnt vmcnt(20)
  s_barrier
  ds_read_b64_tr_b16 v[144:145], v103 offset:32768
  ds_read_b64_tr_b16 v[146:147], v103 offset:33792
  ds_read_b64_tr_b16 v[148:149], v103 offset:40960
  ds_read_b64_tr_b16 v[150:151], v103 offset:41984
  ds_read_b64_tr_b16 v[208:209], v105 offset:32768
  ds_read_b64_tr_b16 v[210:211], v105 offset:33792
  ds_read_b64_tr_b16 v[212:213], v105 offset:40960
  ds_read_b64_tr_b16 v[214:215], v105 offset:41984
  s_waitcnt lgkmcnt(0)
  s_waitcnt vmcnt(16)
  s_barrier
  ds_read_b64_tr_b16 v[152:153], v103 offset:49152
  ds_read_b64_tr_b16 v[154:155], v103 offset:50176
  ds_read_b64_tr_b16 v[156:157], v103 offset:57344
  ds_read_b64_tr_b16 v[158:159], v103 offset:58368
  ds_read_b64_tr_b16 v[216:217], v105 offset:49152
  ds_read_b64_tr_b16 v[218:219], v105 offset:50176
  ds_read_b64_tr_b16 v[220:221], v105 offset:57344
  ds_read_b64_tr_b16 v[222:223], v105 offset:58368
  s_waitcnt lgkmcnt(0)
  s_waitcnt vmcnt(12)
  s_barrier
  ds_read_b64_tr_b16 v[160:161], v104 offset:0
  ds_read_b64_tr_b16 v[162:163], v104 offset:1024
  ds_read_b64_tr_b16 v[164:165], v104 offset:8192
  ds_read_b64_tr_b16 v[166:167], v104 offset:9216
  ds_read_b64_tr_b16 v[224:225], v106 offset:0
  ds_read_b64_tr_b16 v[226:227], v106 offset:1024
  ds_read_b64_tr_b16 v[228:229], v106 offset:8192
  ds_read_b64_tr_b16 v[230:231], v106 offset:9216
  s_waitcnt lgkmcnt(0)
  s_waitcnt vmcnt(8)
  s_barrier
  ds_read_b64_tr_b16 v[168:169], v104 offset:16384
  ds_read_b64_tr_b16 v[170:171], v104 offset:17408
  ds_read_b64_tr_b16 v[172:173], v104 offset:24576
  ds_read_b64_tr_b16 v[174:175], v104 offset:25600
  ds_read_b64_tr_b16 v[232:233], v106 offset:16384
  ds_read_b64_tr_b16 v[234:235], v106 offset:17408
  ds_read_b64_tr_b16 v[236:237], v106 offset:24576
  ds_read_b64_tr_b16 v[238:239], v106 offset:25600
  s_waitcnt lgkmcnt(0)
  s_waitcnt vmcnt(4)
  s_barrier
  ds_read_b64_tr_b16 v[176:177], v104 offset:32768
  ds_read_b64_tr_b16 v[178:179], v104 offset:33792
  ds_read_b64_tr_b16 v[180:181], v104 offset:40960
  ds_read_b64_tr_b16 v[182:183], v104 offset:41984
  ds_read_b64_tr_b16 v[240:241], v106 offset:32768
  ds_read_b64_tr_b16 v[242:243], v106 offset:33792
  ds_read_b64_tr_b16 v[244:245], v106 offset:40960
  ds_read_b64_tr_b16 v[246:247], v106 offset:41984
  s_waitcnt lgkmcnt(0)
  s_waitcnt vmcnt(0)
  s_barrier
  ds_read_b64_tr_b16 v[184:185], v104 offset:49152
  ds_read_b64_tr_b16 v[186:187], v104 offset:50176
  ds_read_b64_tr_b16 v[188:189], v104 offset:57344
  ds_read_b64_tr_b16 v[190:191], v104 offset:58368
  ds_read_b64_tr_b16 v[248:249], v106 offset:49152
  ds_read_b64_tr_b16 v[250:251], v106 offset:50176
  ds_read_b64_tr_b16 v[252:253], v106 offset:57344
  ds_read_b64_tr_b16 v[254:255], v106 offset:58368
  s_waitcnt lgkmcnt(0)
  s_barrier
  v_lshrrev_b32 v124, 4, v0
  v_lshlrev_b32 v124, 2, v124
  v_and_b32 v125, 15, v0
  s_and_b32 s36, s32, 1
  s_lshl_b32 s37, s36, 4
  v_add_u32 v125, s37, v125
  v_add_u32 v126, 0, v124
  v_cmp_le_u32 s[50:51], v126, v125
  v_add_u32 v126, 16, v124
  v_cmp_le_u32 s[58:59], v126, v125
  v_add_u32 v126, 1, v124
  v_cmp_le_u32 s[52:53], v126, v125
  v_add_u32 v126, 17, v124
  v_cmp_le_u32 s[60:61], v126, v125
  v_add_u32 v126, 2, v124
  v_cmp_le_u32 s[54:55], v126, v125
  v_add_u32 v126, 18, v124
  v_cmp_le_u32 s[62:63], v126, v125
  v_add_u32 v126, 3, v124
  v_cmp_le_u32 s[56:57], v126, v125
  v_add_u32 v126, 19, v124
  v_cmp_le_u32 s[92:93], v126, v125
  s_mov_b32 s94, -1
  s_mov_b32 s95, 0
  s_mov_b32 s96, 0
  s_mov_b32 s97, -1
  v_mov_b32 v120, 0x3f803f80
  v_mov_b32 v121, 0x3f803f80
  v_mov_b32 v122, 0x3f803f80
  v_mov_b32 v123, 0x3f803f80
  s_mov_b32 s98, 0x3db504f3
  s_mov_b32 s99, 0xce6e0000
  s_lshr_b32 s100, s32, 1
  s_and_b32 s101, s32, 1
  v_lshlrev_b32 v3, 3, v0
  v_and_b32 v1, 15, v0
  v_lshlrev_b32 v1, 10, v1
  v_lshrrev_b32 v3, 4, v0
  v_lshl_add_u32 v1, v3, 4, v1
  v_lshlrev_b32 v2, 4, v0
  s_mov_b32 s46, s45
  s_cmp_ge_u32 s46, 64
  s_cbranch_scc1 K1_R1b_DONE
  s_lshl_b32 s36, s46, 15
  s_lshl_b32 s37, s32, 8
  s_add_u32 s36, s36, s37
  s_lshl_b32 s37, s32, 12
  s_add_u32 s38, s37, 0
  s_mov_b32 m0, s38
  s_add_u32 s39, s36, 0
  buffer_load_dwordx4 v1, s[24:27], s39 offen lds
  s_add_u32 s38, s37, 1024
  s_mov_b32 m0, s38
  s_add_u32 s39, s36, 64
  buffer_load_dwordx4 v1, s[24:27], s39 offen lds
  s_add_u32 s38, s37, 2048
  s_mov_b32 m0, s38
  s_add_u32 s39, s36, 128
  buffer_load_dwordx4 v1, s[24:27], s39 offen lds
  s_add_u32 s38, s37, 3072
  s_mov_b32 m0, s38
  s_add_u32 s39, s36, 192
  buffer_load_dwordx4 v1, s[24:27], s39 offen lds
  s_add_u32 s38, s37, 16384
  s_mov_b32 m0, s38
  s_add_u32 s39, s36, 16384
  buffer_load_dwordx4 v1, s[24:27], s39 offen lds
  s_add_u32 s38, s37, 17408
  s_mov_b32 m0, s38
  s_add_u32 s39, s36, 16448
  buffer_load_dwordx4 v1, s[24:27], s39 offen lds
  s_add_u32 s38, s37, 18432
  s_mov_b32 m0, s38
  s_add_u32 s39, s36, 16512
  buffer_load_dwordx4 v1, s[24:27], s39 offen lds
  s_add_u32 s38, s37, 19456
  s_mov_b32 m0, s38
  s_add_u32 s39, s36, 16576
  buffer_load_dwordx4 v1, s[24:27], s39 offen lds
  s_mov_b32 s48, 0
  s_waitcnt vmcnt(0)
K1_R1b_L0:
  s_waitcnt vmcnt(1)
  s_barrier
  s_add_u32 s47, s46, 4
  s_min_u32 s36, s47, 63
  s_mov_b32 s44, s36
  s_lshl_b32 s36, s44, 15
  s_lshl_b32 s37, s32, 8
  s_add_u32 s36, s36, s37
  s_lshl_b32 s37, s32, 12
  s_add_u32 s38, s37, 32768
  s_mov_b32 m0, s38
  s_add_u32 s39, s36, 0
  buffer_load_dwordx4 v1, s[24:27], s39 offen lds
  s_add_u32 s38, s37, 33792
  s_mov_b32 m0, s38
  s_add_u32 s39, s36, 64
  buffer_load_dwordx4 v1, s[24:27], s39 offen lds
  s_add_u32 s38, s37, 34816
  s_mov_b32 m0, s38
  s_add_u32 s39, s36, 128
  buffer_load_dwordx4 v1, s[24:27], s39 offen lds
  s_add_u32 s38, s37, 35840
  s_mov_b32 m0, s38
  s_add_u32 s39, s36, 192
  buffer_load_dwordx4 v1, s[24:27], s39 offen lds
  s_add_u32 s38, s37, 49152
  s_mov_b32 m0, s38
  s_add_u32 s39, s36, 16384
  buffer_load_dwordx4 v1, s[24:27], s39 offen lds
  s_add_u32 s38, s37, 50176
  s_mov_b32 m0, s38
  s_add_u32 s39, s36, 16448
  buffer_load_dwordx4 v1, s[24:27], s39 offen lds
  s_add_u32 s38, s37, 51200
  s_mov_b32 m0, s38
  s_add_u32 s39, s36, 16512
  buffer_load_dwordx4 v1, s[24:27], s39 offen lds
  s_add_u32 s38, s37, 52224
  s_mov_b32 m0, s38
  s_add_u32 s39, s36, 16576
  buffer_load_dwordx4 v1, s[24:27], s39 offen lds
  s_lshl_b32 s36, s46, 5
  s_add_u32 s36, s36, s33
  s_lshl_b32 s37, s36, 14
  s_add_u32 s38, s37, 0
  buffer_load_dwordx4 v[36:39], v2, s[4:7], s38 offen
  s_add_u32 s38, s37, 1024
  buffer_load_dwordx4 v[40:43], v2, s[4:7], s38 offen
  s_add_u32 s38, s37, 2048
  buffer_load_dwordx4 v[44:47], v2, s[4:7], s38 offen
  s_add_u32 s38, s37, 3072
  buffer_load_dwordx4 v[48:51], v2, s[4:7], s38 offen
  s_add_u32 s38, s37, 4096
  buffer_load_dwordx4 v[52:55], v2, s[4:7], s38 offen
  s_add_u32 s38, s37, 5120
  buffer_load_dwordx4 v[56:59], v2, s[4:7], s38 offen
  s_add_u32 s38, s37, 6144
  buffer_load_dwordx4 v[60:63], v2, s[4:7], s38 offen
  s_add_u32 s38, s37, 7168
  buffer_load_dwordx4 v[64:67], v2, s[4:7], s38 offen
  s_lshl_b32 s38, s100, 12
  s_add_u32 s37, s37, s38
  s_add_u32 s38, s37, 8192
  buffer_load_dwordx4 v[84:87], v2, s[4:7], s38 offen
  s_add_u32 s38, s37, 9216
  buffer_load_dwordx4 v[88:91], v2, s[4:7], s38 offen
  s_add_u32 s38, s37, 10240
  buffer_load_dwordx4 v[92:95], v2, s[4:7], s38 offen
  s_add_u32 s38, s37, 11264
  buffer_load_dwordx4 v[96:99], v2, s[4:7], s38 offen
  ds_read_b128 v[4:7], v2 offset:0
  ds_read_b128 v[8:11], v2 offset:1024
  ds_read_b128 v[12:15], v2 offset:2048
  ds_read_b128 v[16:19], v2 offset:3072
  s_waitcnt lgkmcnt(3)
  v_mfma_f32_16x16x32_bf16 v[20:23], v[128:131], v[4:7], 0
  v_mfma_f32_16x16x32_bf16 v[24:27], v[192:195], v[4:7], 0
  ds_read_b128 v[4:7], v2 offset:4096
  s_waitcnt lgkmcnt(3)
  v_mfma_f32_16x16x32_bf16 v[20:23], v[132:135], v[8:11], v[20:23]
  v_mfma_f32_16x16x32_bf16 v[24:27], v[196:199], v[8:11], v[24:27]
  ds_read_b128 v[8:11], v2 offset:5120
  s_waitcnt lgkmcnt(3)
  v_mfma_f32_16x16x32_bf16 v[20:23], v[136:139], v[12:15], v[20:23]
  v_mfma_f32_16x16x32_bf16 v[24:27], v[200:203], v[12:15], v[24:27]
  ds_read_b128 v[12:15], v2 offset:6144
  s_waitcnt lgkmcnt(3)
  v_mfma_f32_16x16x32_bf16 v[20:23], v[140:143], v[16:19], v[20:23]
  v_mfma_f32_16x16x32_bf16 v[24:27], v[204:207], v[16:19], v[24:27]
  ds_read_b128 v[16:19], v2 offset:7168
  s_waitcnt lgkmcnt(3)
  v_mfma_f32_16x16x32_bf16 v[20:23], v[144:147], v[4:7], v[20:23]
  v_mfma_f32_16x16x32_bf16 v[24:27], v[208:211], v[4:7], v[24:27]
  ds_read_b128 v[4:7], v2 offset:8192
  s_waitcnt lgkmcnt(3)
  v_mfma_f32_16x16x32_bf16 v[20:23], v[148:151], v[8:11], v[20:23]
  v_mfma_f32_16x16x32_bf16 v[24:27], v[212:215], v[8:11], v[24:27]
  ds_read_b128 v[8:11], v2 offset:9216
  s_waitcnt lgkmcnt(3)
  v_mfma_f32_16x16x32_bf16 v[20:23], v[152:155], v[12:15], v[20:23]
  v_mfma_f32_16x16x32_bf16 v[24:27], v[216:219], v[12:15], v[24:27]
  ds_read_b128 v[12:15], v2 offset:10240
  s_waitcnt lgkmcnt(3)
  v_mfma_f32_16x16x32_bf16 v[20:23], v[156:159], v[16:19], v[20:23]
  v_mfma_f32_16x16x32_bf16 v[24:27], v[220:223], v[16:19], v[24:27]
  ds_read_b128 v[16:19], v2 offset:11264
  s_waitcnt lgkmcnt(3)
  v_mfma_f32_16x16x32_bf16 v[20:23], v[160:163], v[4:7], v[20:23]
  v_mfma_f32_16x16x32_bf16 v[24:27], v[224:227], v[4:7], v[24:27]
  ds_read_b128 v[4:7], v2 offset:12288
  s_waitcnt lgkmcnt(3)
  v_mfma_f32_16x16x32_bf16 v[20:23], v[164:167], v[8:11], v[20:23]
  v_mfma_f32_16x16x32_bf16 v[24:27], v[228:231], v[8:11], v[24:27]
  ds_read_b128 v[8:11], v2 offset:13312
  s_waitcnt lgkmcnt(3)
  v_mfma_f32_16x16x32_bf16 v[20:23], v[168:171], v[12:15], v[20:23]
  v_mfma_f32_16x16x32_bf16 v[24:27], v[232:235], v[12:15], v[24:27]
  ds_read_b128 v[12:15], v2 offset:14336
  s_waitcnt lgkmcnt(3)
  v_mfma_f32_16x16x32_bf16 v[20:23], v[172:175], v[16:19], v[20:23]
  v_mfma_f32_16x16x32_bf16 v[24:27], v[236:239], v[16:19], v[24:27]
  ds_read_b128 v[16:19], v2 offset:15360
  s_waitcnt lgkmcnt(3)
  v_mfma_f32_16x16x32_bf16 v[20:23], v[176:179], v[4:7], v[20:23]
  v_mfma_f32_16x16x32_bf16 v[24:27], v[240:243], v[4:7], v[24:27]
  ds_read_b128 v[4:7], v2 offset:16384
  s_waitcnt lgkmcnt(3)
  v_mfma_f32_16x16x32_bf16 v[20:23], v[180:183], v[8:11], v[20:23]
  v_mfma_f32_16x16x32_bf16 v[24:27], v[244:247], v[8:11], v[24:27]
  ds_read_b128 v[8:11], v2 offset:17408
  s_waitcnt lgkmcnt(3)
  v_mfma_f32_16x16x32_bf16 v[20:23], v[184:187], v[12:15], v[20:23]
  v_mfma_f32_16x16x32_bf16 v[24:27], v[248:251], v[12:15], v[24:27]
  ds_read_b128 v[12:15], v2 offset:18432
  s_waitcnt lgkmcnt(3)
  v_mfma_f32_16x16x32_bf16 v[20:23], v[188:191], v[16:19], v[20:23]
  v_mfma_f32_16x16x32_bf16 v[24:27], v[252:255], v[16:19], v[24:27]
  ds_read_b128 v[16:19], v2 offset:19456
  s_waitcnt lgkmcnt(3)
  v_mfma_f32_16x16x32_bf16 v[28:31], v[128:131], v[4:7], 0
  v_mfma_f32_16x16x32_bf16 v[32:35], v[192:195], v[4:7], 0
  ds_read_b128 v[4:7], v2 offset:20480
  s_waitcnt lgkmcnt(3)
  v_mfma_f32_16x16x32_bf16 v[28:31], v[132:135], v[8:11], v[28:31]
  v_mfma_f32_16x16x32_bf16 v[32:35], v[196:199], v[8:11], v[32:35]
  ds_read_b128 v[8:11], v2 offset:21504
  s_waitcnt lgkmcnt(3)
  v_mfma_f32_16x16x32_bf16 v[28:31], v[136:139], v[12:15], v[28:31]
  v_mfma_f32_16x16x32_bf16 v[32:35], v[200:203], v[12:15], v[32:35]
  ds_read_b128 v[12:15], v2 offset:22528
  s_waitcnt lgkmcnt(3)
  v_mfma_f32_16x16x32_bf16 v[28:31], v[140:143], v[16:19], v[28:31]
  v_mfma_f32_16x16x32_bf16 v[32:35], v[204:207], v[16:19], v[32:35]
  ds_read_b128 v[16:19], v2 offset:23552
  s_waitcnt lgkmcnt(3)
  v_mfma_f32_16x16x32_bf16 v[28:31], v[144:147], v[4:7], v[28:31]
  v_mfma_f32_16x16x32_bf16 v[32:35], v[208:211], v[4:7], v[32:35]
  ds_read_b128 v[4:7], v2 offset:24576
  s_waitcnt lgkmcnt(3)
  v_mfma_f32_16x16x32_bf16 v[28:31], v[148:151], v[8:11], v[28:31]
  v_mfma_f32_16x16x32_bf16 v[32:35], v[212:215], v[8:11], v[32:35]
  ds_read_b128 v[8:11], v2 offset:25600
  s_waitcnt lgkmcnt(3)
  v_mfma_f32_16x16x32_bf16 v[28:31], v[152:155], v[12:15], v[28:31]
  v_mfma_f32_16x16x32_bf16 v[32:35], v[216:219], v[12:15], v[32:35]
  ds_read_b128 v[12:15], v2 offset:26624
  s_waitcnt lgkmcnt(3)
  v_mfma_f32_16x16x32_bf16 v[28:31], v[156:159], v[16:19], v[28:31]
  v_mfma_f32_16x16x32_bf16 v[32:35], v[220:223], v[16:19], v[32:35]
  ds_read_b128 v[16:19], v2 offset:27648
  s_waitcnt lgkmcnt(3)
  v_mfma_f32_16x16x32_bf16 v[28:31], v[160:163], v[4:7], v[28:31]
  v_mfma_f32_16x16x32_bf16 v[32:35], v[224:227], v[4:7], v[32:35]
  ds_read_b128 v[4:7], v2 offset:28672
  s_waitcnt lgkmcnt(3)
  v_mfma_f32_16x16x32_bf16 v[28:31], v[164:167], v[8:11], v[28:31]
  v_mfma_f32_16x16x32_bf16 v[32:35], v[228:231], v[8:11], v[32:35]
  ds_read_b128 v[8:11], v2 offset:29696
  s_waitcnt lgkmcnt(3)
  v_mfma_f32_16x16x32_bf16 v[28:31], v[168:171], v[12:15], v[28:31]
  v_mfma_f32_16x16x32_bf16 v[32:35], v[232:235], v[12:15], v[32:35]
  ds_read_b128 v[12:15], v2 offset:30720
  s_waitcnt lgkmcnt(3)
  v_mfma_f32_16x16x32_bf16 v[28:31], v[172:175], v[16:19], v[28:31]
  v_mfma_f32_16x16x32_bf16 v[32:35], v[236:239], v[16:19], v[32:35]
  ds_read_b128 v[16:19], v2 offset:31744
  s_waitcnt lgkmcnt(3)
  v_mfma_f32_16x16x32_bf16 v[28:31], v[176:179], v[4:7], v[28:31]
  v_mfma_f32_16x16x32_bf16 v[32:35], v[240:243], v[4:7], v[32:35]
  s_waitcnt lgkmcnt(2)
  v_mfma_f32_16x16x32_bf16 v[28:31], v[180:183], v[8:11], v[28:31]
  v_mfma_f32_16x16x32_bf16 v[32:35], v[244:247], v[8:11], v[32:35]
  s_waitcnt lgkmcnt(1)
  v_mfma_f32_16x16x32_bf16 v[28:31], v[184:187], v[12:15], v[28:31]
  v_mfma_f32_16x16x32_bf16 v[32:35], v[248:251], v[12:15], v[32:35]
  s_waitcnt lgkmcnt(0)
  v_mfma_f32_16x16x32_bf16 v[28:31], v[188:191], v[16:19], v[28:31]
  v_mfma_f32_16x16x32_bf16 v[32:35], v[252:255], v[16:19], v[32:35]
  s_lshl_b32 s36, s32, 10
  v_add_u32 v124, s36, v2
  v_add_u32 v124, 65536, v124
  v_cvt_pk_bf16_f32 v4, v20, v21
  v_cvt_pk_bf16_f32 v5, v22, v23
  v_cvt_pk_bf16_f32 v6, v24, v25
  v_cvt_pk_bf16_f32 v7, v26, v27
  ds_write_b128 v124, v[4:7] offset:0
  v_cvt_pk_bf16_f32 v8, v28, v29
  v_cvt_pk_bf16_f32 v9, v30, v31
  v_cvt_pk_bf16_f32 v10, v32, v33
  v_cvt_pk_bf16_f32 v11, v34, v35
  ds_write_b128 v124, v[8:11] offset:4096
  s_lshl_b32 s36, s101, 12
  v_add_u32 v124, s36, v2
  v_add_u32 v124, 65536, v124
  s_waitcnt lgkmcnt(0)
  s_barrier
  ds_read_b128 v[104:107], v124 offset:0
  ds_read_b128 v[108:111], v124 offset:1024
  ds_read_b128 v[112:115], v124 offset:2048
  ds_read_b128 v[116:119], v124 offset:3072
  s_mul_i32 s36, s33, 0x2100
  s_lshl_b32 s37, s46, 7
  s_add_u32 s36, s36, s37
  s_add_u32 s36, s36, 88080640
  s_cmp_lg_u32 s32, 0
  s_cbranch_scc1 WG17
  v_mov_b32 v126, 0
  s_mov_b32 s3, 0x100000
  s_branch WF18
WS18:
  s_sleep 3
WF18:
  buffer_load_dword v127, v126, s[4:7], s36 offen sc1
  s_sub_u32 s3, s3, 1
  s_cbranch_scc1 K1_END
  s_waitcnt vmcnt(0)
  v_cmp_eq_u32 vcc, 0, v127
  s_nop 3
  s_cbranch_vccnz WS18
WG17:
  s_barrier
  s_lshl_b32 s36, s46, 5
  s_add_u32 s36, s36, s33
  s_lshl_b32 s37, s36, 13
  s_add_u32 s37, s37, 67108864
  buffer_load_dwordx4 v[68:71], v2, s[4:7], s37 offen offset:0
  buffer_load_dwordx4 v[72:75], v2, s[4:7], s37 offen offset:1024
  buffer_load_dwordx4 v[76:79], v2, s[4:7], s37 offen offset:2048
  buffer_load_dwordx4 v[80:83], v2, s[4:7], s37 offen offset:3072
  s_lshl_b32 s38, s100, 10
  s_add_u32 s37, s37, s38
  s_add_u32 s37, s37, 4096
  v_lshlrev_b32 v3, 3, v0
  buffer_load_dwordx2 v[100:101], v3, s[4:7], s37 offen offset:0
  buffer_load_dwordx2 v[102:103], v3, s[4:7], s37 offen offset:512
  s_waitcnt vmcnt(0) lgkmcnt(0)
  v_mfma_f32_16x16x32_bf16 v[20:23], v[68:71], v[104:107], 0
  v_mfma_f32_16x16x32_bf16 v[24:27], v[36:39], v[104:107], 0
  v_mfma_f32_16x16x32_bf16 v[28:31], v[52:55], v[104:107], 0
  v_mfma_f32_16x16x32_bf16 v[20:23], v[72:75], v[108:111], v[20:23]
  v_mfma_f32_16x16x32_bf16 v[24:27], v[40:43], v[108:111], v[24:27]
  v_mfma_f32_16x16x32_bf16 v[28:31], v[56:59], v[108:111], v[28:31]
  v_mfma_f32_16x16x32_bf16 v[20:23], v[76:79], v[112:115], v[20:23]
  v_mfma_f32_16x16x32_bf16 v[24:27], v[44:47], v[112:115], v[24:27]
  v_mfma_f32_16x16x32_bf16 v[28:31], v[60:63], v[112:115], v[28:31]
  v_mfma_f32_16x16x32_bf16 v[20:23], v[80:83], v[116:119], v[20:23]
  v_mfma_f32_16x16x32_bf16 v[24:27], v[48:51], v[116:119], v[24:27]
  v_mfma_f32_16x16x32_bf16 v[28:31], v[64:67], v[116:119], v[28:31]
  s_nop 5
  v_cvt_pk_bf16_f32 v124, v20, v21
  v_lshlrev_b32 v20, 16, v124
  v_and_b32 v21, 0xffff0000, v124
  v_cvt_pk_bf16_f32 v124, v22, v23
  v_lshlrev_b32 v22, 16, v124
  v_and_b32 v23, 0xffff0000, v124
  v_cvt_pk_bf16_f32 v124, v24, v25
  v_lshlrev_b32 v24, 16, v124
  v_and_b32 v25, 0xffff0000, v124
  v_cvt_pk_bf16_f32 v124, v26, v27
  v_lshlrev_b32 v26, 16, v124
  v_and_b32 v27, 0xffff0000, v124
  v_cvt_pk_bf16_f32 v124, v28, v29
  v_lshlrev_b32 v28, 16, v124
  v_and_b32 v29, 0xffff0000, v124
  v_cvt_pk_bf16_f32 v124, v30, v31
  v_lshlrev_b32 v30, 16, v124
  v_and_b32 v31, 0xffff0000, v124
  v_mul_f32 v20, s98, v20
  v_mul_f32 v21, s98, v21
  v_mul_f32 v22, s98, v22
  v_mul_f32 v23, s98, v23
  v_mul_f32 v24, s98, v24
  v_mul_f32 v25, s98, v25
  v_mul_f32 v26, s98, v26
  v_mul_f32 v27, s98, v27
  v_mul_f32 v28, s98, v28
  v_mul_f32 v29, s98, v29
  v_mul_f32 v30, s98, v30
  v_mul_f32 v31, s98, v31
  v_cvt_pk_bf16_f32 v124, v20, v21
  v_lshlrev_b32 v20, 16, v124
  v_and_b32 v21, 0xffff0000, v124
  v_cvt_pk_bf16_f32 v124, v22, v23
  v_lshlrev_b32 v22, 16, v124
  v_and_b32 v23, 0xffff0000, v124
  v_cvt_pk_bf16_f32 v124, v24, v25
  v_lshlrev_b32 v24, 16, v124
  v_and_b32 v25, 0xffff0000, v124
  v_cvt_pk_bf16_f32 v124, v26, v27
  v_lshlrev_b32 v26, 16, v124
  v_and_b32 v27, 0xffff0000, v124
  v_cvt_pk_bf16_f32 v124, v28, v29
  v_lshlrev_b32 v28, 16, v124
  v_and_b32 v29, 0xffff0000, v124
  v_cvt_pk_bf16_f32 v124, v30, v31
  v_lshlrev_b32 v30, 16, v124
  v_and_b32 v31, 0xffff0000, v124
  v_mov_b32 v125, s99
  v_cndmask_b32 v24, v125, v24, s[50:51]
  v_cndmask_b32 v28, v125, v28, s[58:59]
  v_cndmask_b32 v25, v125, v25, s[52:53]
  v_cndmask_b32 v29, v125, v29, s[60:61]
  v_cndmask_b32 v26, v125, v26, s[54:55]
  v_cndmask_b32 v30, v125, v30, s[62:63]
  v_cndmask_b32 v27, v125, v27, s[56:57]
  v_cndmask_b32 v31, v125, v31, s[92:93]
  v_max3_f32 v124, v20, v21, v22
  v_max3_f32 v124, v124, v23, v24
  v_max3_f32 v124, v124, v25, v26
  v_max3_f32 v124, v124, v27, v28
  v_max3_f32 v124, v124, v29, v30
  v_max_f32 v124, v124, v31
  v_mov_b32 v125, v124
  s_nop 1
  v_permlane16_swap_b32 v124, v125
  v_max_f32 v124, v124, v125
  v_mov_b32 v125, v124
  s_nop 1
  v_permlane32_swap_b32 v124, v125
  v_max_f32 v124, v124, v125
  v_sub_f32 v20, v20, v124
  v_mul_f32 v20, 0x3fb8aa3b, v20
  v_exp_f32 v20, v20
  v_sub_f32 v21, v21, v124
  v_mul_f32 v21, 0x3fb8aa3b, v21
  v_exp_f32 v21, v21
  v_sub_f32 v22, v22, v124
  v_mul_f32 v22, 0x3fb8aa3b, v22
  v_exp_f32 v22, v22
  v_sub_f32 v23, v23, v124
  v_mul_f32 v23, 0x3fb8aa3b, v23
  v_exp_f32 v23, v23
  v_sub_f32 v24, v24, v124
  v_mul_f32 v24, 0x3fb8aa3b, v24
  v_exp_f32 v24, v24
  v_sub_f32 v25, v25, v124
  v_mul_f32 v25, 0x3fb8aa3b, v25
  v_exp_f32 v25, v25
  v_sub_f32 v26, v26, v124
  v_mul_f32 v26, 0x3fb8aa3b, v26
  v_exp_f32 v26, v26
  v_sub_f32 v27, v27, v124
  v_mul_f32 v27, 0x3fb8aa3b, v27
  v_exp_f32 v27, v27
  v_sub_f32 v28, v28, v124
  v_mul_f32 v28, 0x3fb8aa3b, v28
  v_exp_f32 v28, v28
  v_sub_f32 v29, v29, v124
  v_mul_f32 v29, 0x3fb8aa3b, v29
  v_exp_f32 v29, v29
  v_sub_f32 v30, v30, v124
  v_mul_f32 v30, 0x3fb8aa3b, v30
  v_exp_f32 v30, v30
  v_sub_f32 v31, v31, v124
  v_mul_f32 v31, 0x3fb8aa3b, v31
  v_exp_f32 v31, v31
  v_add_f32 v124, v20, v21
  v_add_f32 v125, v22, v23
  v_add_f32 v124, v124, v125
  v_cndmask_b32 v124, 0, v124, s[94:95]
  v_add_f32 v124, v124, v24
  v_add_f32 v124, v124, v25
  v_add_f32 v124, v124, v26
  v_add_f32 v124, v124, v27
  v_add_f32 v124, v124, v28
  v_add_f32 v124, v124, v29
  v_add_f32 v124, v124, v30
  v_add_f32 v124, v124, v31
  v_mov_b32 v125, v124
  s_nop 1
  v_permlane16_swap_b32 v124, v125
  v_add_f32 v124, v124, v125
  v_mov_b32 v125, v124
  s_nop 1
  v_permlane32_swap_b32 v124, v125
  v_add_f32 v124, v124, v125
  v_rcp_f32 v124, v124
  s_nop 0
  v_mul_f32 v20, v20, v124
  v_mul_f32 v21, v21, v124
  v_mul_f32 v22, v22, v124
  v_mul_f32 v23, v23, v124
  v_mul_f32 v24, v24, v124
  v_mul_f32 v25, v25, v124
  v_mul_f32 v26, v26, v124
  v_mul_f32 v27, v27, v124
  v_mul_f32 v28, v28, v124
  v_mul_f32 v29, v29, v124
  v_mul_f32 v30, v30, v124
  v_mul_f32 v31, v31, v124
  v_cvt_pk_bf16_f32 v4, v24, v25
  v_cvt_pk_bf16_f32 v5, v26, v27
  v_cvt_pk_bf16_f32 v6, v28, v29
  v_cvt_pk_bf16_f32 v7, v30, v31
  v_cvt_pk_bf16_f32 v124, v20, v21
  v_cvt_pk_bf16_f32 v125, v22, v23
  v_cndmask_b32 v8, 0, v124, s[94:95]
  v_cndmask_b32 v10, 0, v124, s[96:97]
  v_cndmask_b32 v9, 0, v125, s[94:95]
  v_cndmask_b32 v11, 0, v125, s[96:97]
  v_mfma_f32_16x16x32_bf16 v[36:39], v[84:87], v[4:7], 0
  v_mfma_f32_16x16x32_bf16 v[40:43], v[88:91], v[4:7], 0
  v_mfma_f32_16x16x32_bf16 v[44:47], v[92:95], v[4:7], 0
  v_mfma_f32_16x16x32_bf16 v[48:51], v[96:99], v[4:7], 0
  v_mfma_f32_16x16x16_bf16 v[36:39], v[100:101], v[8:9], v[36:39]
  v_mfma_f32_16x16x16_bf16 v[40:43], v[100:101], v[10:11], v[40:43]
  v_mfma_f32_16x16x16_bf16 v[44:47], v[102:103], v[8:9], v[44:47]
  v_mfma_f32_16x16x16_bf16 v[48:51], v[102:103], v[10:11], v[48:51]
  s_lshl_b32 s36, s46, 1
  s_add_u32 s36, s36, s101
  s_lshl_b32 s36, s36, 5
  s_add_u32 s36, s36, s33
  s_lshl_b32 s36, s36, 12
  s_lshl_b32 s37, s100, 11
  s_add_u32 s36, s36, s37
  s_add_u32 s36, s36, 33554432
  v_cvt_pk_bf16_f32 v12, v36, v37
  v_cvt_pk_bf16_f32 v13, v38, v39
  v_cvt_pk_bf16_f32 v14, v40, v41
  v_cvt_pk_bf16_f32 v15, v42, v43
  buffer_store_dwordx4 v[12:15], v2, s[4:7], s36 offen offset:0 sc1
  v_cvt_pk_bf16_f32 v16, v44, v45
  v_cvt_pk_bf16_f32 v17, v46, v47
  v_cvt_pk_bf16_f32 v18, v48, v49
  v_cvt_pk_bf16_f32 v19, v50, v51
  buffer_store_dwordx4 v[16:19], v2, s[4:7], s36 offen offset:1024 sc1
  s_lshl_b32 s36, s46, 5
  s_add_u32 s36, s36, s33
  s_lshl_b32 s36, s36, 2
  s_add_u32 s36, s36, 87052544
  s_waitcnt vmcnt(0)
  s_barrier
  s_cmp_lg_u32 s32, 0
  s_cbranch_scc1 SF19
  v_mov_b32 v124, 0
  v_mov_b32 v125, 1
  s_mov_b64 exec, 1
  buffer_store_dword v125, v124, s[4:7], s36 offen sc1
  s_mov_b64 exec, -1
SF19:
  s_mov_b32 s46, s47
  s_cmp_ge_u32 s46, 64
  s_cbranch_scc1 K1_R1b_LAST
K1_R1b_L1:
  s_waitcnt vmcnt(1)
  s_barrier
  s_add_u32 s47, s46, 4
  s_min_u32 s36, s47, 63
  s_mov_b32 s44, s36
  s_lshl_b32 s36, s44, 15
  s_lshl_b32 s37, s32, 8
  s_add_u32 s36, s36, s37
  s_lshl_b32 s37, s32, 12
  s_add_u32 s38, s37, 0
  s_mov_b32 m0, s38
  s_add_u32 s39, s36, 0
  buffer_load_dwordx4 v1, s[24:27], s39 offen lds
  s_add_u32 s38, s37, 1024
  s_mov_b32 m0, s38
  s_add_u32 s39, s36, 64
  buffer_load_dwordx4 v1, s[24:27], s39 offen lds
  s_add_u32 s38, s37, 2048
  s_mov_b32 m0, s38
  s_add_u32 s39, s36, 128
  buffer_load_dwordx4 v1, s[24:27], s39 offen lds
  s_add_u32 s38, s37, 3072
  s_mov_b32 m0, s38
  s_add_u32 s39, s36, 192
  buffer_load_dwordx4 v1, s[24:27], s39 offen lds
  s_add_u32 s38, s37, 16384
  s_mov_b32 m0, s38
  s_add_u32 s39, s36, 16384
  buffer_load_dwordx4 v1, s[24:27], s39 offen lds
  s_add_u32 s38, s37, 17408
  s_mov_b32 m0, s38
  s_add_u32 s39, s36, 16448
  buffer_load_dwordx4 v1, s[24:27], s39 offen lds
  s_add_u32 s38, s37, 18432
  s_mov_b32 m0, s38
  s_add_u32 s39, s36, 16512
  buffer_load_dwordx4 v1, s[24:27], s39 offen lds
  s_add_u32 s38, s37, 19456
  s_mov_b32 m0, s38
  s_add_u32 s39, s36, 16576
  buffer_load_dwordx4 v1, s[24:27], s39 offen lds
  s_lshl_b32 s36, s46, 5
  s_add_u32 s36, s36, s33
  s_lshl_b32 s37, s36, 14
  s_add_u32 s38, s37, 0
  buffer_load_dwordx4 v[36:39], v2, s[4:7], s38 offen
  s_add_u32 s38, s37, 1024
  buffer_load_dwordx4 v[40:43], v2, s[4:7], s38 offen
  s_add_u32 s38, s37, 2048
  buffer_load_dwordx4 v[44:47], v2, s[4:7], s38 offen
  s_add_u32 s38, s37, 3072
  buffer_load_dwordx4 v[48:51], v2, s[4:7], s38 offen
  s_add_u32 s38, s37, 4096
  buffer_load_dwordx4 v[52:55], v2, s[4:7], s38 offen
  s_add_u32 s38, s37, 5120
  buffer_load_dwordx4 v[56:59], v2, s[4:7], s38 offen
  s_add_u32 s38, s37, 6144
  buffer_load_dwordx4 v[60:63], v2, s[4:7], s38 offen
  s_add_u32 s38, s37, 7168
  buffer_load_dwordx4 v[64:67], v2, s[4:7], s38 offen
  s_lshl_b32 s38, s100, 12
  s_add_u32 s37, s37, s38
  s_add_u32 s38, s37, 8192
  buffer_load_dwordx4 v[84:87], v2, s[4:7], s38 offen
  s_add_u32 s38, s37, 9216
  buffer_load_dwordx4 v[88:91], v2, s[4:7], s38 offen
  s_add_u32 s38, s37, 10240
  buffer_load_dwordx4 v[92:95], v2, s[4:7], s38 offen
  s_add_u32 s38, s37, 11264
  buffer_load_dwordx4 v[96:99], v2, s[4:7], s38 offen
  ds_read_b128 v[4:7], v2 offset:32768
  ds_read_b128 v[8:11], v2 offset:33792
  ds_read_b128 v[12:15], v2 offset:34816
  ds_read_b128 v[16:19], v2 offset:35840
  s_waitcnt lgkmcnt(3)
  v_mfma_f32_16x16x32_bf16 v[20:23], v[128:131], v[4:7], 0
  v_mfma_f32_16x16x32_bf16 v[24:27], v[192:195], v[4:7], 0
  ds_read_b128 v[4:7], v2 offset:36864
  s_waitcnt lgkmcnt(3)
  v_mfma_f32_16x16x32_bf16 v[20:23], v[132:135], v[8:11], v[20:23]
  v_mfma_f32_16x16x32_bf16 v[24:27], v[196:199], v[8:11], v[24:27]
  ds_read_b128 v[8:11], v2 offset:37888
  s_waitcnt lgkmcnt(3)
  v_mfma_f32_16x16x32_bf16 v[20:23], v[136:139], v[12:15], v[20:23]
  v_mfma_f32_16x16x32_bf16 v[24:27], v[200:203], v[12:15], v[24:27]
  ds_read_b128 v[12:15], v2 offset:38912
  s_waitcnt lgkmcnt(3)
  v_mfma_f32_16x16x32_bf16 v[20:23], v[140:143], v[16:19], v[20:23]
  v_mfma_f32_16x16x32_bf16 v[24:27], v[204:207], v[16:19], v[24:27]
  ds_read_b128 v[16:19], v2 offset:39936
  s_waitcnt lgkmcnt(3)
  v_mfma_f32_16x16x32_bf16 v[20:23], v[144:147], v[4:7], v[20:23]
  v_mfma_f32_16x16x32_bf16 v[24:27], v[208:211], v[4:7], v[24:27]
  ds_read_b128 v[4:7], v2 offset:40960
  s_waitcnt lgkmcnt(3)
  v_mfma_f32_16x16x32_bf16 v[20:23], v[148:151], v[8:11], v[20:23]
  v_mfma_f32_16x16x32_bf16 v[24:27], v[212:215], v[8:11], v[24:27]
  ds_read_b128 v[8:11], v2 offset:41984
  s_waitcnt lgkmcnt(3)
  v_mfma_f32_16x16x32_bf16 v[20:23], v[152:155], v[12:15], v[20:23]
  v_mfma_f32_16x16x32_bf16 v[24:27], v[216:219], v[12:15], v[24:27]
  ds_read_b128 v[12:15], v2 offset:43008
  s_waitcnt lgkmcnt(3)
  v_mfma_f32_16x16x32_bf16 v[20:23], v[156:159], v[16:19], v[20:23]
  v_mfma_f32_16x16x32_bf16 v[24:27], v[220:223], v[16:19], v[24:27]
  ds_read_b128 v[16:19], v2 offset:44032
  s_waitcnt lgkmcnt(3)
  v_mfma_f32_16x16x32_bf16 v[20:23], v[160:163], v[4:7], v[20:23]
  v_mfma_f32_16x16x32_bf16 v[24:27], v[224:227], v[4:7], v[24:27]
  ds_read_b128 v[4:7], v2 offset:45056
  s_waitcnt lgkmcnt(3)
  v_mfma_f32_16x16x32_bf16 v[20:23], v[164:167], v[8:11], v[20:23]
  v_mfma_f32_16x16x32_bf16 v[24:27], v[228:231], v[8:11], v[24:27]
  ds_read_b128 v[8:11], v2 offset:46080
  s_waitcnt lgkmcnt(3)
  v_mfma_f32_16x16x32_bf16 v[20:23], v[168:171], v[12:15], v[20:23]
  v_mfma_f32_16x16x32_bf16 v[24:27], v[232:235], v[12:15], v[24:27]
  ds_read_b128 v[12:15], v2 offset:47104
  s_waitcnt lgkmcnt(3)
  v_mfma_f32_16x16x32_bf16 v[20:23], v[172:175], v[16:19], v[20:23]
  v_mfma_f32_16x16x32_bf16 v[24:27], v[236:239], v[16:19], v[24:27]
  ds_read_b128 v[16:19], v2 offset:48128
  s_waitcnt lgkmcnt(3)
  v_mfma_f32_16x16x32_bf16 v[20:23], v[176:179], v[4:7], v[20:23]
  v_mfma_f32_16x16x32_bf16 v[24:27], v[240:243], v[4:7], v[24:27]
  ds_read_b128 v[4:7], v2 offset:49152
  s_waitcnt lgkmcnt(3)
  v_mfma_f32_16x16x32_bf16 v[20:23], v[180:183], v[8:11], v[20:23]
  v_mfma_f32_16x16x32_bf16 v[24:27], v[244:247], v[8:11], v[24:27]
  ds_read_b128 v[8:11], v2 offset:50176
  s_waitcnt lgkmcnt(3)
  v_mfma_f32_16x16x32_bf16 v[20:23], v[184:187], v[12:15], v[20:23]
  v_mfma_f32_16x16x32_bf16 v[24:27], v[248:251], v[12:15], v[24:27]
  ds_read_b128 v[12:15], v2 offset:51200
  s_waitcnt lgkmcnt(3)
  v_mfma_f32_16x16x32_bf16 v[20:23], v[188:191], v[16:19], v[20:23]
  v_mfma_f32_16x16x32_bf16 v[24:27], v[252:255], v[16:19], v[24:27]
  ds_read_b128 v[16:19], v2 offset:52224
  s_waitcnt lgkmcnt(3)
  v_mfma_f32_16x16x32_bf16 v[28:31], v[128:131], v[4:7], 0
  v_mfma_f32_16x16x32_bf16 v[32:35], v[192:195], v[4:7], 0
  ds_read_b128 v[4:7], v2 offset:53248
  s_waitcnt lgkmcnt(3)
  v_mfma_f32_16x16x32_bf16 v[28:31], v[132:135], v[8:11], v[28:31]
  v_mfma_f32_16x16x32_bf16 v[32:35], v[196:199], v[8:11], v[32:35]
  ds_read_b128 v[8:11], v2 offset:54272
  s_waitcnt lgkmcnt(3)
  v_mfma_f32_16x16x32_bf16 v[28:31], v[136:139], v[12:15], v[28:31]
  v_mfma_f32_16x16x32_bf16 v[32:35], v[200:203], v[12:15], v[32:35]
  ds_read_b128 v[12:15], v2 offset:55296
  s_waitcnt lgkmcnt(3)
  v_mfma_f32_16x16x32_bf16 v[28:31], v[140:143], v[16:19], v[28:31]
  v_mfma_f32_16x16x32_bf16 v[32:35], v[204:207], v[16:19], v[32:35]
  ds_read_b128 v[16:19], v2 offset:56320
  s_waitcnt lgkmcnt(3)
  v_mfma_f32_16x16x32_bf16 v[28:31], v[144:147], v[4:7], v[28:31]
  v_mfma_f32_16x16x32_bf16 v[32:35], v[208:211], v[4:7], v[32:35]
  ds_read_b128 v[4:7], v2 offset:57344
  s_waitcnt lgkmcnt(3)
  v_mfma_f32_16x16x32_bf16 v[28:31], v[148:151], v[8:11], v[28:31]
  v_mfma_f32_16x16x32_bf16 v[32:35], v[212:215], v[8:11], v[32:35]
  ds_read_b128 v[8:11], v2 offset:58368
  s_waitcnt lgkmcnt(3)
  v_mfma_f32_16x16x32_bf16 v[28:31], v[152:155], v[12:15], v[28:31]
  v_mfma_f32_16x16x32_bf16 v[32:35], v[216:219], v[12:15], v[32:35]
  ds_read_b128 v[12:15], v2 offset:59392
  s_waitcnt lgkmcnt(3)
  v_mfma_f32_16x16x32_bf16 v[28:31], v[156:159], v[16:19], v[28:31]
  v_mfma_f32_16x16x32_bf16 v[32:35], v[220:223], v[16:19], v[32:35]
  ds_read_b128 v[16:19], v2 offset:60416
  s_waitcnt lgkmcnt(3)
  v_mfma_f32_16x16x32_bf16 v[28:31], v[160:163], v[4:7], v[28:31]
  v_mfma_f32_16x16x32_bf16 v[32:35], v[224:227], v[4:7], v[32:35]
  ds_read_b128 v[4:7], v2 offset:61440
  s_waitcnt lgkmcnt(3)
  v_mfma_f32_16x16x32_bf16 v[28:31], v[164:167], v[8:11], v[28:31]
  v_mfma_f32_16x16x32_bf16 v[32:35], v[228:231], v[8:11], v[32:35]
  ds_read_b128 v[8:11], v2 offset:62464
  s_waitcnt lgkmcnt(3)
  v_mfma_f32_16x16x32_bf16 v[28:31], v[168:171], v[12:15], v[28:31]
  v_mfma_f32_16x16x32_bf16 v[32:35], v[232:235], v[12:15], v[32:35]
  ds_read_b128 v[12:15], v2 offset:63488
  s_waitcnt lgkmcnt(3)
  v_mfma_f32_16x16x32_bf16 v[28:31], v[172:175], v[16:19], v[28:31]
  v_mfma_f32_16x16x32_bf16 v[32:35], v[236:239], v[16:19], v[32:35]
  ds_read_b128 v[16:19], v2 offset:64512
  s_waitcnt lgkmcnt(3)
  v_mfma_f32_16x16x32_bf16 v[28:31], v[176:179], v[4:7], v[28:31]
  v_mfma_f32_16x16x32_bf16 v[32:35], v[240:243], v[4:7], v[32:35]
  s_waitcnt lgkmcnt(2)
  v_mfma_f32_16x16x32_bf16 v[28:31], v[180:183], v[8:11], v[28:31]
  v_mfma_f32_16x16x32_bf16 v[32:35], v[244:247], v[8:11], v[32:35]
  s_waitcnt lgkmcnt(1)
  v_mfma_f32_16x16x32_bf16 v[28:31], v[184:187], v[12:15], v[28:31]
  v_mfma_f32_16x16x32_bf16 v[32:35], v[248:251], v[12:15], v[32:35]
  s_waitcnt lgkmcnt(0)
  v_mfma_f32_16x16x32_bf16 v[28:31], v[188:191], v[16:19], v[28:31]
  v_mfma_f32_16x16x32_bf16 v[32:35], v[252:255], v[16:19], v[32:35]
  s_lshl_b32 s36, s32, 10
  v_add_u32 v124, s36, v2
  v_add_u32 v124, 65536, v124
  v_cvt_pk_bf16_f32 v4, v20, v21
  v_cvt_pk_bf16_f32 v5, v22, v23
  v_cvt_pk_bf16_f32 v6, v24, v25
  v_cvt_pk_bf16_f32 v7, v26, v27
  ds_write_b128 v124, v[4:7] offset:0
  v_cvt_pk_bf16_f32 v8, v28, v29
  v_cvt_pk_bf16_f32 v9, v30, v31
  v_cvt_pk_bf16_f32 v10, v32, v33
  v_cvt_pk_bf16_f32 v11, v34, v35
  ds_write_b128 v124, v[8:11] offset:4096
  s_lshl_b32 s36, s101, 12
  v_add_u32 v124, s36, v2
  v_add_u32 v124, 65536, v124
  s_waitcnt lgkmcnt(0)
  s_barrier
  ds_read_b128 v[104:107], v124 offset:0
  ds_read_b128 v[108:111], v124 offset:1024
  ds_read_b128 v[112:115], v124 offset:2048
  ds_read_b128 v[116:119], v124 offset:3072
  s_mul_i32 s36, s33, 0x2100
  s_lshl_b32 s37, s46, 7
  s_add_u32 s36, s36, s37
  s_add_u32 s36, s36, 88080640
  s_cmp_lg_u32 s32, 0
  s_cbranch_scc1 WG20
  v_mov_b32 v126, 0
  s_mov_b32 s3, 0x100000
  s_branch WF21
WS21:
  s_sleep 3
WF21:
  buffer_load_dword v127, v126, s[4:7], s36 offen sc1
  s_sub_u32 s3, s3, 1
  s_cbranch_scc1 K1_END
  s_waitcnt vmcnt(0)
  v_cmp_eq_u32 vcc, 0, v127
  s_nop 3
  s_cbranch_vccnz WS21
WG20:
  s_barrier
  s_lshl_b32 s36, s46, 5
  s_add_u32 s36, s36, s33
  s_lshl_b32 s37, s36, 13
  s_add_u32 s37, s37, 67108864
  buffer_load_dwordx4 v[68:71], v2, s[4:7], s37 offen offset:0
  buffer_load_dwordx4 v[72:75], v2, s[4:7], s37 offen offset:1024
  buffer_load_dwordx4 v[76:79], v2, s[4:7], s37 offen offset:2048
  buffer_load_dwordx4 v[80:83], v2, s[4:7], s37 offen offset:3072
  s_lshl_b32 s38, s100, 10
  s_add_u32 s37, s37, s38
  s_add_u32 s37, s37, 4096
  v_lshlrev_b32 v3, 3, v0
  buffer_load_dwordx2 v[100:101], v3, s[4:7], s37 offen offset:0
  buffer_load_dwordx2 v[102:103], v3, s[4:7], s37 offen offset:512
  s_waitcnt vmcnt(0) lgkmcnt(0)
  v_mfma_f32_16x16x32_bf16 v[20:23], v[68:71], v[104:107], 0
  v_mfma_f32_16x16x32_bf16 v[24:27], v[36:39], v[104:107], 0
  v_mfma_f32_16x16x32_bf16 v[28:31], v[52:55], v[104:107], 0
  v_mfma_f32_16x16x32_bf16 v[20:23], v[72:75], v[108:111], v[20:23]
  v_mfma_f32_16x16x32_bf16 v[24:27], v[40:43], v[108:111], v[24:27]
  v_mfma_f32_16x16x32_bf16 v[28:31], v[56:59], v[108:111], v[28:31]
  v_mfma_f32_16x16x32_bf16 v[20:23], v[76:79], v[112:115], v[20:23]
  v_mfma_f32_16x16x32_bf16 v[24:27], v[44:47], v[112:115], v[24:27]
  v_mfma_f32_16x16x32_bf16 v[28:31], v[60:63], v[112:115], v[28:31]
  v_mfma_f32_16x16x32_bf16 v[20:23], v[80:83], v[116:119], v[20:23]
  v_mfma_f32_16x16x32_bf16 v[24:27], v[48:51], v[116:119], v[24:27]
  v_mfma_f32_16x16x32_bf16 v[28:31], v[64:67], v[116:119], v[28:31]
  s_nop 5
  v_cvt_pk_bf16_f32 v124, v20, v21
  v_lshlrev_b32 v20, 16, v124
  v_and_b32 v21, 0xffff0000, v124
  v_cvt_pk_bf16_f32 v124, v22, v23
  v_lshlrev_b32 v22, 16, v124
  v_and_b32 v23, 0xffff0000, v124
  v_cvt_pk_bf16_f32 v124, v24, v25
  v_lshlrev_b32 v24, 16, v124
  v_and_b32 v25, 0xffff0000, v124
  v_cvt_pk_bf16_f32 v124, v26, v27
  v_lshlrev_b32 v26, 16, v124
  v_and_b32 v27, 0xffff0000, v124
  v_cvt_pk_bf16_f32 v124, v28, v29
  v_lshlrev_b32 v28, 16, v124
  v_and_b32 v29, 0xffff0000, v124
  v_cvt_pk_bf16_f32 v124, v30, v31
  v_lshlrev_b32 v30, 16, v124
  v_and_b32 v31, 0xffff0000, v124
  v_mul_f32 v20, s98, v20
  v_mul_f32 v21, s98, v21
  v_mul_f32 v22, s98, v22
  v_mul_f32 v23, s98, v23
  v_mul_f32 v24, s98, v24
  v_mul_f32 v25, s98, v25
  v_mul_f32 v26, s98, v26
  v_mul_f32 v27, s98, v27
  v_mul_f32 v28, s98, v28
  v_mul_f32 v29, s98, v29
  v_mul_f32 v30, s98, v30
  v_mul_f32 v31, s98, v31
  v_cvt_pk_bf16_f32 v124, v20, v21
  v_lshlrev_b32 v20, 16, v124
  v_and_b32 v21, 0xffff0000, v124
  v_cvt_pk_bf16_f32 v124, v22, v23
  v_lshlrev_b32 v22, 16, v124
  v_and_b32 v23, 0xffff0000, v124
  v_cvt_pk_bf16_f32 v124, v24, v25
  v_lshlrev_b32 v24, 16, v124
  v_and_b32 v25, 0xffff0000, v124
  v_cvt_pk_bf16_f32 v124, v26, v27
  v_lshlrev_b32 v26, 16, v124
  v_and_b32 v27, 0xffff0000, v124
  v_cvt_pk_bf16_f32 v124, v28, v29
  v_lshlrev_b32 v28, 16, v124
  v_and_b32 v29, 0xffff0000, v124
  v_cvt_pk_bf16_f32 v124, v30, v31
  v_lshlrev_b32 v30, 16, v124
  v_and_b32 v31, 0xffff0000, v124
  v_mov_b32 v125, s99
  v_cndmask_b32 v24, v125, v24, s[50:51]
  v_cndmask_b32 v28, v125, v28, s[58:59]
  v_cndmask_b32 v25, v125, v25, s[52:53]
  v_cndmask_b32 v29, v125, v29, s[60:61]
  v_cndmask_b32 v26, v125, v26, s[54:55]
  v_cndmask_b32 v30, v125, v30, s[62:63]
  v_cndmask_b32 v27, v125, v27, s[56:57]
  v_cndmask_b32 v31, v125, v31, s[92:93]
  v_max3_f32 v124, v20, v21, v22
  v_max3_f32 v124, v124, v23, v24
  v_max3_f32 v124, v124, v25, v26
  v_max3_f32 v124, v124, v27, v28
  v_max3_f32 v124, v124, v29, v30
  v_max_f32 v124, v124, v31
  v_mov_b32 v125, v124
  s_nop 1
  v_permlane16_swap_b32 v124, v125
  v_max_f32 v124, v124, v125
  v_mov_b32 v125, v124
  s_nop 1
  v_permlane32_swap_b32 v124, v125
  v_max_f32 v124, v124, v125
  v_sub_f32 v20, v20, v124
  v_mul_f32 v20, 0x3fb8aa3b, v20
  v_exp_f32 v20, v20
  v_sub_f32 v21, v21, v124
  v_mul_f32 v21, 0x3fb8aa3b, v21
  v_exp_f32 v21, v21
  v_sub_f32 v22, v22, v124
  v_mul_f32 v22, 0x3fb8aa3b, v22
  v_exp_f32 v22, v22
  v_sub_f32 v23, v23, v124
  v_mul_f32 v23, 0x3fb8aa3b, v23
  v_exp_f32 v23, v23
  v_sub_f32 v24, v24, v124
  v_mul_f32 v24, 0x3fb8aa3b, v24
  v_exp_f32 v24, v24
  v_sub_f32 v25, v25, v124
  v_mul_f32 v25, 0x3fb8aa3b, v25
  v_exp_f32 v25, v25
  v_sub_f32 v26, v26, v124
  v_mul_f32 v26, 0x3fb8aa3b, v26
  v_exp_f32 v26, v26
  v_sub_f32 v27, v27, v124
  v_mul_f32 v27, 0x3fb8aa3b, v27
  v_exp_f32 v27, v27
  v_sub_f32 v28, v28, v124
  v_mul_f32 v28, 0x3fb8aa3b, v28
  v_exp_f32 v28, v28
  v_sub_f32 v29, v29, v124
  v_mul_f32 v29, 0x3fb8aa3b, v29
  v_exp_f32 v29, v29
  v_sub_f32 v30, v30, v124
  v_mul_f32 v30, 0x3fb8aa3b, v30
  v_exp_f32 v30, v30
  v_sub_f32 v31, v31, v124
  v_mul_f32 v31, 0x3fb8aa3b, v31
  v_exp_f32 v31, v31
  v_add_f32 v124, v20, v21
  v_add_f32 v125, v22, v23
  v_add_f32 v124, v124, v125
  v_cndmask_b32 v124, 0, v124, s[94:95]
  v_add_f32 v124, v124, v24
  v_add_f32 v124, v124, v25
  v_add_f32 v124, v124, v26
  v_add_f32 v124, v124, v27
  v_add_f32 v124, v124, v28
  v_add_f32 v124, v124, v29
  v_add_f32 v124, v124, v30
  v_add_f32 v124, v124, v31
  v_mov_b32 v125, v124
  s_nop 1
  v_permlane16_swap_b32 v124, v125
  v_add_f32 v124, v124, v125
  v_mov_b32 v125, v124
  s_nop 1
  v_permlane32_swap_b32 v124, v125
  v_add_f32 v124, v124, v125
  v_rcp_f32 v124, v124
  s_nop 0
  v_mul_f32 v20, v20, v124
  v_mul_f32 v21, v21, v124
  v_mul_f32 v22, v22, v124
  v_mul_f32 v23, v23, v124
  v_mul_f32 v24, v24, v124
  v_mul_f32 v25, v25, v124
  v_mul_f32 v26, v26, v124
  v_mul_f32 v27, v27, v124
  v_mul_f32 v28, v28, v124
  v_mul_f32 v29, v29, v124
  v_mul_f32 v30, v30, v124
  v_mul_f32 v31, v31, v124
  v_cvt_pk_bf16_f32 v4, v24, v25
  v_cvt_pk_bf16_f32 v5, v26, v27
  v_cvt_pk_bf16_f32 v6, v28, v29
  v_cvt_pk_bf16_f32 v7, v30, v31
  v_cvt_pk_bf16_f32 v124, v20, v21
  v_cvt_pk_bf16_f32 v125, v22, v23
  v_cndmask_b32 v8, 0, v124, s[94:95]
  v_cndmask_b32 v10, 0, v124, s[96:97]
  v_cndmask_b32 v9, 0, v125, s[94:95]
  v_cndmask_b32 v11, 0, v125, s[96:97]
  v_mfma_f32_16x16x32_bf16 v[36:39], v[84:87], v[4:7], 0
  v_mfma_f32_16x16x32_bf16 v[40:43], v[88:91], v[4:7], 0
  v_mfma_f32_16x16x32_bf16 v[44:47], v[92:95], v[4:7], 0
  v_mfma_f32_16x16x32_bf16 v[48:51], v[96:99], v[4:7], 0
  v_mfma_f32_16x16x16_bf16 v[36:39], v[100:101], v[8:9], v[36:39]
  v_mfma_f32_16x16x16_bf16 v[40:43], v[100:101], v[10:11], v[40:43]
  v_mfma_f32_16x16x16_bf16 v[44:47], v[102:103], v[8:9], v[44:47]
  v_mfma_f32_16x16x16_bf16 v[48:51], v[102:103], v[10:11], v[48:51]
  s_lshl_b32 s36, s46, 1
  s_add_u32 s36, s36, s101
  s_lshl_b32 s36, s36, 5
  s_add_u32 s36, s36, s33
  s_lshl_b32 s36, s36, 12
  s_lshl_b32 s37, s100, 11
  s_add_u32 s36, s36, s37
  s_add_u32 s36, s36, 33554432
  v_cvt_pk_bf16_f32 v12, v36, v37
  v_cvt_pk_bf16_f32 v13, v38, v39
  v_cvt_pk_bf16_f32 v14, v40, v41
  v_cvt_pk_bf16_f32 v15, v42, v43
  buffer_store_dwordx4 v[12:15], v2, s[4:7], s36 offen offset:0 sc1
  v_cvt_pk_bf16_f32 v16, v44, v45
  v_cvt_pk_bf16_f32 v17, v46, v47
  v_cvt_pk_bf16_f32 v18, v48, v49
  v_cvt_pk_bf16_f32 v19, v50, v51
  buffer_store_dwordx4 v[16:19], v2, s[4:7], s36 offen offset:1024 sc1
  s_lshl_b32 s36, s46, 5
  s_add_u32 s36, s36, s33
  s_lshl_b32 s36, s36, 2
  s_add_u32 s36, s36, 87052544
  s_waitcnt vmcnt(0)
  s_barrier
  s_cmp_lg_u32 s32, 0
  s_cbranch_scc1 SF22
  v_mov_b32 v124, 0
  v_mov_b32 v125, 1
  s_mov_b64 exec, 1
  buffer_store_dword v125, v124, s[4:7], s36 offen sc1
  s_mov_b64 exec, -1
SF22:
  s_mov_b32 s46, s47
  s_cmp_ge_u32 s46, 64
  s_cbranch_scc1 K1_R1b_LAST
  s_branch K1_R1b_L0
K1_R1b_LAST:
  s_waitcnt vmcnt(0)
  s_barrier
K1_R1b_DONE:
  s_branch K1_END
K1_N1:
  s_cmp_lt_u32 s34, 5
  s_cbranch_scc1 K1_N2
  s_cmp_gt_u32 s34, 7
  s_cbranch_scc1 K1_N2
  s_sub_u32 s36, s34, 5
  s_lshl_b32 s36, s36, 5
  s_add_u32 s45, s36, s35
  s_mov_b32 s12, s68
  s_and_b32 s13, s69, 0xffff
  s_mov_b32 s14, 0x400000
  s_mov_b32 s15, 0x20000
  s_mov_b32 s16, s74
  s_and_b32 s17, s75, 0xffff
  s_mov_b32 s18, 0x400000
  s_mov_b32 s19, 0x20000
  v_lshlrev_b32 v2, 4, v0
  s_lshl_b32 s50, s45, 2
  s_add_u32 s50, s50, s32
  s_lshl_b32 s50, s50, 14
  buffer_load_dwordx4 v[4:7], v2, s[12:15], s50 offen offset:0
  buffer_load_dwordx4 v[8:11], v2, s[16:19], s50 offen offset:0
  buffer_load_dwordx4 v[4:7], v2, s[12:15], s50 offen offset:1024
  buffer_load_dwordx4 v[8:11], v2, s[16:19], s50 offen offset:1024
  buffer_load_dwordx4 v[4:7], v2, s[12:15], s50 offen offset:2048
  buffer_load_dwordx4 v[8:11], v2, s[16:19], s50 offen offset:2048
  buffer_load_dwordx4 v[4:7], v2, s[12:15], s50 offen offset:3072
  buffer_load_dwordx4 v[8:11], v2, s[16:19], s50 offen offset:3072
  s_add_u32 s50, s50, 4096
  buffer_load_dwordx4 v[4:7], v2, s[12:15], s50 offen offset:0
  buffer_load_dwordx4 v[8:11], v2, s[16:19], s50 offen offset:0
  buffer_load_dwordx4 v[4:7], v2, s[12:15], s50 offen offset:1024
  buffer_load_dwordx4 v[8:11], v2, s[16:19], s50 offen offset:1024
  buffer_load_dwordx4 v[4:7], v2, s[12:15], s50 offen offset:2048
  buffer_load_dwordx4 v[8:11], v2, s[16:19], s50 offen offset:2048
  buffer_load_dwordx4 v[4:7], v2, s[12:15], s50 offen offset:3072
  buffer_load_dwordx4 v[8:11], v2, s[16:19], s50 offen offset:3072
  s_add_u32 s50, s50, 4096
  buffer_load_dwordx4 v[4:7], v2, s[12:15], s50 offen offset:0
  buffer_load_dwordx4 v[8:11], v2, s[16:19], s50 offen offset:0
  buffer_load_dwordx4 v[4:7], v2, s[12:15], s50 offen offset:1024
  buffer_load_dwordx4 v[8:11], v2, s[16:19], s50 offen offset:1024
  buffer_load_dwordx4 v[4:7], v2, s[12:15], s50 offen offset:2048
  buffer_load_dwordx4 v[8:11], v2, s[16:19], s50 offen offset:2048
  buffer_load_dwordx4 v[4:7], v2, s[12:15], s50 offen offset:3072
  buffer_load_dwordx4 v[8:11], v2, s[16:19], s50 offen offset:3072
  s_add_u32 s50, s50, 4096
  buffer_load_dwordx4 v[4:7], v2, s[12:15], s50 offen offset:0
  buffer_load_dwordx4 v[8:11], v2, s[16:19], s50 offen offset:0
  buffer_load_dwordx4 v[4:7], v2, s[12:15], s50 offen offset:1024
  buffer_load_dwordx4 v[8:11], v2, s[16:19], s50 offen offset:1024
  buffer_load_dwordx4 v[4:7], v2, s[12:15], s50 offen offset:2048
  buffer_load_dwordx4 v[8:11], v2, s[16:19], s50 offen offset:2048
  buffer_load_dwordx4 v[4:7], v2, s[12:15], s50 offen offset:3072
  buffer_load_dwordx4 v[8:11], v2, s[16:19], s50 offen offset:3072
  s_add_u32 s50, s50, 4096
  s_mov_b32 s8, s80
  s_and_b32 s9, s81, 0xffff
  s_mov_b32 s10, 0x1c0000
  s_mov_b32 s11, 0x20000
  s_mov_b32 s24, s64
  s_and_b32 s25, s65, 0xffff
  s_mov_b32 s26, 0x200000
  s_mov_b32 s27, 0x20000
  s_cmp_ge_u32 s45, 91
  s_cbranch_scc1 K1_R2a_GATE
  s_mul_i32 s36, s45, 147
  s_lshr_b32 s50, s36, 10
  s_mul_i32 s36, s50, 7
  s_sub_u32 s51, s45, s36
  s_lshl_b32 s49, s51, 9
  s_add_u32 s52, s49, 256
  v_lshrrev_b32 v109, 4, v0
  v_bfe_u32 v107, v0, 1, 3
  v_xor_b32 v108, v107, v109
  v_lshlrev_b32 v108, 5, v108
  v_and_b32 v100, 1, v0
  v_lshl_add_u32 v108, v100, 4, v108
  s_mov_b32 s36, 3584
  v_mad_u32_u24 v100, v109, s36, v108
  v_xor_b32 v101, 0x80, v100
  v_bfe_u32 v110, v0, 2, 2
  v_and_b32 v111, 3, v0
  s_lshl_b32 s36, s32, 1
  v_and_b32 v112, 1, v109
  v_lshl_or_b32 v112, v112, 2, v110
  v_xor_b32 v107, s36, v112
  v_lshlrev_b32 v107, 5, v107
  v_lshl_add_u32 v107, v111, 3, v107
  v_lshl_add_u32 v108, v109, 3, v110
  v_lshl_add_u32 v103, v108, 8, v107
  v_xor_b32 v105, 32, v103
  v_add_u32 v104, 0x10000, v103
  v_add_u32 v106, 0x10000, v105
  s_mul_i32 s36, s32, 57344
  s_add_u32 s40, s49, s36
  s_add_u32 s41, s52, s36
  s_lshl_b32 s44, s32, 12
  s_add_u32 s36, s44, 0
  s_mov_b32 m0, s36
  s_add_u32 s37, s40, 0
  buffer_load_dwordx4 v100, s[8:11], s37 offen lds
  s_add_u32 s36, s44, 1024
  s_mov_b32 m0, s36
  s_add_u32 s37, s40, 14336
  buffer_load_dwordx4 v100, s[8:11], s37 offen lds
  s_add_u32 s36, s44, 2048
  s_mov_b32 m0, s36
  s_add_u32 s37, s40, 28672
  buffer_load_dwordx4 v101, s[8:11], s37 offen lds
  s_add_u32 s36, s44, 3072
  s_mov_b32 m0, s36
  s_add_u32 s37, s40, 43008
  buffer_load_dwordx4 v101, s[8:11], s37 offen lds
  s_add_u32 s36, s44, 16384
  s_mov_b32 m0, s36
  s_add_u32 s37, s40, 229376
  buffer_load_dwordx4 v100, s[8:11], s37 offen lds
  s_add_u32 s36, s44, 17408
  s_mov_b32 m0, s36
  s_add_u32 s37, s40, 243712
  buffer_load_dwordx4 v100, s[8:11], s37 offen lds
  s_add_u32 s36, s44, 18432
  s_mov_b32 m0, s36
  s_add_u32 s37, s40, 258048
  buffer_load_dwordx4 v101, s[8:11], s37 offen lds
  s_add_u32 s36, s44, 19456
  s_mov_b32 m0, s36
  s_add_u32 s37, s40, 272384
  buffer_load_dwordx4 v101, s[8:11], s37 offen lds
  s_add_u32 s36, s44, 32768
  s_mov_b32 m0, s36
  s_add_u32 s37, s40, 458752
  buffer_load_dwordx4 v100, s[8:11], s37 offen lds
  s_add_u32 s36, s44, 33792
  s_mov_b32 m0, s36
  s_add_u32 s37, s40, 473088
  buffer_load_dwordx4 v100, s[8:11], s37 offen lds
  s_add_u32 s36, s44, 34816
  s_mov_b32 m0, s36
  s_add_u32 s37, s40, 487424
  buffer_load_dwordx4 v101, s[8:11], s37 offen lds
  s_add_u32 s36, s44, 35840
  s_mov_b32 m0, s36
  s_add_u32 s37, s40, 501760
  buffer_load_dwordx4 v101, s[8:11], s37 offen lds
  s_add_u32 s36, s44, 49152
  s_mov_b32 m0, s36
  s_add_u32 s37, s40, 688128
  buffer_load_dwordx4 v100, s[8:11], s37 offen lds
  s_add_u32 s36, s44, 50176
  s_mov_b32 m0, s36
  s_add_u32 s37, s40, 702464
  buffer_load_dwordx4 v100, s[8:11], s37 offen lds
  s_add_u32 s36, s44, 51200
  s_mov_b32 m0, s36
  s_add_u32 s37, s40, 716800
  buffer_load_dwordx4 v101, s[8:11], s37 offen lds
  s_add_u32 s36, s44, 52224
  s_mov_b32 m0, s36
  s_add_u32 s37, s40, 731136
  buffer_load_dwordx4 v101, s[8:11], s37 offen lds
  s_add_u32 s36, s44, 65536
  s_mov_b32 m0, s36
  s_add_u32 s37, s40, 917504
  buffer_load_dwordx4 v100, s[8:11], s37 offen lds
  s_add_u32 s36, s44, 66560
  s_mov_b32 m0, s36
  s_add_u32 s37, s40, 931840
  buffer_load_dwordx4 v100, s[8:11], s37 offen lds
  s_add_u32 s36, s44, 67584
  s_mov_b32 m0, s36
  s_add_u32 s37, s40, 946176
  buffer_load_dwordx4 v101, s[8:11], s37 offen lds
  s_add_u32 s36, s44, 68608
  s_mov_b32 m0, s36
  s_add_u32 s37, s40, 960512
  buffer_load_dwordx4 v101, s[8:11], s37 offen lds
  s_add_u32 s36, s44, 81920
  s_mov_b32 m0, s36
  s_add_u32 s37, s40, 1146880
  buffer_load_dwordx4 v100, s[8:11], s37 offen lds
  s_add_u32 s36, s44, 82944
  s_mov_b32 m0, s36
  s_add_u32 s37, s40, 1161216
  buffer_load_dwordx4 v100, s[8:11], s37 offen lds
  s_add_u32 s36, s44, 83968
  s_mov_b32 m0, s36
  s_add_u32 s37, s40, 1175552
  buffer_load_dwordx4 v101, s[8:11], s37 offen lds
  s_add_u32 s36, s44, 84992
  s_mov_b32 m0, s36
  s_add_u32 s37, s40, 1189888
  buffer_load_dwordx4 v101, s[8:11], s37 offen lds
  s_add_u32 s36, s44, 98304
  s_mov_b32 m0, s36
  s_add_u32 s37, s40, 1376256
  buffer_load_dwordx4 v100, s[8:11], s37 offen lds
  s_add_u32 s36, s44, 99328
  s_mov_b32 m0, s36
  s_add_u32 s37, s40, 1390592
  buffer_load_dwordx4 v100, s[8:11], s37 offen lds
  s_add_u32 s36, s44, 100352
  s_mov_b32 m0, s36
  s_add_u32 s37, s40, 1404928
  buffer_load_dwordx4 v101, s[8:11], s37 offen lds
  s_add_u32 s36, s44, 101376
  s_mov_b32 m0, s36
  s_add_u32 s37, s40, 1419264
  buffer_load_dwordx4 v101, s[8:11], s37 offen lds
  s_waitcnt vmcnt(24)
  s_barrier
  s_add_u32 s36, s44, 114688
  s_mov_b32 m0, s36
  s_add_u32 s37, s40, 1605632
  buffer_load_dwordx4 v100, s[8:11], s37 offen lds
  s_add_u32 s36, s44, 115712
  s_mov_b32 m0, s36
  s_add_u32 s37, s40, 1619968
  buffer_load_dwordx4 v100, s[8:11], s37 offen lds
  s_add_u32 s36, s44, 116736
  s_mov_b32 m0, s36
  s_add_u32 s37, s40, 1634304
  buffer_load_dwordx4 v101, s[8:11], s37 offen lds
  s_add_u32 s36, s44, 117760
  s_mov_b32 m0, s36
  s_add_u32 s37, s40, 1648640
  buffer_load_dwordx4 v101, s[8:11], s37 offen lds
  ds_read_b64_tr_b16 a[0:1], v103 offset:0
  ds_read_b64_tr_b16 a[2:3], v103 offset:1024
  ds_read_b64_tr_b16 a[4:5], v103 offset:8192
  ds_read_b64_tr_b16 a[6:7], v103 offset:9216
  ds_read_b64_tr_b16 a[64:65], v105 offset:0
  ds_read_b64_tr_b16 a[66:67], v105 offset:1024
  ds_read_b64_tr_b16 a[68:69], v105 offset:8192
  ds_read_b64_tr_b16 a[70:71], v105 offset:9216
  s_waitcnt lgkmcnt(0)
  s_waitcnt vmcnt(24)
  s_barrier
  s_add_u32 s36, s44, 0
  s_mov_b32 m0, s36
  s_add_u32 s37, s41, 0
  buffer_load_dwordx4 v100, s[8:11], s37 offen lds
  s_add_u32 s36, s44, 1024
  s_mov_b32 m0, s36
  s_add_u32 s37, s41, 14336
  buffer_load_dwordx4 v100, s[8:11], s37 offen lds
  s_add_u32 s36, s44, 2048
  s_mov_b32 m0, s36
  s_add_u32 s37, s41, 28672
  buffer_load_dwordx4 v101, s[8:11], s37 offen lds
  s_add_u32 s36, s44, 3072
  s_mov_b32 m0, s36
  s_add_u32 s37, s41, 43008
  buffer_load_dwordx4 v101, s[8:11], s37 offen lds
  ds_read_b64_tr_b16 a[8:9], v103 offset:16384
  ds_read_b64_tr_b16 a[10:11], v103 offset:17408
  ds_read_b64_tr_b16 a[12:13], v103 offset:24576
  ds_read_b64_tr_b16 a[14:15], v103 offset:25600
  ds_read_b64_tr_b16 a[72:73], v105 offset:16384
  ds_read_b64_tr_b16 a[74:75], v105 offset:17408
  ds_read_b64_tr_b16 a[76:77], v105 offset:24576
  ds_read_b64_tr_b16 a[78:79], v105 offset:25600
  s_waitcnt lgkmcnt(0)
  s_waitcnt vmcnt(24)
  s_barrier
  s_add_u32 s36, s44, 16384
  s_mov_b32 m0, s36
  s_add_u32 s37, s41, 229376
  buffer_load_dwordx4 v100, s[8:11], s37 offen lds
  s_add_u32 s36, s44, 17408
  s_mov_b32 m0, s36
  s_add_u32 s37, s41, 243712
  buffer_load_dwordx4 v100, s[8:11], s37 offen lds
  s_add_u32 s36, s44, 18432
  s_mov_b32 m0, s36
  s_add_u32 s37, s41, 258048
  buffer_load_dwordx4 v101, s[8:11], s37 offen lds
  s_add_u32 s36, s44, 19456
  s_mov_b32 m0, s36
  s_add_u32 s37, s41, 272384
  buffer_load_dwordx4 v101, s[8:11], s37 offen lds
  ds_read_b64_tr_b16 a[16:17], v103 offset:32768
  ds_read_b64_tr_b16 a[18:19], v103 offset:33792
  ds_read_b64_tr_b16 a[20:21], v103 offset:40960
  ds_read_b64_tr_b16 a[22:23], v103 offset:41984
  ds_read_b64_tr_b16 a[80:81], v105 offset:32768
  ds_read_b64_tr_b16 a[82:83], v105 offset:33792
  ds_read_b64_tr_b16 a[84:85], v105 offset:40960
  ds_read_b64_tr_b16 a[86:87], v105 offset:41984
  s_waitcnt lgkmcnt(0)
  s_waitcnt vmcnt(24)
  s_barrier
  s_add_u32 s36, s44, 32768
  s_mov_b32 m0, s36
  s_add_u32 s37, s41, 458752
  buffer_load_dwordx4 v100, s[8:11], s37 offen lds
  s_add_u32 s36, s44, 33792
  s_mov_b32 m0, s36
  s_add_u32 s37, s41, 473088
  buffer_load_dwordx4 v100, s[8:11], s37 offen lds
  s_add_u32 s36, s44, 34816
  s_mov_b32 m0, s36
  s_add_u32 s37, s41, 487424
  buffer_load_dwordx4 v101, s[8:11], s37 offen lds
  s_add_u32 s36, s44, 35840
  s_mov_b32 m0, s36
  s_add_u32 s37, s41, 501760
  buffer_load_dwordx4 v101, s[8:11], s37 offen lds
  ds_read_b64_tr_b16 a[24:25], v103 offset:49152
  ds_read_b64_tr_b16 a[26:27], v103 offset:50176
  ds_read_b64_tr_b16 a[28:29], v103 offset:57344
  ds_read_b64_tr_b16 a[30:31], v103 offset:58368
  ds_read_b64_tr_b16 a[88:89], v105 offset:49152
  ds_read_b64_tr_b16 a[90:91], v105 offset:50176
  ds_read_b64_tr_b16 a[92:93], v105 offset:57344
  ds_read_b64_tr_b16 a[94:95], v105 offset:58368
  s_waitcnt lgkmcnt(0)
  s_waitcnt vmcnt(24)
  s_barrier
  s_add_u32 s36, s44, 49152
  s_mov_b32 m0, s36
  s_add_u32 s37, s41, 688128
  buffer_load_dwordx4 v100, s[8:11], s37 offen lds
  s_add_u32 s36, s44, 50176
  s_mov_b32 m0, s36
  s_add_u32 s37, s41, 702464
  buffer_load_dwordx4 v100, s[8:11], s37 offen lds
  s_add_u32 s36, s44, 51200
  s_mov_b32 m0, s36
  s_add_u32 s37, s41, 716800
  buffer_load_dwordx4 v101, s[8:11], s37 offen lds
  s_add_u32 s36, s44, 52224
  s_mov_b32 m0, s36
  s_add_u32 s37, s41, 731136
  buffer_load_dwordx4 v101, s[8:11], s37 offen lds
  ds_read_b64_tr_b16 a[32:33], v104 offset:0
  ds_read_b64_tr_b16 a[34:35], v104 offset:1024
  ds_read_b64_tr_b16 a[36:37], v104 offset:8192
  ds_read_b64_tr_b16 a[38:39], v104 offset:9216
  ds_read_b64_tr_b16 a[96:97], v106 offset:0
  ds_read_b64_tr_b16 a[98:99], v106 offset:1024
  ds_read_b64_tr_b16 a[100:101], v106 offset:8192
  ds_read_b64_tr_b16 a[102:103], v106 offset:9216
  s_waitcnt lgkmcnt(0)
  s_waitcnt vmcnt(24)
  s_barrier
  s_add_u32 s36, s44, 65536
  s_mov_b32 m0, s36
  s_add_u32 s37, s41, 917504
  buffer_load_dwordx4 v100, s[8:11], s37 offen lds
  s_add_u32 s36, s44, 66560
  s_mov_b32 m0, s36
  s_add_u32 s37, s41, 931840
  buffer_load_dwordx4 v100, s[8:11], s37 offen lds
  s_add_u32 s36, s44, 67584
  s_mov_b32 m0, s36
  s_add_u32 s37, s41, 946176
  buffer_load_dwordx4 v101, s[8:11], s37 offen lds
  s_add_u32 s36, s44, 68608
  s_mov_b32 m0, s36
  s_add_u32 s37, s41, 960512
  buffer_load_dwordx4 v101, s[8:11], s37 offen lds
  ds_read_b64_tr_b16 a[40:41], v104 offset:16384
  ds_read_b64_tr_b16 a[42:43], v104 offset:17408
  ds_read_b64_tr_b16 a[44:45], v104 offset:24576
  ds_read_b64_tr_b16 a[46:47], v104 offset:25600
  ds_read_b64_tr_b16 a[104:105], v106 offset:16384
  ds_read_b64_tr_b16 a[106:107], v106 offset:17408
  ds_read_b64_tr_b16 a[108:109], v106 offset:24576
  ds_read_b64_tr_b16 a[110:111], v106 offset:25600
  s_waitcnt lgkmcnt(0)
  s_waitcnt vmcnt(24)
  s_barrier
  s_add_u32 s36, s44, 81920
  s_mov_b32 m0, s36
  s_add_u32 s37, s41, 1146880
  buffer_load_dwordx4 v100, s[8:11], s37 offen lds
  s_add_u32 s36, s44, 82944
  s_mov_b32 m0, s36
  s_add_u32 s37, s41, 1161216
  buffer_load_dwordx4 v100, s[8:11], s37 offen lds
  s_add_u32 s36, s44, 83968
  s_mov_b32 m0, s36
  s_add_u32 s37, s41, 1175552
  buffer_load_dwordx4 v101, s[8:11], s37 offen lds
  s_add_u32 s36, s44, 84992
  s_mov_b32 m0, s36
  s_add_u32 s37, s41, 1189888
  buffer_load_dwordx4 v101, s[8:11], s37 offen lds
  ds_read_b64_tr_b16 a[48:49], v104 offset:32768
  ds_read_b64_tr_b16 a[50:51], v104 offset:33792
  ds_read_b64_tr_b16 a[52:53], v104 offset:40960
  ds_read_b64_tr_b16 a[54:55], v104 offset:41984
  ds_read_b64_tr_b16 a[112:113], v106 offset:32768
  ds_read_b64_tr_b16 a[114:115], v106 offset:33792
  ds_read_b64_tr_b16 a[116:117], v106 offset:40960
  ds_read_b64_tr_b16 a[118:119], v106 offset:41984
  s_waitcnt lgkmcnt(0)
  s_waitcnt vmcnt(24)
  s_barrier
  s_add_u32 s36, s44, 98304
  s_mov_b32 m0, s36
  s_add_u32 s37, s41, 1376256
  buffer_load_dwordx4 v100, s[8:11], s37 offen lds
  s_add_u32 s36, s44, 99328
  s_mov_b32 m0, s36
  s_add_u32 s37, s41, 1390592
  buffer_load_dwordx4 v100, s[8:11], s37 offen lds
  s_add_u32 s36, s44, 100352
  s_mov_b32 m0, s36
  s_add_u32 s37, s41, 1404928
  buffer_load_dwordx4 v101, s[8:11], s37 offen lds
  s_add_u32 s36, s44, 101376
  s_mov_b32 m0, s36
  s_add_u32 s37, s41, 1419264
  buffer_load_dwordx4 v101, s[8:11], s37 offen lds
  ds_read_b64_tr_b16 a[56:57], v104 offset:49152
  ds_read_b64_tr_b16 a[58:59], v104 offset:50176
  ds_read_b64_tr_b16 a[60:61], v104 offset:57344
  ds_read_b64_tr_b16 a[62:63], v104 offset:58368
  ds_read_b64_tr_b16 a[120:121], v106 offset:49152
  ds_read_b64_tr_b16 a[122:123], v106 offset:50176
  ds_read_b64_tr_b16 a[124:125], v106 offset:57344
  ds_read_b64_tr_b16 a[126:127], v106 offset:58368
  s_waitcnt lgkmcnt(0)
  s_waitcnt vmcnt(24)
  s_barrier
  s_add_u32 s36, s44, 114688
  s_mov_b32 m0, s36
  s_add_u32 s37, s41, 1605632
  buffer_load_dwordx4 v100, s[8:11], s37 offen lds
  s_add_u32 s36, s44, 115712
  s_mov_b32 m0, s36
  s_add_u32 s37, s41, 1619968
  buffer_load_dwordx4 v100, s[8:11], s37 offen lds
  s_add_u32 s36, s44, 116736
  s_mov_b32 m0, s36
  s_add_u32 s37, s41, 1634304
  buffer_load_dwordx4 v101, s[8:11], s37 offen lds
  s_add_u32 s36, s44, 117760
  s_mov_b32 m0, s36
  s_add_u32 s37, s41, 1648640
  buffer_load_dwordx4 v101, s[8:11], s37 offen lds
  ds_read_b64_tr_b16 a[128:129], v103 offset:0
  ds_read_b64_tr_b16 a[130:131], v103 offset:1024
  ds_read_b64_tr_b16 a[132:133], v103 offset:8192
  ds_read_b64_tr_b16 a[134:135], v103 offset:9216
  ds_read_b64_tr_b16 a[192:193], v105 offset:0
  ds_read_b64_tr_b16 a[194:195], v105 offset:1024
  ds_read_b64_tr_b16 a[196:197], v105 offset:8192
  ds_read_b64_tr_b16 a[198:199], v105 offset:9216
  s_waitcnt lgkmcnt(0)
  s_waitcnt vmcnt(24)
  s_barrier
  ds_read_b64_tr_b16 a[136:137], v103 offset:16384
  ds_read_b64_tr_b16 a[138:139], v103 offset:17408
  ds_read_b64_tr_b16 a[140:141], v103 offset:24576
  ds_read_b64_tr_b16 a[142:143], v103 offset:25600
  ds_read_b64_tr_b16 a[200:201], v105 offset:16384
  ds_read_b64_tr_b16 a[202:203], v105 offset:17408
  ds_read_b64_tr_b16 a[204:205], v105 offset:24576
  ds_read_b64_tr_b16 a[206:207], v105 offset:25600
  s_waitcnt lgkmcnt(0)
  s_waitcnt vmcnt(20)
  s_barrier
  ds_read_b64_tr_b16 a[144:145], v103 offset:32768
  ds_read_b64_tr_b16 a[146:147], v103 offset:33792
  ds_read_b64_tr_b16 a[148:149], v103 offset:40960
  ds_read_b64_tr_b16 a[150:151], v103 offset:41984
  ds_read_b64_tr_b16 a[208:209], v105 offset:32768
  ds_read_b64_tr_b16 a[210:211], v105 offset:33792
  ds_read_b64_tr_b16 a[212:213], v105 offset:40960
  ds_read_b64_tr_b16 a[214:215], v105 offset:41984
  s_waitcnt lgkmcnt(0)
  s_waitcnt vmcnt(16)
  s_barrier
  ds_read_b64_tr_b16 a[152:153], v103 offset:49152
  ds_read_b64_tr_b16 a[154:155], v103 offset:50176
  ds_read_b64_tr_b16 a[156:157], v103 offset:57344
  ds_read_b64_tr_b16 a[158:159], v103 offset:58368
  ds_read_b64_tr_b16 a[216:217], v105 offset:49152
  ds_read_b64_tr_b16 a[218:219], v105 offset:50176
  ds_read_b64_tr_b16 a[220:221], v105 offset:57344
  ds_read_b64_tr_b16 a[222:223], v105 offset:58368
  s_waitcnt lgkmcnt(0)
  s_waitcnt vmcnt(12)
  s_barrier
  ds_read_b64_tr_b16 a[160:161], v104 offset:0
  ds_read_b64_tr_b16 a[162:163], v104 offset:1024
  ds_read_b64_tr_b16 a[164:165], v104 offset:8192
  ds_read_b64_tr_b16 a[166:167], v104 offset:9216
  ds_read_b64_tr_b16 a[224:225], v106 offset:0
  ds_read_b64_tr_b16 a[226:227], v106 offset:1024
  ds_read_b64_tr_b16 a[228:229], v106 offset:8192
  ds_read_b64_tr_b16 a[230:231], v106 offset:9216
  s_waitcnt lgkmcnt(0)
  s_waitcnt vmcnt(8)
  s_barrier
  ds_read_b64_tr_b16 a[168:169], v104 offset:16384
  ds_read_b64_tr_b16 a[170:171], v104 offset:17408
  ds_read_b64_tr_b16 a[172:173], v104 offset:24576
  ds_read_b64_tr_b16 a[174:175], v104 offset:25600
  ds_read_b64_tr_b16 a[232:233], v106 offset:16384
  ds_read_b64_tr_b16 a[234:235], v106 offset:17408
  ds_read_b64_tr_b16 a[236:237], v106 offset:24576
  ds_read_b64_tr_b16 a[238:239], v106 offset:25600
  s_waitcnt lgkmcnt(0)
  s_waitcnt vmcnt(4)
  s_barrier
  ds_read_b64_tr_b16 a[176:177], v104 offset:32768
  ds_read_b64_tr_b16 a[178:179], v104 offset:33792
  ds_read_b64_tr_b16 a[180:181], v104 offset:40960
  ds_read_b64_tr_b16 a[182:183], v104 offset:41984
  ds_read_b64_tr_b16 a[240:241], v106 offset:32768
  ds_read_b64_tr_b16 a[242:243], v106 offset:33792
  ds_read_b64_tr_b16 a[244:245], v106 offset:40960
  ds_read_b64_tr_b16 a[246:247], v106 offset:41984
  s_waitcnt lgkmcnt(0)
  s_waitcnt vmcnt(0)
  s_barrier
  ds_read_b64_tr_b16 a[184:185], v104 offset:49152
  ds_read_b64_tr_b16 a[186:187], v104 offset:50176
  ds_read_b64_tr_b16 a[188:189], v104 offset:57344
  ds_read_b64_tr_b16 a[190:191], v104 offset:58368
  ds_read_b64_tr_b16 a[248:249], v106 offset:49152
  ds_read_b64_tr_b16 a[250:251], v106 offset:50176
  ds_read_b64_tr_b16 a[252:253], v106 offset:57344
  ds_read_b64_tr_b16 a[254:255], v106 offset:58368
  s_waitcnt lgkmcnt(0)
  s_barrier
  s_mov_b32 s96, 0xbfb8aa3b
  v_and_b32 v1, 15, v0
  v_lshlrev_b32 v1, 10, v1
  v_lshrrev_b32 v3, 4, v0
  v_lshl_add_u32 v1, v3, 4, v1
  v_lshlrev_b32 v2, 4, v0
  s_mov_b32 s46, s50
  s_cmp_ge_u32 s46, 64
  s_cbranch_scc1 K1_R2a_DONE
  s_lshl_b32 s36, s46, 15
  s_lshl_b32 s37, s32, 8
  s_add_u32 s36, s36, s37
  s_lshl_b32 s37, s32, 12
  s_add_u32 s38, s37, 0
  s_mov_b32 m0, s38
  s_add_u32 s39, s36, 0
  buffer_load_dwordx4 v1, s[24:27], s39 offen lds
  s_add_u32 s38, s37, 1024
  s_mov_b32 m0, s38
  s_add_u32 s39, s36, 64
  buffer_load_dwordx4 v1, s[24:27], s39 offen lds
  s_add_u32 s38, s37, 2048
  s_mov_b32 m0, s38
  s_add_u32 s39, s36, 128
  buffer_load_dwordx4 v1, s[24:27], s39 offen lds
  s_add_u32 s38, s37, 3072
  s_mov_b32 m0, s38
  s_add_u32 s39, s36, 192
  buffer_load_dwordx4 v1, s[24:27], s39 offen lds
  s_add_u32 s38, s37, 16384
  s_mov_b32 m0, s38
  s_add_u32 s39, s36, 16384
  buffer_load_dwordx4 v1, s[24:27], s39 offen lds
  s_add_u32 s38, s37, 17408
  s_mov_b32 m0, s38
  s_add_u32 s39, s36, 16448
  buffer_load_dwordx4 v1, s[24:27], s39 offen lds
  s_add_u32 s38, s37, 18432
  s_mov_b32 m0, s38
  s_add_u32 s39, s36, 16512
  buffer_load_dwordx4 v1, s[24:27], s39 offen lds
  s_add_u32 s38, s37, 19456
  s_mov_b32 m0, s38
  s_add_u32 s39, s36, 16576
  buffer_load_dwordx4 v1, s[24:27], s39 offen lds
  s_mov_b32 s48, 0
  s_waitcnt vmcnt(0)
  s_lshl_b32 s43, s46, 5
  s_add_u32 s43, s43, s51
  s_lshl_b32 s43, s43, 2
  s_add_u32 s43, s43, 87062784
K1_R2a_L0:
  s_waitcnt vmcnt(4)
  s_barrier
  s_add_u32 s47, s46, 13
  s_min_u32 s36, s47, 63
  s_mov_b32 s44, s36
  s_lshl_b32 s36, s44, 15
  s_lshl_b32 s37, s32, 8
  s_add_u32 s36, s36, s37
  s_lshl_b32 s37, s32, 12
  s_add_u32 s38, s37, 32768
  s_mov_b32 m0, s38
  s_add_u32 s39, s36, 0
  buffer_load_dwordx4 v1, s[24:27], s39 offen lds
  s_add_u32 s38, s37, 33792
  s_mov_b32 m0, s38
  s_add_u32 s39, s36, 64
  buffer_load_dwordx4 v1, s[24:27], s39 offen lds
  s_add_u32 s38, s37, 34816
  s_mov_b32 m0, s38
  s_add_u32 s39, s36, 128
  buffer_load_dwordx4 v1, s[24:27], s39 offen lds
  s_add_u32 s38, s37, 35840
  s_mov_b32 m0, s38
  s_add_u32 s39, s36, 192
  buffer_load_dwordx4 v1, s[24:27], s39 offen lds
  s_add_u32 s38, s37, 49152
  s_mov_b32 m0, s38
  s_add_u32 s39, s36, 16384
  buffer_load_dwordx4 v1, s[24:27], s39 offen lds
  s_add_u32 s38, s37, 50176
  s_mov_b32 m0, s38
  s_add_u32 s39, s36, 16448
  buffer_load_dwordx4 v1, s[24:27], s39 offen lds
  s_add_u32 s38, s37, 51200
  s_mov_b32 m0, s38
  s_add_u32 s39, s36, 16512
  buffer_load_dwordx4 v1, s[24:27], s39 offen lds
  s_add_u32 s38, s37, 52224
  s_mov_b32 m0, s38
  s_add_u32 s39, s36, 16576
  buffer_load_dwordx4 v1, s[24:27], s39 offen lds
  ds_read_b128 v[4:7], v2 offset:0
  ds_read_b128 v[8:11], v2 offset:1024
  ds_read_b128 v[12:15], v2 offset:2048
  ds_read_b128 v[16:19], v2 offset:3072
  s_waitcnt lgkmcnt(3)
  v_mfma_f32_16x16x32_bf16 v[32:35], a[0:3], v[4:7], 0
  v_mfma_f32_16x16x32_bf16 v[36:39], a[64:67], v[4:7], 0
  v_mfma_f32_16x16x32_bf16 v[48:51], a[128:131], v[4:7], 0
  v_mfma_f32_16x16x32_bf16 v[52:55], a[192:195], v[4:7], 0
  ds_read_b128 v[4:7], v2 offset:4096
  s_waitcnt lgkmcnt(3)
  v_mfma_f32_16x16x32_bf16 v[32:35], a[4:7], v[8:11], v[32:35]
  v_mfma_f32_16x16x32_bf16 v[36:39], a[68:71], v[8:11], v[36:39]
  v_mfma_f32_16x16x32_bf16 v[48:51], a[132:135], v[8:11], v[48:51]
  v_mfma_f32_16x16x32_bf16 v[52:55], a[196:199], v[8:11], v[52:55]
  ds_read_b128 v[8:11], v2 offset:5120
  s_waitcnt lgkmcnt(3)
  v_mfma_f32_16x16x32_bf16 v[32:35], a[8:11], v[12:15], v[32:35]
  v_mfma_f32_16x16x32_bf16 v[36:39], a[72:75], v[12:15], v[36:39]
  v_mfma_f32_16x16x32_bf16 v[48:51], a[136:139], v[12:15], v[48:51]
  v_mfma_f32_16x16x32_bf16 v[52:55], a[200:203], v[12:15], v[52:55]
  ds_read_b128 v[12:15], v2 offset:6144
  s_waitcnt lgkmcnt(3)
  v_mfma_f32_16x16x32_bf16 v[32:35], a[12:15], v[16:19], v[32:35]
  v_mfma_f32_16x16x32_bf16 v[36:39], a[76:79], v[16:19], v[36:39]
  v_mfma_f32_16x16x32_bf16 v[48:51], a[140:143], v[16:19], v[48:51]
  v_mfma_f32_16x16x32_bf16 v[52:55], a[204:207], v[16:19], v[52:55]
  ds_read_b128 v[16:19], v2 offset:7168
  s_waitcnt lgkmcnt(3)
  v_mfma_f32_16x16x32_bf16 v[32:35], a[16:19], v[4:7], v[32:35]
  v_mfma_f32_16x16x32_bf16 v[36:39], a[80:83], v[4:7], v[36:39]
  v_mfma_f32_16x16x32_bf16 v[48:51], a[144:147], v[4:7], v[48:51]
  v_mfma_f32_16x16x32_bf16 v[52:55], a[208:211], v[4:7], v[52:55]
  ds_read_b128 v[4:7], v2 offset:8192
  s_waitcnt lgkmcnt(3)
  v_mfma_f32_16x16x32_bf16 v[32:35], a[20:23], v[8:11], v[32:35]
  v_mfma_f32_16x16x32_bf16 v[36:39], a[84:87], v[8:11], v[36:39]
  v_mfma_f32_16x16x32_bf16 v[48:51], a[148:151], v[8:11], v[48:51]
  v_mfma_f32_16x16x32_bf16 v[52:55], a[212:215], v[8:11], v[52:55]
  ds_read_b128 v[8:11], v2 offset:9216
  s_waitcnt lgkmcnt(3)
  v_mfma_f32_16x16x32_bf16 v[32:35], a[24:27], v[12:15], v[32:35]
  v_mfma_f32_16x16x32_bf16 v[36:39], a[88:91], v[12:15], v[36:39]
  v_mfma_f32_16x16x32_bf16 v[48:51], a[152:155], v[12:15], v[48:51]
  v_mfma_f32_16x16x32_bf16 v[52:55], a[216:219], v[12:15], v[52:55]
  ds_read_b128 v[12:15], v2 offset:10240
  s_waitcnt lgkmcnt(3)
  v_mfma_f32_16x16x32_bf16 v[32:35], a[28:31], v[16:19], v[32:35]
  v_mfma_f32_16x16x32_bf16 v[36:39], a[92:95], v[16:19], v[36:39]
  v_mfma_f32_16x16x32_bf16 v[48:51], a[156:159], v[16:19], v[48:51]
  v_mfma_f32_16x16x32_bf16 v[52:55], a[220:223], v[16:19], v[52:55]
  ds_read_b128 v[16:19], v2 offset:11264
  s_waitcnt lgkmcnt(3)
  v_mfma_f32_16x16x32_bf16 v[32:35], a[32:35], v[4:7], v[32:35]
  v_mfma_f32_16x16x32_bf16 v[36:39], a[96:99], v[4:7], v[36:39]
  v_mfma_f32_16x16x32_bf16 v[48:51], a[160:163], v[4:7], v[48:51]
  v_mfma_f32_16x16x32_bf16 v[52:55], a[224:227], v[4:7], v[52:55]
  ds_read_b128 v[4:7], v2 offset:12288
  s_waitcnt lgkmcnt(3)
  v_mfma_f32_16x16x32_bf16 v[32:35], a[36:39], v[8:11], v[32:35]
  v_mfma_f32_16x16x32_bf16 v[36:39], a[100:103], v[8:11], v[36:39]
  v_mfma_f32_16x16x32_bf16 v[48:51], a[164:167], v[8:11], v[48:51]
  v_mfma_f32_16x16x32_bf16 v[52:55], a[228:231], v[8:11], v[52:55]
  ds_read_b128 v[8:11], v2 offset:13312
  s_waitcnt lgkmcnt(3)
  v_mfma_f32_16x16x32_bf16 v[32:35], a[40:43], v[12:15], v[32:35]
  v_mfma_f32_16x16x32_bf16 v[36:39], a[104:107], v[12:15], v[36:39]
  v_mfma_f32_16x16x32_bf16 v[48:51], a[168:171], v[12:15], v[48:51]
  v_mfma_f32_16x16x32_bf16 v[52:55], a[232:235], v[12:15], v[52:55]
  ds_read_b128 v[12:15], v2 offset:14336
  s_waitcnt lgkmcnt(3)
  v_mfma_f32_16x16x32_bf16 v[32:35], a[44:47], v[16:19], v[32:35]
  v_mfma_f32_16x16x32_bf16 v[36:39], a[108:111], v[16:19], v[36:39]
  v_mfma_f32_16x16x32_bf16 v[48:51], a[172:175], v[16:19], v[48:51]
  v_mfma_f32_16x16x32_bf16 v[52:55], a[236:239], v[16:19], v[52:55]
  ds_read_b128 v[16:19], v2 offset:15360
  s_waitcnt lgkmcnt(3)
  v_mfma_f32_16x16x32_bf16 v[32:35], a[48:51], v[4:7], v[32:35]
  v_mfma_f32_16x16x32_bf16 v[36:39], a[112:115], v[4:7], v[36:39]
  v_mfma_f32_16x16x32_bf16 v[48:51], a[176:179], v[4:7], v[48:51]
  v_mfma_f32_16x16x32_bf16 v[52:55], a[240:243], v[4:7], v[52:55]
  ds_read_b128 v[4:7], v2 offset:16384
  s_waitcnt lgkmcnt(3)
  v_mfma_f32_16x16x32_bf16 v[32:35], a[52:55], v[8:11], v[32:35]
  v_mfma_f32_16x16x32_bf16 v[36:39], a[116:119], v[8:11], v[36:39]
  v_mfma_f32_16x16x32_bf16 v[48:51], a[180:183], v[8:11], v[48:51]
  v_mfma_f32_16x16x32_bf16 v[52:55], a[244:247], v[8:11], v[52:55]
  ds_read_b128 v[8:11], v2 offset:17408
  s_waitcnt lgkmcnt(3)
  v_mfma_f32_16x16x32_bf16 v[32:35], a[56:59], v[12:15], v[32:35]
  v_mfma_f32_16x16x32_bf16 v[36:39], a[120:123], v[12:15], v[36:39]
  v_mfma_f32_16x16x32_bf16 v[48:51], a[184:187], v[12:15], v[48:51]
  v_mfma_f32_16x16x32_bf16 v[52:55], a[248:251], v[12:15], v[52:55]
  ds_read_b128 v[12:15], v2 offset:18432
  s_waitcnt lgkmcnt(3)
  v_mfma_f32_16x16x32_bf16 v[32:35], a[60:63], v[16:19], v[32:35]
  v_mfma_f32_16x16x32_bf16 v[36:39], a[124:127], v[16:19], v[36:39]
  v_mfma_f32_16x16x32_bf16 v[48:51], a[188:191], v[16:19], v[48:51]
  v_mfma_f32_16x16x32_bf16 v[52:55], a[252:255], v[16:19], v[52:55]
  s_waitcnt vmcnt(8)
  s_barrier
  s_cmp_eq_u32 s48, 0
  s_nop 3
  s_cbranch_scc1 PF23
  s_cmp_lg_u32 s48, s43
  s_cbranch_scc1 PG23
  s_mov_b32 s28, s88
  s_and_b32 s29, s89, 0xffff
  s_mov_b32 s30, 0x100
  s_mov_b32 s31, 0x20000
  v_and_b32 v124, 31, v0
  v_lshlrev_b32 v124, 2, v124
  s_mov_b32 s3, 0x100000
  s_nop 0
WI24:
  buffer_load_dword v125, v124, s[28:31], 0 offen sc1
  s_sub_u32 s3, s3, 1
  s_cbranch_scc1 K1_END
  s_waitcnt vmcnt(0)
  v_cmp_eq_u32 vcc, 0, v125
  s_nop 3
  s_cbranch_vccnz WI24
PG23:
  s_cmp_lg_u32 s32, 0
  s_cbranch_scc1 SF25
  v_mov_b32 v124, 0
  v_mov_b32 v125, 1
  s_mov_b64 exec, 1
  buffer_store_dword v125, v124, s[4:7], s48 offen sc1
  s_mov_b64 exec, -1
SF25:
PF23:
  ds_read_b128 v[16:19], v2 offset:19456
  s_waitcnt lgkmcnt(3)
  v_mfma_f32_16x16x32_bf16 v[40:43], a[0:3], v[4:7], 0
  v_mfma_f32_16x16x32_bf16 v[44:47], a[64:67], v[4:7], 0
  v_mfma_f32_16x16x32_bf16 v[56:59], a[128:131], v[4:7], 0
  v_mfma_f32_16x16x32_bf16 v[60:63], a[192:195], v[4:7], 0
  ds_read_b128 v[4:7], v2 offset:20480
  s_waitcnt lgkmcnt(3)
  v_mfma_f32_16x16x32_bf16 v[40:43], a[4:7], v[8:11], v[40:43]
  v_mfma_f32_16x16x32_bf16 v[44:47], a[68:71], v[8:11], v[44:47]
  v_mfma_f32_16x16x32_bf16 v[56:59], a[132:135], v[8:11], v[56:59]
  v_mfma_f32_16x16x32_bf16 v[60:63], a[196:199], v[8:11], v[60:63]
  ds_read_b128 v[8:11], v2 offset:21504
  s_waitcnt lgkmcnt(3)
  v_mfma_f32_16x16x32_bf16 v[40:43], a[8:11], v[12:15], v[40:43]
  v_mfma_f32_16x16x32_bf16 v[44:47], a[72:75], v[12:15], v[44:47]
  v_mfma_f32_16x16x32_bf16 v[56:59], a[136:139], v[12:15], v[56:59]
  v_mfma_f32_16x16x32_bf16 v[60:63], a[200:203], v[12:15], v[60:63]
  ds_read_b128 v[12:15], v2 offset:22528
  s_waitcnt lgkmcnt(3)
  v_mfma_f32_16x16x32_bf16 v[40:43], a[12:15], v[16:19], v[40:43]
  v_mfma_f32_16x16x32_bf16 v[44:47], a[76:79], v[16:19], v[44:47]
  v_mfma_f32_16x16x32_bf16 v[56:59], a[140:143], v[16:19], v[56:59]
  v_mfma_f32_16x16x32_bf16 v[60:63], a[204:207], v[16:19], v[60:63]
  ds_read_b128 v[16:19], v2 offset:23552
  s_waitcnt lgkmcnt(3)
  v_mfma_f32_16x16x32_bf16 v[40:43], a[16:19], v[4:7], v[40:43]
  v_mfma_f32_16x16x32_bf16 v[44:47], a[80:83], v[4:7], v[44:47]
  v_mfma_f32_16x16x32_bf16 v[56:59], a[144:147], v[4:7], v[56:59]
  v_mfma_f32_16x16x32_bf16 v[60:63], a[208:211], v[4:7], v[60:63]
  ds_read_b128 v[4:7], v2 offset:24576
  s_waitcnt lgkmcnt(3)
  v_mfma_f32_16x16x32_bf16 v[40:43], a[20:23], v[8:11], v[40:43]
  v_mfma_f32_16x16x32_bf16 v[44:47], a[84:87], v[8:11], v[44:47]
  v_mfma_f32_16x16x32_bf16 v[56:59], a[148:151], v[8:11], v[56:59]
  v_mfma_f32_16x16x32_bf16 v[60:63], a[212:215], v[8:11], v[60:63]
  ds_read_b128 v[8:11], v2 offset:25600
  s_waitcnt lgkmcnt(3)
  v_mfma_f32_16x16x32_bf16 v[40:43], a[24:27], v[12:15], v[40:43]
  v_mfma_f32_16x16x32_bf16 v[44:47], a[88:91], v[12:15], v[44:47]
  v_mfma_f32_16x16x32_bf16 v[56:59], a[152:155], v[12:15], v[56:59]
  v_mfma_f32_16x16x32_bf16 v[60:63], a[216:219], v[12:15], v[60:63]
  ds_read_b128 v[12:15], v2 offset:26624
  s_waitcnt lgkmcnt(3)
  v_mfma_f32_16x16x32_bf16 v[40:43], a[28:31], v[16:19], v[40:43]
  v_mfma_f32_16x16x32_bf16 v[44:47], a[92:95], v[16:19], v[44:47]
  v_mfma_f32_16x16x32_bf16 v[56:59], a[156:159], v[16:19], v[56:59]
  v_mfma_f32_16x16x32_bf16 v[60:63], a[220:223], v[16:19], v[60:63]
  ds_read_b128 v[16:19], v2 offset:27648
  s_waitcnt lgkmcnt(3)
  v_mfma_f32_16x16x32_bf16 v[40:43], a[32:35], v[4:7], v[40:43]
  v_mfma_f32_16x16x32_bf16 v[44:47], a[96:99], v[4:7], v[44:47]
  v_mfma_f32_16x16x32_bf16 v[56:59], a[160:163], v[4:7], v[56:59]
  v_mfma_f32_16x16x32_bf16 v[60:63], a[224:227], v[4:7], v[60:63]
  ds_read_b128 v[4:7], v2 offset:28672
  s_waitcnt lgkmcnt(3)
  v_mfma_f32_16x16x32_bf16 v[40:43], a[36:39], v[8:11], v[40:43]
  v_mfma_f32_16x16x32_bf16 v[44:47], a[100:103], v[8:11], v[44:47]
  v_mfma_f32_16x16x32_bf16 v[56:59], a[164:167], v[8:11], v[56:59]
  v_mfma_f32_16x16x32_bf16 v[60:63], a[228:231], v[8:11], v[60:63]
  ds_read_b128 v[8:11], v2 offset:29696
  s_waitcnt lgkmcnt(3)
  v_mfma_f32_16x16x32_bf16 v[40:43], a[40:43], v[12:15], v[40:43]
  v_mfma_f32_16x16x32_bf16 v[44:47], a[104:107], v[12:15], v[44:47]
  v_mfma_f32_16x16x32_bf16 v[56:59], a[168:171], v[12:15], v[56:59]
  v_mfma_f32_16x16x32_bf16 v[60:63], a[232:235], v[12:15], v[60:63]
  ds_read_b128 v[12:15], v2 offset:30720
  s_waitcnt lgkmcnt(3)
  v_mfma_f32_16x16x32_bf16 v[40:43], a[44:47], v[16:19], v[40:43]
  v_mfma_f32_16x16x32_bf16 v[44:47], a[108:111], v[16:19], v[44:47]
  v_mfma_f32_16x16x32_bf16 v[56:59], a[172:175], v[16:19], v[56:59]
  v_mfma_f32_16x16x32_bf16 v[60:63], a[236:239], v[16:19], v[60:63]
  ds_read_b128 v[16:19], v2 offset:31744
  s_waitcnt lgkmcnt(3)
  v_mfma_f32_16x16x32_bf16 v[40:43], a[48:51], v[4:7], v[40:43]
  v_mfma_f32_16x16x32_bf16 v[44:47], a[112:115], v[4:7], v[44:47]
  v_mfma_f32_16x16x32_bf16 v[56:59], a[176:179], v[4:7], v[56:59]
  v_mfma_f32_16x16x32_bf16 v[60:63], a[240:243], v[4:7], v[60:63]
  s_waitcnt lgkmcnt(2)
  v_mfma_f32_16x16x32_bf16 v[40:43], a[52:55], v[8:11], v[40:43]
  v_mfma_f32_16x16x32_bf16 v[44:47], a[116:119], v[8:11], v[44:47]
  v_mfma_f32_16x16x32_bf16 v[56:59], a[180:183], v[8:11], v[56:59]
  v_mfma_f32_16x16x32_bf16 v[60:63], a[244:247], v[8:11], v[60:63]
  s_waitcnt lgkmcnt(1)
  v_mfma_f32_16x16x32_bf16 v[40:43], a[56:59], v[12:15], v[40:43]
  v_mfma_f32_16x16x32_bf16 v[44:47], a[120:123], v[12:15], v[44:47]
  v_mfma_f32_16x16x32_bf16 v[56:59], a[184:187], v[12:15], v[56:59]
  v_mfma_f32_16x16x32_bf16 v[60:63], a[248:251], v[12:15], v[60:63]
  s_waitcnt lgkmcnt(0)
  v_mfma_f32_16x16x32_bf16 v[40:43], a[60:63], v[16:19], v[40:43]
  v_mfma_f32_16x16x32_bf16 v[44:47], a[124:127], v[16:19], v[44:47]
  v_mfma_f32_16x16x32_bf16 v[56:59], a[188:191], v[16:19], v[56:59]
  v_mfma_f32_16x16x32_bf16 v[60:63], a[252:255], v[16:19], v[60:63]
  s_mul_i32 s36, s46, 114688
  s_lshl_b32 s37, s51, 3
  s_add_u32 s37, s37, s32
  s_lshl_b32 s37, s37, 10
  s_add_u32 s36, s36, s37
  s_add_u32 s36, s36, 50331648
  v_cvt_pk_bf16_f32 v64, v32, v33
  v_cvt_pk_bf16_f32 v65, v34, v35
  v_cvt_pk_bf16_f32 v66, v36, v37
  v_cvt_pk_bf16_f32 v67, v38, v39
  v_lshlrev_b32 v32, 16, v64
  v_and_b32 v33, 0xffff0000, v64
  v_lshlrev_b32 v34, 16, v65
  v_and_b32 v35, 0xffff0000, v65
  v_lshlrev_b32 v36, 16, v66
  v_and_b32 v37, 0xffff0000, v66
  v_lshlrev_b32 v38, 16, v67
  v_and_b32 v39, 0xffff0000, v67
  v_mul_f32 v68, s96, v32
  v_exp_f32 v68, v68
  v_mul_f32 v69, s96, v33
  v_exp_f32 v69, v69
  v_mul_f32 v70, s96, v34
  v_exp_f32 v70, v70
  v_mul_f32 v71, s96, v35
  v_exp_f32 v71, v71
  v_mul_f32 v72, s96, v36
  v_exp_f32 v72, v72
  v_mul_f32 v73, s96, v37
  v_exp_f32 v73, v73
  v_mul_f32 v74, s96, v38
  v_exp_f32 v74, v74
  v_mul_f32 v75, s96, v39
  v_exp_f32 v75, v75
  v_add_f32 v68, 1.0, v68
  v_rcp_f32 v68, v68
  v_add_f32 v69, 1.0, v69
  v_rcp_f32 v69, v69
  v_add_f32 v70, 1.0, v70
  v_rcp_f32 v70, v70
  v_add_f32 v71, 1.0, v71
  v_rcp_f32 v71, v71
  v_add_f32 v72, 1.0, v72
  v_rcp_f32 v72, v72
  v_add_f32 v73, 1.0, v73
  v_rcp_f32 v73, v73
  v_add_f32 v74, 1.0, v74
  v_rcp_f32 v74, v74
  v_add_f32 v75, 1.0, v75
  v_rcp_f32 v75, v75
  v_mul_f32 v32, v32, v68
  v_mul_f32 v33, v33, v69
  v_mul_f32 v34, v34, v70
  v_mul_f32 v35, v35, v71
  v_mul_f32 v36, v36, v72
  v_mul_f32 v37, v37, v73
  v_mul_f32 v38, v38, v74
  v_mul_f32 v39, v39, v75
  v_cvt_pk_bf16_f32 v76, v32, v33
  v_cvt_pk_bf16_f32 v77, v34, v35
  v_cvt_pk_bf16_f32 v78, v36, v37
  v_cvt_pk_bf16_f32 v79, v38, v39
  s_add_u32 s37, s36, 0
  buffer_store_dwordx4 v[76:79], v2, s[4:7], s37 offen sc1
  v_cvt_pk_bf16_f32 v64, v40, v41
  v_cvt_pk_bf16_f32 v65, v42, v43
  v_cvt_pk_bf16_f32 v66, v44, v45
  v_cvt_pk_bf16_f32 v67, v46, v47
  v_lshlrev_b32 v40, 16, v64
  v_and_b32 v41, 0xffff0000, v64
  v_lshlrev_b32 v42, 16, v65
  v_and_b32 v43, 0xffff0000, v65
  v_lshlrev_b32 v44, 16, v66
  v_and_b32 v45, 0xffff0000, v66
  v_lshlrev_b32 v46, 16, v67
  v_and_b32 v47, 0xffff0000, v67
  v_mul_f32 v68, s96, v40
  v_exp_f32 v68, v68
  v_mul_f32 v69, s96, v41
  v_exp_f32 v69, v69
  v_mul_f32 v70, s96, v42
  v_exp_f32 v70, v70
  v_mul_f32 v71, s96, v43
  v_exp_f32 v71, v71
  v_mul_f32 v72, s96, v44
  v_exp_f32 v72, v72
  v_mul_f32 v73, s96, v45
  v_exp_f32 v73, v73
  v_mul_f32 v74, s96, v46
  v_exp_f32 v74, v74
  v_mul_f32 v75, s96, v47
  v_exp_f32 v75, v75
  v_add_f32 v68, 1.0, v68
  v_rcp_f32 v68, v68
  v_add_f32 v69, 1.0, v69
  v_rcp_f32 v69, v69
  v_add_f32 v70, 1.0, v70
  v_rcp_f32 v70, v70
  v_add_f32 v71, 1.0, v71
  v_rcp_f32 v71, v71
  v_add_f32 v72, 1.0, v72
  v_rcp_f32 v72, v72
  v_add_f32 v73, 1.0, v73
  v_rcp_f32 v73, v73
  v_add_f32 v74, 1.0, v74
  v_rcp_f32 v74, v74
  v_add_f32 v75, 1.0, v75
  v_rcp_f32 v75, v75
  v_mul_f32 v40, v40, v68
  v_mul_f32 v41, v41, v69
  v_mul_f32 v42, v42, v70
  v_mul_f32 v43, v43, v71
  v_mul_f32 v44, v44, v72
  v_mul_f32 v45, v45, v73
  v_mul_f32 v46, v46, v74
  v_mul_f32 v47, v47, v75
  v_cvt_pk_bf16_f32 v80, v40, v41
  v_cvt_pk_bf16_f32 v81, v42, v43
  v_cvt_pk_bf16_f32 v82, v44, v45
  v_cvt_pk_bf16_f32 v83, v46, v47
  s_add_u32 s37, s36, 57344
  buffer_store_dwordx4 v[80:83], v2, s[4:7], s37 offen sc1
  v_cvt_pk_bf16_f32 v64, v48, v49
  v_cvt_pk_bf16_f32 v65, v50, v51
  v_cvt_pk_bf16_f32 v66, v52, v53
  v_cvt_pk_bf16_f32 v67, v54, v55
  v_lshlrev_b32 v48, 16, v64
  v_and_b32 v49, 0xffff0000, v64
  v_lshlrev_b32 v50, 16, v65
  v_and_b32 v51, 0xffff0000, v65
  v_lshlrev_b32 v52, 16, v66
  v_and_b32 v53, 0xffff0000, v66
  v_lshlrev_b32 v54, 16, v67
  v_and_b32 v55, 0xffff0000, v67
  v_mul_f32 v68, s96, v48
  v_exp_f32 v68, v68
  v_mul_f32 v69, s96, v49
  v_exp_f32 v69, v69
  v_mul_f32 v70, s96, v50
  v_exp_f32 v70, v70
  v_mul_f32 v71, s96, v51
  v_exp_f32 v71, v71
  v_mul_f32 v72, s96, v52
  v_exp_f32 v72, v72
  v_mul_f32 v73, s96, v53
  v_exp_f32 v73, v73
  v_mul_f32 v74, s96, v54
  v_exp_f32 v74, v74
  v_mul_f32 v75, s96, v55
  v_exp_f32 v75, v75
  v_add_f32 v68, 1.0, v68
  v_rcp_f32 v68, v68
  v_add_f32 v69, 1.0, v69
  v_rcp_f32 v69, v69
  v_add_f32 v70, 1.0, v70
  v_rcp_f32 v70, v70
  v_add_f32 v71, 1.0, v71
  v_rcp_f32 v71, v71
  v_add_f32 v72, 1.0, v72
  v_rcp_f32 v72, v72
  v_add_f32 v73, 1.0, v73
  v_rcp_f32 v73, v73
  v_add_f32 v74, 1.0, v74
  v_rcp_f32 v74, v74
  v_add_f32 v75, 1.0, v75
  v_rcp_f32 v75, v75
  v_mul_f32 v48, v48, v68
  v_mul_f32 v49, v49, v69
  v_mul_f32 v50, v50, v70
  v_mul_f32 v51, v51, v71
  v_mul_f32 v52, v52, v72
  v_mul_f32 v53, v53, v73
  v_mul_f32 v54, v54, v74
  v_mul_f32 v55, v55, v75
  v_cvt_pk_bf16_f32 v76, v48, v49
  v_cvt_pk_bf16_f32 v77, v50, v51
  v_cvt_pk_bf16_f32 v78, v52, v53
  v_cvt_pk_bf16_f32 v79, v54, v55
  s_add_u32 s37, s36, 4096
  buffer_store_dwordx4 v[76:79], v2, s[4:7], s37 offen sc1
  v_cvt_pk_bf16_f32 v64, v56, v57
  v_cvt_pk_bf16_f32 v65, v58, v59
  v_cvt_pk_bf16_f32 v66, v60, v61
  v_cvt_pk_bf16_f32 v67, v62, v63
  v_lshlrev_b32 v56, 16, v64
  v_and_b32 v57, 0xffff0000, v64
  v_lshlrev_b32 v58, 16, v65
  v_and_b32 v59, 0xffff0000, v65
  v_lshlrev_b32 v60, 16, v66
  v_and_b32 v61, 0xffff0000, v66
  v_lshlrev_b32 v62, 16, v67
  v_and_b32 v63, 0xffff0000, v67
  v_mul_f32 v68, s96, v56
  v_exp_f32 v68, v68
  v_mul_f32 v69, s96, v57
  v_exp_f32 v69, v69
  v_mul_f32 v70, s96, v58
  v_exp_f32 v70, v70
  v_mul_f32 v71, s96, v59
  v_exp_f32 v71, v71
  v_mul_f32 v72, s96, v60
  v_exp_f32 v72, v72
  v_mul_f32 v73, s96, v61
  v_exp_f32 v73, v73
  v_mul_f32 v74, s96, v62
  v_exp_f32 v74, v74
  v_mul_f32 v75, s96, v63
  v_exp_f32 v75, v75
  v_add_f32 v68, 1.0, v68
  v_rcp_f32 v68, v68
  v_add_f32 v69, 1.0, v69
  v_rcp_f32 v69, v69
  v_add_f32 v70, 1.0, v70
  v_rcp_f32 v70, v70
  v_add_f32 v71, 1.0, v71
  v_rcp_f32 v71, v71
  v_add_f32 v72, 1.0, v72
  v_rcp_f32 v72, v72
  v_add_f32 v73, 1.0, v73
  v_rcp_f32 v73, v73
  v_add_f32 v74, 1.0, v74
  v_rcp_f32 v74, v74
  v_add_f32 v75, 1.0, v75
  v_rcp_f32 v75, v75
  v_mul_f32 v56, v56, v68
  v_mul_f32 v57, v57, v69
  v_mul_f32 v58, v58, v70
  v_mul_f32 v59, v59, v71
  v_mul_f32 v60, v60, v72
  v_mul_f32 v61, v61, v73
  v_mul_f32 v62, v62, v74
  v_mul_f32 v63, v63, v75
  v_cvt_pk_bf16_f32 v80, v56, v57
  v_cvt_pk_bf16_f32 v81, v58, v59
  v_cvt_pk_bf16_f32 v82, v60, v61
  v_cvt_pk_bf16_f32 v83, v62, v63
  s_add_u32 s37, s36, 61440
  buffer_store_dwordx4 v[80:83], v2, s[4:7], s37 offen sc1
  s_lshl_b32 s48, s46, 5
  s_add_u32 s48, s48, s51
  s_lshl_b32 s48, s48, 2
  s_add_u32 s48, s48, 87062784
  s_mov_b32 s46, s47
  s_cmp_ge_u32 s46, 64
  s_cbranch_scc1 K1_R2a_LAST
K1_R2a_L1:
  s_waitcnt vmcnt(4)
  s_barrier
  s_add_u32 s47, s46, 13
  s_min_u32 s36, s47, 63
  s_mov_b32 s44, s36
  s_lshl_b32 s36, s44, 15
  s_lshl_b32 s37, s32, 8
  s_add_u32 s36, s36, s37
  s_lshl_b32 s37, s32, 12
  s_add_u32 s38, s37, 0
  s_mov_b32 m0, s38
  s_add_u32 s39, s36, 0
  buffer_load_dwordx4 v1, s[24:27], s39 offen lds
  s_add_u32 s38, s37, 1024
  s_mov_b32 m0, s38
  s_add_u32 s39, s36, 64
  buffer_load_dwordx4 v1, s[24:27], s39 offen lds
  s_add_u32 s38, s37, 2048
  s_mov_b32 m0, s38
  s_add_u32 s39, s36, 128
  buffer_load_dwordx4 v1, s[24:27], s39 offen lds
  s_add_u32 s38, s37, 3072
  s_mov_b32 m0, s38
  s_add_u32 s39, s36, 192
  buffer_load_dwordx4 v1, s[24:27], s39 offen lds
  s_add_u32 s38, s37, 16384
  s_mov_b32 m0, s38
  s_add_u32 s39, s36, 16384
  buffer_load_dwordx4 v1, s[24:27], s39 offen lds
  s_add_u32 s38, s37, 17408
  s_mov_b32 m0, s38
  s_add_u32 s39, s36, 16448
  buffer_load_dwordx4 v1, s[24:27], s39 offen lds
  s_add_u32 s38, s37, 18432
  s_mov_b32 m0, s38
  s_add_u32 s39, s36, 16512
  buffer_load_dwordx4 v1, s[24:27], s39 offen lds
  s_add_u32 s38, s37, 19456
  s_mov_b32 m0, s38
  s_add_u32 s39, s36, 16576
  buffer_load_dwordx4 v1, s[24:27], s39 offen lds
  ds_read_b128 v[4:7], v2 offset:32768
  ds_read_b128 v[8:11], v2 offset:33792
  ds_read_b128 v[12:15], v2 offset:34816
  ds_read_b128 v[16:19], v2 offset:35840
  s_waitcnt lgkmcnt(3)
  v_mfma_f32_16x16x32_bf16 v[32:35], a[0:3], v[4:7], 0
  v_mfma_f32_16x16x32_bf16 v[36:39], a[64:67], v[4:7], 0
  v_mfma_f32_16x16x32_bf16 v[48:51], a[128:131], v[4:7], 0
  v_mfma_f32_16x16x32_bf16 v[52:55], a[192:195], v[4:7], 0
  ds_read_b128 v[4:7], v2 offset:36864
  s_waitcnt lgkmcnt(3)
  v_mfma_f32_16x16x32_bf16 v[32:35], a[4:7], v[8:11], v[32:35]
  v_mfma_f32_16x16x32_bf16 v[36:39], a[68:71], v[8:11], v[36:39]
  v_mfma_f32_16x16x32_bf16 v[48:51], a[132:135], v[8:11], v[48:51]
  v_mfma_f32_16x16x32_bf16 v[52:55], a[196:199], v[8:11], v[52:55]
  ds_read_b128 v[8:11], v2 offset:37888
  s_waitcnt lgkmcnt(3)
  v_mfma_f32_16x16x32_bf16 v[32:35], a[8:11], v[12:15], v[32:35]
  v_mfma_f32_16x16x32_bf16 v[36:39], a[72:75], v[12:15], v[36:39]
  v_mfma_f32_16x16x32_bf16 v[48:51], a[136:139], v[12:15], v[48:51]
  v_mfma_f32_16x16x32_bf16 v[52:55], a[200:203], v[12:15], v[52:55]
  ds_read_b128 v[12:15], v2 offset:38912
  s_waitcnt lgkmcnt(3)
  v_mfma_f32_16x16x32_bf16 v[32:35], a[12:15], v[16:19], v[32:35]
  v_mfma_f32_16x16x32_bf16 v[36:39], a[76:79], v[16:19], v[36:39]
  v_mfma_f32_16x16x32_bf16 v[48:51], a[140:143], v[16:19], v[48:51]
  v_mfma_f32_16x16x32_bf16 v[52:55], a[204:207], v[16:19], v[52:55]
  ds_read_b128 v[16:19], v2 offset:39936
  s_waitcnt lgkmcnt(3)
  v_mfma_f32_16x16x32_bf16 v[32:35], a[16:19], v[4:7], v[32:35]
  v_mfma_f32_16x16x32_bf16 v[36:39], a[80:83], v[4:7], v[36:39]
  v_mfma_f32_16x16x32_bf16 v[48:51], a[144:147], v[4:7], v[48:51]
  v_mfma_f32_16x16x32_bf16 v[52:55], a[208:211], v[4:7], v[52:55]
  ds_read_b128 v[4:7], v2 offset:40960
  s_waitcnt lgkmcnt(3)
  v_mfma_f32_16x16x32_bf16 v[32:35], a[20:23], v[8:11], v[32:35]
  v_mfma_f32_16x16x32_bf16 v[36:39], a[84:87], v[8:11], v[36:39]
  v_mfma_f32_16x16x32_bf16 v[48:51], a[148:151], v[8:11], v[48:51]
  v_mfma_f32_16x16x32_bf16 v[52:55], a[212:215], v[8:11], v[52:55]
  ds_read_b128 v[8:11], v2 offset:41984
  s_waitcnt lgkmcnt(3)
  v_mfma_f32_16x16x32_bf16 v[32:35], a[24:27], v[12:15], v[32:35]
  v_mfma_f32_16x16x32_bf16 v[36:39], a[88:91], v[12:15], v[36:39]
  v_mfma_f32_16x16x32_bf16 v[48:51], a[152:155], v[12:15], v[48:51]
  v_mfma_f32_16x16x32_bf16 v[52:55], a[216:219], v[12:15], v[52:55]
  ds_read_b128 v[12:15], v2 offset:43008
  s_waitcnt lgkmcnt(3)
  v_mfma_f32_16x16x32_bf16 v[32:35], a[28:31], v[16:19], v[32:35]
  v_mfma_f32_16x16x32_bf16 v[36:39], a[92:95], v[16:19], v[36:39]
  v_mfma_f32_16x16x32_bf16 v[48:51], a[156:159], v[16:19], v[48:51]
  v_mfma_f32_16x16x32_bf16 v[52:55], a[220:223], v[16:19], v[52:55]
  ds_read_b128 v[16:19], v2 offset:44032
  s_waitcnt lgkmcnt(3)
  v_mfma_f32_16x16x32_bf16 v[32:35], a[32:35], v[4:7], v[32:35]
  v_mfma_f32_16x16x32_bf16 v[36:39], a[96:99], v[4:7], v[36:39]
  v_mfma_f32_16x16x32_bf16 v[48:51], a[160:163], v[4:7], v[48:51]
  v_mfma_f32_16x16x32_bf16 v[52:55], a[224:227], v[4:7], v[52:55]
  ds_read_b128 v[4:7], v2 offset:45056
  s_waitcnt lgkmcnt(3)
  v_mfma_f32_16x16x32_bf16 v[32:35], a[36:39], v[8:11], v[32:35]
  v_mfma_f32_16x16x32_bf16 v[36:39], a[100:103], v[8:11], v[36:39]
  v_mfma_f32_16x16x32_bf16 v[48:51], a[164:167], v[8:11], v[48:51]
  v_mfma_f32_16x16x32_bf16 v[52:55], a[228:231], v[8:11], v[52:55]
  ds_read_b128 v[8:11], v2 offset:46080
  s_waitcnt lgkmcnt(3)
  v_mfma_f32_16x16x32_bf16 v[32:35], a[40:43], v[12:15], v[32:35]
  v_mfma_f32_16x16x32_bf16 v[36:39], a[104:107], v[12:15], v[36:39]
  v_mfma_f32_16x16x32_bf16 v[48:51], a[168:171], v[12:15], v[48:51]
  v_mfma_f32_16x16x32_bf16 v[52:55], a[232:235], v[12:15], v[52:55]
  ds_read_b128 v[12:15], v2 offset:47104
  s_waitcnt lgkmcnt(3)
  v_mfma_f32_16x16x32_bf16 v[32:35], a[44:47], v[16:19], v[32:35]
  v_mfma_f32_16x16x32_bf16 v[36:39], a[108:111], v[16:19], v[36:39]
  v_mfma_f32_16x16x32_bf16 v[48:51], a[172:175], v[16:19], v[48:51]
  v_mfma_f32_16x16x32_bf16 v[52:55], a[236:239], v[16:19], v[52:55]
  ds_read_b128 v[16:19], v2 offset:48128
  s_waitcnt lgkmcnt(3)
  v_mfma_f32_16x16x32_bf16 v[32:35], a[48:51], v[4:7], v[32:35]
  v_mfma_f32_16x16x32_bf16 v[36:39], a[112:115], v[4:7], v[36:39]
  v_mfma_f32_16x16x32_bf16 v[48:51], a[176:179], v[4:7], v[48:51]
  v_mfma_f32_16x16x32_bf16 v[52:55], a[240:243], v[4:7], v[52:55]
  ds_read_b128 v[4:7], v2 offset:49152
  s_waitcnt lgkmcnt(3)
  v_mfma_f32_16x16x32_bf16 v[32:35], a[52:55], v[8:11], v[32:35]
  v_mfma_f32_16x16x32_bf16 v[36:39], a[116:119], v[8:11], v[36:39]
  v_mfma_f32_16x16x32_bf16 v[48:51], a[180:183], v[8:11], v[48:51]
  v_mfma_f32_16x16x32_bf16 v[52:55], a[244:247], v[8:11], v[52:55]
  ds_read_b128 v[8:11], v2 offset:50176
  s_waitcnt lgkmcnt(3)
  v_mfma_f32_16x16x32_bf16 v[32:35], a[56:59], v[12:15], v[32:35]
  v_mfma_f32_16x16x32_bf16 v[36:39], a[120:123], v[12:15], v[36:39]
  v_mfma_f32_16x16x32_bf16 v[48:51], a[184:187], v[12:15], v[48:51]
  v_mfma_f32_16x16x32_bf16 v[52:55], a[248:251], v[12:15], v[52:55]
  ds_read_b128 v[12:15], v2 offset:51200
  s_waitcnt lgkmcnt(3)
  v_mfma_f32_16x16x32_bf16 v[32:35], a[60:63], v[16:19], v[32:35]
  v_mfma_f32_16x16x32_bf16 v[36:39], a[124:127], v[16:19], v[36:39]
  v_mfma_f32_16x16x32_bf16 v[48:51], a[188:191], v[16:19], v[48:51]
  v_mfma_f32_16x16x32_bf16 v[52:55], a[252:255], v[16:19], v[52:55]
  s_waitcnt vmcnt(8)
  s_barrier
  s_cmp_eq_u32 s48, 0
  s_nop 3
  s_cbranch_scc1 PF26
  s_cmp_lg_u32 s48, s43
  s_cbranch_scc1 PG26
  s_mov_b32 s28, s88
  s_and_b32 s29, s89, 0xffff
  s_mov_b32 s30, 0x100
  s_mov_b32 s31, 0x20000
  v_and_b32 v124, 31, v0
  v_lshlrev_b32 v124, 2, v124
  s_mov_b32 s3, 0x100000
  s_nop 0
WI27:
  buffer_load_dword v125, v124, s[28:31], 0 offen sc1
  s_sub_u32 s3, s3, 1
  s_cbranch_scc1 K1_END
  s_waitcnt vmcnt(0)
  v_cmp_eq_u32 vcc, 0, v125
  s_nop 3
  s_cbranch_vccnz WI27
PG26:
  s_cmp_lg_u32 s32, 0
  s_cbranch_scc1 SF28
  v_mov_b32 v124, 0
  v_mov_b32 v125, 1
  s_mov_b64 exec, 1
  buffer_store_dword v125, v124, s[4:7], s48 offen sc1
  s_mov_b64 exec, -1
SF28:
PF26:
  ds_read_b128 v[16:19], v2 offset:52224
  s_waitcnt lgkmcnt(3)
  v_mfma_f32_16x16x32_bf16 v[40:43], a[0:3], v[4:7], 0
  v_mfma_f32_16x16x32_bf16 v[44:47], a[64:67], v[4:7], 0
  v_mfma_f32_16x16x32_bf16 v[56:59], a[128:131], v[4:7], 0
  v_mfma_f32_16x16x32_bf16 v[60:63], a[192:195], v[4:7], 0
  ds_read_b128 v[4:7], v2 offset:53248
  s_waitcnt lgkmcnt(3)
  v_mfma_f32_16x16x32_bf16 v[40:43], a[4:7], v[8:11], v[40:43]
  v_mfma_f32_16x16x32_bf16 v[44:47], a[68:71], v[8:11], v[44:47]
  v_mfma_f32_16x16x32_bf16 v[56:59], a[132:135], v[8:11], v[56:59]
  v_mfma_f32_16x16x32_bf16 v[60:63], a[196:199], v[8:11], v[60:63]
  ds_read_b128 v[8:11], v2 offset:54272
  s_waitcnt lgkmcnt(3)
  v_mfma_f32_16x16x32_bf16 v[40:43], a[8:11], v[12:15], v[40:43]
  v_mfma_f32_16x16x32_bf16 v[44:47], a[72:75], v[12:15], v[44:47]
  v_mfma_f32_16x16x32_bf16 v[56:59], a[136:139], v[12:15], v[56:59]
  v_mfma_f32_16x16x32_bf16 v[60:63], a[200:203], v[12:15], v[60:63]
  ds_read_b128 v[12:15], v2 offset:55296
  s_waitcnt lgkmcnt(3)
  v_mfma_f32_16x16x32_bf16 v[40:43], a[12:15], v[16:19], v[40:43]
  v_mfma_f32_16x16x32_bf16 v[44:47], a[76:79], v[16:19], v[44:47]
  v_mfma_f32_16x16x32_bf16 v[56:59], a[140:143], v[16:19], v[56:59]
  v_mfma_f32_16x16x32_bf16 v[60:63], a[204:207], v[16:19], v[60:63]
  ds_read_b128 v[16:19], v2 offset:56320
  s_waitcnt lgkmcnt(3)
  v_mfma_f32_16x16x32_bf16 v[40:43], a[16:19], v[4:7], v[40:43]
  v_mfma_f32_16x16x32_bf16 v[44:47], a[80:83], v[4:7], v[44:47]
  v_mfma_f32_16x16x32_bf16 v[56:59], a[144:147], v[4:7], v[56:59]
  v_mfma_f32_16x16x32_bf16 v[60:63], a[208:211], v[4:7], v[60:63]
  ds_read_b128 v[4:7], v2 offset:57344
  s_waitcnt lgkmcnt(3)
  v_mfma_f32_16x16x32_bf16 v[40:43], a[20:23], v[8:11], v[40:43]
  v_mfma_f32_16x16x32_bf16 v[44:47], a[84:87], v[8:11], v[44:47]
  v_mfma_f32_16x16x32_bf16 v[56:59], a[148:151], v[8:11], v[56:59]
  v_mfma_f32_16x16x32_bf16 v[60:63], a[212:215], v[8:11], v[60:63]
  ds_read_b128 v[8:11], v2 offset:58368
  s_waitcnt lgkmcnt(3)
  v_mfma_f32_16x16x32_bf16 v[40:43], a[24:27], v[12:15], v[40:43]
  v_mfma_f32_16x16x32_bf16 v[44:47], a[88:91], v[12:15], v[44:47]
  v_mfma_f32_16x16x32_bf16 v[56:59], a[152:155], v[12:15], v[56:59]
  v_mfma_f32_16x16x32_bf16 v[60:63], a[216:219], v[12:15], v[60:63]
  ds_read_b128 v[12:15], v2 offset:59392
  s_waitcnt lgkmcnt(3)
  v_mfma_f32_16x16x32_bf16 v[40:43], a[28:31], v[16:19], v[40:43]
  v_mfma_f32_16x16x32_bf16 v[44:47], a[92:95], v[16:19], v[44:47]
  v_mfma_f32_16x16x32_bf16 v[56:59], a[156:159], v[16:19], v[56:59]
  v_mfma_f32_16x16x32_bf16 v[60:63], a[220:223], v[16:19], v[60:63]
  ds_read_b128 v[16:19], v2 offset:60416
  s_waitcnt lgkmcnt(3)
  v_mfma_f32_16x16x32_bf16 v[40:43], a[32:35], v[4:7], v[40:43]
  v_mfma_f32_16x16x32_bf16 v[44:47], a[96:99], v[4:7], v[44:47]
  v_mfma_f32_16x16x32_bf16 v[56:59], a[160:163], v[4:7], v[56:59]
  v_mfma_f32_16x16x32_bf16 v[60:63], a[224:227], v[4:7], v[60:63]
  ds_read_b128 v[4:7], v2 offset:61440
  s_waitcnt lgkmcnt(3)
  v_mfma_f32_16x16x32_bf16 v[40:43], a[36:39], v[8:11], v[40:43]
  v_mfma_f32_16x16x32_bf16 v[44:47], a[100:103], v[8:11], v[44:47]
  v_mfma_f32_16x16x32_bf16 v[56:59], a[164:167], v[8:11], v[56:59]
  v_mfma_f32_16x16x32_bf16 v[60:63], a[228:231], v[8:11], v[60:63]
  ds_read_b128 v[8:11], v2 offset:62464
  s_waitcnt lgkmcnt(3)
  v_mfma_f32_16x16x32_bf16 v[40:43], a[40:43], v[12:15], v[40:43]
  v_mfma_f32_16x16x32_bf16 v[44:47], a[104:107], v[12:15], v[44:47]
  v_mfma_f32_16x16x32_bf16 v[56:59], a[168:171], v[12:15], v[56:59]
  v_mfma_f32_16x16x32_bf16 v[60:63], a[232:235], v[12:15], v[60:63]
  ds_read_b128 v[12:15], v2 offset:63488
  s_waitcnt lgkmcnt(3)
  v_mfma_f32_16x16x32_bf16 v[40:43], a[44:47], v[16:19], v[40:43]
  v_mfma_f32_16x16x32_bf16 v[44:47], a[108:111], v[16:19], v[44:47]
  v_mfma_f32_16x16x32_bf16 v[56:59], a[172:175], v[16:19], v[56:59]
  v_mfma_f32_16x16x32_bf16 v[60:63], a[236:239], v[16:19], v[60:63]
  ds_read_b128 v[16:19], v2 offset:64512
  s_waitcnt lgkmcnt(3)
  v_mfma_f32_16x16x32_bf16 v[40:43], a[48:51], v[4:7], v[40:43]
  v_mfma_f32_16x16x32_bf16 v[44:47], a[112:115], v[4:7], v[44:47]
  v_mfma_f32_16x16x32_bf16 v[56:59], a[176:179], v[4:7], v[56:59]
  v_mfma_f32_16x16x32_bf16 v[60:63], a[240:243], v[4:7], v[60:63]
  s_waitcnt lgkmcnt(2)
  v_mfma_f32_16x16x32_bf16 v[40:43], a[52:55], v[8:11], v[40:43]
  v_mfma_f32_16x16x32_bf16 v[44:47], a[116:119], v[8:11], v[44:47]
  v_mfma_f32_16x16x32_bf16 v[56:59], a[180:183], v[8:11], v[56:59]
  v_mfma_f32_16x16x32_bf16 v[60:63], a[244:247], v[8:11], v[60:63]
  s_waitcnt lgkmcnt(1)
  v_mfma_f32_16x16x32_bf16 v[40:43], a[56:59], v[12:15], v[40:43]
  v_mfma_f32_16x16x32_bf16 v[44:47], a[120:123], v[12:15], v[44:47]
  v_mfma_f32_16x16x32_bf16 v[56:59], a[184:187], v[12:15], v[56:59]
  v_mfma_f32_16x16x32_bf16 v[60:63], a[248:251], v[12:15], v[60:63]
  s_waitcnt lgkmcnt(0)
  v_mfma_f32_16x16x32_bf16 v[40:43], a[60:63], v[16:19], v[40:43]
  v_mfma_f32_16x16x32_bf16 v[44:47], a[124:127], v[16:19], v[44:47]
  v_mfma_f32_16x16x32_bf16 v[56:59], a[188:191], v[16:19], v[56:59]
  v_mfma_f32_16x16x32_bf16 v[60:63], a[252:255], v[16:19], v[60:63]
  s_mul_i32 s36, s46, 114688
  s_lshl_b32 s37, s51, 3
  s_add_u32 s37, s37, s32
  s_lshl_b32 s37, s37, 10
  s_add_u32 s36, s36, s37
  s_add_u32 s36, s36, 50331648
  v_cvt_pk_bf16_f32 v64, v32, v33
  v_cvt_pk_bf16_f32 v65, v34, v35
  v_cvt_pk_bf16_f32 v66, v36, v37
  v_cvt_pk_bf16_f32 v67, v38, v39
  v_lshlrev_b32 v32, 16, v64
  v_and_b32 v33, 0xffff0000, v64
  v_lshlrev_b32 v34, 16, v65
  v_and_b32 v35, 0xffff0000, v65
  v_lshlrev_b32 v36, 16, v66
  v_and_b32 v37, 0xffff0000, v66
  v_lshlrev_b32 v38, 16, v67
  v_and_b32 v39, 0xffff0000, v67
  v_mul_f32 v68, s96, v32
  v_exp_f32 v68, v68
  v_mul_f32 v69, s96, v33
  v_exp_f32 v69, v69
  v_mul_f32 v70, s96, v34
  v_exp_f32 v70, v70
  v_mul_f32 v71, s96, v35
  v_exp_f32 v71, v71
  v_mul_f32 v72, s96, v36
  v_exp_f32 v72, v72
  v_mul_f32 v73, s96, v37
  v_exp_f32 v73, v73
  v_mul_f32 v74, s96, v38
  v_exp_f32 v74, v74
  v_mul_f32 v75, s96, v39
  v_exp_f32 v75, v75
  v_add_f32 v68, 1.0, v68
  v_rcp_f32 v68, v68
  v_add_f32 v69, 1.0, v69
  v_rcp_f32 v69, v69
  v_add_f32 v70, 1.0, v70
  v_rcp_f32 v70, v70
  v_add_f32 v71, 1.0, v71
  v_rcp_f32 v71, v71
  v_add_f32 v72, 1.0, v72
  v_rcp_f32 v72, v72
  v_add_f32 v73, 1.0, v73
  v_rcp_f32 v73, v73
  v_add_f32 v74, 1.0, v74
  v_rcp_f32 v74, v74
  v_add_f32 v75, 1.0, v75
  v_rcp_f32 v75, v75
  v_mul_f32 v32, v32, v68
  v_mul_f32 v33, v33, v69
  v_mul_f32 v34, v34, v70
  v_mul_f32 v35, v35, v71
  v_mul_f32 v36, v36, v72
  v_mul_f32 v37, v37, v73
  v_mul_f32 v38, v38, v74
  v_mul_f32 v39, v39, v75
  v_cvt_pk_bf16_f32 v76, v32, v33
  v_cvt_pk_bf16_f32 v77, v34, v35
  v_cvt_pk_bf16_f32 v78, v36, v37
  v_cvt_pk_bf16_f32 v79, v38, v39
  s_add_u32 s37, s36, 0
  buffer_store_dwordx4 v[76:79], v2, s[4:7], s37 offen sc1
  v_cvt_pk_bf16_f32 v64, v40, v41
  v_cvt_pk_bf16_f32 v65, v42, v43
  v_cvt_pk_bf16_f32 v66, v44, v45
  v_cvt_pk_bf16_f32 v67, v46, v47
  v_lshlrev_b32 v40, 16, v64
  v_and_b32 v41, 0xffff0000, v64
  v_lshlrev_b32 v42, 16, v65
  v_and_b32 v43, 0xffff0000, v65
  v_lshlrev_b32 v44, 16, v66
  v_and_b32 v45, 0xffff0000, v66
  v_lshlrev_b32 v46, 16, v67
  v_and_b32 v47, 0xffff0000, v67
  v_mul_f32 v68, s96, v40
  v_exp_f32 v68, v68
  v_mul_f32 v69, s96, v41
  v_exp_f32 v69, v69
  v_mul_f32 v70, s96, v42
  v_exp_f32 v70, v70
  v_mul_f32 v71, s96, v43
  v_exp_f32 v71, v71
  v_mul_f32 v72, s96, v44
  v_exp_f32 v72, v72
  v_mul_f32 v73, s96, v45
  v_exp_f32 v73, v73
  v_mul_f32 v74, s96, v46
  v_exp_f32 v74, v74
  v_mul_f32 v75, s96, v47
  v_exp_f32 v75, v75
  v_add_f32 v68, 1.0, v68
  v_rcp_f32 v68, v68
  v_add_f32 v69, 1.0, v69
  v_rcp_f32 v69, v69
  v_add_f32 v70, 1.0, v70
  v_rcp_f32 v70, v70
  v_add_f32 v71, 1.0, v71
  v_rcp_f32 v71, v71
  v_add_f32 v72, 1.0, v72
  v_rcp_f32 v72, v72
  v_add_f32 v73, 1.0, v73
  v_rcp_f32 v73, v73
  v_add_f32 v74, 1.0, v74
  v_rcp_f32 v74, v74
  v_add_f32 v75, 1.0, v75
  v_rcp_f32 v75, v75
  v_mul_f32 v40, v40, v68
  v_mul_f32 v41, v41, v69
  v_mul_f32 v42, v42, v70
  v_mul_f32 v43, v43, v71
  v_mul_f32 v44, v44, v72
  v_mul_f32 v45, v45, v73
  v_mul_f32 v46, v46, v74
  v_mul_f32 v47, v47, v75
  v_cvt_pk_bf16_f32 v80, v40, v41
  v_cvt_pk_bf16_f32 v81, v42, v43
  v_cvt_pk_bf16_f32 v82, v44, v45
  v_cvt_pk_bf16_f32 v83, v46, v47
  s_add_u32 s37, s36, 57344
  buffer_store_dwordx4 v[80:83], v2, s[4:7], s37 offen sc1
  v_cvt_pk_bf16_f32 v64, v48, v49
  v_cvt_pk_bf16_f32 v65, v50, v51
  v_cvt_pk_bf16_f32 v66, v52, v53
  v_cvt_pk_bf16_f32 v67, v54, v55
  v_lshlrev_b32 v48, 16, v64
  v_and_b32 v49, 0xffff0000, v64
  v_lshlrev_b32 v50, 16, v65
  v_and_b32 v51, 0xffff0000, v65
  v_lshlrev_b32 v52, 16, v66
  v_and_b32 v53, 0xffff0000, v66
  v_lshlrev_b32 v54, 16, v67
  v_and_b32 v55, 0xffff0000, v67
  v_mul_f32 v68, s96, v48
  v_exp_f32 v68, v68
  v_mul_f32 v69, s96, v49
  v_exp_f32 v69, v69
  v_mul_f32 v70, s96, v50
  v_exp_f32 v70, v70
  v_mul_f32 v71, s96, v51
  v_exp_f32 v71, v71
  v_mul_f32 v72, s96, v52
  v_exp_f32 v72, v72
  v_mul_f32 v73, s96, v53
  v_exp_f32 v73, v73
  v_mul_f32 v74, s96, v54
  v_exp_f32 v74, v74
  v_mul_f32 v75, s96, v55
  v_exp_f32 v75, v75
  v_add_f32 v68, 1.0, v68
  v_rcp_f32 v68, v68
  v_add_f32 v69, 1.0, v69
  v_rcp_f32 v69, v69
  v_add_f32 v70, 1.0, v70
  v_rcp_f32 v70, v70
  v_add_f32 v71, 1.0, v71
  v_rcp_f32 v71, v71
  v_add_f32 v72, 1.0, v72
  v_rcp_f32 v72, v72
  v_add_f32 v73, 1.0, v73
  v_rcp_f32 v73, v73
  v_add_f32 v74, 1.0, v74
  v_rcp_f32 v74, v74
  v_add_f32 v75, 1.0, v75
  v_rcp_f32 v75, v75
  v_mul_f32 v48, v48, v68
  v_mul_f32 v49, v49, v69
  v_mul_f32 v50, v50, v70
  v_mul_f32 v51, v51, v71
  v_mul_f32 v52, v52, v72
  v_mul_f32 v53, v53, v73
  v_mul_f32 v54, v54, v74
  v_mul_f32 v55, v55, v75
  v_cvt_pk_bf16_f32 v76, v48, v49
  v_cvt_pk_bf16_f32 v77, v50, v51
  v_cvt_pk_bf16_f32 v78, v52, v53
  v_cvt_pk_bf16_f32 v79, v54, v55
  s_add_u32 s37, s36, 4096
  buffer_store_dwordx4 v[76:79], v2, s[4:7], s37 offen sc1
  v_cvt_pk_bf16_f32 v64, v56, v57
  v_cvt_pk_bf16_f32 v65, v58, v59
  v_cvt_pk_bf16_f32 v66, v60, v61
  v_cvt_pk_bf16_f32 v67, v62, v63
  v_lshlrev_b32 v56, 16, v64
  v_and_b32 v57, 0xffff0000, v64
  v_lshlrev_b32 v58, 16, v65
  v_and_b32 v59, 0xffff0000, v65
  v_lshlrev_b32 v60, 16, v66
  v_and_b32 v61, 0xffff0000, v66
  v_lshlrev_b32 v62, 16, v67
  v_and_b32 v63, 0xffff0000, v67
  v_mul_f32 v68, s96, v56
  v_exp_f32 v68, v68
  v_mul_f32 v69, s96, v57
  v_exp_f32 v69, v69
  v_mul_f32 v70, s96, v58
  v_exp_f32 v70, v70
  v_mul_f32 v71, s96, v59
  v_exp_f32 v71, v71
  v_mul_f32 v72, s96, v60
  v_exp_f32 v72, v72
  v_mul_f32 v73, s96, v61
  v_exp_f32 v73, v73
  v_mul_f32 v74, s96, v62
  v_exp_f32 v74, v74
  v_mul_f32 v75, s96, v63
  v_exp_f32 v75, v75
  v_add_f32 v68, 1.0, v68
  v_rcp_f32 v68, v68
  v_add_f32 v69, 1.0, v69
  v_rcp_f32 v69, v69
  v_add_f32 v70, 1.0, v70
  v_rcp_f32 v70, v70
  v_add_f32 v71, 1.0, v71
  v_rcp_f32 v71, v71
  v_add_f32 v72, 1.0, v72
  v_rcp_f32 v72, v72
  v_add_f32 v73, 1.0, v73
  v_rcp_f32 v73, v73
  v_add_f32 v74, 1.0, v74
  v_rcp_f32 v74, v74
  v_add_f32 v75, 1.0, v75
  v_rcp_f32 v75, v75
  v_mul_f32 v56, v56, v68
  v_mul_f32 v57, v57, v69
  v_mul_f32 v58, v58, v70
  v_mul_f32 v59, v59, v71
  v_mul_f32 v60, v60, v72
  v_mul_f32 v61, v61, v73
  v_mul_f32 v62, v62, v74
  v_mul_f32 v63, v63, v75
  v_cvt_pk_bf16_f32 v80, v56, v57
  v_cvt_pk_bf16_f32 v81, v58, v59
  v_cvt_pk_bf16_f32 v82, v60, v61
  v_cvt_pk_bf16_f32 v83, v62, v63
  s_add_u32 s37, s36, 61440
  buffer_store_dwordx4 v[80:83], v2, s[4:7], s37 offen sc1
  s_lshl_b32 s48, s46, 5
  s_add_u32 s48, s48, s51
  s_lshl_b32 s48, s48, 2
  s_add_u32 s48, s48, 87062784
  s_mov_b32 s46, s47
  s_cmp_ge_u32 s46, 64
  s_cbranch_scc1 K1_R2a_LAST
  s_branch K1_R2a_L0
K1_R2a_LAST:
  s_waitcnt vmcnt(0)
  s_barrier
  s_cmp_eq_u32 s48, 0
  s_cbranch_scc1 PF29
  s_cmp_lg_u32 s48, s43
  s_cbranch_scc1 PG29
  s_mov_b32 s28, s88
  s_and_b32 s29, s89, 0xffff
  s_mov_b32 s30, 0x100
  s_mov_b32 s31, 0x20000
  v_and_b32 v124, 31, v0
  v_lshlrev_b32 v124, 2, v124
  s_mov_b32 s3, 0x100000
  s_nop 0
WI30:
  buffer_load_dword v125, v124, s[28:31], 0 offen sc1
  s_sub_u32 s3, s3, 1
  s_cbranch_scc1 K1_END
  s_waitcnt vmcnt(0)
  v_cmp_eq_u32 vcc, 0, v125
  s_nop 3
  s_cbranch_vccnz WI30
PG29:
  s_cmp_lg_u32 s32, 0
  s_cbranch_scc1 SF31
  v_mov_b32 v124, 0
  v_mov_b32 v125, 1
  s_mov_b64 exec, 1
  buffer_store_dword v125, v124, s[4:7], s48 offen sc1
  s_mov_b64 exec, -1
SF31:
PF29:
K1_R2a_DONE:
  s_branch K1_R2a_FIN
K1_R2a_GATE:
  s_mov_b32 s12, s84
  s_and_b32 s13, s85, 0xffff
  s_mov_b32 s14, 0x400
  s_mov_b32 s15, 0x20000
  s_sub_u32 s50, s45, 91
  s_lshl_b32 s50, s50, 2
  s_add_u32 s50, s50, s32
  v_and_b32 v1, 15, v0
  v_lshlrev_b32 v1, 4, v1
  v_lshrrev_b32 v2, 4, v0
  v_lshl_add_u32 v3, v2, 10, v1
  buffer_load_dwordx4 v[4:7], v1, s[12:15], 0 offen offset:0
  buffer_load_dwordx4 v[8:11], v1, s[12:15], 0 offen offset:256
  buffer_load_dwordx4 v[12:15], v1, s[12:15], 0 offen offset:512
  buffer_load_dwordx4 v[16:19], v1, s[12:15], 0 offen offset:768
  v_mov_b32 v52, 0x3f803f80
  s_mov_b32 s96, 0xbfb8aa3b
  s_waitcnt vmcnt(0)
  v_lshlrev_b32 v20, 16, v4
  v_and_b32 v21, 0xffff0000, v4
  v_lshlrev_b32 v22, 16, v5
  v_and_b32 v23, 0xffff0000, v5
  v_lshlrev_b32 v24, 16, v6
  v_and_b32 v25, 0xffff0000, v6
  v_lshlrev_b32 v26, 16, v7
  v_and_b32 v27, 0xffff0000, v7
  v_lshlrev_b32 v28, 16, v8
  v_and_b32 v29, 0xffff0000, v8
  v_lshlrev_b32 v30, 16, v9
  v_and_b32 v31, 0xffff0000, v9
  v_lshlrev_b32 v32, 16, v10
  v_and_b32 v33, 0xffff0000, v10
  v_lshlrev_b32 v34, 16, v11
  v_and_b32 v35, 0xffff0000, v11
  v_lshlrev_b32 v36, 16, v12
  v_and_b32 v37, 0xffff0000, v12
  v_lshlrev_b32 v38, 16, v13
  v_and_b32 v39, 0xffff0000, v13
  v_lshlrev_b32 v40, 16, v14
  v_and_b32 v41, 0xffff0000, v14
  v_lshlrev_b32 v42, 16, v15
  v_and_b32 v43, 0xffff0000, v15
  v_lshlrev_b32 v44, 16, v16
  v_and_b32 v45, 0xffff0000, v16
  v_lshlrev_b32 v46, 16, v17
  v_and_b32 v47, 0xffff0000, v17
  v_lshlrev_b32 v48, 16, v18
  v_and_b32 v49, 0xffff0000, v18
  v_lshlrev_b32 v50, 16, v19
  v_and_b32 v51, 0xffff0000, v19
  v_and_b32 v53, 15, v0
  v_cmp_eq_u32 s[54:55], 0, v53
  s_nop 4
K1_R2a_GL:
  s_lshl_b32 s51, s50, 12
  buffer_load_dwordx4 v[4:7], v3, s[24:27], s51 offen offset:0
  buffer_load_dwordx4 v[8:11], v3, s[24:27], s51 offen offset:256
  buffer_load_dwordx4 v[12:15], v3, s[24:27], s51 offen offset:512
  buffer_load_dwordx4 v[16:19], v3, s[24:27], s51 offen offset:768
  v_mov_b32 v54, 0
  s_waitcnt vmcnt(0)
  v_lshlrev_b32 v55, 16, v4
  v_and_b32 v56, 0xffff0000, v4
  v_mul_f32 v55, v55, v20
  v_mul_f32 v56, v56, v21
  v_cvt_pk_bf16_f32 v55, v55, v56
  v_lshlrev_b32 v56, 16, v55
  v_and_b32 v55, 0xffff0000, v55
  v_add_f32 v54, v54, v56
  v_add_f32 v54, v54, v55
  v_lshlrev_b32 v55, 16, v5
  v_and_b32 v56, 0xffff0000, v5
  v_mul_f32 v55, v55, v22
  v_mul_f32 v56, v56, v23
  v_cvt_pk_bf16_f32 v55, v55, v56
  v_lshlrev_b32 v56, 16, v55
  v_and_b32 v55, 0xffff0000, v55
  v_add_f32 v54, v54, v56
  v_add_f32 v54, v54, v55
  v_lshlrev_b32 v55, 16, v6
  v_and_b32 v56, 0xffff0000, v6
  v_mul_f32 v55, v55, v24
  v_mul_f32 v56, v56, v25
  v_cvt_pk_bf16_f32 v55, v55, v56
  v_lshlrev_b32 v56, 16, v55
  v_and_b32 v55, 0xffff0000, v55
  v_add_f32 v54, v54, v56
  v_add_f32 v54, v54, v55
  v_lshlrev_b32 v55, 16, v7
  v_and_b32 v56, 0xffff0000, v7
  v_mul_f32 v55, v55, v26
  v_mul_f32 v56, v56, v27
  v_cvt_pk_bf16_f32 v55, v55, v56
  v_lshlrev_b32 v56, 16, v55
  v_and_b32 v55, 0xffff0000, v55
  v_add_f32 v54, v54, v56
  v_add_f32 v54, v54, v55
  v_lshlrev_b32 v55, 16, v8
  v_and_b32 v56, 0xffff0000, v8
  v_mul_f32 v55, v55, v28
  v_mul_f32 v56, v56, v29
  v_cvt_pk_bf16_f32 v55, v55, v56
  v_lshlrev_b32 v56, 16, v55
  v_and_b32 v55, 0xffff0000, v55
  v_add_f32 v54, v54, v56
  v_add_f32 v54, v54, v55
  v_lshlrev_b32 v55, 16, v9
  v_and_b32 v56, 0xffff0000, v9
  v_mul_f32 v55, v55, v30
  v_mul_f32 v56, v56, v31
  v_cvt_pk_bf16_f32 v55, v55, v56
  v_lshlrev_b32 v56, 16, v55
  v_and_b32 v55, 0xffff0000, v55
  v_add_f32 v54, v54, v56
  v_add_f32 v54, v54, v55
  v_lshlrev_b32 v55, 16, v10
  v_and_b32 v56, 0xffff0000, v10
  v_mul_f32 v55, v55, v32
  v_mul_f32 v56, v56, v33
  v_cvt_pk_bf16_f32 v55, v55, v56
  v_lshlrev_b32 v56, 16, v55
  v_and_b32 v55, 0xffff0000, v55
  v_add_f32 v54, v54, v56
  v_add_f32 v54, v54, v55
  v_lshlrev_b32 v55, 16, v11
  v_and_b32 v56, 0xffff0000, v11
  v_mul_f32 v55, v55, v34
  v_mul_f32 v56, v56, v35
  v_cvt_pk_bf16_f32 v55, v55, v56
  v_lshlrev_b32 v56, 16, v55
  v_and_b32 v55, 0xffff0000, v55
  v_add_f32 v54, v54, v56
  v_add_f32 v54, v54, v55
  v_lshlrev_b32 v55, 16, v12
  v_and_b32 v56, 0xffff0000, v12
  v_mul_f32 v55, v55, v36
  v_mul_f32 v56, v56, v37
  v_cvt_pk_bf16_f32 v55, v55, v56
  v_lshlrev_b32 v56, 16, v55
  v_and_b32 v55, 0xffff0000, v55
  v_add_f32 v54, v54, v56
  v_add_f32 v54, v54, v55
  v_lshlrev_b32 v55, 16, v13
  v_and_b32 v56, 0xffff0000, v13
  v_mul_f32 v55, v55, v38
  v_mul_f32 v56, v56, v39
  v_cvt_pk_bf16_f32 v55, v55, v56
  v_lshlrev_b32 v56, 16, v55
  v_and_b32 v55, 0xffff0000, v55
  v_add_f32 v54, v54, v56
  v_add_f32 v54, v54, v55
  v_lshlrev_b32 v55, 16, v14
  v_and_b32 v56, 0xffff0000, v14
  v_mul_f32 v55, v55, v40
  v_mul_f32 v56, v56, v41
  v_cvt_pk_bf16_f32 v55, v55, v56
  v_lshlrev_b32 v56, 16, v55
  v_and_b32 v55, 0xffff0000, v55
  v_add_f32 v54, v54, v56
  v_add_f32 v54, v54, v55
  v_lshlrev_b32 v55, 16, v15
  v_and_b32 v56, 0xffff0000, v15
  v_mul_f32 v55, v55, v42
  v_mul_f32 v56, v56, v43
  v_cvt_pk_bf16_f32 v55, v55, v56
  v_lshlrev_b32 v56, 16, v55
  v_and_b32 v55, 0xffff0000, v55
  v_add_f32 v54, v54, v56
  v_add_f32 v54, v54, v55
  v_lshlrev_b32 v55, 16, v16
  v_and_b32 v56, 0xffff0000, v16
  v_mul_f32 v55, v55, v44
  v_mul_f32 v56, v56, v45
  v_cvt_pk_bf16_f32 v55, v55, v56
  v_lshlrev_b32 v56, 16, v55
  v_and_b32 v55, 0xffff0000, v55
  v_add_f32 v54, v54, v56
  v_add_f32 v54, v54, v55
  v_lshlrev_b32 v55, 16, v17
  v_and_b32 v56, 0xffff0000, v17
  v_mul_f32 v55, v55, v46
  v_mul_f32 v56, v56, v47
  v_cvt_pk_bf16_f32 v55, v55, v56
  v_lshlrev_b32 v56, 16, v55
  v_and_b32 v55, 0xffff0000, v55
  v_add_f32 v54, v54, v56
  v_add_f32 v54, v54, v55
  v_lshlrev_b32 v55, 16, v18
  v_and_b32 v56, 0xffff0000, v18
  v_mul_f32 v55, v55, v48
  v_mul_f32 v56, v56, v49
  v_cvt_pk_bf16_f32 v55, v55, v56
  v_lshlrev_b32 v56, 16, v55
  v_and_b32 v55, 0xffff0000, v55
  v_add_f32 v54, v54, v56
  v_add_f32 v54, v54, v55
  v_lshlrev_b32 v55, 16, v19
  v_and_b32 v56, 0xffff0000, v19
  v_mul_f32 v55, v55, v50
  v_mul_f32 v56, v56, v51
  v_cvt_pk_bf16_f32 v55, v55, v56
  v_lshlrev_b32 v56, 16, v55
  v_and_b32 v55, 0xffff0000, v55
  v_add_f32 v54, v54, v56
  v_add_f32 v54, v54, v55
  s_nop 1
  v_add_f32_dpp v54, v54, v54 row_ror:8 row_mask:0xf bank_mask:0xf
  s_nop 1
  v_add_f32_dpp v54, v54, v54 row_ror:4 row_mask:0xf bank_mask:0xf
  s_nop 1
  v_add_f32_dpp v54, v54, v54 row_ror:2 row_mask:0xf bank_mask:0xf
  s_nop 1
  v_add_f32_dpp v54, v54, v54 row_ror:1 row_mask:0xf bank_mask:0xf
  v_cvt_pk_bf16_f32 v54, v54, v54
  v_and_b32 v54, 0xffff0000, v54
  v_mul_f32 v54, s96, v54
  v_exp_f32 v54, v54
  s_nop 0
  v_add_f32 v54, 1.0, v54
  v_rcp_f32 v54, v54
  s_nop 0
  v_cvt_pk_bf16_f32 v54, v54, v54
  v_and_b32 v54, 0xffff0000, v54
  s_lshl_b32 s51, s50, 4
  s_add_u32 s51, s51, 60817408
  v_lshlrev_b32 v55, 2, v2
  s_mov_b64 exec, s[54:55]
  buffer_store_dword v54, v55, s[4:7], s51 offen sc1
  s_mov_b64 exec, -1
  s_add_u32 s50, s50, 20
  s_cmp_lt_u32 s50, 512
  s_cbranch_scc1 K1_R2a_GL
  s_mov_b32 s28, s88
  s_and_b32 s29, s89, 0xffff
  s_mov_b32 s30, 0x100
  s_mov_b32 s31, 0x20000
  v_and_b32 v124, 31, v0
  v_lshlrev_b32 v124, 2, v124
  s_mov_b32 s3, 0x100000
  s_nop 0
WI32:
  buffer_load_dword v125, v124, s[28:31], 0 offen sc1
  s_sub_u32 s3, s3, 1
  s_cbranch_scc1 K1_END
  s_waitcnt vmcnt(0)
  v_cmp_eq_u32 vcc, 0, v125
  s_nop 3
  s_cbranch_vccnz WI32
  s_waitcnt vmcnt(0)
  s_barrier
  s_sub_u32 s50, s45, 91
  s_lshl_b32 s50, s50, 2
  s_add_u32 s50, s50, 87083264
  s_cmp_lg_u32 s32, 0
  s_cbranch_scc1 SF33
  v_mov_b32 v124, 0
  v_mov_b32 v125, 1
  s_mov_b64 exec, 1
  buffer_store_dword v125, v124, s[4:7], s50 offen sc1
  s_mov_b64 exec, -1
SF33:
K1_R2a_FIN:
  s_sub_u32 s36, s34, 5
  s_lshl_b32 s36, s36, 5
  s_add_u32 s45, s36, s35
  s_mov_b32 s8, s82
  s_and_b32 s9, s83, 0xffff
  s_mov_b32 s10, 0x1c0000
  s_mov_b32 s11, 0x20000
  s_mov_b32 s28, s86
  s_and_b32 s29, s87, 0xffff
  s_mov_b32 s30, 0x200000
  s_mov_b32 s31, 0x20000
  s_and_b32 s51, s45, 7
  s_lshr_b32 s50, s45, 3
  s_bfe_u32 s56, s45, 0x10004
  s_mul_i32 s49, s32, 458752
  s_mul_i32 s36, s51, 128
  s_add_u32 s49, s49, s36
  v_lshrrev_b32 v104, 3, v0
  v_bfe_u32 v102, v0, 1, 2
  v_bfe_u32 v103, v104, 1, 2
  v_xor_b32 v102, v102, v103
  v_lshlrev_b32 v102, 5, v102
  v_and_b32 v103, 1, v0
  v_lshl_add_u32 v102, v103, 4, v102
  v_lshl_add_u32 v100, v104, 10, v102
  v_lshrrev_b32 v104, 4, v0
  v_bfe_u32 v105, v0, 2, 2
  v_and_b32 v106, 3, v0
  v_lshl_add_u32 v102, v104, 2, v105
  v_bfe_u32 v103, v102, 1, 2
  v_lshlrev_b32 v103, 5, v103
  v_lshl_add_u32 v103, v106, 3, v103
  s_mov_b32 s36, 128
  v_mad_u32_u24 v101, v102, s36, v103
  s_mul_i32 s44, s32, 40960
  v_add_u32 v101, s44, v101
  s_add_u32 s36, s44, 0
  s_mov_b32 m0, s36
  s_add_u32 s37, s49, 0
  buffer_load_dwordx4 v100, s[8:11], s37 offen lds
  s_add_u32 s36, s44, 1024
  s_mov_b32 m0, s36
  s_add_u32 s37, s49, 8192
  buffer_load_dwordx4 v100, s[8:11], s37 offen lds
  s_add_u32 s36, s44, 2048
  s_mov_b32 m0, s36
  s_add_u32 s37, s49, 16384
  buffer_load_dwordx4 v100, s[8:11], s37 offen lds
  s_add_u32 s36, s44, 3072
  s_mov_b32 m0, s36
  s_add_u32 s37, s49, 24576
  buffer_load_dwordx4 v100, s[8:11], s37 offen lds
  s_add_u32 s36, s44, 4096
  s_mov_b32 m0, s36
  s_add_u32 s37, s49, 32768
  buffer_load_dwordx4 v100, s[8:11], s37 offen lds
  s_add_u32 s36, s44, 5120
  s_mov_b32 m0, s36
  s_add_u32 s37, s49, 40960
  buffer_load_dwordx4 v100, s[8:11], s37 offen lds
  s_add_u32 s36, s44, 6144
  s_mov_b32 m0, s36
  s_add_u32 s37, s49, 49152
  buffer_load_dwordx4 v100, s[8:11], s37 offen lds
  s_add_u32 s36, s44, 7168
  s_mov_b32 m0, s36
  s_add_u32 s37, s49, 57344
  buffer_load_dwordx4 v100, s[8:11], s37 offen lds
  s_add_u32 s36, s44, 8192
  s_mov_b32 m0, s36
  s_add_u32 s37, s49, 65536
  buffer_load_dwordx4 v100, s[8:11], s37 offen lds
  s_add_u32 s36, s44, 9216
  s_mov_b32 m0, s36
  s_add_u32 s37, s49, 73728
  buffer_load_dwordx4 v100, s[8:11], s37 offen lds
  s_add_u32 s36, s44, 10240
  s_mov_b32 m0, s36
  s_add_u32 s37, s49, 81920
  buffer_load_dwordx4 v100, s[8:11], s37 offen lds
  s_add_u32 s36, s44, 11264
  s_mov_b32 m0, s36
  s_add_u32 s37, s49, 90112
  buffer_load_dwordx4 v100, s[8:11], s37 offen lds
  s_add_u32 s36, s44, 12288
  s_mov_b32 m0, s36
  s_add_u32 s37, s49, 98304
  buffer_load_dwordx4 v100, s[8:11], s37 offen lds
  s_add_u32 s36, s44, 13312
  s_mov_b32 m0, s36
  s_add_u32 s37, s49, 106496
  buffer_load_dwordx4 v100, s[8:11], s37 offen lds
  s_add_u32 s36, s44, 14336
  s_mov_b32 m0, s36
  s_add_u32 s37, s49, 114688
  buffer_load_dwordx4 v100, s[8:11], s37 offen lds
  s_add_u32 s36, s44, 15360
  s_mov_b32 m0, s36
  s_add_u32 s37, s49, 122880
  buffer_load_dwordx4 v100, s[8:11], s37 offen lds
  s_add_u32 s36, s44, 16384
  s_mov_b32 m0, s36
  s_add_u32 s37, s49, 131072
  buffer_load_dwordx4 v100, s[8:11], s37 offen lds
  s_add_u32 s36, s44, 17408
  s_mov_b32 m0, s36
  s_add_u32 s37, s49, 139264
  buffer_load_dwordx4 v100, s[8:11], s37 offen lds
  s_add_u32 s36, s44, 18432
  s_mov_b32 m0, s36
  s_add_u32 s37, s49, 147456
  buffer_load_dwordx4 v100, s[8:11], s37 offen lds
  s_add_u32 s36, s44, 19456
  s_mov_b32 m0, s36
  s_add_u32 s37, s49, 155648
  buffer_load_dwordx4 v100, s[8:11], s37 offen lds
  s_add_u32 s36, s44, 20480
  s_mov_b32 m0, s36
  s_add_u32 s37, s49, 163840
  buffer_load_dwordx4 v100, s[8:11], s37 offen lds
  s_add_u32 s36, s44, 21504
  s_mov_b32 m0, s36
  s_add_u32 s37, s49, 172032
  buffer_load_dwordx4 v100, s[8:11], s37 offen lds
  s_add_u32 s36, s44, 22528
  s_mov_b32 m0, s36
  s_add_u32 s37, s49, 180224
  buffer_load_dwordx4 v100, s[8:11], s37 offen lds
  s_add_u32 s36, s44, 23552
  s_mov_b32 m0, s36
  s_add_u32 s37, s49, 188416
  buffer_load_dwordx4 v100, s[8:11], s37 offen lds
  s_add_u32 s36, s44, 24576
  s_mov_b32 m0, s36
  s_add_u32 s37, s49, 196608
  buffer_load_dwordx4 v100, s[8:11], s37 offen lds
  s_add_u32 s36, s44, 25600
  s_mov_b32 m0, s36
  s_add_u32 s37, s49, 204800
  buffer_load_dwordx4 v100, s[8:11], s37 offen lds
  s_add_u32 s36, s44, 26624
  s_mov_b32 m0, s36
  s_add_u32 s37, s49, 212992
  buffer_load_dwordx4 v100, s[8:11], s37 offen lds
  s_add_u32 s36, s44, 27648
  s_mov_b32 m0, s36
  s_add_u32 s37, s49, 221184
  buffer_load_dwordx4 v100, s[8:11], s37 offen lds
  s_add_u32 s36, s44, 28672
  s_mov_b32 m0, s36
  s_add_u32 s37, s49, 229376
  buffer_load_dwordx4 v100, s[8:11], s37 offen lds
  s_add_u32 s36, s44, 29696
  s_mov_b32 m0, s36
  s_add_u32 s37, s49, 237568
  buffer_load_dwordx4 v100, s[8:11], s37 offen lds
  s_add_u32 s36, s44, 30720
  s_mov_b32 m0, s36
  s_add_u32 s37, s49, 245760
  buffer_load_dwordx4 v100, s[8:11], s37 offen lds
  s_add_u32 s36, s44, 31744
  s_mov_b32 m0, s36
  s_add_u32 s37, s49, 253952
  buffer_load_dwordx4 v100, s[8:11], s37 offen lds
  s_waitcnt vmcnt(0)
  v_xor_b32 v102, 0, v101
  ds_read_b64_tr_b16 a[0:1], v102 offset:0
  ds_read_b64_tr_b16 a[2:3], v102 offset:2048
  ds_read_b64_tr_b16 a[16:17], v102 offset:4096
  ds_read_b64_tr_b16 a[18:19], v102 offset:6144
  ds_read_b64_tr_b16 a[32:33], v102 offset:8192
  ds_read_b64_tr_b16 a[34:35], v102 offset:10240
  ds_read_b64_tr_b16 a[48:49], v102 offset:12288
  ds_read_b64_tr_b16 a[50:51], v102 offset:14336
  s_waitcnt lgkmcnt(0)
  ds_read_b64_tr_b16 a[64:65], v102 offset:16384
  ds_read_b64_tr_b16 a[66:67], v102 offset:18432
  ds_read_b64_tr_b16 a[80:81], v102 offset:20480
  ds_read_b64_tr_b16 a[82:83], v102 offset:22528
  ds_read_b64_tr_b16 a[96:97], v102 offset:24576
  ds_read_b64_tr_b16 a[98:99], v102 offset:26624
  ds_read_b64_tr_b16 a[112:113], v102 offset:28672
  ds_read_b64_tr_b16 a[114:115], v102 offset:30720
  s_waitcnt lgkmcnt(0)
  s_waitcnt lgkmcnt(0)
  v_xor_b32 v102, 32, v101
  ds_read_b64_tr_b16 a[4:5], v102 offset:0
  ds_read_b64_tr_b16 a[6:7], v102 offset:2048
  ds_read_b64_tr_b16 a[20:21], v102 offset:4096
  ds_read_b64_tr_b16 a[22:23], v102 offset:6144
  ds_read_b64_tr_b16 a[36:37], v102 offset:8192
  ds_read_b64_tr_b16 a[38:39], v102 offset:10240
  ds_read_b64_tr_b16 a[52:53], v102 offset:12288
  ds_read_b64_tr_b16 a[54:55], v102 offset:14336
  s_waitcnt lgkmcnt(0)
  ds_read_b64_tr_b16 a[68:69], v102 offset:16384
  ds_read_b64_tr_b16 a[70:71], v102 offset:18432
  ds_read_b64_tr_b16 a[84:85], v102 offset:20480
  ds_read_b64_tr_b16 a[86:87], v102 offset:22528
  ds_read_b64_tr_b16 a[100:101], v102 offset:24576
  ds_read_b64_tr_b16 a[102:103], v102 offset:26624
  ds_read_b64_tr_b16 a[116:117], v102 offset:28672
  ds_read_b64_tr_b16 a[118:119], v102 offset:30720
  s_waitcnt lgkmcnt(0)
  s_waitcnt lgkmcnt(0)
  v_xor_b32 v102, 64, v101
  ds_read_b64_tr_b16 a[8:9], v102 offset:0
  ds_read_b64_tr_b16 a[10:11], v102 offset:2048
  ds_read_b64_tr_b16 a[24:25], v102 offset:4096
  ds_read_b64_tr_b16 a[26:27], v102 offset:6144
  ds_read_b64_tr_b16 a[40:41], v102 offset:8192
  ds_read_b64_tr_b16 a[42:43], v102 offset:10240
  ds_read_b64_tr_b16 a[56:57], v102 offset:12288
  ds_read_b64_tr_b16 a[58:59], v102 offset:14336
  s_waitcnt lgkmcnt(0)
  ds_read_b64_tr_b16 a[72:73], v102 offset:16384
  ds_read_b64_tr_b16 a[74:75], v102 offset:18432
  ds_read_b64_tr_b16 a[88:89], v102 offset:20480
  ds_read_b64_tr_b16 a[90:91], v102 offset:22528
  ds_read_b64_tr_b16 a[104:105], v102 offset:24576
  ds_read_b64_tr_b16 a[106:107], v102 offset:26624
  ds_read_b64_tr_b16 a[120:121], v102 offset:28672
  ds_read_b64_tr_b16 a[122:123], v102 offset:30720
  s_waitcnt lgkmcnt(0)
  s_waitcnt lgkmcnt(0)
  v_xor_b32 v102, 96, v101
  ds_read_b64_tr_b16 a[12:13], v102 offset:0
  ds_read_b64_tr_b16 a[14:15], v102 offset:2048
  ds_read_b64_tr_b16 a[28:29], v102 offset:4096
  ds_read_b64_tr_b16 a[30:31], v102 offset:6144
  ds_read_b64_tr_b16 a[44:45], v102 offset:8192
  ds_read_b64_tr_b16 a[46:47], v102 offset:10240
  ds_read_b64_tr_b16 a[60:61], v102 offset:12288
  ds_read_b64_tr_b16 a[62:63], v102 offset:14336
  s_waitcnt lgkmcnt(0)
  ds_read_b64_tr_b16 a[76:77], v102 offset:16384
  ds_read_b64_tr_b16 a[78:79], v102 offset:18432
  ds_read_b64_tr_b16 a[92:93], v102 offset:20480
  ds_read_b64_tr_b16 a[94:95], v102 offset:22528
  ds_read_b64_tr_b16 a[108:109], v102 offset:24576
  ds_read_b64_tr_b16 a[110:111], v102 offset:26624
  ds_read_b64_tr_b16 a[124:125], v102 offset:28672
  ds_read_b64_tr_b16 a[126:127], v102 offset:30720
  s_waitcnt lgkmcnt(0)
  s_waitcnt lgkmcnt(0)
  s_add_u32 s36, s44, 0
  s_mov_b32 m0, s36
  s_add_u32 s37, s49, 262144
  buffer_load_dwordx4 v100, s[8:11], s37 offen lds
  s_add_u32 s36, s44, 1024
  s_mov_b32 m0, s36
  s_add_u32 s37, s49, 270336
  buffer_load_dwordx4 v100, s[8:11], s37 offen lds
  s_add_u32 s36, s44, 2048
  s_mov_b32 m0, s36
  s_add_u32 s37, s49, 278528
  buffer_load_dwordx4 v100, s[8:11], s37 offen lds
  s_add_u32 s36, s44, 3072
  s_mov_b32 m0, s36
  s_add_u32 s37, s49, 286720
  buffer_load_dwordx4 v100, s[8:11], s37 offen lds
  s_add_u32 s36, s44, 4096
  s_mov_b32 m0, s36
  s_add_u32 s37, s49, 294912
  buffer_load_dwordx4 v100, s[8:11], s37 offen lds
  s_add_u32 s36, s44, 5120
  s_mov_b32 m0, s36
  s_add_u32 s37, s49, 303104
  buffer_load_dwordx4 v100, s[8:11], s37 offen lds
  s_add_u32 s36, s44, 6144
  s_mov_b32 m0, s36
  s_add_u32 s37, s49, 311296
  buffer_load_dwordx4 v100, s[8:11], s37 offen lds
  s_add_u32 s36, s44, 7168
  s_mov_b32 m0, s36
  s_add_u32 s37, s49, 319488
  buffer_load_dwordx4 v100, s[8:11], s37 offen lds
  s_add_u32 s36, s44, 8192
  s_mov_b32 m0, s36
  s_add_u32 s37, s49, 327680
  buffer_load_dwordx4 v100, s[8:11], s37 offen lds
  s_add_u32 s36, s44, 9216
  s_mov_b32 m0, s36
  s_add_u32 s37, s49, 335872
  buffer_load_dwordx4 v100, s[8:11], s37 offen lds
  s_add_u32 s36, s44, 10240
  s_mov_b32 m0, s36
  s_add_u32 s37, s49, 344064
  buffer_load_dwordx4 v100, s[8:11], s37 offen lds
  s_add_u32 s36, s44, 11264
  s_mov_b32 m0, s36
  s_add_u32 s37, s49, 352256
  buffer_load_dwordx4 v100, s[8:11], s37 offen lds
  s_add_u32 s36, s44, 12288
  s_mov_b32 m0, s36
  s_add_u32 s37, s49, 360448
  buffer_load_dwordx4 v100, s[8:11], s37 offen lds
  s_add_u32 s36, s44, 13312
  s_mov_b32 m0, s36
  s_add_u32 s37, s49, 368640
  buffer_load_dwordx4 v100, s[8:11], s37 offen lds
  s_add_u32 s36, s44, 14336
  s_mov_b32 m0, s36
  s_add_u32 s37, s49, 376832
  buffer_load_dwordx4 v100, s[8:11], s37 offen lds
  s_add_u32 s36, s44, 15360
  s_mov_b32 m0, s36
  s_add_u32 s37, s49, 385024
  buffer_load_dwordx4 v100, s[8:11], s37 offen lds
  s_add_u32 s36, s44, 16384
  s_mov_b32 m0, s36
  s_add_u32 s37, s49, 393216
  buffer_load_dwordx4 v100, s[8:11], s37 offen lds
  s_add_u32 s36, s44, 17408
  s_mov_b32 m0, s36
  s_add_u32 s37, s49, 401408
  buffer_load_dwordx4 v100, s[8:11], s37 offen lds
  s_add_u32 s36, s44, 18432
  s_mov_b32 m0, s36
  s_add_u32 s37, s49, 409600
  buffer_load_dwordx4 v100, s[8:11], s37 offen lds
  s_add_u32 s36, s44, 19456
  s_mov_b32 m0, s36
  s_add_u32 s37, s49, 417792
  buffer_load_dwordx4 v100, s[8:11], s37 offen lds
  s_add_u32 s36, s44, 20480
  s_mov_b32 m0, s36
  s_add_u32 s37, s49, 425984
  buffer_load_dwordx4 v100, s[8:11], s37 offen lds
  s_add_u32 s36, s44, 21504
  s_mov_b32 m0, s36
  s_add_u32 s37, s49, 434176
  buffer_load_dwordx4 v100, s[8:11], s37 offen lds
  s_add_u32 s36, s44, 22528
  s_mov_b32 m0, s36
  s_add_u32 s37, s49, 442368
  buffer_load_dwordx4 v100, s[8:11], s37 offen lds
  s_add_u32 s36, s44, 23552
  s_mov_b32 m0, s36
  s_add_u32 s37, s49, 450560
  buffer_load_dwordx4 v100, s[8:11], s37 offen lds
  s_waitcnt vmcnt(0)
  v_xor_b32 v102, 0, v101
  ds_read_b64_tr_b16 a[128:129], v102 offset:0
  ds_read_b64_tr_b16 a[130:131], v102 offset:2048
  ds_read_b64_tr_b16 a[144:145], v102 offset:4096
  ds_read_b64_tr_b16 a[146:147], v102 offset:6144
  ds_read_b64_tr_b16 a[160:161], v102 offset:8192
  ds_read_b64_tr_b16 a[162:163], v102 offset:10240
  ds_read_b64_tr_b16 a[176:177], v102 offset:12288
  ds_read_b64_tr_b16 a[178:179], v102 offset:14336
  s_waitcnt lgkmcnt(0)
  ds_read_b64_tr_b16 a[192:193], v102 offset:16384
  ds_read_b64_tr_b16 a[194:195], v102 offset:18432
  ds_read_b64_tr_b16 a[208:209], v102 offset:20480
  ds_read_b64_tr_b16 a[210:211], v102 offset:22528
  s_waitcnt lgkmcnt(0)
  v_xor_b32 v102, 32, v101
  ds_read_b64_tr_b16 a[132:133], v102 offset:0
  ds_read_b64_tr_b16 a[134:135], v102 offset:2048
  ds_read_b64_tr_b16 a[148:149], v102 offset:4096
  ds_read_b64_tr_b16 a[150:151], v102 offset:6144
  ds_read_b64_tr_b16 a[164:165], v102 offset:8192
  ds_read_b64_tr_b16 a[166:167], v102 offset:10240
  ds_read_b64_tr_b16 a[180:181], v102 offset:12288
  ds_read_b64_tr_b16 a[182:183], v102 offset:14336
  s_waitcnt lgkmcnt(0)
  ds_read_b64_tr_b16 a[196:197], v102 offset:16384
  ds_read_b64_tr_b16 a[198:199], v102 offset:18432
  ds_read_b64_tr_b16 a[212:213], v102 offset:20480
  ds_read_b64_tr_b16 a[214:215], v102 offset:22528
  s_waitcnt lgkmcnt(0)
  v_xor_b32 v102, 64, v101
  ds_read_b64_tr_b16 a[136:137], v102 offset:0
  ds_read_b64_tr_b16 a[138:139], v102 offset:2048
  ds_read_b64_tr_b16 a[152:153], v102 offset:4096
  ds_read_b64_tr_b16 a[154:155], v102 offset:6144
  ds_read_b64_tr_b16 a[168:169], v102 offset:8192
  ds_read_b64_tr_b16 a[170:171], v102 offset:10240
  ds_read_b64_tr_b16 a[184:185], v102 offset:12288
  ds_read_b64_tr_b16 a[186:187], v102 offset:14336
  s_waitcnt lgkmcnt(0)
  ds_read_b64_tr_b16 a[200:201], v102 offset:16384
  ds_read_b64_tr_b16 a[202:203], v102 offset:18432
  ds_read_b64_tr_b16 a[216:217], v102 offset:20480
  ds_read_b64_tr_b16 a[218:219], v102 offset:22528
  s_waitcnt lgkmcnt(0)
  v_xor_b32 v102, 96, v101
  ds_read_b64_tr_b16 a[140:141], v102 offset:0
  ds_read_b64_tr_b16 a[142:143], v102 offset:2048
  ds_read_b64_tr_b16 a[156:157], v102 offset:4096
  ds_read_b64_tr_b16 a[158:159], v102 offset:6144
  ds_read_b64_tr_b16 a[172:173], v102 offset:8192
  ds_read_b64_tr_b16 a[174:175], v102 offset:10240
  ds_read_b64_tr_b16 a[188:189], v102 offset:12288
  ds_read_b64_tr_b16 a[190:191], v102 offset:14336
  s_waitcnt lgkmcnt(0)
  ds_read_b64_tr_b16 a[204:205], v102 offset:16384
  ds_read_b64_tr_b16 a[206:207], v102 offset:18432
  ds_read_b64_tr_b16 a[220:221], v102 offset:20480
  ds_read_b64_tr_b16 a[222:223], v102 offset:22528
  s_waitcnt lgkmcnt(0)
  s_barrier
  v_lshlrev_b32 v2, 4, v0
  s_lshl_b32 s36, s32, 13
  v_add_u32 v3, s36, v2
  v_and_b32 v1, 15, v0
  v_lshrrev_b32 v36, 4, v0
  v_lshlrev_b32 v37, 10, v1
  v_lshl_add_u32 v37, v36, 3, v37
  v_lshlrev_b32 v38, 2, v1
  s_mul_i32 s52, s32, 14336
  s_add_u32 s52, s52, 50331648
  s_mov_b32 s36, 87083264
  s_cmp_lg_u32 s32, 0
  s_cbranch_scc1 WG34
  v_min_u32 v240, 4, v0
  v_lshlrev_b32 v240, 2, v240
  s_mov_b32 s3, 0x100000
  s_branch WF35
WS35:
  s_sleep 3
WF35:
  buffer_load_dword v241, v240, s[4:7], s36 offen sc1
  s_sub_u32 s3, s3, 1
  s_cbranch_scc1 K1_END
  s_waitcnt vmcnt(0)
  v_cmp_eq_u32 vcc, 0, v241
  s_nop 3
  s_cbranch_vccnz WS35
WG34:
  s_barrier
K1_R2b_L:
  s_lshr_b32 s36, s32, 1
  s_lshl_b32 s37, s50, 1
  s_add_u32 s36, s36, s37
  s_lshl_b32 s37, s36, 6
  s_add_u32 s37, s37, 60817408
  buffer_load_dword v236, v38, s[4:7], s37 offen
  s_lshl_b32 s36, s36, 14
  s_and_b32 s37, s32, 1
  s_mul_i32 s37, s37, 64
  s_add_u32 s36, s36, s37
  s_mul_i32 s37, s51, 128
  s_add_u32 s54, s36, s37
  s_add_u32 s55, s54, 58720256
  s_lshl_b32 s36, s50, 7
  s_add_u32 s36, s36, 87062784
  s_cmp_lg_u32 s32, 0
  s_cbranch_scc1 WG36
  v_min_u32 v240, 6, v0
  v_lshlrev_b32 v240, 2, v240
  s_mov_b32 s3, 0x100000
  s_branch WF37
WS37:
  s_sleep 3
WF37:
  buffer_load_dword v241, v240, s[4:7], s36 offen sc1
  s_sub_u32 s3, s3, 1
  s_cbranch_scc1 K1_END
  s_waitcnt vmcnt(0)
  v_cmp_eq_u32 vcc, 0, v241
  s_nop 3
  s_cbranch_vccnz WS37
WG36:
  s_barrier
  s_mul_i32 s53, s50, 114688
  s_add_u32 s53, s53, s52
  s_add_u32 s36, s53, 0
  buffer_load_dwordx4 v[40:43], v2, s[4:7], s36 offen
  s_add_u32 s36, s53, 1024
  buffer_load_dwordx4 v[44:47], v2, s[4:7], s36 offen
  s_add_u32 s36, s53, 2048
  buffer_load_dwordx4 v[48:51], v2, s[4:7], s36 offen
  s_add_u32 s36, s53, 3072
  buffer_load_dwordx4 v[52:55], v2, s[4:7], s36 offen
  s_add_u32 s36, s53, 4096
  buffer_load_dwordx4 v[56:59], v2, s[4:7], s36 offen
  s_add_u32 s36, s53, 5120
  buffer_load_dwordx4 v[60:63], v2, s[4:7], s36 offen
  s_add_u32 s36, s53, 6144
  buffer_load_dwordx4 v[64:67], v2, s[4:7], s36 offen
  s_add_u32 s36, s53, 7168
  buffer_load_dwordx4 v[68:71], v2, s[4:7], s36 offen
  s_add_u32 s36, s53, 8192
  buffer_load_dwordx4 v[72:75], v2, s[4:7], s36 offen
  s_add_u32 s36, s53, 9216
  buffer_load_dwordx4 v[76:79], v2, s[4:7], s36 offen
  s_add_u32 s36, s53, 10240
  buffer_load_dwordx4 v[80:83], v2, s[4:7], s36 offen
  s_add_u32 s36, s53, 11264
  buffer_load_dwordx4 v[84:87], v2, s[4:7], s36 offen
  s_add_u32 s36, s53, 12288
  buffer_load_dwordx4 v[88:91], v2, s[4:7], s36 offen
  s_add_u32 s36, s53, 13312
  buffer_load_dwordx4 v[92:95], v2, s[4:7], s36 offen
  s_add_u32 s36, s53, 57344
  buffer_load_dwordx4 v[96:99], v2, s[4:7], s36 offen
  s_add_u32 s36, s53, 58368
  buffer_load_dwordx4 v[100:103], v2, s[4:7], s36 offen
  s_add_u32 s36, s53, 59392
  buffer_load_dwordx4 v[104:107], v2, s[4:7], s36 offen
  s_add_u32 s36, s53, 60416
  buffer_load_dwordx4 v[108:111], v2, s[4:7], s36 offen
  s_add_u32 s36, s53, 61440
  buffer_load_dwordx4 v[112:115], v2, s[4:7], s36 offen
  s_add_u32 s36, s53, 62464
  buffer_load_dwordx4 v[116:119], v2, s[4:7], s36 offen
  s_add_u32 s36, s53, 63488
  buffer_load_dwordx4 v[120:123], v2, s[4:7], s36 offen
  s_add_u32 s36, s53, 64512
  buffer_load_dwordx4 v[124:127], v2, s[4:7], s36 offen
  s_add_u32 s36, s53, 65536
  buffer_load_dwordx4 v[128:131], v2, s[4:7], s36 offen
  s_add_u32 s36, s53, 66560
  buffer_load_dwordx4 v[132:135], v2, s[4:7], s36 offen
  s_add_u32 s36, s53, 67584
  buffer_load_dwordx4 v[136:139], v2, s[4:7], s36 offen
  s_add_u32 s36, s53, 68608
  buffer_load_dwordx4 v[140:143], v2, s[4:7], s36 offen
  s_add_u32 s36, s53, 69632
  buffer_load_dwordx4 v[144:147], v2, s[4:7], s36 offen
  s_add_u32 s36, s53, 70656
  buffer_load_dwordx4 v[148:151], v2, s[4:7], s36 offen
  s_waitcnt vmcnt(27)
  v_mfma_f32_16x16x32_bf16 v[4:7], a[0:3], v[40:43], 0
  v_mfma_f32_16x16x32_bf16 v[8:11], a[4:7], v[40:43], 0
  v_mfma_f32_16x16x32_bf16 v[12:15], a[8:11], v[40:43], 0
  v_mfma_f32_16x16x32_bf16 v[16:19], a[12:15], v[40:43], 0
  s_waitcnt vmcnt(26)
  v_mfma_f32_16x16x32_bf16 v[4:7], a[16:19], v[44:47], v[4:7]
  v_mfma_f32_16x16x32_bf16 v[8:11], a[20:23], v[44:47], v[8:11]
  v_mfma_f32_16x16x32_bf16 v[12:15], a[24:27], v[44:47], v[12:15]
  v_mfma_f32_16x16x32_bf16 v[16:19], a[28:31], v[44:47], v[16:19]
  s_waitcnt vmcnt(25)
  v_mfma_f32_16x16x32_bf16 v[4:7], a[32:35], v[48:51], v[4:7]
  v_mfma_f32_16x16x32_bf16 v[8:11], a[36:39], v[48:51], v[8:11]
  v_mfma_f32_16x16x32_bf16 v[12:15], a[40:43], v[48:51], v[12:15]
  v_mfma_f32_16x16x32_bf16 v[16:19], a[44:47], v[48:51], v[16:19]
  s_waitcnt vmcnt(24)
  v_mfma_f32_16x16x32_bf16 v[4:7], a[48:51], v[52:55], v[4:7]
  v_mfma_f32_16x16x32_bf16 v[8:11], a[52:55], v[52:55], v[8:11]
  v_mfma_f32_16x16x32_bf16 v[12:15], a[56:59], v[52:55], v[12:15]
  v_mfma_f32_16x16x32_bf16 v[16:19], a[60:63], v[52:55], v[16:19]
  s_waitcnt vmcnt(23)
  v_mfma_f32_16x16x32_bf16 v[4:7], a[64:67], v[56:59], v[4:7]
  v_mfma_f32_16x16x32_bf16 v[8:11], a[68:71], v[56:59], v[8:11]
  v_mfma_f32_16x16x32_bf16 v[12:15], a[72:75], v[56:59], v[12:15]
  v_mfma_f32_16x16x32_bf16 v[16:19], a[76:79], v[56:59], v[16:19]
  s_waitcnt vmcnt(22)
  v_mfma_f32_16x16x32_bf16 v[4:7], a[80:83], v[60:63], v[4:7]
  v_mfma_f32_16x16x32_bf16 v[8:11], a[84:87], v[60:63], v[8:11]
  v_mfma_f32_16x16x32_bf16 v[12:15], a[88:91], v[60:63], v[12:15]
  v_mfma_f32_16x16x32_bf16 v[16:19], a[92:95], v[60:63], v[16:19]
  s_waitcnt vmcnt(21)
  v_mfma_f32_16x16x32_bf16 v[4:7], a[96:99], v[64:67], v[4:7]
  v_mfma_f32_16x16x32_bf16 v[8:11], a[100:103], v[64:67], v[8:11]
  v_mfma_f32_16x16x32_bf16 v[12:15], a[104:107], v[64:67], v[12:15]
  v_mfma_f32_16x16x32_bf16 v[16:19], a[108:111], v[64:67], v[16:19]
  s_waitcnt vmcnt(20)
  v_mfma_f32_16x16x32_bf16 v[4:7], a[112:115], v[68:71], v[4:7]
  v_mfma_f32_16x16x32_bf16 v[8:11], a[116:119], v[68:71], v[8:11]
  v_mfma_f32_16x16x32_bf16 v[12:15], a[120:123], v[68:71], v[12:15]
  v_mfma_f32_16x16x32_bf16 v[16:19], a[124:127], v[68:71], v[16:19]
  s_waitcnt vmcnt(19)
  v_mfma_f32_16x16x32_bf16 v[4:7], a[128:131], v[72:75], v[4:7]
  v_mfma_f32_16x16x32_bf16 v[8:11], a[132:135], v[72:75], v[8:11]
  v_mfma_f32_16x16x32_bf16 v[12:15], a[136:139], v[72:75], v[12:15]
  v_mfma_f32_16x16x32_bf16 v[16:19], a[140:143], v[72:75], v[16:19]
  s_waitcnt vmcnt(18)
  v_mfma_f32_16x16x32_bf16 v[4:7], a[144:147], v[76:79], v[4:7]
  v_mfma_f32_16x16x32_bf16 v[8:11], a[148:151], v[76:79], v[8:11]
  v_mfma_f32_16x16x32_bf16 v[12:15], a[152:155], v[76:79], v[12:15]
  v_mfma_f32_16x16x32_bf16 v[16:19], a[156:159], v[76:79], v[16:19]
  s_waitcnt vmcnt(17)
  v_mfma_f32_16x16x32_bf16 v[4:7], a[160:163], v[80:83], v[4:7]
  v_mfma_f32_16x16x32_bf16 v[8:11], a[164:167], v[80:83], v[8:11]
  v_mfma_f32_16x16x32_bf16 v[12:15], a[168:171], v[80:83], v[12:15]
  v_mfma_f32_16x16x32_bf16 v[16:19], a[172:175], v[80:83], v[16:19]
  s_waitcnt vmcnt(16)
  v_mfma_f32_16x16x32_bf16 v[4:7], a[176:179], v[84:87], v[4:7]
  v_mfma_f32_16x16x32_bf16 v[8:11], a[180:183], v[84:87], v[8:11]
  v_mfma_f32_16x16x32_bf16 v[12:15], a[184:187], v[84:87], v[12:15]
  v_mfma_f32_16x16x32_bf16 v[16:19], a[188:191], v[84:87], v[16:19]
  s_waitcnt vmcnt(15)
  v_mfma_f32_16x16x32_bf16 v[4:7], a[192:195], v[88:91], v[4:7]
  v_mfma_f32_16x16x32_bf16 v[8:11], a[196:199], v[88:91], v[8:11]
  v_mfma_f32_16x16x32_bf16 v[12:15], a[200:203], v[88:91], v[12:15]
  v_mfma_f32_16x16x32_bf16 v[16:19], a[204:207], v[88:91], v[16:19]
  s_waitcnt vmcnt(14)
  v_mfma_f32_16x16x32_bf16 v[4:7], a[208:211], v[92:95], v[4:7]
  v_mfma_f32_16x16x32_bf16 v[8:11], a[212:215], v[92:95], v[8:11]
  v_mfma_f32_16x16x32_bf16 v[12:15], a[216:219], v[92:95], v[12:15]
  v_mfma_f32_16x16x32_bf16 v[16:19], a[220:223], v[92:95], v[16:19]
  s_waitcnt vmcnt(13)
  v_mfma_f32_16x16x32_bf16 v[20:23], a[0:3], v[96:99], 0
  v_mfma_f32_16x16x32_bf16 v[24:27], a[4:7], v[96:99], 0
  v_mfma_f32_16x16x32_bf16 v[28:31], a[8:11], v[96:99], 0
  v_mfma_f32_16x16x32_bf16 v[32:35], a[12:15], v[96:99], 0
  s_waitcnt vmcnt(12)
  v_mfma_f32_16x16x32_bf16 v[20:23], a[16:19], v[100:103], v[20:23]
  v_mfma_f32_16x16x32_bf16 v[24:27], a[20:23], v[100:103], v[24:27]
  v_mfma_f32_16x16x32_bf16 v[28:31], a[24:27], v[100:103], v[28:31]
  v_mfma_f32_16x16x32_bf16 v[32:35], a[28:31], v[100:103], v[32:35]
  s_waitcnt vmcnt(11)
  v_mfma_f32_16x16x32_bf16 v[20:23], a[32:35], v[104:107], v[20:23]
  v_mfma_f32_16x16x32_bf16 v[24:27], a[36:39], v[104:107], v[24:27]
  v_mfma_f32_16x16x32_bf16 v[28:31], a[40:43], v[104:107], v[28:31]
  v_mfma_f32_16x16x32_bf16 v[32:35], a[44:47], v[104:107], v[32:35]
  s_waitcnt vmcnt(10)
  v_mfma_f32_16x16x32_bf16 v[20:23], a[48:51], v[108:111], v[20:23]
  v_mfma_f32_16x16x32_bf16 v[24:27], a[52:55], v[108:111], v[24:27]
  v_mfma_f32_16x16x32_bf16 v[28:31], a[56:59], v[108:111], v[28:31]
  v_mfma_f32_16x16x32_bf16 v[32:35], a[60:63], v[108:111], v[32:35]
  s_waitcnt vmcnt(9)
  v_mfma_f32_16x16x32_bf16 v[20:23], a[64:67], v[112:115], v[20:23]
  v_mfma_f32_16x16x32_bf16 v[24:27], a[68:71], v[112:115], v[24:27]
  v_mfma_f32_16x16x32_bf16 v[28:31], a[72:75], v[112:115], v[28:31]
  v_mfma_f32_16x16x32_bf16 v[32:35], a[76:79], v[112:115], v[32:35]
  s_waitcnt vmcnt(8)
  v_mfma_f32_16x16x32_bf16 v[20:23], a[80:83], v[116:119], v[20:23]
  v_mfma_f32_16x16x32_bf16 v[24:27], a[84:87], v[116:119], v[24:27]
  v_mfma_f32_16x16x32_bf16 v[28:31], a[88:91], v[116:119], v[28:31]
  v_mfma_f32_16x16x32_bf16 v[32:35], a[92:95], v[116:119], v[32:35]
  s_waitcnt vmcnt(7)
  v_mfma_f32_16x16x32_bf16 v[20:23], a[96:99], v[120:123], v[20:23]
  v_mfma_f32_16x16x32_bf16 v[24:27], a[100:103], v[120:123], v[24:27]
  v_mfma_f32_16x16x32_bf16 v[28:31], a[104:107], v[120:123], v[28:31]
  v_mfma_f32_16x16x32_bf16 v[32:35], a[108:111], v[120:123], v[32:35]
  s_waitcnt vmcnt(6)
  v_mfma_f32_16x16x32_bf16 v[20:23], a[112:115], v[124:127], v[20:23]
  v_mfma_f32_16x16x32_bf16 v[24:27], a[116:119], v[124:127], v[24:27]
  v_mfma_f32_16x16x32_bf16 v[28:31], a[120:123], v[124:127], v[28:31]
  v_mfma_f32_16x16x32_bf16 v[32:35], a[124:127], v[124:127], v[32:35]
  s_waitcnt vmcnt(5)
  v_mfma_f32_16x16x32_bf16 v[20:23], a[128:131], v[128:131], v[20:23]
  v_mfma_f32_16x16x32_bf16 v[24:27], a[132:135], v[128:131], v[24:27]
  v_mfma_f32_16x16x32_bf16 v[28:31], a[136:139], v[128:131], v[28:31]
  v_mfma_f32_16x16x32_bf16 v[32:35], a[140:143], v[128:131], v[32:35]
  s_waitcnt vmcnt(4)
  v_mfma_f32_16x16x32_bf16 v[20:23], a[144:147], v[132:135], v[20:23]
  v_mfma_f32_16x16x32_bf16 v[24:27], a[148:151], v[132:135], v[24:27]
  v_mfma_f32_16x16x32_bf16 v[28:31], a[152:155], v[132:135], v[28:31]
  v_mfma_f32_16x16x32_bf16 v[32:35], a[156:159], v[132:135], v[32:35]
  s_waitcnt vmcnt(3)
  v_mfma_f32_16x16x32_bf16 v[20:23], a[160:163], v[136:139], v[20:23]
  v_mfma_f32_16x16x32_bf16 v[24:27], a[164:167], v[136:139], v[24:27]
  v_mfma_f32_16x16x32_bf16 v[28:31], a[168:171], v[136:139], v[28:31]
  v_mfma_f32_16x16x32_bf16 v[32:35], a[172:175], v[136:139], v[32:35]
  s_waitcnt vmcnt(2)
  v_mfma_f32_16x16x32_bf16 v[20:23], a[176:179], v[140:143], v[20:23]
  v_mfma_f32_16x16x32_bf16 v[24:27], a[180:183], v[140:143], v[24:27]
  v_mfma_f32_16x16x32_bf16 v[28:31], a[184:187], v[140:143], v[28:31]
  v_mfma_f32_16x16x32_bf16 v[32:35], a[188:191], v[140:143], v[32:35]
  s_waitcnt vmcnt(1)
  v_mfma_f32_16x16x32_bf16 v[20:23], a[192:195], v[144:147], v[20:23]
  v_mfma_f32_16x16x32_bf16 v[24:27], a[196:199], v[144:147], v[24:27]
  v_mfma_f32_16x16x32_bf16 v[28:31], a[200:203], v[144:147], v[28:31]
  v_mfma_f32_16x16x32_bf16 v[32:35], a[204:207], v[144:147], v[32:35]
  s_waitcnt vmcnt(0)
  v_mfma_f32_16x16x32_bf16 v[20:23], a[208:211], v[148:151], v[20:23]
  v_mfma_f32_16x16x32_bf16 v[24:27], a[212:215], v[148:151], v[24:27]
  v_mfma_f32_16x16x32_bf16 v[28:31], a[216:219], v[148:151], v[28:31]
  v_mfma_f32_16x16x32_bf16 v[32:35], a[220:223], v[148:151], v[32:35]
  s_barrier
  ds_write_b128 v3, v[4:7] offset:0
  ds_write_b128 v3, v[8:11] offset:1024
  ds_write_b128 v3, v[12:15] offset:2048
  ds_write_b128 v3, v[16:19] offset:3072
  ds_write_b128 v3, v[20:23] offset:4096
  ds_write_b128 v3, v[24:27] offset:5120
  ds_write_b128 v3, v[28:31] offset:6144
  ds_write_b128 v3, v[32:35] offset:7168
  s_waitcnt lgkmcnt(0)
  s_barrier
  s_and_b32 s36, s32, 3
  s_mul_i32 s36, s36, 2048
  v_add_u32 v39, s36, v2
  ds_read_b128 v[40:43], v39 offset:0
  ds_read_b128 v[44:47], v39 offset:8192
  ds_read_b128 v[48:51], v39 offset:16384
  ds_read_b128 v[52:55], v39 offset:24576
  ds_read_b128 v[56:59], v39 offset:1024
  ds_read_b128 v[60:63], v39 offset:9216
  ds_read_b128 v[64:67], v39 offset:17408
  ds_read_b128 v[68:71], v39 offset:25600
  s_waitcnt lgkmcnt(0)
  v_add_f32 v40, v40, v44
  v_add_f32 v48, v48, v52
  v_add_f32 v41, v41, v45
  v_add_f32 v49, v49, v53
  v_add_f32 v42, v42, v46
  v_add_f32 v50, v50, v54
  v_add_f32 v43, v43, v47
  v_add_f32 v51, v51, v55
  v_add_f32 v40, v40, v48
  v_add_f32 v41, v41, v49
  v_add_f32 v42, v42, v50
  v_add_f32 v43, v43, v51
  v_cvt_pk_bf16_f32 v44, v40, v41
  v_cvt_pk_bf16_f32 v45, v42, v43
  v_lshlrev_b32 v40, 16, v44
  v_and_b32 v41, 0xffff0000, v44
  v_lshlrev_b32 v42, 16, v45
  v_and_b32 v43, 0xffff0000, v45
  v_add_f32 v56, v56, v60
  v_add_f32 v64, v64, v68
  v_add_f32 v57, v57, v61
  v_add_f32 v65, v65, v69
  v_add_f32 v58, v58, v62
  v_add_f32 v66, v66, v70
  v_add_f32 v59, v59, v63
  v_add_f32 v67, v67, v71
  v_add_f32 v56, v56, v64
  v_add_f32 v57, v57, v65
  v_add_f32 v58, v58, v66
  v_add_f32 v59, v59, v67
  v_cvt_pk_bf16_f32 v60, v56, v57
  v_cvt_pk_bf16_f32 v61, v58, v59
  v_lshlrev_b32 v56, 16, v60
  v_and_b32 v57, 0xffff0000, v60
  v_lshlrev_b32 v58, 16, v61
  v_and_b32 v59, 0xffff0000, v61
  v_sub_f32 v236, 1.0, v236
  v_cvt_pk_bf16_f32 v236, v236, v236
  v_and_b32 v236, 0xffff0000, v236
  v_mul_f32 v40, v40, v236
  v_mul_f32 v41, v41, v236
  v_mul_f32 v42, v42, v236
  v_mul_f32 v43, v43, v236
  v_cvt_pk_bf16_f32 v44, v40, v41
  v_cvt_pk_bf16_f32 v45, v42, v43
  buffer_store_dwordx2 v[44:45], v37, s[4:7], s55 offen offset:0 sc1
  v_mul_f32 v56, v56, v236
  v_mul_f32 v57, v57, v236
  v_mul_f32 v58, v58, v236
  v_mul_f32 v59, v59, v236
  v_cvt_pk_bf16_f32 v60, v56, v57
  v_cvt_pk_bf16_f32 v61, v58, v59
  buffer_store_dwordx2 v[60:61], v37, s[4:7], s55 offen offset:32 sc1
  s_waitcnt vmcnt(0)
  s_barrier
  s_lshl_b32 s36, s50, 5
  s_add_u32 s36, s36, s51
  s_lshl_b32 s36, s36, 2
  s_add_u32 s36, s36, 87073024
  s_cmp_lg_u32 s32, 0
  s_cbranch_scc1 SF38
  v_mov_b32 v240, 0
  v_mov_b32 v241, 1
  s_mov_b64 exec, 1
  buffer_store_dword v241, v240, s[4:7], s36 offen sc1
  s_mov_b64 exec, -1
SF38:
  s_add_u32 s50, s50, 12
  s_cmp_lt_u32 s50, 64
  s_cbranch_scc1 K1_R2b_L
  s_waitcnt vmcnt(0) lgkmcnt(0)
  s_barrier
  s_sub_u32 s36, s34, 5
  s_lshl_b32 s36, s36, 5
  s_add_u32 s45, s36, s35
  s_mov_b32 s8, s74
  s_and_b32 s9, s75, 0xffff
  s_mov_b32 s10, 0x400000
  s_mov_b32 s11, 0x20000
  s_mov_b32 s28, s86
  s_and_b32 s29, s87, 0xffff
  s_mov_b32 s30, 0x200000
  s_mov_b32 s31, 0x20000
  s_and_b32 s51, s45, 15
  s_lshr_b32 s50, s45, 5
  s_bfe_u32 s56, s45, 0x10004
  s_mul_i32 s49, s32, 1048576
  s_mul_i32 s36, s51, 64
  s_add_u32 s49, s49, s36
  v_lshrrev_b32 v104, 2, v0
  v_bfe_u32 v102, v0, 1, 1
  v_bfe_u32 v103, v104, 2, 1
  v_xor_b32 v102, v102, v103
  v_lshlrev_b32 v102, 5, v102
  v_and_b32 v103, 1, v0
  v_lshl_add_u32 v102, v103, 4, v102
  v_lshl_add_u32 v100, v104, 10, v102
  v_lshrrev_b32 v104, 4, v0
  v_bfe_u32 v105, v0, 2, 2
  v_and_b32 v106, 3, v0
  v_lshl_add_u32 v102, v104, 2, v105
  v_bfe_u32 v103, v102, 2, 1
  v_lshlrev_b32 v103, 5, v103
  v_lshl_add_u32 v103, v106, 3, v103
  s_mov_b32 s36, 64
  v_mad_u32_u24 v101, v102, s36, v103
  s_mul_i32 s44, s32, 40960
  v_add_u32 v101, s44, v101
  s_add_u32 s36, s44, 0
  s_mov_b32 m0, s36
  s_add_u32 s37, s49, 0
  buffer_load_dwordx4 v100, s[8:11], s37 offen lds
  s_add_u32 s36, s44, 1024
  s_mov_b32 m0, s36
  s_add_u32 s37, s49, 16384
  buffer_load_dwordx4 v100, s[8:11], s37 offen lds
  s_add_u32 s36, s44, 2048
  s_mov_b32 m0, s36
  s_add_u32 s37, s49, 32768
  buffer_load_dwordx4 v100, s[8:11], s37 offen lds
  s_add_u32 s36, s44, 3072
  s_mov_b32 m0, s36
  s_add_u32 s37, s49, 49152
  buffer_load_dwordx4 v100, s[8:11], s37 offen lds
  s_add_u32 s36, s44, 4096
  s_mov_b32 m0, s36
  s_add_u32 s37, s49, 65536
  buffer_load_dwordx4 v100, s[8:11], s37 offen lds
  s_add_u32 s36, s44, 5120
  s_mov_b32 m0, s36
  s_add_u32 s37, s49, 81920
  buffer_load_dwordx4 v100, s[8:11], s37 offen lds
  s_add_u32 s36, s44, 6144
  s_mov_b32 m0, s36
  s_add_u32 s37, s49, 98304
  buffer_load_dwordx4 v100, s[8:11], s37 offen lds
  s_add_u32 s36, s44, 7168
  s_mov_b32 m0, s36
  s_add_u32 s37, s49, 114688
  buffer_load_dwordx4 v100, s[8:11], s37 offen lds
  s_add_u32 s36, s44, 8192
  s_mov_b32 m0, s36
  s_add_u32 s37, s49, 131072
  buffer_load_dwordx4 v100, s[8:11], s37 offen lds
  s_add_u32 s36, s44, 9216
  s_mov_b32 m0, s36
  s_add_u32 s37, s49, 147456
  buffer_load_dwordx4 v100, s[8:11], s37 offen lds
  s_add_u32 s36, s44, 10240
  s_mov_b32 m0, s36
  s_add_u32 s37, s49, 163840
  buffer_load_dwordx4 v100, s[8:11], s37 offen lds
  s_add_u32 s36, s44, 11264
  s_mov_b32 m0, s36
  s_add_u32 s37, s49, 180224
  buffer_load_dwordx4 v100, s[8:11], s37 offen lds
  s_add_u32 s36, s44, 12288
  s_mov_b32 m0, s36
  s_add_u32 s37, s49, 196608
  buffer_load_dwordx4 v100, s[8:11], s37 offen lds
  s_add_u32 s36, s44, 13312
  s_mov_b32 m0, s36
  s_add_u32 s37, s49, 212992
  buffer_load_dwordx4 v100, s[8:11], s37 offen lds
  s_add_u32 s36, s44, 14336
  s_mov_b32 m0, s36
  s_add_u32 s37, s49, 229376
  buffer_load_dwordx4 v100, s[8:11], s37 offen lds
  s_add_u32 s36, s44, 15360
  s_mov_b32 m0, s36
  s_add_u32 s37, s49, 245760
  buffer_load_dwordx4 v100, s[8:11], s37 offen lds
  s_add_u32 s36, s44, 16384
  s_mov_b32 m0, s36
  s_add_u32 s37, s49, 262144
  buffer_load_dwordx4 v100, s[8:11], s37 offen lds
  s_add_u32 s36, s44, 17408
  s_mov_b32 m0, s36
  s_add_u32 s37, s49, 278528
  buffer_load_dwordx4 v100, s[8:11], s37 offen lds
  s_add_u32 s36, s44, 18432
  s_mov_b32 m0, s36
  s_add_u32 s37, s49, 294912
  buffer_load_dwordx4 v100, s[8:11], s37 offen lds
  s_add_u32 s36, s44, 19456
  s_mov_b32 m0, s36
  s_add_u32 s37, s49, 311296
  buffer_load_dwordx4 v100, s[8:11], s37 offen lds
  s_add_u32 s36, s44, 20480
  s_mov_b32 m0, s36
  s_add_u32 s37, s49, 327680
  buffer_load_dwordx4 v100, s[8:11], s37 offen lds
  s_add_u32 s36, s44, 21504
  s_mov_b32 m0, s36
  s_add_u32 s37, s49, 344064
  buffer_load_dwordx4 v100, s[8:11], s37 offen lds
  s_add_u32 s36, s44, 22528
  s_mov_b32 m0, s36
  s_add_u32 s37, s49, 360448
  buffer_load_dwordx4 v100, s[8:11], s37 offen lds
  s_add_u32 s36, s44, 23552
  s_mov_b32 m0, s36
  s_add_u32 s37, s49, 376832
  buffer_load_dwordx4 v100, s[8:11], s37 offen lds
  s_add_u32 s36, s44, 24576
  s_mov_b32 m0, s36
  s_add_u32 s37, s49, 393216
  buffer_load_dwordx4 v100, s[8:11], s37 offen lds
  s_add_u32 s36, s44, 25600
  s_mov_b32 m0, s36
  s_add_u32 s37, s49, 409600
  buffer_load_dwordx4 v100, s[8:11], s37 offen lds
  s_add_u32 s36, s44, 26624
  s_mov_b32 m0, s36
  s_add_u32 s37, s49, 425984
  buffer_load_dwordx4 v100, s[8:11], s37 offen lds
  s_add_u32 s36, s44, 27648
  s_mov_b32 m0, s36
  s_add_u32 s37, s49, 442368
  buffer_load_dwordx4 v100, s[8:11], s37 offen lds
  s_add_u32 s36, s44, 28672
  s_mov_b32 m0, s36
  s_add_u32 s37, s49, 458752
  buffer_load_dwordx4 v100, s[8:11], s37 offen lds
  s_add_u32 s36, s44, 29696
  s_mov_b32 m0, s36
  s_add_u32 s37, s49, 475136
  buffer_load_dwordx4 v100, s[8:11], s37 offen lds
  s_add_u32 s36, s44, 30720
  s_mov_b32 m0, s36
  s_add_u32 s37, s49, 491520
  buffer_load_dwordx4 v100, s[8:11], s37 offen lds
  s_add_u32 s36, s44, 31744
  s_mov_b32 m0, s36
  s_add_u32 s37, s49, 507904
  buffer_load_dwordx4 v100, s[8:11], s37 offen lds
  s_waitcnt vmcnt(0)
  v_xor_b32 v102, 0, v101
  ds_read_b64_tr_b16 a[0:1], v102 offset:0
  ds_read_b64_tr_b16 a[2:3], v102 offset:1024
  ds_read_b64_tr_b16 a[8:9], v102 offset:2048
  ds_read_b64_tr_b16 a[10:11], v102 offset:3072
  ds_read_b64_tr_b16 a[16:17], v102 offset:4096
  ds_read_b64_tr_b16 a[18:19], v102 offset:5120
  ds_read_b64_tr_b16 a[24:25], v102 offset:6144
  ds_read_b64_tr_b16 a[26:27], v102 offset:7168
  s_waitcnt lgkmcnt(0)
  ds_read_b64_tr_b16 a[32:33], v102 offset:8192
  ds_read_b64_tr_b16 a[34:35], v102 offset:9216
  ds_read_b64_tr_b16 a[40:41], v102 offset:10240
  ds_read_b64_tr_b16 a[42:43], v102 offset:11264
  ds_read_b64_tr_b16 a[48:49], v102 offset:12288
  ds_read_b64_tr_b16 a[50:51], v102 offset:13312
  ds_read_b64_tr_b16 a[56:57], v102 offset:14336
  ds_read_b64_tr_b16 a[58:59], v102 offset:15360
  s_waitcnt lgkmcnt(0)
  ds_read_b64_tr_b16 a[64:65], v102 offset:16384
  ds_read_b64_tr_b16 a[66:67], v102 offset:17408
  ds_read_b64_tr_b16 a[72:73], v102 offset:18432
  ds_read_b64_tr_b16 a[74:75], v102 offset:19456
  ds_read_b64_tr_b16 a[80:81], v102 offset:20480
  ds_read_b64_tr_b16 a[82:83], v102 offset:21504
  ds_read_b64_tr_b16 a[88:89], v102 offset:22528
  ds_read_b64_tr_b16 a[90:91], v102 offset:23552
  s_waitcnt lgkmcnt(0)
  ds_read_b64_tr_b16 a[96:97], v102 offset:24576
  ds_read_b64_tr_b16 a[98:99], v102 offset:25600
  ds_read_b64_tr_b16 a[104:105], v102 offset:26624
  ds_read_b64_tr_b16 a[106:107], v102 offset:27648
  ds_read_b64_tr_b16 a[112:113], v102 offset:28672
  ds_read_b64_tr_b16 a[114:115], v102 offset:29696
  ds_read_b64_tr_b16 a[120:121], v102 offset:30720
  ds_read_b64_tr_b16 a[122:123], v102 offset:31744
  s_waitcnt lgkmcnt(0)
  s_waitcnt lgkmcnt(0)
  v_xor_b32 v102, 32, v101
  ds_read_b64_tr_b16 a[4:5], v102 offset:0
  ds_read_b64_tr_b16 a[6:7], v102 offset:1024
  ds_read_b64_tr_b16 a[12:13], v102 offset:2048
  ds_read_b64_tr_b16 a[14:15], v102 offset:3072
  ds_read_b64_tr_b16 a[20:21], v102 offset:4096
  ds_read_b64_tr_b16 a[22:23], v102 offset:5120
  ds_read_b64_tr_b16 a[28:29], v102 offset:6144
  ds_read_b64_tr_b16 a[30:31], v102 offset:7168
  s_waitcnt lgkmcnt(0)
  ds_read_b64_tr_b16 a[36:37], v102 offset:8192
  ds_read_b64_tr_b16 a[38:39], v102 offset:9216
  ds_read_b64_tr_b16 a[44:45], v102 offset:10240
  ds_read_b64_tr_b16 a[46:47], v102 offset:11264
  ds_read_b64_tr_b16 a[52:53], v102 offset:12288
  ds_read_b64_tr_b16 a[54:55], v102 offset:13312
  ds_read_b64_tr_b16 a[60:61], v102 offset:14336
  ds_read_b64_tr_b16 a[62:63], v102 offset:15360
  s_waitcnt lgkmcnt(0)
  ds_read_b64_tr_b16 a[68:69], v102 offset:16384
  ds_read_b64_tr_b16 a[70:71], v102 offset:17408
  ds_read_b64_tr_b16 a[76:77], v102 offset:18432
  ds_read_b64_tr_b16 a[78:79], v102 offset:19456
  ds_read_b64_tr_b16 a[84:85], v102 offset:20480
  ds_read_b64_tr_b16 a[86:87], v102 offset:21504
  ds_read_b64_tr_b16 a[92:93], v102 offset:22528
  ds_read_b64_tr_b16 a[94:95], v102 offset:23552
  s_waitcnt lgkmcnt(0)
  ds_read_b64_tr_b16 a[100:101], v102 offset:24576
  ds_read_b64_tr_b16 a[102:103], v102 offset:25600
  ds_read_b64_tr_b16 a[108:109], v102 offset:26624
  ds_read_b64_tr_b16 a[110:111], v102 offset:27648
  ds_read_b64_tr_b16 a[116:117], v102 offset:28672
  ds_read_b64_tr_b16 a[118:119], v102 offset:29696
  ds_read_b64_tr_b16 a[124:125], v102 offset:30720
  ds_read_b64_tr_b16 a[126:127], v102 offset:31744
  s_waitcnt lgkmcnt(0)
  s_waitcnt lgkmcnt(0)
  s_add_u32 s36, s44, 0
  s_mov_b32 m0, s36
  s_add_u32 s37, s49, 524288
  buffer_load_dwordx4 v100, s[8:11], s37 offen lds
  s_add_u32 s36, s44, 1024
  s_mov_b32 m0, s36
  s_add_u32 s37, s49, 540672
  buffer_load_dwordx4 v100, s[8:11], s37 offen lds
  s_add_u32 s36, s44, 2048
  s_mov_b32 m0, s36
  s_add_u32 s37, s49, 557056
  buffer_load_dwordx4 v100, s[8:11], s37 offen lds
  s_add_u32 s36, s44, 3072
  s_mov_b32 m0, s36
  s_add_u32 s37, s49, 573440
  buffer_load_dwordx4 v100, s[8:11], s37 offen lds
  s_add_u32 s36, s44, 4096
  s_mov_b32 m0, s36
  s_add_u32 s37, s49, 589824
  buffer_load_dwordx4 v100, s[8:11], s37 offen lds
  s_add_u32 s36, s44, 5120
  s_mov_b32 m0, s36
  s_add_u32 s37, s49, 606208
  buffer_load_dwordx4 v100, s[8:11], s37 offen lds
  s_add_u32 s36, s44, 6144
  s_mov_b32 m0, s36
  s_add_u32 s37, s49, 622592
  buffer_load_dwordx4 v100, s[8:11], s37 offen lds
  s_add_u32 s36, s44, 7168
  s_mov_b32 m0, s36
  s_add_u32 s37, s49, 638976
  buffer_load_dwordx4 v100, s[8:11], s37 offen lds
  s_add_u32 s36, s44, 8192
  s_mov_b32 m0, s36
  s_add_u32 s37, s49, 655360
  buffer_load_dwordx4 v100, s[8:11], s37 offen lds
  s_add_u32 s36, s44, 9216
  s_mov_b32 m0, s36
  s_add_u32 s37, s49, 671744
  buffer_load_dwordx4 v100, s[8:11], s37 offen lds
  s_add_u32 s36, s44, 10240
  s_mov_b32 m0, s36
  s_add_u32 s37, s49, 688128
  buffer_load_dwordx4 v100, s[8:11], s37 offen lds
  s_add_u32 s36, s44, 11264
  s_mov_b32 m0, s36
  s_add_u32 s37, s49, 704512
  buffer_load_dwordx4 v100, s[8:11], s37 offen lds
  s_add_u32 s36, s44, 12288
  s_mov_b32 m0, s36
  s_add_u32 s37, s49, 720896
  buffer_load_dwordx4 v100, s[8:11], s37 offen lds
  s_add_u32 s36, s44, 13312
  s_mov_b32 m0, s36
  s_add_u32 s37, s49, 737280
  buffer_load_dwordx4 v100, s[8:11], s37 offen lds
  s_add_u32 s36, s44, 14336
  s_mov_b32 m0, s36
  s_add_u32 s37, s49, 753664
  buffer_load_dwordx4 v100, s[8:11], s37 offen lds
  s_add_u32 s36, s44, 15360
  s_mov_b32 m0, s36
  s_add_u32 s37, s49, 770048
  buffer_load_dwordx4 v100, s[8:11], s37 offen lds
  s_add_u32 s36, s44, 16384
  s_mov_b32 m0, s36
  s_add_u32 s37, s49, 786432
  buffer_load_dwordx4 v100, s[8:11], s37 offen lds
  s_add_u32 s36, s44, 17408
  s_mov_b32 m0, s36
  s_add_u32 s37, s49, 802816
  buffer_load_dwordx4 v100, s[8:11], s37 offen lds
  s_add_u32 s36, s44, 18432
  s_mov_b32 m0, s36
  s_add_u32 s37, s49, 819200
  buffer_load_dwordx4 v100, s[8:11], s37 offen lds
  s_add_u32 s36, s44, 19456
  s_mov_b32 m0, s36
  s_add_u32 s37, s49, 835584
  buffer_load_dwordx4 v100, s[8:11], s37 offen lds
  s_add_u32 s36, s44, 20480
  s_mov_b32 m0, s36
  s_add_u32 s37, s49, 851968
  buffer_load_dwordx4 v100, s[8:11], s37 offen lds
  s_add_u32 s36, s44, 21504
  s_mov_b32 m0, s36
  s_add_u32 s37, s49, 868352
  buffer_load_dwordx4 v100, s[8:11], s37 offen lds
  s_add_u32 s36, s44, 22528
  s_mov_b32 m0, s36
  s_add_u32 s37, s49, 884736
  buffer_load_dwordx4 v100, s[8:11], s37 offen lds
  s_add_u32 s36, s44, 23552
  s_mov_b32 m0, s36
  s_add_u32 s37, s49, 901120
  buffer_load_dwordx4 v100, s[8:11], s37 offen lds
  s_add_u32 s36, s44, 24576
  s_mov_b32 m0, s36
  s_add_u32 s37, s49, 917504
  buffer_load_dwordx4 v100, s[8:11], s37 offen lds
  s_add_u32 s36, s44, 25600
  s_mov_b32 m0, s36
  s_add_u32 s37, s49, 933888
  buffer_load_dwordx4 v100, s[8:11], s37 offen lds
  s_add_u32 s36, s44, 26624
  s_mov_b32 m0, s36
  s_add_u32 s37, s49, 950272
  buffer_load_dwordx4 v100, s[8:11], s37 offen lds
  s_add_u32 s36, s44, 27648
  s_mov_b32 m0, s36
  s_add_u32 s37, s49, 966656
  buffer_load_dwordx4 v100, s[8:11], s37 offen lds
  s_add_u32 s36, s44, 28672
  s_mov_b32 m0, s36
  s_add_u32 s37, s49, 983040
  buffer_load_dwordx4 v100, s[8:11], s37 offen lds
  s_add_u32 s36, s44, 29696
  s_mov_b32 m0, s36
  s_add_u32 s37, s49, 999424
  buffer_load_dwordx4 v100, s[8:11], s37 offen lds
  s_add_u32 s36, s44, 30720
  s_mov_b32 m0, s36
  s_add_u32 s37, s49, 1015808
  buffer_load_dwordx4 v100, s[8:11], s37 offen lds
  s_add_u32 s36, s44, 31744
  s_mov_b32 m0, s36
  s_add_u32 s37, s49, 1032192
  buffer_load_dwordx4 v100, s[8:11], s37 offen lds
  s_waitcnt vmcnt(0)
  v_xor_b32 v102, 0, v101
  ds_read_b64_tr_b16 a[128:129], v102 offset:0
  ds_read_b64_tr_b16 a[130:131], v102 offset:1024
  ds_read_b64_tr_b16 a[136:137], v102 offset:2048
  ds_read_b64_tr_b16 a[138:139], v102 offset:3072
  ds_read_b64_tr_b16 a[144:145], v102 offset:4096
  ds_read_b64_tr_b16 a[146:147], v102 offset:5120
  ds_read_b64_tr_b16 a[152:153], v102 offset:6144
  ds_read_b64_tr_b16 a[154:155], v102 offset:7168
  s_waitcnt lgkmcnt(0)
  ds_read_b64_tr_b16 a[160:161], v102 offset:8192
  ds_read_b64_tr_b16 a[162:163], v102 offset:9216
  ds_read_b64_tr_b16 a[168:169], v102 offset:10240
  ds_read_b64_tr_b16 a[170:171], v102 offset:11264
  ds_read_b64_tr_b16 a[176:177], v102 offset:12288
  ds_read_b64_tr_b16 a[178:179], v102 offset:13312
  ds_read_b64_tr_b16 a[184:185], v102 offset:14336
  ds_read_b64_tr_b16 a[186:187], v102 offset:15360
  s_waitcnt lgkmcnt(0)
  ds_read_b64_tr_b16 a[192:193], v102 offset:16384
  ds_read_b64_tr_b16 a[194:195], v102 offset:17408
  ds_read_b64_tr_b16 a[200:201], v102 offset:18432
  ds_read_b64_tr_b16 a[202:203], v102 offset:19456
  ds_read_b64_tr_b16 a[208:209], v102 offset:20480
  ds_read_b64_tr_b16 a[210:211], v102 offset:21504
  ds_read_b64_tr_b16 a[216:217], v102 offset:22528
  ds_read_b64_tr_b16 a[218:219], v102 offset:23552
  s_waitcnt lgkmcnt(0)
  ds_read_b64_tr_b16 a[224:225], v102 offset:24576
  ds_read_b64_tr_b16 a[226:227], v102 offset:25600
  ds_read_b64_tr_b16 a[232:233], v102 offset:26624
  ds_read_b64_tr_b16 a[234:235], v102 offset:27648
  ds_read_b64_tr_b16 a[240:241], v102 offset:28672
  ds_read_b64_tr_b16 a[242:243], v102 offset:29696
  ds_read_b64_tr_b16 a[248:249], v102 offset:30720
  ds_read_b64_tr_b16 a[250:251], v102 offset:31744
  s_waitcnt lgkmcnt(0)
  s_waitcnt lgkmcnt(0)
  v_xor_b32 v102, 32, v101
  ds_read_b64_tr_b16 a[132:133], v102 offset:0
  ds_read_b64_tr_b16 a[134:135], v102 offset:1024
  ds_read_b64_tr_b16 a[140:141], v102 offset:2048
  ds_read_b64_tr_b16 a[142:143], v102 offset:3072
  ds_read_b64_tr_b16 a[148:149], v102 offset:4096
  ds_read_b64_tr_b16 a[150:151], v102 offset:5120
  ds_read_b64_tr_b16 a[156:157], v102 offset:6144
  ds_read_b64_tr_b16 a[158:159], v102 offset:7168
  s_waitcnt lgkmcnt(0)
  ds_read_b64_tr_b16 a[164:165], v102 offset:8192
  ds_read_b64_tr_b16 a[166:167], v102 offset:9216
  ds_read_b64_tr_b16 a[172:173], v102 offset:10240
  ds_read_b64_tr_b16 a[174:175], v102 offset:11264
  ds_read_b64_tr_b16 a[180:181], v102 offset:12288
  ds_read_b64_tr_b16 a[182:183], v102 offset:13312
  ds_read_b64_tr_b16 a[188:189], v102 offset:14336
  ds_read_b64_tr_b16 a[190:191], v102 offset:15360
  s_waitcnt lgkmcnt(0)
  ds_read_b64_tr_b16 a[196:197], v102 offset:16384
  ds_read_b64_tr_b16 a[198:199], v102 offset:17408
  ds_read_b64_tr_b16 a[204:205], v102 offset:18432
  ds_read_b64_tr_b16 a[206:207], v102 offset:19456
  ds_read_b64_tr_b16 a[212:213], v102 offset:20480
  ds_read_b64_tr_b16 a[214:215], v102 offset:21504
  ds_read_b64_tr_b16 a[220:221], v102 offset:22528
  ds_read_b64_tr_b16 a[222:223], v102 offset:23552
  s_waitcnt lgkmcnt(0)
  ds_read_b64_tr_b16 a[228:229], v102 offset:24576
  ds_read_b64_tr_b16 a[230:231], v102 offset:25600
  ds_read_b64_tr_b16 a[236:237], v102 offset:26624
  ds_read_b64_tr_b16 a[238:239], v102 offset:27648
  ds_read_b64_tr_b16 a[244:245], v102 offset:28672
  ds_read_b64_tr_b16 a[246:247], v102 offset:29696
  ds_read_b64_tr_b16 a[252:253], v102 offset:30720
  ds_read_b64_tr_b16 a[254:255], v102 offset:31744
  s_waitcnt lgkmcnt(0)
  s_waitcnt lgkmcnt(0)
  s_barrier
  v_lshlrev_b32 v2, 4, v0
  s_lshl_b32 s36, s32, 13
  v_add_u32 v3, s36, v2
  v_and_b32 v1, 15, v0
  v_lshrrev_b32 v36, 4, v0
  v_lshlrev_b32 v37, 10, v1
  v_lshl_add_u32 v37, v36, 3, v37
  v_lshlrev_b32 v38, 2, v1
  s_mul_i32 s52, s32, 32768
  s_add_u32 s52, s52, 33554432
  s_mul_i32 s36, s56, 131072
  s_add_u32 s52, s52, s36
K1_R2c_L:
  s_lshl_b32 s36, s50, 7
  s_lshr_b32 s37, s51, 1
  s_lshl_b32 s37, s37, 2
  s_add_u32 s36, s36, s37
  s_add_u32 s36, s36, 87073024
  s_cmp_lg_u32 s32, 0
  s_cbranch_scc1 WG39
  v_mov_b32 v240, 0
  s_mov_b32 s3, 0x100000
  s_branch WF40
WS40:
  s_sleep 3
WF40:
  buffer_load_dword v241, v240, s[4:7], s36 offen sc1
  s_sub_u32 s3, s3, 1
  s_cbranch_scc1 K1_END
  s_waitcnt vmcnt(0)
  v_cmp_eq_u32 vcc, 0, v241
  s_nop 3
  s_cbranch_vccnz WS40
WG39:
  s_barrier
  s_mov_b32 s36, s56
  s_lshl_b32 s37, s50, 1
  s_add_u32 s36, s36, s37
  s_lshl_b32 s37, s36, 6
  s_add_u32 s37, s37, 60817408
  buffer_load_dword v236, v38, s[4:7], s37 offen
  s_lshl_b32 s36, s36, 14
  s_and_b32 s37, s32, 1
  s_mul_i32 s37, s37, 32
  s_add_u32 s36, s36, s37
  s_mul_i32 s37, s51, 64
  s_add_u32 s54, s36, s37
  s_add_u32 s55, s54, 58720256
  buffer_load_dwordx2 v[238:239], v37, s[4:7], s55 offen
  s_lshl_b32 s36, s50, 7
  s_add_u32 s36, s36, 87052544
  s_cmp_lg_u32 s32, 0
  s_cbranch_scc1 WG41
  v_min_u32 v240, 31, v0
  v_lshlrev_b32 v240, 2, v240
  s_mov_b32 s3, 0x100000
  s_branch WF42
WS42:
  s_sleep 3
WF42:
  buffer_load_dword v241, v240, s[4:7], s36 offen sc1
  s_sub_u32 s3, s3, 1
  s_cbranch_scc1 K1_END
  s_waitcnt vmcnt(0)
  v_cmp_eq_u32 vcc, 0, v241
  s_nop 3
  s_cbranch_vccnz WS42
WG41:
  s_barrier
  s_mul_i32 s53, s50, 262144
  s_add_u32 s53, s53, s52
  s_add_u32 s36, s53, 0
  buffer_load_dwordx4 v[40:43], v2, s[4:7], s36 offen
  s_add_u32 s36, s53, 1024
  buffer_load_dwordx4 v[44:47], v2, s[4:7], s36 offen
  s_add_u32 s36, s53, 2048
  buffer_load_dwordx4 v[48:51], v2, s[4:7], s36 offen
  s_add_u32 s36, s53, 3072
  buffer_load_dwordx4 v[52:55], v2, s[4:7], s36 offen
  s_add_u32 s36, s53, 4096
  buffer_load_dwordx4 v[56:59], v2, s[4:7], s36 offen
  s_add_u32 s36, s53, 5120
  buffer_load_dwordx4 v[60:63], v2, s[4:7], s36 offen
  s_add_u32 s36, s53, 6144
  buffer_load_dwordx4 v[64:67], v2, s[4:7], s36 offen
  s_add_u32 s36, s53, 7168
  buffer_load_dwordx4 v[68:71], v2, s[4:7], s36 offen
  s_add_u32 s36, s53, 8192
  buffer_load_dwordx4 v[72:75], v2, s[4:7], s36 offen
  s_add_u32 s36, s53, 9216
  buffer_load_dwordx4 v[76:79], v2, s[4:7], s36 offen
  s_add_u32 s36, s53, 10240
  buffer_load_dwordx4 v[80:83], v2, s[4:7], s36 offen
  s_add_u32 s36, s53, 11264
  buffer_load_dwordx4 v[84:87], v2, s[4:7], s36 offen
  s_add_u32 s36, s53, 12288
  buffer_load_dwordx4 v[88:91], v2, s[4:7], s36 offen
  s_add_u32 s36, s53, 13312
  buffer_load_dwordx4 v[92:95], v2, s[4:7], s36 offen
  s_add_u32 s36, s53, 14336
  buffer_load_dwordx4 v[96:99], v2, s[4:7], s36 offen
  s_add_u32 s36, s53, 15360
  buffer_load_dwordx4 v[100:103], v2, s[4:7], s36 offen
  s_add_u32 s36, s53, 16384
  buffer_load_dwordx4 v[104:107], v2, s[4:7], s36 offen
  s_add_u32 s36, s53, 17408
  buffer_load_dwordx4 v[108:111], v2, s[4:7], s36 offen
  s_add_u32 s36, s53, 18432
  buffer_load_dwordx4 v[112:115], v2, s[4:7], s36 offen
  s_add_u32 s36, s53, 19456
  buffer_load_dwordx4 v[116:119], v2, s[4:7], s36 offen
  s_add_u32 s36, s53, 20480
  buffer_load_dwordx4 v[120:123], v2, s[4:7], s36 offen
  s_add_u32 s36, s53, 21504
  buffer_load_dwordx4 v[124:127], v2, s[4:7], s36 offen
  s_add_u32 s36, s53, 22528
  buffer_load_dwordx4 v[128:131], v2, s[4:7], s36 offen
  s_add_u32 s36, s53, 23552
  buffer_load_dwordx4 v[132:135], v2, s[4:7], s36 offen
  s_add_u32 s36, s53, 24576
  buffer_load_dwordx4 v[136:139], v2, s[4:7], s36 offen
  s_add_u32 s36, s53, 25600
  buffer_load_dwordx4 v[140:143], v2, s[4:7], s36 offen
  s_add_u32 s36, s53, 26624
  buffer_load_dwordx4 v[144:147], v2, s[4:7], s36 offen
  s_add_u32 s36, s53, 27648
  buffer_load_dwordx4 v[148:151], v2, s[4:7], s36 offen
  s_add_u32 s36, s53, 28672
  buffer_load_dwordx4 v[152:155], v2, s[4:7], s36 offen
  s_add_u32 s36, s53, 29696
  buffer_load_dwordx4 v[156:159], v2, s[4:7], s36 offen
  s_add_u32 s36, s53, 30720
  buffer_load_dwordx4 v[160:163], v2, s[4:7], s36 offen
  s_add_u32 s36, s53, 31744
  buffer_load_dwordx4 v[164:167], v2, s[4:7], s36 offen
  s_waitcnt vmcnt(31)
  v_mfma_f32_16x16x32_bf16 v[4:7], a[0:3], v[40:43], 0
  v_mfma_f32_16x16x32_bf16 v[8:11], a[4:7], v[40:43], 0
  s_waitcnt vmcnt(30)
  v_mfma_f32_16x16x32_bf16 v[4:7], a[8:11], v[44:47], v[4:7]
  v_mfma_f32_16x16x32_bf16 v[8:11], a[12:15], v[44:47], v[8:11]
  s_waitcnt vmcnt(29)
  v_mfma_f32_16x16x32_bf16 v[4:7], a[16:19], v[48:51], v[4:7]
  v_mfma_f32_16x16x32_bf16 v[8:11], a[20:23], v[48:51], v[8:11]
  s_waitcnt vmcnt(28)
  v_mfma_f32_16x16x32_bf16 v[4:7], a[24:27], v[52:55], v[4:7]
  v_mfma_f32_16x16x32_bf16 v[8:11], a[28:31], v[52:55], v[8:11]
  s_waitcnt vmcnt(27)
  v_mfma_f32_16x16x32_bf16 v[4:7], a[32:35], v[56:59], v[4:7]
  v_mfma_f32_16x16x32_bf16 v[8:11], a[36:39], v[56:59], v[8:11]
  s_waitcnt vmcnt(26)
  v_mfma_f32_16x16x32_bf16 v[4:7], a[40:43], v[60:63], v[4:7]
  v_mfma_f32_16x16x32_bf16 v[8:11], a[44:47], v[60:63], v[8:11]
  s_waitcnt vmcnt(25)
  v_mfma_f32_16x16x32_bf16 v[4:7], a[48:51], v[64:67], v[4:7]
  v_mfma_f32_16x16x32_bf16 v[8:11], a[52:55], v[64:67], v[8:11]
  s_waitcnt vmcnt(24)
  v_mfma_f32_16x16x32_bf16 v[4:7], a[56:59], v[68:71], v[4:7]
  v_mfma_f32_16x16x32_bf16 v[8:11], a[60:63], v[68:71], v[8:11]
  s_waitcnt vmcnt(23)
  v_mfma_f32_16x16x32_bf16 v[4:7], a[64:67], v[72:75], v[4:7]
  v_mfma_f32_16x16x32_bf16 v[8:11], a[68:71], v[72:75], v[8:11]
  s_waitcnt vmcnt(22)
  v_mfma_f32_16x16x32_bf16 v[4:7], a[72:75], v[76:79], v[4:7]
  v_mfma_f32_16x16x32_bf16 v[8:11], a[76:79], v[76:79], v[8:11]
  s_waitcnt vmcnt(21)
  v_mfma_f32_16x16x32_bf16 v[4:7], a[80:83], v[80:83], v[4:7]
  v_mfma_f32_16x16x32_bf16 v[8:11], a[84:87], v[80:83], v[8:11]
  s_waitcnt vmcnt(20)
  v_mfma_f32_16x16x32_bf16 v[4:7], a[88:91], v[84:87], v[4:7]
  v_mfma_f32_16x16x32_bf16 v[8:11], a[92:95], v[84:87], v[8:11]
  s_waitcnt vmcnt(19)
  v_mfma_f32_16x16x32_bf16 v[4:7], a[96:99], v[88:91], v[4:7]
  v_mfma_f32_16x16x32_bf16 v[8:11], a[100:103], v[88:91], v[8:11]
  s_waitcnt vmcnt(18)
  v_mfma_f32_16x16x32_bf16 v[4:7], a[104:107], v[92:95], v[4:7]
  v_mfma_f32_16x16x32_bf16 v[8:11], a[108:111], v[92:95], v[8:11]
  s_waitcnt vmcnt(17)
  v_mfma_f32_16x16x32_bf16 v[4:7], a[112:115], v[96:99], v[4:7]
  v_mfma_f32_16x16x32_bf16 v[8:11], a[116:119], v[96:99], v[8:11]
  s_waitcnt vmcnt(16)
  v_mfma_f32_16x16x32_bf16 v[4:7], a[120:123], v[100:103], v[4:7]
  v_mfma_f32_16x16x32_bf16 v[8:11], a[124:127], v[100:103], v[8:11]
  s_waitcnt vmcnt(15)
  v_mfma_f32_16x16x32_bf16 v[4:7], a[128:131], v[104:107], v[4:7]
  v_mfma_f32_16x16x32_bf16 v[8:11], a[132:135], v[104:107], v[8:11]
  s_waitcnt vmcnt(14)
  v_mfma_f32_16x16x32_bf16 v[4:7], a[136:139], v[108:111], v[4:7]
  v_mfma_f32_16x16x32_bf16 v[8:11], a[140:143], v[108:111], v[8:11]
  s_waitcnt vmcnt(13)
  v_mfma_f32_16x16x32_bf16 v[4:7], a[144:147], v[112:115], v[4:7]
  v_mfma_f32_16x16x32_bf16 v[8:11], a[148:151], v[112:115], v[8:11]
  s_waitcnt vmcnt(12)
  v_mfma_f32_16x16x32_bf16 v[4:7], a[152:155], v[116:119], v[4:7]
  v_mfma_f32_16x16x32_bf16 v[8:11], a[156:159], v[116:119], v[8:11]
  s_waitcnt vmcnt(11)
  v_mfma_f32_16x16x32_bf16 v[4:7], a[160:163], v[120:123], v[4:7]
  v_mfma_f32_16x16x32_bf16 v[8:11], a[164:167], v[120:123], v[8:11]
  s_waitcnt vmcnt(10)
  v_mfma_f32_16x16x32_bf16 v[4:7], a[168:171], v[124:127], v[4:7]
  v_mfma_f32_16x16x32_bf16 v[8:11], a[172:175], v[124:127], v[8:11]
  s_waitcnt vmcnt(9)
  v_mfma_f32_16x16x32_bf16 v[4:7], a[176:179], v[128:131], v[4:7]
  v_mfma_f32_16x16x32_bf16 v[8:11], a[180:183], v[128:131], v[8:11]
  s_waitcnt vmcnt(8)
  v_mfma_f32_16x16x32_bf16 v[4:7], a[184:187], v[132:135], v[4:7]
  v_mfma_f32_16x16x32_bf16 v[8:11], a[188:191], v[132:135], v[8:11]
  s_waitcnt vmcnt(7)
  v_mfma_f32_16x16x32_bf16 v[4:7], a[192:195], v[136:139], v[4:7]
  v_mfma_f32_16x16x32_bf16 v[8:11], a[196:199], v[136:139], v[8:11]
  s_waitcnt vmcnt(6)
  v_mfma_f32_16x16x32_bf16 v[4:7], a[200:203], v[140:143], v[4:7]
  v_mfma_f32_16x16x32_bf16 v[8:11], a[204:207], v[140:143], v[8:11]
  s_waitcnt vmcnt(5)
  v_mfma_f32_16x16x32_bf16 v[4:7], a[208:211], v[144:147], v[4:7]
  v_mfma_f32_16x16x32_bf16 v[8:11], a[212:215], v[144:147], v[8:11]
  s_waitcnt vmcnt(4)
  v_mfma_f32_16x16x32_bf16 v[4:7], a[216:219], v[148:151], v[4:7]
  v_mfma_f32_16x16x32_bf16 v[8:11], a[220:223], v[148:151], v[8:11]
  s_waitcnt vmcnt(3)
  v_mfma_f32_16x16x32_bf16 v[4:7], a[224:227], v[152:155], v[4:7]
  v_mfma_f32_16x16x32_bf16 v[8:11], a[228:231], v[152:155], v[8:11]
  s_waitcnt vmcnt(2)
  v_mfma_f32_16x16x32_bf16 v[4:7], a[232:235], v[156:159], v[4:7]
  v_mfma_f32_16x16x32_bf16 v[8:11], a[236:239], v[156:159], v[8:11]
  s_waitcnt vmcnt(1)
  v_mfma_f32_16x16x32_bf16 v[4:7], a[240:243], v[160:163], v[4:7]
  v_mfma_f32_16x16x32_bf16 v[8:11], a[244:247], v[160:163], v[8:11]
  s_waitcnt vmcnt(0)
  v_mfma_f32_16x16x32_bf16 v[4:7], a[248:251], v[164:167], v[4:7]
  v_mfma_f32_16x16x32_bf16 v[8:11], a[252:255], v[164:167], v[8:11]
  s_barrier
  s_nop 5
  ds_write_b128 v3, v[4:7] offset:0
  ds_write_b128 v3, v[8:11] offset:1024
  s_waitcnt lgkmcnt(0)
  s_barrier
  s_and_b32 s36, s32, 1
  s_mul_i32 s36, s36, 1024
  v_add_u32 v39, s36, v2
  ds_read_b128 v[40:43], v39 offset:0
  ds_read_b128 v[44:47], v39 offset:8192
  ds_read_b128 v[48:51], v39 offset:16384
  ds_read_b128 v[52:55], v39 offset:24576
  s_waitcnt lgkmcnt(0)
  v_add_f32 v40, v40, v44
  v_add_f32 v48, v48, v52
  v_add_f32 v41, v41, v45
  v_add_f32 v49, v49, v53
  v_add_f32 v42, v42, v46
  v_add_f32 v50, v50, v54
  v_add_f32 v43, v43, v47
  v_add_f32 v51, v51, v55
  v_add_f32 v40, v40, v48
  v_add_f32 v41, v41, v49
  v_add_f32 v42, v42, v50
  v_add_f32 v43, v43, v51
  v_cvt_pk_bf16_f32 v44, v40, v41
  v_cvt_pk_bf16_f32 v45, v42, v43
  v_lshlrev_b32 v40, 16, v44
  v_and_b32 v41, 0xffff0000, v44
  v_lshlrev_b32 v42, 16, v45
  v_and_b32 v43, 0xffff0000, v45
  v_mul_f32 v40, v40, v236
  v_mul_f32 v41, v41, v236
  v_mul_f32 v42, v42, v236
  v_mul_f32 v43, v43, v236
  v_cvt_pk_bf16_f32 v44, v40, v41
  v_cvt_pk_bf16_f32 v45, v42, v43
  v_lshlrev_b32 v40, 16, v44
  v_and_b32 v41, 0xffff0000, v44
  v_lshlrev_b32 v48, 16, v238
  v_and_b32 v49, 0xffff0000, v238
  v_lshlrev_b32 v42, 16, v45
  v_and_b32 v43, 0xffff0000, v45
  v_lshlrev_b32 v50, 16, v239
  v_and_b32 v51, 0xffff0000, v239
  v_add_f32 v40, v40, v48
  v_add_f32 v41, v41, v49
  v_add_f32 v42, v42, v50
  v_add_f32 v43, v43, v51
  v_cvt_pk_bf16_f32 v44, v40, v41
  v_cvt_pk_bf16_f32 v45, v42, v43
  buffer_store_dwordx2 v[44:45], v37, s[28:31], s54 offen
  s_add_u32 s50, s50, 3
  s_cmp_lt_u32 s50, 64
  s_cbranch_scc1 K1_R2c_L
  s_waitcnt vmcnt(0) lgkmcnt(0)
  s_barrier
  s_branch K1_END
K1_N2:
K1_END:
  s_endpgm
.section .rodata,"a"
.p2align 6
.amdhsa_kernel gated_mix__memory_aug_recurrent_mem_tr__dense_activation_silu__prompt_kernel
  .amdhsa_next_free_vgpr 512
  .amdhsa_next_free_sgpr 102
  .amdhsa_accum_offset 256
  .amdhsa_group_segment_fixed_size 0
  .amdhsa_float_denorm_mode_32 3
  .amdhsa_kernarg_size 112
  .amdhsa_user_sgpr_count 2
  .amdhsa_user_sgpr_kernarg_segment_ptr 1
  .amdhsa_system_sgpr_workgroup_id_x 1
.end_amdhsa_kernel
```
